```python
import torch

def _softmax(x, axis=-1):
    return torch.softmax(x, dim=axis)

def _gelu(x):
    return torch.nn.functional.gelu(x, approximate='tanh')

def _silu(x):
    return torch.nn.functional.silu(x)

def _sigmoid(x):
    return torch.sigmoid(x)

def _layernorm(x, axis=-1, eps=1e-05):
    m = x.mean(dim=axis, keepdim=True)
    v = x.var(dim=axis, keepdim=True, unbiased=False)
    return (x - m) / torch.sqrt(v + eps)

def _scatter_add(tgt, idx, src, axis=0):
    return tgt.clone().index_add_(axis, idx, src)

def _segment_sum(src, seg, n):
    out = torch.zeros((n,) + src.shape[1:], dtype=src.dtype)
    return out.index_add_(0, seg, src)

def _pad(x, pw):
    flat = tuple((v for pair in reversed(pw) for v in pair))
    return torch.nn.functional.pad(x, flat)
kernel_name = 'gated_mix__memory_aug_recurrent_mem_tr__glu_gated_geglu__prompt'

def setup_inputs():

    _w = lambda a: (lambda t: t.to(torch.bfloat16) if t.is_floating_point() else t)(torch.as_tensor(a))

    def _A_setup():
        B, S, Dm = (1, 2048, 640)
        H, Dh = (32, 128)
        M, seg = (8, 32)
        seg = min(seg, S)
        S = S // seg * seg
        return {'x': _w((lambda *s: torch.randn(*s, dtype=torch.bfloat16) * 0.05)(B, S, Dm)), 'mem0': _w((lambda *s: torch.randn(*s, dtype=torch.bfloat16) * 0.4)(B, M, Dm)), 'Wq': _w((lambda *s: torch.randn(*s, dtype=torch.bfloat16) * 6.4)(Dm, H, Dh) * Dm ** (-0.5)), 'Wk': _w((lambda *s: torch.randn(*s, dtype=torch.bfloat16) * 6.4)(Dm, H, Dh) * Dm ** (-0.5)), 'Wv': _w((lambda *s: torch.randn(*s, dtype=torch.bfloat16) * 0.4)(Dm, H, Dh) * Dm ** (-0.5)), 'Wo': _w((lambda *s: torch.randn(*s, dtype=torch.bfloat16) * 0.4)(H, Dh, Dm) * (H * Dh) ** (-0.5)), 'seg_len': seg}
    _A_in = _A_setup()

    def _B_setup():
        B, S, Dm, Df = (1, 2048, 640, 1728)
        return {'x': _w((lambda *s: torch.randn(*s, dtype=torch.bfloat16) * 0.05)(B, S, Dm)), 'w_gate': _w((lambda *s: torch.randn(*s, dtype=torch.bfloat16) * 1.6)(Dm, Df) * Dm ** (-0.5)), 'w_up': _w((lambda *s: torch.randn(*s, dtype=torch.bfloat16) * 1.6)(Dm, Df) * Dm ** (-0.5)), 'w_down': _w((lambda *s: torch.randn(*s, dtype=torch.bfloat16) * 1.6)(Df, Dm) * Df ** (-0.5))}
    _B_in = _B_setup()
    return {'A_x': _A_in['x'], 'A_mem0': _A_in['mem0'], 'A_Wq': _A_in['Wq'], 'A_Wk': _A_in['Wk'], 'A_Wv': _A_in['Wv'], 'A_Wo': _A_in['Wo'], 'A_seg_len': _A_in['seg_len'], 'B_x': _B_in['x'], 'B_w_gate': _B_in['w_gate'], 'B_w_up': _B_in['w_up'], 'B_w_down': _B_in['w_down'], 'gate_w': _w((lambda *s: torch.randn(*s, dtype=torch.bfloat16) * 0.05)(640) * 16.0)}

def reference(A_x, A_mem0, A_Wq, A_Wk, A_Wv, A_Wo, A_seg_len, B_x, B_w_gate, B_w_up, B_w_down, gate_w):

    def _A_ref(x, mem0, Wq, Wk, Wv, Wo, seg_len):
        B, S, Dm = x.shape
        H, Dh = (Wq.shape[1], Wq.shape[2])
        M = mem0.shape[1]
        scale = Dh ** (-0.5)
        n_seg = S // seg_len
        L = M + seg_len
        idx = torch.arange(L)
        mask = (idx[:, None] < M) | (idx[:, None] >= idx[None, :])
        mem = mem0
        outs = []
        for s in range(n_seg):
            xs = x[:, s * seg_len:(s + 1) * seg_len, :].clone()
            h = torch.concatenate([mem, xs], axis=1)
            q = torch.einsum('btd,dhe->bhte', h, Wq)
            k = torch.einsum('btd,dhe->bhte', h, Wk)
            v = torch.einsum('btd,dhe->bhte', h, Wv)
            scores = torch.einsum('bhqe,bhke->bhqk', q, k) * scale
            scores = torch.where(mask[None, None], scores, -1000000000.0)
            p = _softmax(scores, axis=-1)
            o = torch.einsum('bhqk,bhke->bhqe', p, v)
            o = torch.einsum('bhte,hed->btd', o, Wo)
            mem = o[:, :M, :].clone()
            outs.append(o[:, M:, :])
        return torch.concatenate(outs, axis=1)

    def _B_ref(x, w_gate, w_up, w_down):
        g = torch.einsum('bsd,df->bsf', x, w_gate)
        u = torch.einsum('bsd,df->bsf', x, w_up)
        h = _gelu(g) * u
        return torch.einsum('bsf,fd->bsd', h, w_down)
    x = A_x
    g = _sigmoid((x * gate_w).sum(-1, keepdims=True))
    a = _A_ref(x, A_mem0, A_Wq, A_Wk, A_Wv, A_Wo, A_seg_len)
    b = _B_ref(x, B_w_gate, B_w_up, B_w_down)
    return g * a + (1 - g) * b
```

```asm
; @launch kernel=mega_kernel grid=(256,1,1) block=(256,1,1) lds=163840
.amdgcn_target "amdgcn-amd-amdhsa--gfx950"
.text
.globl mega_kernel
.p2align 8
.type mega_kernel,@function
mega_kernel:
    s_load_dwordx2 s[4:5], s[0:1], 104
    s_getreg_b32 s59, hwreg(HW_REG_XCC_ID)
    s_and_b32 s59, s59, 7
    v_lshrrev_b32 v1, 6, v0
    v_mov_b32 v2, 1
    v_mov_b32 v4, 0
    v_readfirstlane_b32 s3, v1
    s_lshl_b32 s6, s59, 2
    s_add_u32 s6, s6, 192
    v_mov_b32 v1, s6
    s_waitcnt lgkmcnt(0)
    s_cmp_lg_u32 s3, 0
    s_cbranch_scc1 mega_tk
    s_mov_b64 exec, 1
    global_atomic_add v3, v1, v2, s[4:5] sc0 sc1
    s_waitcnt vmcnt(0)
    ds_write_b32 v4, v3
    s_mov_b64 exec, -1
    s_waitcnt lgkmcnt(0)
mega_tk:
    s_barrier
    ds_read_b32 v3, v4
    s_waitcnt lgkmcnt(0)
    v_readfirstlane_b32 s7, v3
    s_barrier
    s_cmp_ge_u32 s7, 32
    s_cbranch_scc1 mega_end
    s_and_b32 s58, s59, 3
    s_lshl_b32 s58, s58, 5
    s_add_u32 s58, s58, s7
    s_cmp_ge_u32 s59, 4
    s_cbranch_scc1 mega_worker
    s_load_dwordx2 s[52:53], s[0:1], 104
    s_load_dwordx2 s[6:7], s[0:1], 8
    s_load_dwordx4 s[8:11], s[0:1], 16
    s_load_dwordx4 s[12:15], s[0:1], 32
    s_load_dwordx2 s[16:17], s[0:1], 112
    s_lshr_b32 s3, s58, 2
    s_and_b32 s4, s58, 3
    v_lshrrev_b32 v20, 6, v0
    v_and_b32 v1, 63, v0
    v_readfirstlane_b32 s5, v20
    v_and_b32 v2, 15, v0
    v_lshrrev_b32 v3, 4, v1
    v_cmp_gt_u32 s[32:33], 8, v2
    v_cmp_gt_u32 s[34:35], 2, v3
    s_waitcnt lgkmcnt(0)
    s_add_u32 s18, s16, 16777216
    s_addc_u32 s19, s17, 0
    s_add_u32 s20, s16, 33554432
    s_addc_u32 s21, s17, 0
    s_add_u32 s22, s16, 75497472
    s_addc_u32 s23, s17, 0
    s_add_u32 s24, s16, 79691776
    s_addc_u32 s25, s17, 0
    s_add_u32 s26, s16, 83886080
    s_addc_u32 s27, s17, 0
    s_add_u32 s28, s16, 96468992
    s_addc_u32 s29, s17, 0
    v_lshrrev_b32 v5, 4, v0
    v_lshlrev_b32 v5, 13, v5
    v_lshlrev_b32 v20, 4, v2
    v_add_u32 v5, v5, v20
    s_lshl_b32 s31, s3, 8
    v_add_u32 v5, s31, v5
    v_lshlrev_b32 v6, 4, v0
    v_lshrrev_b32 v20, 2, v2
    v_lshl_add_u32 v20, v3, 3, v20
    v_lshlrev_b32 v20, 8, v20
    v_and_b32 v21, 3, v0
    v_lshl_add_u32 v20, v21, 3, v20
    s_lshl_b32 s31, s5, 6
    v_add_u32 v8, s31, v20
    v_add_u32 v9, 40960, v8
    s_and_b32 s31, s5, 1
    s_lshl_b32 s31, s31, 5
    s_lshl_b32 s41, s4, 6
    s_add_u32 s31, s31, s41
    s_add_u32 s31, s31, 81920
    v_add_u32 v10, s31, v20
    s_mov_b32 s62, 5242880
    s_mov_b32 s63, 0x00020000
    s_lshl_b32 s43, s5, 10
    s_mov_b32 s60, s8
    s_and_b32 s61, s9, 0xffff
    s_mov_b32 s62, 5242880
    s_mov_b32 s63, 0x00020000
    s_mov_b32 s64, s10
    s_and_b32 s65, s11, 0xffff
    s_mov_b32 s66, 5242880
    s_mov_b32 s67, 0x00020000
    s_mov_b32 s68, s12
    s_and_b32 s69, s13, 0xffff
    s_mov_b32 s70, 5242880
    s_mov_b32 s71, 0x00020000
    s_mov_b32 s72, s14
    s_and_b32 s73, s15, 0xffff
    s_mov_b32 s74, 5242880
    s_mov_b32 s75, 0x00020000
    v_lshrrev_b32 v20, 2, v1
    v_and_b32 v21, 3, v1
    v_lshlrev_b32 v5, 13, v20
    v_lshl_add_u32 v5, v21, 4, v5
    s_lshl_b32 s31, s3, 8
    s_lshl_b32 s41, s5, 6
    s_add_u32 s41, s41, s31
    v_add_u32 v5, s41, v5
    v_mul_u32_u24 v7, 1280, v20
    v_lshl_add_u32 v7, v21, 4, v7
    s_and_b32 s41, s58, 31
    s_lshl_b32 s41, s41, 6
    s_lshl_b32 s43, s59, 2
    s_add_u32 s43, s43, s5
    s_mul_i32 s43, s43, 327680
    s_add_u32 s41, s41, s43
    v_add_u32 v7, s41, v7
    v_lshrrev_b32 v20, 1, v1
    v_and_b32 v21, 1, v1
    v_lshlrev_b32 v6, 13, v20
    v_lshl_add_u32 v6, v21, 4, v6
    s_lshl_b32 s41, s4, 6
    s_add_u32 s31, s31, s41
    s_lshr_b32 s41, s5, 1
    s_mul_i32 s41, s41, 2621440
    s_add_u32 s31, s31, s41
    v_add_u32 v6, s31, v6
    s_and_b32 s41, s5, 1
    s_mul_i32 s31, s41, 1572832
    s_add_u32 s31, s31, 32
    v_add_u32 v11, s31, v6
    s_mul_i32 s31, s41, 1048608
    v_add_u32 v6, s31, v6
    s_lshl_b32 s43, s5, 15
    v_lshrrev_b32 v20, 2, v2
    v_and_b32 v21, 3, v0
    v_lshlrev_b32 v21, 3, v21
    v_add_u32 v21, s43, v21
    v_lshl_add_u32 v22, v3, 3, v20
    v_lshl_add_u32 v8, v22, 6, v21
    v_lshl_add_u32 v9, v22, 5, v21
    v_lshl_add_u32 v22, v3, 2, v20
    v_lshl_add_u32 v10, v22, 6, v21
    v_and_b32 v22, 1, v3
    v_lshl_add_u32 v10, v22, 10, v21
    v_lshrrev_b32 v22, 1, v3
    v_lshl_add_u32 v10, v22, 9, v10
    v_and_b32 v22, 1, v20
    v_lshl_add_u32 v10, v22, 6, v10
    v_lshrrev_b32 v22, 1, v20
    v_lshl_add_u32 v10, v22, 8, v10
    s_and_b32 s41, s58, 31
    s_cmp_ge_u32 s41, 20
    s_cbranch_scc1 rec_stn
    s_add_u32 m0, s43, 0
    s_mov_b32 s31, 0
    buffer_load_dwordx4 v7, s[72:75], s31 offen lds
    s_add_u32 m0, s43, 1024
    s_mov_b32 s31, 20480
    buffer_load_dwordx4 v7, s[72:75], s31 offen lds
    s_add_u32 m0, s43, 2048
    s_mov_b32 s31, 40960
    buffer_load_dwordx4 v7, s[72:75], s31 offen lds
    s_add_u32 m0, s43, 3072
    s_mov_b32 s31, 61440
    buffer_load_dwordx4 v7, s[72:75], s31 offen lds
    s_add_u32 m0, s43, 4096
    s_mov_b32 s31, 81920
    buffer_load_dwordx4 v7, s[72:75], s31 offen lds
    s_add_u32 m0, s43, 5120
    s_mov_b32 s31, 102400
    buffer_load_dwordx4 v7, s[72:75], s31 offen lds
    s_add_u32 m0, s43, 6144
    s_mov_b32 s31, 122880
    buffer_load_dwordx4 v7, s[72:75], s31 offen lds
    s_add_u32 m0, s43, 7168
    s_mov_b32 s31, 143360
    buffer_load_dwordx4 v7, s[72:75], s31 offen lds
    s_add_u32 m0, s43, 8192
    s_mov_b32 s31, 163840
    buffer_load_dwordx4 v7, s[72:75], s31 offen lds
    s_add_u32 m0, s43, 9216
    s_mov_b32 s31, 184320
    buffer_load_dwordx4 v7, s[72:75], s31 offen lds
    s_add_u32 m0, s43, 10240
    s_mov_b32 s31, 204800
    buffer_load_dwordx4 v7, s[72:75], s31 offen lds
    s_add_u32 m0, s43, 11264
    s_mov_b32 s31, 225280
    buffer_load_dwordx4 v7, s[72:75], s31 offen lds
    s_add_u32 m0, s43, 12288
    s_mov_b32 s31, 245760
    buffer_load_dwordx4 v7, s[72:75], s31 offen lds
    s_add_u32 m0, s43, 13312
    s_mov_b32 s31, 266240
    buffer_load_dwordx4 v7, s[72:75], s31 offen lds
    s_add_u32 m0, s43, 14336
    s_mov_b32 s31, 286720
    buffer_load_dwordx4 v7, s[72:75], s31 offen lds
    s_add_u32 m0, s43, 15360
    s_mov_b32 s31, 307200
    buffer_load_dwordx4 v7, s[72:75], s31 offen lds
    s_add_u32 m0, s43, 16384
    s_mov_b32 s31, 0
    buffer_load_dwordx4 v6, s[68:71], s31 offen lds
    s_add_u32 m0, s43, 17408
    s_mov_b32 s31, 262144
    buffer_load_dwordx4 v6, s[68:71], s31 offen lds
    s_add_u32 m0, s43, 18432
    s_mov_b32 s31, 0
    buffer_load_dwordx4 v11, s[68:71], s31 offen lds
    s_add_u32 m0, s43, 19456
    s_mov_b32 s31, 262144
    buffer_load_dwordx4 v11, s[68:71], s31 offen lds
    s_add_u32 m0, s43, 20480
    s_mov_b32 s31, 524288
    buffer_load_dwordx4 v6, s[68:71], s31 offen lds
    s_add_u32 m0, s43, 21504
    s_mov_b32 s31, 786432
    buffer_load_dwordx4 v6, s[68:71], s31 offen lds
    s_add_u32 m0, s43, 22528
    s_mov_b32 s31, 524288
    buffer_load_dwordx4 v11, s[68:71], s31 offen lds
    s_add_u32 m0, s43, 23552
    s_mov_b32 s31, 786432
    buffer_load_dwordx4 v11, s[68:71], s31 offen lds
    s_add_u32 m0, s43, 24576
    s_mov_b32 s31, 1048576
    buffer_load_dwordx4 v6, s[68:71], s31 offen lds
    s_add_u32 m0, s43, 25600
    s_mov_b32 s31, 1310720
    buffer_load_dwordx4 v6, s[68:71], s31 offen lds
    s_add_u32 m0, s43, 26624
    s_mov_b32 s31, 0
    buffer_load_dwordx4 v5, s[60:63], s31 offen lds
    s_add_u32 m0, s43, 27648
    s_mov_b32 s31, 131072
    buffer_load_dwordx4 v5, s[60:63], s31 offen lds
    s_add_u32 m0, s43, 28672
    s_mov_b32 s31, 0
    buffer_load_dwordx4 v5, s[64:67], s31 offen lds
    s_add_u32 m0, s43, 29696
    s_mov_b32 s31, 131072
    buffer_load_dwordx4 v5, s[64:67], s31 offen lds
    s_add_u32 m0, s43, 30720
    s_mov_b32 s31, 262144
    buffer_load_dwordx4 v5, s[60:63], s31 offen lds
    s_add_u32 m0, s43, 31744
    s_mov_b32 s31, 393216
    buffer_load_dwordx4 v5, s[60:63], s31 offen lds
    s_waitcnt vmcnt(30)
    ds_read_b64_tr_b16 v[216:217], v10 offset:0
    ds_read_b64_tr_b16 v[218:219], v10 offset:128
    ds_read_b64_tr_b16 v[224:225], v10 offset:32
    ds_read_b64_tr_b16 v[226:227], v10 offset:160
    s_waitcnt vmcnt(28)
    ds_read_b64_tr_b16 v[220:221], v10 offset:2048
    ds_read_b64_tr_b16 v[222:223], v10 offset:2176
    ds_read_b64_tr_b16 v[228:229], v10 offset:2080
    ds_read_b64_tr_b16 v[230:231], v10 offset:2208
    s_waitcnt lgkmcnt(4)
    s_add_u32 m0, s43, 0
    s_mov_b32 s31, 262144
    buffer_load_dwordx4 v5, s[64:67], s31 offen lds
    s_add_u32 m0, s43, 1024
    s_mov_b32 s31, 393216
    buffer_load_dwordx4 v5, s[64:67], s31 offen lds
    s_waitcnt vmcnt(28)
    ds_read_b64_tr_b16 v[232:233], v10 offset:4096
    ds_read_b64_tr_b16 v[234:235], v10 offset:4224
    ds_read_b64_tr_b16 v[240:241], v10 offset:4128
    ds_read_b64_tr_b16 v[242:243], v10 offset:4256
    s_waitcnt lgkmcnt(4)
    s_add_u32 m0, s43, 2048
    s_mov_b32 s31, 524288
    buffer_load_dwordx4 v5, s[60:63], s31 offen lds
    s_add_u32 m0, s43, 3072
    s_mov_b32 s31, 655360
    buffer_load_dwordx4 v5, s[60:63], s31 offen lds
    s_waitcnt vmcnt(28)
    ds_read_b64_tr_b16 v[236:237], v10 offset:6144
    ds_read_b64_tr_b16 v[238:239], v10 offset:6272
    ds_read_b64_tr_b16 v[244:245], v10 offset:6176
    ds_read_b64_tr_b16 v[246:247], v10 offset:6304
    s_waitcnt lgkmcnt(4)
    s_add_u32 m0, s43, 4096
    s_mov_b32 s31, 524288
    buffer_load_dwordx4 v5, s[64:67], s31 offen lds
    s_add_u32 m0, s43, 5120
    s_mov_b32 s31, 655360
    buffer_load_dwordx4 v5, s[64:67], s31 offen lds
    s_waitcnt vmcnt(28)
    ds_read_b64_tr_b16 v[248:249], v10 offset:8192
    ds_read_b64_tr_b16 v[250:251], v10 offset:8320
    ds_read_b64_tr_b16 v[104:105], v10 offset:8224
    ds_read_b64_tr_b16 v[106:107], v10 offset:8352
    s_waitcnt lgkmcnt(4)
    s_add_u32 m0, s43, 6144
    s_mov_b32 s31, 786432
    buffer_load_dwordx4 v5, s[60:63], s31 offen lds
    s_add_u32 m0, s43, 7168
    s_mov_b32 s31, 917504
    buffer_load_dwordx4 v5, s[60:63], s31 offen lds
    s_waitcnt vmcnt(28)
    ds_read_b64_tr_b16 v[252:253], v10 offset:10240
    ds_read_b64_tr_b16 v[254:255], v10 offset:10368
    ds_read_b64_tr_b16 v[108:109], v10 offset:10272
    ds_read_b64_tr_b16 v[110:111], v10 offset:10400
    s_waitcnt lgkmcnt(4)
    s_add_u32 m0, s43, 8192
    s_mov_b32 s31, 786432
    buffer_load_dwordx4 v5, s[64:67], s31 offen lds
    s_add_u32 m0, s43, 9216
    s_mov_b32 s31, 917504
    buffer_load_dwordx4 v5, s[64:67], s31 offen lds
    s_waitcnt vmcnt(28)
    ds_read_b64_tr_b16 v[80:81], v10 offset:12288
    ds_read_b64_tr_b16 v[82:83], v10 offset:12416
    ds_read_b64_tr_b16 v[88:89], v10 offset:12320
    ds_read_b64_tr_b16 v[90:91], v10 offset:12448
    s_waitcnt lgkmcnt(4)
    s_add_u32 m0, s43, 10240
    s_mov_b32 s31, 1048576
    buffer_load_dwordx4 v5, s[60:63], s31 offen lds
    s_add_u32 m0, s43, 11264
    s_mov_b32 s31, 1179648
    buffer_load_dwordx4 v5, s[60:63], s31 offen lds
    s_waitcnt vmcnt(28)
    ds_read_b64_tr_b16 v[84:85], v10 offset:14336
    ds_read_b64_tr_b16 v[86:87], v10 offset:14464
    ds_read_b64_tr_b16 v[92:93], v10 offset:14368
    ds_read_b64_tr_b16 v[94:95], v10 offset:14496
    s_waitcnt lgkmcnt(4)
    s_add_u32 m0, s43, 12288
    s_mov_b32 s31, 1048576
    buffer_load_dwordx4 v5, s[64:67], s31 offen lds
    s_add_u32 m0, s43, 13312
    s_mov_b32 s31, 1179648
    buffer_load_dwordx4 v5, s[64:67], s31 offen lds
    s_waitcnt vmcnt(28)
    ds_read_b64_tr_b16 v[176:177], v9 offset:16384
    ds_read_b64_tr_b16 v[178:179], v9 offset:16512
    ds_read_b64_tr_b16 v[180:181], v9 offset:17408
    ds_read_b64_tr_b16 v[182:183], v9 offset:17536
    s_waitcnt lgkmcnt(4)
    s_add_u32 m0, s43, 14336
    s_mov_b32 s31, 1310720
    buffer_load_dwordx4 v5, s[60:63], s31 offen lds
    s_add_u32 m0, s43, 15360
    s_mov_b32 s31, 1441792
    buffer_load_dwordx4 v5, s[60:63], s31 offen lds
    s_waitcnt vmcnt(28)
    ds_read_b64_tr_b16 v[184:185], v9 offset:18432
    ds_read_b64_tr_b16 v[186:187], v9 offset:18560
    ds_read_b64_tr_b16 v[188:189], v9 offset:19456
    ds_read_b64_tr_b16 v[190:191], v9 offset:19584
    s_waitcnt lgkmcnt(4)
    s_add_u32 m0, s43, 16384
    s_mov_b32 s31, 1310720
    buffer_load_dwordx4 v5, s[64:67], s31 offen lds
    s_add_u32 m0, s43, 17408
    s_mov_b32 s31, 1441792
    buffer_load_dwordx4 v5, s[64:67], s31 offen lds
    s_waitcnt vmcnt(28)
    ds_read_b64_tr_b16 v[192:193], v9 offset:20480
    ds_read_b64_tr_b16 v[194:195], v9 offset:20608
    ds_read_b64_tr_b16 v[196:197], v9 offset:21504
    ds_read_b64_tr_b16 v[198:199], v9 offset:21632
    s_waitcnt lgkmcnt(4)
    s_add_u32 m0, s43, 18432
    s_mov_b32 s31, 1572864
    buffer_load_dwordx4 v5, s[60:63], s31 offen lds
    s_add_u32 m0, s43, 19456
    s_mov_b32 s31, 1703936
    buffer_load_dwordx4 v5, s[60:63], s31 offen lds
    s_waitcnt vmcnt(28)
    ds_read_b64_tr_b16 v[200:201], v9 offset:22528
    ds_read_b64_tr_b16 v[202:203], v9 offset:22656
    ds_read_b64_tr_b16 v[204:205], v9 offset:23552
    ds_read_b64_tr_b16 v[206:207], v9 offset:23680
    s_waitcnt lgkmcnt(4)
    s_add_u32 m0, s43, 20480
    s_mov_b32 s31, 1572864
    buffer_load_dwordx4 v5, s[64:67], s31 offen lds
    s_add_u32 m0, s43, 21504
    s_mov_b32 s31, 1703936
    buffer_load_dwordx4 v5, s[64:67], s31 offen lds
    s_waitcnt vmcnt(28)
    ds_read_b64_tr_b16 v[208:209], v9 offset:24576
    ds_read_b64_tr_b16 v[210:211], v9 offset:24704
    ds_read_b64_tr_b16 v[212:213], v9 offset:25600
    ds_read_b64_tr_b16 v[214:215], v9 offset:25728
    s_waitcnt lgkmcnt(4)
    s_add_u32 m0, s43, 22528
    s_mov_b32 s31, 1835008
    buffer_load_dwordx4 v5, s[60:63], s31 offen lds
    s_add_u32 m0, s43, 23552
    s_mov_b32 s31, 1966080
    buffer_load_dwordx4 v5, s[60:63], s31 offen lds
    s_waitcnt vmcnt(28)
    ds_read_b64_tr_b16 a[0:1], v8 offset:26624
    ds_read_b64_tr_b16 a[2:3], v8 offset:26880
    ds_read_b64_tr_b16 a[80:81], v8 offset:26656
    ds_read_b64_tr_b16 a[82:83], v8 offset:26912
    s_waitcnt lgkmcnt(4)
    s_add_u32 m0, s43, 24576
    s_mov_b32 s31, 1835008
    buffer_load_dwordx4 v5, s[64:67], s31 offen lds
    s_add_u32 m0, s43, 25600
    s_mov_b32 s31, 1966080
    buffer_load_dwordx4 v5, s[64:67], s31 offen lds
    s_waitcnt vmcnt(28)
    ds_read_b64_tr_b16 a[160:161], v8 offset:28672
    ds_read_b64_tr_b16 a[162:163], v8 offset:28928
    ds_read_b64_tr_b16 a[240:241], v8 offset:28704
    ds_read_b64_tr_b16 a[242:243], v8 offset:28960
    s_waitcnt lgkmcnt(4)
    s_add_u32 m0, s43, 26624
    s_mov_b32 s31, 2097152
    buffer_load_dwordx4 v5, s[60:63], s31 offen lds
    s_add_u32 m0, s43, 27648
    s_mov_b32 s31, 2228224
    buffer_load_dwordx4 v5, s[60:63], s31 offen lds
    s_waitcnt vmcnt(28)
    ds_read_b64_tr_b16 a[4:5], v8 offset:30720
    ds_read_b64_tr_b16 a[6:7], v8 offset:30976
    ds_read_b64_tr_b16 a[84:85], v8 offset:30752
    ds_read_b64_tr_b16 a[86:87], v8 offset:31008
    s_waitcnt lgkmcnt(4)
    s_add_u32 m0, s43, 28672
    s_mov_b32 s31, 2097152
    buffer_load_dwordx4 v5, s[64:67], s31 offen lds
    s_add_u32 m0, s43, 29696
    s_mov_b32 s31, 2228224
    buffer_load_dwordx4 v5, s[64:67], s31 offen lds
    s_waitcnt vmcnt(28)
    ds_read_b64_tr_b16 a[164:165], v8 offset:0
    ds_read_b64_tr_b16 a[166:167], v8 offset:256
    ds_read_b64_tr_b16 a[244:245], v8 offset:32
    ds_read_b64_tr_b16 a[246:247], v8 offset:288
    s_waitcnt lgkmcnt(4)
    s_add_u32 m0, s43, 30720
    s_mov_b32 s31, 2359296
    buffer_load_dwordx4 v5, s[60:63], s31 offen lds
    s_add_u32 m0, s43, 31744
    s_mov_b32 s31, 2490368
    buffer_load_dwordx4 v5, s[60:63], s31 offen lds
    s_waitcnt vmcnt(28)
    ds_read_b64_tr_b16 a[8:9], v8 offset:2048
    ds_read_b64_tr_b16 a[10:11], v8 offset:2304
    ds_read_b64_tr_b16 a[88:89], v8 offset:2080
    ds_read_b64_tr_b16 a[90:91], v8 offset:2336
    s_waitcnt lgkmcnt(4)
    s_add_u32 m0, s43, 0
    s_mov_b32 s31, 2359296
    buffer_load_dwordx4 v5, s[64:67], s31 offen lds
    s_add_u32 m0, s43, 1024
    s_mov_b32 s31, 2490368
    buffer_load_dwordx4 v5, s[64:67], s31 offen lds
    s_waitcnt vmcnt(28)
    ds_read_b64_tr_b16 a[168:169], v8 offset:4096
    ds_read_b64_tr_b16 a[170:171], v8 offset:4352
    ds_read_b64_tr_b16 a[248:249], v8 offset:4128
    ds_read_b64_tr_b16 a[250:251], v8 offset:4384
    s_waitcnt lgkmcnt(4)
    s_add_u32 m0, s43, 2048
    s_mov_b32 s31, 2621440
    buffer_load_dwordx4 v5, s[60:63], s31 offen lds
    s_add_u32 m0, s43, 3072
    s_mov_b32 s31, 2752512
    buffer_load_dwordx4 v5, s[60:63], s31 offen lds
    s_waitcnt vmcnt(28)
    ds_read_b64_tr_b16 a[12:13], v8 offset:6144
    ds_read_b64_tr_b16 a[14:15], v8 offset:6400
    ds_read_b64_tr_b16 a[92:93], v8 offset:6176
    ds_read_b64_tr_b16 a[94:95], v8 offset:6432
    s_waitcnt lgkmcnt(4)
    s_add_u32 m0, s43, 4096
    s_mov_b32 s31, 2621440
    buffer_load_dwordx4 v5, s[64:67], s31 offen lds
    s_add_u32 m0, s43, 5120
    s_mov_b32 s31, 2752512
    buffer_load_dwordx4 v5, s[64:67], s31 offen lds
    s_waitcnt vmcnt(28)
    ds_read_b64_tr_b16 a[172:173], v8 offset:8192
    ds_read_b64_tr_b16 a[174:175], v8 offset:8448
    ds_read_b64_tr_b16 a[252:253], v8 offset:8224
    ds_read_b64_tr_b16 a[254:255], v8 offset:8480
    s_waitcnt lgkmcnt(4)
    s_add_u32 m0, s43, 6144
    s_mov_b32 s31, 2883584
    buffer_load_dwordx4 v5, s[60:63], s31 offen lds
    s_add_u32 m0, s43, 7168
    s_mov_b32 s31, 3014656
    buffer_load_dwordx4 v5, s[60:63], s31 offen lds
    s_waitcnt vmcnt(28)
    ds_read_b64_tr_b16 a[16:17], v8 offset:10240
    ds_read_b64_tr_b16 a[18:19], v8 offset:10496
    ds_read_b64_tr_b16 a[96:97], v8 offset:10272
    ds_read_b64_tr_b16 a[98:99], v8 offset:10528
    s_waitcnt lgkmcnt(4)
    s_add_u32 m0, s43, 8192
    s_mov_b32 s31, 2883584
    buffer_load_dwordx4 v5, s[64:67], s31 offen lds
    s_add_u32 m0, s43, 9216
    s_mov_b32 s31, 3014656
    buffer_load_dwordx4 v5, s[64:67], s31 offen lds
    s_waitcnt vmcnt(28)
    ds_read_b64_tr_b16 a[176:177], v8 offset:12288
    ds_read_b64_tr_b16 a[178:179], v8 offset:12544
    ds_read_b64_tr_b16 v[112:113], v8 offset:12320
    ds_read_b64_tr_b16 v[114:115], v8 offset:12576
    s_waitcnt lgkmcnt(4)
    s_add_u32 m0, s43, 10240
    s_mov_b32 s31, 3145728
    buffer_load_dwordx4 v5, s[60:63], s31 offen lds
    s_add_u32 m0, s43, 11264
    s_mov_b32 s31, 3276800
    buffer_load_dwordx4 v5, s[60:63], s31 offen lds
    s_waitcnt vmcnt(28)
    ds_read_b64_tr_b16 a[20:21], v8 offset:14336
    ds_read_b64_tr_b16 a[22:23], v8 offset:14592
    ds_read_b64_tr_b16 a[100:101], v8 offset:14368
    ds_read_b64_tr_b16 a[102:103], v8 offset:14624
    s_waitcnt lgkmcnt(4)
    s_add_u32 m0, s43, 12288
    s_mov_b32 s31, 3145728
    buffer_load_dwordx4 v5, s[64:67], s31 offen lds
    s_add_u32 m0, s43, 13312
    s_mov_b32 s31, 3276800
    buffer_load_dwordx4 v5, s[64:67], s31 offen lds
    s_waitcnt vmcnt(28)
    ds_read_b64_tr_b16 a[180:181], v8 offset:16384
    ds_read_b64_tr_b16 a[182:183], v8 offset:16640
    ds_read_b64_tr_b16 v[116:117], v8 offset:16416
    ds_read_b64_tr_b16 v[118:119], v8 offset:16672
    s_waitcnt lgkmcnt(4)
    s_add_u32 m0, s43, 14336
    s_mov_b32 s31, 3407872
    buffer_load_dwordx4 v5, s[60:63], s31 offen lds
    s_add_u32 m0, s43, 15360
    s_mov_b32 s31, 3538944
    buffer_load_dwordx4 v5, s[60:63], s31 offen lds
    s_waitcnt vmcnt(28)
    ds_read_b64_tr_b16 a[24:25], v8 offset:18432
    ds_read_b64_tr_b16 a[26:27], v8 offset:18688
    ds_read_b64_tr_b16 a[104:105], v8 offset:18464
    ds_read_b64_tr_b16 a[106:107], v8 offset:18720
    s_waitcnt lgkmcnt(4)
    s_add_u32 m0, s43, 16384
    s_mov_b32 s31, 3407872
    buffer_load_dwordx4 v5, s[64:67], s31 offen lds
    s_add_u32 m0, s43, 17408
    s_mov_b32 s31, 3538944
    buffer_load_dwordx4 v5, s[64:67], s31 offen lds
    s_waitcnt vmcnt(28)
    ds_read_b64_tr_b16 a[184:185], v8 offset:20480
    ds_read_b64_tr_b16 a[186:187], v8 offset:20736
    ds_read_b64_tr_b16 v[120:121], v8 offset:20512
    ds_read_b64_tr_b16 v[122:123], v8 offset:20768
    s_waitcnt lgkmcnt(4)
    s_add_u32 m0, s43, 18432
    s_mov_b32 s31, 3670016
    buffer_load_dwordx4 v5, s[60:63], s31 offen lds
    s_add_u32 m0, s43, 19456
    s_mov_b32 s31, 3801088
    buffer_load_dwordx4 v5, s[60:63], s31 offen lds
    s_waitcnt vmcnt(28)
    ds_read_b64_tr_b16 a[28:29], v8 offset:22528
    ds_read_b64_tr_b16 a[30:31], v8 offset:22784
    ds_read_b64_tr_b16 a[108:109], v8 offset:22560
    ds_read_b64_tr_b16 a[110:111], v8 offset:22816
    s_waitcnt lgkmcnt(4)
    s_add_u32 m0, s43, 20480
    s_mov_b32 s31, 3670016
    buffer_load_dwordx4 v5, s[64:67], s31 offen lds
    s_add_u32 m0, s43, 21504
    s_mov_b32 s31, 3801088
    buffer_load_dwordx4 v5, s[64:67], s31 offen lds
    s_waitcnt vmcnt(28)
    ds_read_b64_tr_b16 a[188:189], v8 offset:24576
    ds_read_b64_tr_b16 a[190:191], v8 offset:24832
    ds_read_b64_tr_b16 v[124:125], v8 offset:24608
    ds_read_b64_tr_b16 v[126:127], v8 offset:24864
    s_waitcnt lgkmcnt(4)
    s_add_u32 m0, s43, 22528
    s_mov_b32 s31, 3932160
    buffer_load_dwordx4 v5, s[60:63], s31 offen lds
    s_add_u32 m0, s43, 23552
    s_mov_b32 s31, 4063232
    buffer_load_dwordx4 v5, s[60:63], s31 offen lds
    s_waitcnt vmcnt(28)
    ds_read_b64_tr_b16 a[32:33], v8 offset:26624
    ds_read_b64_tr_b16 a[34:35], v8 offset:26880
    ds_read_b64_tr_b16 a[112:113], v8 offset:26656
    ds_read_b64_tr_b16 a[114:115], v8 offset:26912
    s_waitcnt lgkmcnt(4)
    s_add_u32 m0, s43, 24576
    s_mov_b32 s31, 3932160
    buffer_load_dwordx4 v5, s[64:67], s31 offen lds
    s_add_u32 m0, s43, 25600
    s_mov_b32 s31, 4063232
    buffer_load_dwordx4 v5, s[64:67], s31 offen lds
    s_waitcnt vmcnt(28)
    ds_read_b64_tr_b16 a[192:193], v8 offset:28672
    ds_read_b64_tr_b16 a[194:195], v8 offset:28928
    ds_read_b64_tr_b16 v[128:129], v8 offset:28704
    ds_read_b64_tr_b16 v[130:131], v8 offset:28960
    s_waitcnt lgkmcnt(4)
    s_add_u32 m0, s43, 26624
    s_mov_b32 s31, 4194304
    buffer_load_dwordx4 v5, s[60:63], s31 offen lds
    s_add_u32 m0, s43, 27648
    s_mov_b32 s31, 4325376
    buffer_load_dwordx4 v5, s[60:63], s31 offen lds
    s_waitcnt vmcnt(28)
    ds_read_b64_tr_b16 a[36:37], v8 offset:30720
    ds_read_b64_tr_b16 a[38:39], v8 offset:30976
    ds_read_b64_tr_b16 a[116:117], v8 offset:30752
    ds_read_b64_tr_b16 a[118:119], v8 offset:31008
    s_waitcnt lgkmcnt(4)
    s_add_u32 m0, s43, 28672
    s_mov_b32 s31, 4194304
    buffer_load_dwordx4 v5, s[64:67], s31 offen lds
    s_add_u32 m0, s43, 29696
    s_mov_b32 s31, 4325376
    buffer_load_dwordx4 v5, s[64:67], s31 offen lds
    s_waitcnt vmcnt(28)
    ds_read_b64_tr_b16 a[196:197], v8 offset:0
    ds_read_b64_tr_b16 a[198:199], v8 offset:256
    ds_read_b64_tr_b16 v[132:133], v8 offset:32
    ds_read_b64_tr_b16 v[134:135], v8 offset:288
    s_waitcnt lgkmcnt(4)
    s_add_u32 m0, s43, 30720
    s_mov_b32 s31, 4456448
    buffer_load_dwordx4 v5, s[60:63], s31 offen lds
    s_add_u32 m0, s43, 31744
    s_mov_b32 s31, 4587520
    buffer_load_dwordx4 v5, s[60:63], s31 offen lds
    s_waitcnt vmcnt(28)
    ds_read_b64_tr_b16 a[40:41], v8 offset:2048
    ds_read_b64_tr_b16 a[42:43], v8 offset:2304
    ds_read_b64_tr_b16 a[120:121], v8 offset:2080
    ds_read_b64_tr_b16 a[122:123], v8 offset:2336
    s_waitcnt lgkmcnt(4)
    s_add_u32 m0, s43, 0
    s_mov_b32 s31, 4456448
    buffer_load_dwordx4 v5, s[64:67], s31 offen lds
    s_add_u32 m0, s43, 1024
    s_mov_b32 s31, 4587520
    buffer_load_dwordx4 v5, s[64:67], s31 offen lds
    s_waitcnt vmcnt(28)
    ds_read_b64_tr_b16 a[200:201], v8 offset:4096
    ds_read_b64_tr_b16 a[202:203], v8 offset:4352
    ds_read_b64_tr_b16 v[136:137], v8 offset:4128
    ds_read_b64_tr_b16 v[138:139], v8 offset:4384
    s_waitcnt lgkmcnt(4)
    s_add_u32 m0, s43, 2048
    s_mov_b32 s31, 4718592
    buffer_load_dwordx4 v5, s[60:63], s31 offen lds
    s_add_u32 m0, s43, 3072
    s_mov_b32 s31, 4849664
    buffer_load_dwordx4 v5, s[60:63], s31 offen lds
    s_waitcnt vmcnt(28)
    ds_read_b64_tr_b16 a[44:45], v8 offset:6144
    ds_read_b64_tr_b16 a[46:47], v8 offset:6400
    ds_read_b64_tr_b16 a[124:125], v8 offset:6176
    ds_read_b64_tr_b16 a[126:127], v8 offset:6432
    s_waitcnt lgkmcnt(4)
    s_add_u32 m0, s43, 4096
    s_mov_b32 s31, 4718592
    buffer_load_dwordx4 v5, s[64:67], s31 offen lds
    s_add_u32 m0, s43, 5120
    s_mov_b32 s31, 4849664
    buffer_load_dwordx4 v5, s[64:67], s31 offen lds
    s_waitcnt vmcnt(28)
    ds_read_b64_tr_b16 a[204:205], v8 offset:8192
    ds_read_b64_tr_b16 a[206:207], v8 offset:8448
    ds_read_b64_tr_b16 v[140:141], v8 offset:8224
    ds_read_b64_tr_b16 v[142:143], v8 offset:8480
    s_waitcnt lgkmcnt(4)
    s_add_u32 m0, s43, 6144
    s_mov_b32 s31, 4980736
    buffer_load_dwordx4 v5, s[60:63], s31 offen lds
    s_add_u32 m0, s43, 7168
    s_mov_b32 s31, 5111808
    buffer_load_dwordx4 v5, s[60:63], s31 offen lds
    s_waitcnt vmcnt(28)
    ds_read_b64_tr_b16 a[48:49], v8 offset:10240
    ds_read_b64_tr_b16 a[50:51], v8 offset:10496
    ds_read_b64_tr_b16 a[128:129], v8 offset:10272
    ds_read_b64_tr_b16 a[130:131], v8 offset:10528
    s_waitcnt lgkmcnt(4)
    s_add_u32 m0, s43, 8192
    s_mov_b32 s31, 4980736
    buffer_load_dwordx4 v5, s[64:67], s31 offen lds
    s_add_u32 m0, s43, 9216
    s_mov_b32 s31, 5111808
    buffer_load_dwordx4 v5, s[64:67], s31 offen lds
    v_and_b32 v96, 31, v1
    v_lshlrev_b32 v96, 2, v96
    global_load_dword v96, v96, s[52:53] sc1
    s_waitcnt vmcnt(29)
    ds_read_b64_tr_b16 a[208:209], v8 offset:12288
    ds_read_b64_tr_b16 a[210:211], v8 offset:12544
    ds_read_b64_tr_b16 v[144:145], v8 offset:12320
    ds_read_b64_tr_b16 v[146:147], v8 offset:12576
    s_waitcnt vmcnt(27)
    ds_read_b64_tr_b16 a[52:53], v8 offset:14336
    ds_read_b64_tr_b16 a[54:55], v8 offset:14592
    ds_read_b64_tr_b16 a[132:133], v8 offset:14368
    ds_read_b64_tr_b16 a[134:135], v8 offset:14624
    s_waitcnt vmcnt(25)
    ds_read_b64_tr_b16 a[212:213], v8 offset:16384
    ds_read_b64_tr_b16 a[214:215], v8 offset:16640
    ds_read_b64_tr_b16 v[148:149], v8 offset:16416
    ds_read_b64_tr_b16 v[150:151], v8 offset:16672
    s_waitcnt vmcnt(23)
    ds_read_b64_tr_b16 a[56:57], v8 offset:18432
    ds_read_b64_tr_b16 a[58:59], v8 offset:18688
    ds_read_b64_tr_b16 a[136:137], v8 offset:18464
    ds_read_b64_tr_b16 a[138:139], v8 offset:18720
    s_waitcnt vmcnt(21)
    ds_read_b64_tr_b16 a[216:217], v8 offset:20480
    ds_read_b64_tr_b16 a[218:219], v8 offset:20736
    ds_read_b64_tr_b16 v[152:153], v8 offset:20512
    ds_read_b64_tr_b16 v[154:155], v8 offset:20768
    s_waitcnt vmcnt(19)
    ds_read_b64_tr_b16 a[60:61], v8 offset:22528
    ds_read_b64_tr_b16 a[62:63], v8 offset:22784
    ds_read_b64_tr_b16 a[140:141], v8 offset:22560
    ds_read_b64_tr_b16 a[142:143], v8 offset:22816
    s_waitcnt vmcnt(17)
    ds_read_b64_tr_b16 a[220:221], v8 offset:24576
    ds_read_b64_tr_b16 a[222:223], v8 offset:24832
    ds_read_b64_tr_b16 v[156:157], v8 offset:24608
    ds_read_b64_tr_b16 v[158:159], v8 offset:24864
    s_waitcnt vmcnt(15)
    ds_read_b64_tr_b16 a[64:65], v8 offset:26624
    ds_read_b64_tr_b16 a[66:67], v8 offset:26880
    ds_read_b64_tr_b16 a[144:145], v8 offset:26656
    ds_read_b64_tr_b16 a[146:147], v8 offset:26912
    s_waitcnt vmcnt(13)
    ds_read_b64_tr_b16 a[224:225], v8 offset:28672
    ds_read_b64_tr_b16 a[226:227], v8 offset:28928
    ds_read_b64_tr_b16 v[160:161], v8 offset:28704
    ds_read_b64_tr_b16 v[162:163], v8 offset:28960
    s_waitcnt vmcnt(11)
    ds_read_b64_tr_b16 a[68:69], v8 offset:30720
    ds_read_b64_tr_b16 a[70:71], v8 offset:30976
    ds_read_b64_tr_b16 a[148:149], v8 offset:30752
    ds_read_b64_tr_b16 a[150:151], v8 offset:31008
    s_waitcnt vmcnt(9)
    ds_read_b64_tr_b16 a[228:229], v8 offset:0
    ds_read_b64_tr_b16 a[230:231], v8 offset:256
    ds_read_b64_tr_b16 v[164:165], v8 offset:32
    ds_read_b64_tr_b16 v[166:167], v8 offset:288
    s_waitcnt vmcnt(7)
    ds_read_b64_tr_b16 a[72:73], v8 offset:2048
    ds_read_b64_tr_b16 a[74:75], v8 offset:2304
    ds_read_b64_tr_b16 a[152:153], v8 offset:2080
    ds_read_b64_tr_b16 a[154:155], v8 offset:2336
    s_waitcnt vmcnt(5)
    ds_read_b64_tr_b16 a[232:233], v8 offset:4096
    ds_read_b64_tr_b16 a[234:235], v8 offset:4352
    ds_read_b64_tr_b16 v[168:169], v8 offset:4128
    ds_read_b64_tr_b16 v[170:171], v8 offset:4384
    s_waitcnt vmcnt(3)
    ds_read_b64_tr_b16 a[76:77], v8 offset:6144
    ds_read_b64_tr_b16 a[78:79], v8 offset:6400
    ds_read_b64_tr_b16 a[156:157], v8 offset:6176
    ds_read_b64_tr_b16 a[158:159], v8 offset:6432
    s_waitcnt vmcnt(1)
    ds_read_b64_tr_b16 a[236:237], v8 offset:8192
    ds_read_b64_tr_b16 a[238:239], v8 offset:8448
    ds_read_b64_tr_b16 v[172:173], v8 offset:8224
    ds_read_b64_tr_b16 v[174:175], v8 offset:8480
    s_waitcnt lgkmcnt(0)
    s_barrier
    v_lshlrev_b32 v20, 4, v1
    s_lshl_b32 s41, s5, 12
    v_add_u32 v20, s41, v20
    ds_write_b128 v20, v[80:83] offset:35584
    ds_write_b128 v20, v[84:87] offset:36608
    ds_write_b128 v20, v[88:91] offset:37632
    ds_write_b128 v20, v[92:95] offset:38656
    s_waitcnt lgkmcnt(0)
    s_branch rec_std
rec_stn:
    s_add_u32 m0, s43, 0
    s_mov_b32 s31, 0
    buffer_load_dwordx4 v6, s[68:71], s31 offen lds
    s_add_u32 m0, s43, 1024
    s_mov_b32 s31, 262144
    buffer_load_dwordx4 v6, s[68:71], s31 offen lds
    s_add_u32 m0, s43, 2048
    s_mov_b32 s31, 0
    buffer_load_dwordx4 v11, s[68:71], s31 offen lds
    s_add_u32 m0, s43, 3072
    s_mov_b32 s31, 262144
    buffer_load_dwordx4 v11, s[68:71], s31 offen lds
    s_add_u32 m0, s43, 4096
    s_mov_b32 s31, 524288
    buffer_load_dwordx4 v6, s[68:71], s31 offen lds
    s_add_u32 m0, s43, 5120
    s_mov_b32 s31, 786432
    buffer_load_dwordx4 v6, s[68:71], s31 offen lds
    s_add_u32 m0, s43, 6144
    s_mov_b32 s31, 524288
    buffer_load_dwordx4 v11, s[68:71], s31 offen lds
    s_add_u32 m0, s43, 7168
    s_mov_b32 s31, 786432
    buffer_load_dwordx4 v11, s[68:71], s31 offen lds
    s_add_u32 m0, s43, 8192
    s_mov_b32 s31, 1048576
    buffer_load_dwordx4 v6, s[68:71], s31 offen lds
    s_add_u32 m0, s43, 9216
    s_mov_b32 s31, 1310720
    buffer_load_dwordx4 v6, s[68:71], s31 offen lds
    s_add_u32 m0, s43, 10240
    s_mov_b32 s31, 0
    buffer_load_dwordx4 v5, s[60:63], s31 offen lds
    s_add_u32 m0, s43, 11264
    s_mov_b32 s31, 131072
    buffer_load_dwordx4 v5, s[60:63], s31 offen lds
    s_add_u32 m0, s43, 12288
    s_mov_b32 s31, 0
    buffer_load_dwordx4 v5, s[64:67], s31 offen lds
    s_add_u32 m0, s43, 13312
    s_mov_b32 s31, 131072
    buffer_load_dwordx4 v5, s[64:67], s31 offen lds
    s_add_u32 m0, s43, 14336
    s_mov_b32 s31, 262144
    buffer_load_dwordx4 v5, s[60:63], s31 offen lds
    s_add_u32 m0, s43, 15360
    s_mov_b32 s31, 393216
    buffer_load_dwordx4 v5, s[60:63], s31 offen lds
    s_add_u32 m0, s43, 16384
    s_mov_b32 s31, 262144
    buffer_load_dwordx4 v5, s[64:67], s31 offen lds
    s_add_u32 m0, s43, 17408
    s_mov_b32 s31, 393216
    buffer_load_dwordx4 v5, s[64:67], s31 offen lds
    s_add_u32 m0, s43, 18432
    s_mov_b32 s31, 524288
    buffer_load_dwordx4 v5, s[60:63], s31 offen lds
    s_add_u32 m0, s43, 19456
    s_mov_b32 s31, 655360
    buffer_load_dwordx4 v5, s[60:63], s31 offen lds
    s_add_u32 m0, s43, 20480
    s_mov_b32 s31, 524288
    buffer_load_dwordx4 v5, s[64:67], s31 offen lds
    s_add_u32 m0, s43, 21504
    s_mov_b32 s31, 655360
    buffer_load_dwordx4 v5, s[64:67], s31 offen lds
    s_add_u32 m0, s43, 22528
    s_mov_b32 s31, 786432
    buffer_load_dwordx4 v5, s[60:63], s31 offen lds
    s_add_u32 m0, s43, 23552
    s_mov_b32 s31, 917504
    buffer_load_dwordx4 v5, s[60:63], s31 offen lds
    s_add_u32 m0, s43, 24576
    s_mov_b32 s31, 786432
    buffer_load_dwordx4 v5, s[64:67], s31 offen lds
    s_add_u32 m0, s43, 25600
    s_mov_b32 s31, 917504
    buffer_load_dwordx4 v5, s[64:67], s31 offen lds
    s_add_u32 m0, s43, 26624
    s_mov_b32 s31, 1048576
    buffer_load_dwordx4 v5, s[60:63], s31 offen lds
    s_add_u32 m0, s43, 27648
    s_mov_b32 s31, 1179648
    buffer_load_dwordx4 v5, s[60:63], s31 offen lds
    s_add_u32 m0, s43, 28672
    s_mov_b32 s31, 1048576
    buffer_load_dwordx4 v5, s[64:67], s31 offen lds
    s_add_u32 m0, s43, 29696
    s_mov_b32 s31, 1179648
    buffer_load_dwordx4 v5, s[64:67], s31 offen lds
    s_add_u32 m0, s43, 30720
    s_mov_b32 s31, 1310720
    buffer_load_dwordx4 v5, s[60:63], s31 offen lds
    s_add_u32 m0, s43, 31744
    s_mov_b32 s31, 1441792
    buffer_load_dwordx4 v5, s[60:63], s31 offen lds
    s_waitcnt vmcnt(30)
    ds_read_b64_tr_b16 v[176:177], v9 offset:0
    ds_read_b64_tr_b16 v[178:179], v9 offset:128
    ds_read_b64_tr_b16 v[180:181], v9 offset:1024
    ds_read_b64_tr_b16 v[182:183], v9 offset:1152
    s_waitcnt vmcnt(28)
    ds_read_b64_tr_b16 v[184:185], v9 offset:2048
    ds_read_b64_tr_b16 v[186:187], v9 offset:2176
    ds_read_b64_tr_b16 v[188:189], v9 offset:3072
    ds_read_b64_tr_b16 v[190:191], v9 offset:3200
    s_waitcnt lgkmcnt(4)
    s_add_u32 m0, s43, 0
    s_mov_b32 s31, 1310720
    buffer_load_dwordx4 v5, s[64:67], s31 offen lds
    s_add_u32 m0, s43, 1024
    s_mov_b32 s31, 1441792
    buffer_load_dwordx4 v5, s[64:67], s31 offen lds
    s_waitcnt vmcnt(28)
    ds_read_b64_tr_b16 v[192:193], v9 offset:4096
    ds_read_b64_tr_b16 v[194:195], v9 offset:4224
    ds_read_b64_tr_b16 v[196:197], v9 offset:5120
    ds_read_b64_tr_b16 v[198:199], v9 offset:5248
    s_waitcnt lgkmcnt(4)
    s_add_u32 m0, s43, 2048
    s_mov_b32 s31, 1572864
    buffer_load_dwordx4 v5, s[60:63], s31 offen lds
    s_add_u32 m0, s43, 3072
    s_mov_b32 s31, 1703936
    buffer_load_dwordx4 v5, s[60:63], s31 offen lds
    s_waitcnt vmcnt(28)
    ds_read_b64_tr_b16 v[200:201], v9 offset:6144
    ds_read_b64_tr_b16 v[202:203], v9 offset:6272
    ds_read_b64_tr_b16 v[204:205], v9 offset:7168
    ds_read_b64_tr_b16 v[206:207], v9 offset:7296
    s_waitcnt lgkmcnt(4)
    s_add_u32 m0, s43, 4096
    s_mov_b32 s31, 1572864
    buffer_load_dwordx4 v5, s[64:67], s31 offen lds
    s_add_u32 m0, s43, 5120
    s_mov_b32 s31, 1703936
    buffer_load_dwordx4 v5, s[64:67], s31 offen lds
    s_waitcnt vmcnt(28)
    ds_read_b64_tr_b16 v[208:209], v9 offset:8192
    ds_read_b64_tr_b16 v[210:211], v9 offset:8320
    ds_read_b64_tr_b16 v[212:213], v9 offset:9216
    ds_read_b64_tr_b16 v[214:215], v9 offset:9344
    s_waitcnt lgkmcnt(4)
    s_add_u32 m0, s43, 6144
    s_mov_b32 s31, 1835008
    buffer_load_dwordx4 v5, s[60:63], s31 offen lds
    s_add_u32 m0, s43, 7168
    s_mov_b32 s31, 1966080
    buffer_load_dwordx4 v5, s[60:63], s31 offen lds
    s_waitcnt vmcnt(28)
    ds_read_b64_tr_b16 a[0:1], v8 offset:10240
    ds_read_b64_tr_b16 a[2:3], v8 offset:10496
    ds_read_b64_tr_b16 a[80:81], v8 offset:10272
    ds_read_b64_tr_b16 a[82:83], v8 offset:10528
    s_waitcnt lgkmcnt(4)
    s_add_u32 m0, s43, 8192
    s_mov_b32 s31, 1835008
    buffer_load_dwordx4 v5, s[64:67], s31 offen lds
    s_add_u32 m0, s43, 9216
    s_mov_b32 s31, 1966080
    buffer_load_dwordx4 v5, s[64:67], s31 offen lds
    s_waitcnt vmcnt(28)
    ds_read_b64_tr_b16 a[160:161], v8 offset:12288
    ds_read_b64_tr_b16 a[162:163], v8 offset:12544
    ds_read_b64_tr_b16 a[240:241], v8 offset:12320
    ds_read_b64_tr_b16 a[242:243], v8 offset:12576
    s_waitcnt lgkmcnt(4)
    s_add_u32 m0, s43, 10240
    s_mov_b32 s31, 2097152
    buffer_load_dwordx4 v5, s[60:63], s31 offen lds
    s_add_u32 m0, s43, 11264
    s_mov_b32 s31, 2228224
    buffer_load_dwordx4 v5, s[60:63], s31 offen lds
    s_waitcnt vmcnt(28)
    ds_read_b64_tr_b16 a[4:5], v8 offset:14336
    ds_read_b64_tr_b16 a[6:7], v8 offset:14592
    ds_read_b64_tr_b16 a[84:85], v8 offset:14368
    ds_read_b64_tr_b16 a[86:87], v8 offset:14624
    s_waitcnt lgkmcnt(4)
    s_add_u32 m0, s43, 12288
    s_mov_b32 s31, 2097152
    buffer_load_dwordx4 v5, s[64:67], s31 offen lds
    s_add_u32 m0, s43, 13312
    s_mov_b32 s31, 2228224
    buffer_load_dwordx4 v5, s[64:67], s31 offen lds
    s_waitcnt vmcnt(28)
    ds_read_b64_tr_b16 a[164:165], v8 offset:16384
    ds_read_b64_tr_b16 a[166:167], v8 offset:16640
    ds_read_b64_tr_b16 a[244:245], v8 offset:16416
    ds_read_b64_tr_b16 a[246:247], v8 offset:16672
    s_waitcnt lgkmcnt(4)
    s_add_u32 m0, s43, 14336
    s_mov_b32 s31, 2359296
    buffer_load_dwordx4 v5, s[60:63], s31 offen lds
    s_add_u32 m0, s43, 15360
    s_mov_b32 s31, 2490368
    buffer_load_dwordx4 v5, s[60:63], s31 offen lds
    s_waitcnt vmcnt(28)
    ds_read_b64_tr_b16 a[8:9], v8 offset:18432
    ds_read_b64_tr_b16 a[10:11], v8 offset:18688
    ds_read_b64_tr_b16 a[88:89], v8 offset:18464
    ds_read_b64_tr_b16 a[90:91], v8 offset:18720
    s_waitcnt lgkmcnt(4)
    s_add_u32 m0, s43, 16384
    s_mov_b32 s31, 2359296
    buffer_load_dwordx4 v5, s[64:67], s31 offen lds
    s_add_u32 m0, s43, 17408
    s_mov_b32 s31, 2490368
    buffer_load_dwordx4 v5, s[64:67], s31 offen lds
    s_waitcnt vmcnt(28)
    ds_read_b64_tr_b16 a[168:169], v8 offset:20480
    ds_read_b64_tr_b16 a[170:171], v8 offset:20736
    ds_read_b64_tr_b16 a[248:249], v8 offset:20512
    ds_read_b64_tr_b16 a[250:251], v8 offset:20768
    s_waitcnt lgkmcnt(4)
    s_add_u32 m0, s43, 18432
    s_mov_b32 s31, 2621440
    buffer_load_dwordx4 v5, s[60:63], s31 offen lds
    s_add_u32 m0, s43, 19456
    s_mov_b32 s31, 2752512
    buffer_load_dwordx4 v5, s[60:63], s31 offen lds
    s_waitcnt vmcnt(28)
    ds_read_b64_tr_b16 a[12:13], v8 offset:22528
    ds_read_b64_tr_b16 a[14:15], v8 offset:22784
    ds_read_b64_tr_b16 a[92:93], v8 offset:22560
    ds_read_b64_tr_b16 a[94:95], v8 offset:22816
    s_waitcnt lgkmcnt(4)
    s_add_u32 m0, s43, 20480
    s_mov_b32 s31, 2621440
    buffer_load_dwordx4 v5, s[64:67], s31 offen lds
    s_add_u32 m0, s43, 21504
    s_mov_b32 s31, 2752512
    buffer_load_dwordx4 v5, s[64:67], s31 offen lds
    s_waitcnt vmcnt(28)
    ds_read_b64_tr_b16 a[172:173], v8 offset:24576
    ds_read_b64_tr_b16 a[174:175], v8 offset:24832
    ds_read_b64_tr_b16 a[252:253], v8 offset:24608
    ds_read_b64_tr_b16 a[254:255], v8 offset:24864
    s_waitcnt lgkmcnt(4)
    s_add_u32 m0, s43, 22528
    s_mov_b32 s31, 2883584
    buffer_load_dwordx4 v5, s[60:63], s31 offen lds
    s_add_u32 m0, s43, 23552
    s_mov_b32 s31, 3014656
    buffer_load_dwordx4 v5, s[60:63], s31 offen lds
    s_waitcnt vmcnt(28)
    ds_read_b64_tr_b16 a[16:17], v8 offset:26624
    ds_read_b64_tr_b16 a[18:19], v8 offset:26880
    ds_read_b64_tr_b16 a[96:97], v8 offset:26656
    ds_read_b64_tr_b16 a[98:99], v8 offset:26912
    s_waitcnt lgkmcnt(4)
    s_add_u32 m0, s43, 24576
    s_mov_b32 s31, 2883584
    buffer_load_dwordx4 v5, s[64:67], s31 offen lds
    s_add_u32 m0, s43, 25600
    s_mov_b32 s31, 3014656
    buffer_load_dwordx4 v5, s[64:67], s31 offen lds
    s_waitcnt vmcnt(28)
    ds_read_b64_tr_b16 a[176:177], v8 offset:28672
    ds_read_b64_tr_b16 a[178:179], v8 offset:28928
    ds_read_b64_tr_b16 v[112:113], v8 offset:28704
    ds_read_b64_tr_b16 v[114:115], v8 offset:28960
    s_waitcnt lgkmcnt(4)
    s_add_u32 m0, s43, 26624
    s_mov_b32 s31, 3145728
    buffer_load_dwordx4 v5, s[60:63], s31 offen lds
    s_add_u32 m0, s43, 27648
    s_mov_b32 s31, 3276800
    buffer_load_dwordx4 v5, s[60:63], s31 offen lds
    s_waitcnt vmcnt(28)
    ds_read_b64_tr_b16 a[20:21], v8 offset:30720
    ds_read_b64_tr_b16 a[22:23], v8 offset:30976
    ds_read_b64_tr_b16 a[100:101], v8 offset:30752
    ds_read_b64_tr_b16 a[102:103], v8 offset:31008
    s_waitcnt lgkmcnt(4)
    s_add_u32 m0, s43, 28672
    s_mov_b32 s31, 3145728
    buffer_load_dwordx4 v5, s[64:67], s31 offen lds
    s_add_u32 m0, s43, 29696
    s_mov_b32 s31, 3276800
    buffer_load_dwordx4 v5, s[64:67], s31 offen lds
    s_waitcnt vmcnt(28)
    ds_read_b64_tr_b16 a[180:181], v8 offset:0
    ds_read_b64_tr_b16 a[182:183], v8 offset:256
    ds_read_b64_tr_b16 v[116:117], v8 offset:32
    ds_read_b64_tr_b16 v[118:119], v8 offset:288
    s_waitcnt lgkmcnt(4)
    s_add_u32 m0, s43, 30720
    s_mov_b32 s31, 3407872
    buffer_load_dwordx4 v5, s[60:63], s31 offen lds
    s_add_u32 m0, s43, 31744
    s_mov_b32 s31, 3538944
    buffer_load_dwordx4 v5, s[60:63], s31 offen lds
    s_waitcnt vmcnt(28)
    ds_read_b64_tr_b16 a[24:25], v8 offset:2048
    ds_read_b64_tr_b16 a[26:27], v8 offset:2304
    ds_read_b64_tr_b16 a[104:105], v8 offset:2080
    ds_read_b64_tr_b16 a[106:107], v8 offset:2336
    s_waitcnt lgkmcnt(4)
    s_add_u32 m0, s43, 0
    s_mov_b32 s31, 3407872
    buffer_load_dwordx4 v5, s[64:67], s31 offen lds
    s_add_u32 m0, s43, 1024
    s_mov_b32 s31, 3538944
    buffer_load_dwordx4 v5, s[64:67], s31 offen lds
    s_waitcnt vmcnt(28)
    ds_read_b64_tr_b16 a[184:185], v8 offset:4096
    ds_read_b64_tr_b16 a[186:187], v8 offset:4352
    ds_read_b64_tr_b16 v[120:121], v8 offset:4128
    ds_read_b64_tr_b16 v[122:123], v8 offset:4384
    s_waitcnt lgkmcnt(4)
    s_add_u32 m0, s43, 2048
    s_mov_b32 s31, 3670016
    buffer_load_dwordx4 v5, s[60:63], s31 offen lds
    s_add_u32 m0, s43, 3072
    s_mov_b32 s31, 3801088
    buffer_load_dwordx4 v5, s[60:63], s31 offen lds
    s_waitcnt vmcnt(28)
    ds_read_b64_tr_b16 a[28:29], v8 offset:6144
    ds_read_b64_tr_b16 a[30:31], v8 offset:6400
    ds_read_b64_tr_b16 a[108:109], v8 offset:6176
    ds_read_b64_tr_b16 a[110:111], v8 offset:6432
    s_waitcnt lgkmcnt(4)
    s_add_u32 m0, s43, 4096
    s_mov_b32 s31, 3670016
    buffer_load_dwordx4 v5, s[64:67], s31 offen lds
    s_add_u32 m0, s43, 5120
    s_mov_b32 s31, 3801088
    buffer_load_dwordx4 v5, s[64:67], s31 offen lds
    s_waitcnt vmcnt(28)
    ds_read_b64_tr_b16 a[188:189], v8 offset:8192
    ds_read_b64_tr_b16 a[190:191], v8 offset:8448
    ds_read_b64_tr_b16 v[124:125], v8 offset:8224
    ds_read_b64_tr_b16 v[126:127], v8 offset:8480
    s_waitcnt lgkmcnt(4)
    s_add_u32 m0, s43, 6144
    s_mov_b32 s31, 3932160
    buffer_load_dwordx4 v5, s[60:63], s31 offen lds
    s_add_u32 m0, s43, 7168
    s_mov_b32 s31, 4063232
    buffer_load_dwordx4 v5, s[60:63], s31 offen lds
    s_waitcnt vmcnt(28)
    ds_read_b64_tr_b16 a[32:33], v8 offset:10240
    ds_read_b64_tr_b16 a[34:35], v8 offset:10496
    ds_read_b64_tr_b16 a[112:113], v8 offset:10272
    ds_read_b64_tr_b16 a[114:115], v8 offset:10528
    s_waitcnt lgkmcnt(4)
    s_add_u32 m0, s43, 8192
    s_mov_b32 s31, 3932160
    buffer_load_dwordx4 v5, s[64:67], s31 offen lds
    s_add_u32 m0, s43, 9216
    s_mov_b32 s31, 4063232
    buffer_load_dwordx4 v5, s[64:67], s31 offen lds
    s_waitcnt vmcnt(28)
    ds_read_b64_tr_b16 a[192:193], v8 offset:12288
    ds_read_b64_tr_b16 a[194:195], v8 offset:12544
    ds_read_b64_tr_b16 v[128:129], v8 offset:12320
    ds_read_b64_tr_b16 v[130:131], v8 offset:12576
    s_waitcnt lgkmcnt(4)
    s_add_u32 m0, s43, 10240
    s_mov_b32 s31, 4194304
    buffer_load_dwordx4 v5, s[60:63], s31 offen lds
    s_add_u32 m0, s43, 11264
    s_mov_b32 s31, 4325376
    buffer_load_dwordx4 v5, s[60:63], s31 offen lds
    s_waitcnt vmcnt(28)
    ds_read_b64_tr_b16 a[36:37], v8 offset:14336
    ds_read_b64_tr_b16 a[38:39], v8 offset:14592
    ds_read_b64_tr_b16 a[116:117], v8 offset:14368
    ds_read_b64_tr_b16 a[118:119], v8 offset:14624
    s_waitcnt lgkmcnt(4)
    s_add_u32 m0, s43, 12288
    s_mov_b32 s31, 4194304
    buffer_load_dwordx4 v5, s[64:67], s31 offen lds
    s_add_u32 m0, s43, 13312
    s_mov_b32 s31, 4325376
    buffer_load_dwordx4 v5, s[64:67], s31 offen lds
    s_waitcnt vmcnt(28)
    ds_read_b64_tr_b16 a[196:197], v8 offset:16384
    ds_read_b64_tr_b16 a[198:199], v8 offset:16640
    ds_read_b64_tr_b16 v[132:133], v8 offset:16416
    ds_read_b64_tr_b16 v[134:135], v8 offset:16672
    s_waitcnt lgkmcnt(4)
    s_add_u32 m0, s43, 14336
    s_mov_b32 s31, 4456448
    buffer_load_dwordx4 v5, s[60:63], s31 offen lds
    s_add_u32 m0, s43, 15360
    s_mov_b32 s31, 4587520
    buffer_load_dwordx4 v5, s[60:63], s31 offen lds
    s_waitcnt vmcnt(28)
    ds_read_b64_tr_b16 a[40:41], v8 offset:18432
    ds_read_b64_tr_b16 a[42:43], v8 offset:18688
    ds_read_b64_tr_b16 a[120:121], v8 offset:18464
    ds_read_b64_tr_b16 a[122:123], v8 offset:18720
    s_waitcnt lgkmcnt(4)
    s_add_u32 m0, s43, 16384
    s_mov_b32 s31, 4456448
    buffer_load_dwordx4 v5, s[64:67], s31 offen lds
    s_add_u32 m0, s43, 17408
    s_mov_b32 s31, 4587520
    buffer_load_dwordx4 v5, s[64:67], s31 offen lds
    s_waitcnt vmcnt(28)
    ds_read_b64_tr_b16 a[200:201], v8 offset:20480
    ds_read_b64_tr_b16 a[202:203], v8 offset:20736
    ds_read_b64_tr_b16 v[136:137], v8 offset:20512
    ds_read_b64_tr_b16 v[138:139], v8 offset:20768
    s_waitcnt lgkmcnt(4)
    s_add_u32 m0, s43, 18432
    s_mov_b32 s31, 4718592
    buffer_load_dwordx4 v5, s[60:63], s31 offen lds
    s_add_u32 m0, s43, 19456
    s_mov_b32 s31, 4849664
    buffer_load_dwordx4 v5, s[60:63], s31 offen lds
    s_waitcnt vmcnt(28)
    ds_read_b64_tr_b16 a[44:45], v8 offset:22528
    ds_read_b64_tr_b16 a[46:47], v8 offset:22784
    ds_read_b64_tr_b16 a[124:125], v8 offset:22560
    ds_read_b64_tr_b16 a[126:127], v8 offset:22816
    s_waitcnt lgkmcnt(4)
    s_add_u32 m0, s43, 20480
    s_mov_b32 s31, 4718592
    buffer_load_dwordx4 v5, s[64:67], s31 offen lds
    s_add_u32 m0, s43, 21504
    s_mov_b32 s31, 4849664
    buffer_load_dwordx4 v5, s[64:67], s31 offen lds
    s_waitcnt vmcnt(28)
    ds_read_b64_tr_b16 a[204:205], v8 offset:24576
    ds_read_b64_tr_b16 a[206:207], v8 offset:24832
    ds_read_b64_tr_b16 v[140:141], v8 offset:24608
    ds_read_b64_tr_b16 v[142:143], v8 offset:24864
    s_waitcnt lgkmcnt(4)
    s_add_u32 m0, s43, 22528
    s_mov_b32 s31, 4980736
    buffer_load_dwordx4 v5, s[60:63], s31 offen lds
    s_add_u32 m0, s43, 23552
    s_mov_b32 s31, 5111808
    buffer_load_dwordx4 v5, s[60:63], s31 offen lds
    s_waitcnt vmcnt(28)
    ds_read_b64_tr_b16 a[48:49], v8 offset:26624
    ds_read_b64_tr_b16 a[50:51], v8 offset:26880
    ds_read_b64_tr_b16 a[128:129], v8 offset:26656
    ds_read_b64_tr_b16 a[130:131], v8 offset:26912
    s_waitcnt lgkmcnt(4)
    s_add_u32 m0, s43, 24576
    s_mov_b32 s31, 4980736
    buffer_load_dwordx4 v5, s[64:67], s31 offen lds
    s_add_u32 m0, s43, 25600
    s_mov_b32 s31, 5111808
    buffer_load_dwordx4 v5, s[64:67], s31 offen lds
    v_and_b32 v96, 31, v1
    v_lshlrev_b32 v96, 2, v96
    global_load_dword v96, v96, s[52:53] sc1
    s_waitcnt vmcnt(29)
    ds_read_b64_tr_b16 a[208:209], v8 offset:28672
    ds_read_b64_tr_b16 a[210:211], v8 offset:28928
    ds_read_b64_tr_b16 v[144:145], v8 offset:28704
    ds_read_b64_tr_b16 v[146:147], v8 offset:28960
    s_waitcnt vmcnt(27)
    ds_read_b64_tr_b16 a[52:53], v8 offset:30720
    ds_read_b64_tr_b16 a[54:55], v8 offset:30976
    ds_read_b64_tr_b16 a[132:133], v8 offset:30752
    ds_read_b64_tr_b16 a[134:135], v8 offset:31008
    s_waitcnt vmcnt(25)
    ds_read_b64_tr_b16 a[212:213], v8 offset:0
    ds_read_b64_tr_b16 a[214:215], v8 offset:256
    ds_read_b64_tr_b16 v[148:149], v8 offset:32
    ds_read_b64_tr_b16 v[150:151], v8 offset:288
    s_waitcnt vmcnt(23)
    ds_read_b64_tr_b16 a[56:57], v8 offset:2048
    ds_read_b64_tr_b16 a[58:59], v8 offset:2304
    ds_read_b64_tr_b16 a[136:137], v8 offset:2080
    ds_read_b64_tr_b16 a[138:139], v8 offset:2336
    s_waitcnt vmcnt(21)
    ds_read_b64_tr_b16 a[216:217], v8 offset:4096
    ds_read_b64_tr_b16 a[218:219], v8 offset:4352
    ds_read_b64_tr_b16 v[152:153], v8 offset:4128
    ds_read_b64_tr_b16 v[154:155], v8 offset:4384
    s_waitcnt vmcnt(19)
    ds_read_b64_tr_b16 a[60:61], v8 offset:6144
    ds_read_b64_tr_b16 a[62:63], v8 offset:6400
    ds_read_b64_tr_b16 a[140:141], v8 offset:6176
    ds_read_b64_tr_b16 a[142:143], v8 offset:6432
    s_waitcnt vmcnt(17)
    ds_read_b64_tr_b16 a[220:221], v8 offset:8192
    ds_read_b64_tr_b16 a[222:223], v8 offset:8448
    ds_read_b64_tr_b16 v[156:157], v8 offset:8224
    ds_read_b64_tr_b16 v[158:159], v8 offset:8480
    s_waitcnt vmcnt(15)
    ds_read_b64_tr_b16 a[64:65], v8 offset:10240
    ds_read_b64_tr_b16 a[66:67], v8 offset:10496
    ds_read_b64_tr_b16 a[144:145], v8 offset:10272
    ds_read_b64_tr_b16 a[146:147], v8 offset:10528
    s_waitcnt vmcnt(13)
    ds_read_b64_tr_b16 a[224:225], v8 offset:12288
    ds_read_b64_tr_b16 a[226:227], v8 offset:12544
    ds_read_b64_tr_b16 v[160:161], v8 offset:12320
    ds_read_b64_tr_b16 v[162:163], v8 offset:12576
    s_waitcnt vmcnt(11)
    ds_read_b64_tr_b16 a[68:69], v8 offset:14336
    ds_read_b64_tr_b16 a[70:71], v8 offset:14592
    ds_read_b64_tr_b16 a[148:149], v8 offset:14368
    ds_read_b64_tr_b16 a[150:151], v8 offset:14624
    s_waitcnt vmcnt(9)
    ds_read_b64_tr_b16 a[228:229], v8 offset:16384
    ds_read_b64_tr_b16 a[230:231], v8 offset:16640
    ds_read_b64_tr_b16 v[164:165], v8 offset:16416
    ds_read_b64_tr_b16 v[166:167], v8 offset:16672
    s_waitcnt vmcnt(7)
    ds_read_b64_tr_b16 a[72:73], v8 offset:18432
    ds_read_b64_tr_b16 a[74:75], v8 offset:18688
    ds_read_b64_tr_b16 a[152:153], v8 offset:18464
    ds_read_b64_tr_b16 a[154:155], v8 offset:18720
    s_waitcnt vmcnt(5)
    ds_read_b64_tr_b16 a[232:233], v8 offset:20480
    ds_read_b64_tr_b16 a[234:235], v8 offset:20736
    ds_read_b64_tr_b16 v[168:169], v8 offset:20512
    ds_read_b64_tr_b16 v[170:171], v8 offset:20768
    s_waitcnt vmcnt(3)
    ds_read_b64_tr_b16 a[76:77], v8 offset:22528
    ds_read_b64_tr_b16 a[78:79], v8 offset:22784
    ds_read_b64_tr_b16 a[156:157], v8 offset:22560
    ds_read_b64_tr_b16 a[158:159], v8 offset:22816
    s_waitcnt vmcnt(1)
    ds_read_b64_tr_b16 a[236:237], v8 offset:24576
    ds_read_b64_tr_b16 a[238:239], v8 offset:24832
    ds_read_b64_tr_b16 v[172:173], v8 offset:24608
    ds_read_b64_tr_b16 v[174:175], v8 offset:24864
    s_waitcnt lgkmcnt(0)
    s_barrier
rec_std:
    v_and_b32 v20, 7, v0
    v_mul_u32_u24 v4, 1312, v20
    v_lshl_add_u32 v4, v3, 4, v4
    v_lshlrev_b32 v5, 4, v0
    v_add_u32 v6, 6144, v5
    v_add_u32 v7, 8192, v5
    v_mul_u32_u24 v8, 1312, v20
    v_lshrrev_b32 v21, 3, v0
    v_lshl_add_u32 v8, v21, 4, v8
    v_add_u32 v9, 512, v8
    v_add_u32 v10, 1024, v8
    v_mul_u32_u24 v11, 208, v2
    v_lshl_add_u32 v11, v3, 4, v11
    s_mul_i32 s31, s5, 1664
    s_add_u32 s31, s31, 10496
    v_add_u32 v11, s31, v11
    v_lshrrev_b32 v21, 3, v2
    v_lshl_add_u32 v21, v21, 4, v20
    v_mul_u32_u24 v12, 208, v21
    v_lshl_add_u32 v12, v3, 4, v12
    v_add_u32 v12, 10496, v12
    v_lshlrev_b32 v13, 5, v2
    v_and_b32 v21, 1, v3
    v_lshl_add_u32 v14, v21, 4, v13
    v_add_u32 v14, 17152, v14
    v_lshl_add_u32 v13, v3, 4, v13
    s_lshl_b32 s31, s5, 9
    s_add_u32 s31, s31, 17152
    v_add_u32 v13, s31, v13
    v_lshlrev_b32 v15, 13, v2
    v_lshl_add_u32 v15, v3, 3, v15
    s_lshl_b32 s31, s3, 8
    s_lshl_b32 s41, s5, 6
    s_add_u32 s31, s31, s41
    v_add_u32 v15, s31, v15
    v_lshlrev_b32 v16, 12, v2
    v_lshl_add_u32 v16, v3, 3, v16
    s_lshl_b32 s31, s58, 17
    v_add_u32 v16, s31, v16
    v_mul_u32_u24 v15, 272, v2
    v_lshl_add_u32 v15, v3, 3, v15
    s_lshl_b32 s41, s5, 6
    s_add_u32 s41, s41, 24320
    v_add_u32 v15, s41, v15
    v_mul_u32_u24 v16, 80, v2
    v_lshl_add_u32 v16, v3, 3, v16
    v_add_u32 v16, 33024, v16
    v_lshlrev_b32 v16, 4, v1
    s_lshl_b32 s41, s5, 10
    s_add_u32 s41, s41, 24320
    v_add_u32 v15, s41, v16
    v_add_u32 v16, 33024, v16
    v_lshlrev_b32 v17, 13, v2
    v_lshl_add_u32 v17, v3, 3, v17
    s_lshl_b32 s31, s58, 6
    v_add_u32 v17, s31, v17
    v_lshlrev_b32 v17, 4, v2
    v_lshl_add_u32 v17, v3, 7, v17
    s_lshl_b32 s31, s58, 9
    v_add_u32 v17, s31, v17
    v_lshlrev_b32 v18, 4, v2
    v_lshl_add_u32 v18, v3, 3, v18
    s_lshl_b32 s31, s58, 9
    v_add_u32 v18, s31, v18
    v_lshlrev_b32 v21, 7, v3
    v_lshl_add_u32 v19, v2, 4, v21
    s_and_b32 s41, s58, 31
    s_lshl_b32 s41, s41, 9
    v_add_u32 v19, s41, v19
    v_lshl_add_u32 v25, v20, 4, v21
    s_lshl_b32 s41, s5, 12
    v_add_u32 v25, s41, v25
    v_mul_u32_u24 v26, 160, v2
    v_lshl_add_u32 v26, v3, 4, v26
    s_mul_i32 s41, s5, 1280
    s_add_u32 s41, s41, 19200
    v_add_u32 v26, s41, v26
    v_bfe_u32 v27, v0, 2, 3
    v_mul_u32_u24 v27, 160, v27
    v_lshrrev_b32 v21, 5, v0
    v_lshl_add_u32 v27, v21, 5, v27
    v_and_b32 v21, 3, v0
    v_lshl_add_u32 v27, v21, 3, v27
    v_add_u32 v27, 19200, v27
    s_and_b64 s[84:85], s[32:33], s[34:35]
    v_lshlrev_b32 v23, 3, v0
    v_add_u32 v24, 5120, v23
    v_lshlrev_b32 v24, 4, v1
    s_lshl_b32 s41, s5, 12
    s_add_u32 s41, s41, 35584
    v_add_u32 v24, s41, v24
    v_and_b32 v20, 7, v0
    v_mul_u32_u24 v4, 1312, v20
    v_lshl_add_u32 v4, v3, 5, v4
    v_lshrrev_b32 v21, 3, v2
    v_lshl_add_u32 v4, v21, 4, v4
    v_mov_b32 v7, 0x44444444
    v_mov_b32 v21, 0xeeeeeeee
    v_cndmask_b32 v7, v21, v7, s[32:33]
    v_lshrrev_b32 v21, 1, v3
    v_lshl_add_u32 v11, v21, 4, v2
    v_lshlrev_b32 v11, 4, v11
    v_and_b32 v22, 1, v3
    v_lshl_add_u32 v11, v22, 3, v11
    s_lshl_b32 s31, s5, 9
    s_add_u32 s31, s31, 10496
    v_add_u32 v11, s31, v11
    v_lshrrev_b32 v12, 2, v2
    v_lshl_add_u32 v12, v3, 2, v12
    v_lshlrev_b32 v12, 4, v12
    v_and_b32 v20, 1, v0
    v_lshl_add_u32 v12, v20, 3, v12
    v_add_u32 v12, 10496, v12
    s_lshl_b32 s31, s4, 9
    s_add_u32 s31, s31, 2048
    v_add_u32 v9, s31, v12
    v_lshlrev_b32 v13, 5, v2
    v_lshl_add_u32 v13, v22, 4, v13
    v_lshl_add_u32 v13, v21, 3, v13
    s_lshl_b32 s31, s5, 9
    s_add_u32 s31, s31, 17152
    v_add_u32 v13, s31, v13
    v_lshlrev_b32 v15, 4, v1
    v_add_u32 v15, 24320, v15
    v_bfe_u32 v27, v0, 2, 3
    v_mul_u32_u24 v27, 160, v27
    v_lshrrev_b32 v21, 6, v0
    v_lshl_add_u32 v27, v21, 6, v27
    v_and_b32 v21, 3, v0
    v_lshl_add_u32 v27, v21, 4, v27
    v_bfe_u32 v21, v0, 5, 1
    v_lshl_add_u32 v27, v21, 3, v27
    v_add_u32 v27, 19200, v27
    v_lshlrev_b32 v4, 4, v1
    s_mul_i32 s31, s5, 5
    s_lshr_b32 s31, s31, 1
    s_lshl_b32 s31, s31, 10
    v_add_u32 v5, s31, v4
    v_add_u32 v14, 53248, v4
    s_lshl_b32 s31, s5, 10
    v_add_u32 v13, s31, v14
    v_lshrrev_b32 v21, 1, v3
    v_lshl_add_u32 v18, v21, 4, v2
    v_lshlrev_b32 v18, 4, v18
    v_and_b32 v22, 1, v3
    v_lshl_add_u32 v18, v22, 3, v18
    s_lshl_b32 s31, s58, 9
    v_add_u32 v18, s31, v18
    s_lshl_b32 s31, s5, 12
    v_add_u32 v25, s31, v4
    v_lshrrev_b32 v21, 1, v3
    v_lshl_add_u32 v21, v21, 4, v2
    v_mul_u32_u24 v26, 48, v21
    v_and_b32 v22, 1, v3
    v_lshl_add_u32 v26, v22, 4, v26
    s_mul_i32 s31, s5, 1536
    s_add_u32 s31, s31, 57344
    v_add_u32 v26, s31, v26
    v_lshrrev_b32 v21, 6, v0
    v_lshlrev_b32 v21, 4, v21
    v_and_b32 v22, 3, v0
    v_lshl_add_u32 v21, v22, 2, v21
    v_bfe_u32 v22, v0, 5, 1
    v_lshl_add_u32 v21, v22, 1, v21
    v_mul_u32_u24 v27, 48, v21
    v_bfe_u32 v22, v0, 2, 3
    v_lshl_add_u32 v27, v22, 2, v27
    v_add_u32 v27, 57344, v27
    v_add_u32 v10, 48, v27
    s_sub_u32 s55, 0, s16
    s_and_b32 s55, s55, 0x1fffff
    s_add_u32 s55, s55, 134217728
    s_sub_u32 s31, s58, 20
    s_lshl_b32 s31, s31, 21
    s_add_u32 s60, s55, s31
    s_add_u32 s60, s60, 196608
    s_and_b32 s31, s58, 30
    s_lshl_b32 s31, s31, 13
    s_add_u32 s55, s55, s31
    s_and_b32 s31, s58, 1
    s_lshl_b32 s31, s31, 12
    s_add_u32 s55, s55, s31
    s_mov_b64 s[38:39], -1
    s_mov_b32 s42, 1040356334
    s_mov_b32 s30, 0
    s_mov_b32 s31, s59
    s_mul_i32 s31, s31, 10240
    s_add_u32 s48, s26, s31
    s_addc_u32 s49, s27, 0
    s_lshl_b32 s31, s58, 2
    s_add_u32 s31, s31, 117440512
    s_add_u32 s56, s16, s31
    s_addc_u32 s57, s17, 0
    s_mov_b32 s54, 0
    s_mov_b32 s40, 0
    v_mov_b32 v21, 0
    s_waitcnt vmcnt(0)
    v_readlane_b32 s31, v96, 16
    v_readlane_b32 s38, v96, 18
    v_and_b32 v96, 255, v96
    v_cmp_eq_u32 vcc, 64, v96
    s_and_b32 s54, vcc_lo, 589823
    s_cmp_ge_u32 s31, 64
    s_cbranch_scc1 rec_cwd
rec_cw:
    global_load_dword v20, v21, s[52:53] offset:64 sc1
    s_add_u32 s40, s40, 1
    s_waitcnt vmcnt(0)
    v_readfirstlane_b32 s31, v20
    s_cmp_ge_u32 s40, 16384
    s_cbranch_scc1 rec_cwd
    s_cmp_lt_u32 s31, 64
    s_cbranch_scc0 rec_cwd
    s_sleep 8
    s_branch rec_cw
rec_cwd:
    s_cmp_lg_u32 s5, 3
    s_cbranch_scc1 rec_loop
    s_lshr_b32 s31, s30, 2
    s_cmp_lt_u32 s30, 2
    s_cselect_b32 s31, 19, s31
    s_bitcmp1_b32 s54, s31
    s_cbranch_scc1 rec_kvokp
    s_mov_b32 s40, 0
    v_and_b32 v21, 31, v1
    v_lshlrev_b32 v21, 2, v21
rec_kvpp:
    global_load_dword v20, v21, s[52:53] sc1
    s_add_u32 s40, s40, 1
    s_waitcnt vmcnt(0)
    v_and_b32 v20, 255, v20
    v_cmp_eq_u32 vcc, 64, v20
    s_and_b32 s54, vcc_lo, 589823
    s_cmp_ge_u32 s40, 16384
    s_cbranch_scc1 rec_kvokp
    s_bitcmp1_b32 s54, s31
    s_cbranch_scc1 rec_kvokp
    s_sleep 8
    s_branch rec_kvpp
rec_kvokp:
    s_lshl_b32 s31, s30, 18
    s_lshl_b32 s41, s3, 12
    s_add_u32 s41, s31, s41
    s_add_u32 s62, s18, s41
    s_addc_u32 s63, s19, 0
    v_lshlrev_b32 v20, 4, v1
    v_add_u32 v21, 0x20000, v20
    s_mov_b32 m0, 24320
    s_nop 0
    global_load_lds_dwordx4 v20, s[62:63] offset:0 sc1
    global_load_lds_dwordx4 v20, s[62:63] offset:1024 sc1
    global_load_lds_dwordx4 v20, s[62:63] offset:2048 sc1
    global_load_lds_dwordx4 v20, s[62:63] offset:3072 sc1
    s_mov_b32 m0, 28416
    s_nop 0
    global_load_lds_dwordx4 v21, s[62:63] offset:0 sc1
    global_load_lds_dwordx4 v21, s[62:63] offset:1024 sc1
    global_load_lds_dwordx4 v21, s[62:63] offset:2048 sc1
    global_load_lds_dwordx4 v21, s[62:63] offset:3072 sc1
    s_lshl_b32 s41, s58, 11
    s_add_u32 s31, s31, s41
    s_add_u32 s62, s20, s31
    s_addc_u32 s63, s21, 0
    s_mov_b32 m0, 33024
    s_nop 0
    global_load_lds_dwordx4 v20, s[62:63] offset:0 sc1
    global_load_lds_dwordx4 v20, s[62:63] offset:1024 sc1
    s_waitcnt vmcnt(0)
    s_mov_b32 s40, 0
    v_mov_b32 v21, 0
    v_mov_b32 v20, s38
    s_cmp_ge_u32 s38, 65536
    s_cbranch_scc1 rec_c0q
rec_c0p:
    global_load_dword v20, v21, s[52:53] offset:72 sc1
    s_add_u32 s40, s40, 1
    s_waitcnt vmcnt(0)
    v_readfirstlane_b32 s31, v20
    s_cmp_ge_u32 s40, 16384
    s_cbranch_scc1 rec_c0q
    s_cmp_ge_u32 s31, 65536
    s_cbranch_scc1 rec_c0q
    s_sleep 8
    s_branch rec_c0p
rec_c0q:
    ds_write_b32 v21, v20 offset:17152
rec_loop:
    s_cmp_lg_u32 s30, 0
    s_cbranch_scc1 rec_poll
    v_and_b32 v20, 7, v0
    v_mul_u32_u24 v20, 1280, v20
    v_lshl_add_u32 v20, v3, 5, v20
    s_mul_i32 s31, s5, 5
    s_lshr_b32 s31, s31, 1
    s_lshl_b32 s31, s31, 7
    v_add_u32 v20, s31, v20
    global_load_dwordx4 v[72:75], v20, s[6:7] offset:0
    global_load_dwordx4 v[76:79], v20, s[6:7] offset:16
    global_load_dwordx4 v[80:83], v20, s[6:7] offset:128
    global_load_dwordx4 v[84:87], v20, s[6:7] offset:144
    global_load_dwordx4 v[88:91], v20, s[6:7] offset:256
    global_load_dwordx4 v[92:95], v20, s[6:7] offset:272
    v_mov_b32 v44, 0
    v_mov_b32 v45, 0
    v_mov_b32 v46, 0
    v_mov_b32 v47, 0
    v_mov_b32 v48, 0
    v_mov_b32 v49, 0
    v_mov_b32 v50, 0
    v_mov_b32 v51, 0
    v_mov_b32 v52, 0
    v_mov_b32 v53, 0
    v_mov_b32 v54, 0
    v_mov_b32 v55, 0
    v_mov_b32 v56, 0
    v_mov_b32 v57, 0
    v_mov_b32 v58, 0
    v_mov_b32 v59, 0
    v_mov_b32 v60, 0
    v_mov_b32 v61, 0
    v_mov_b32 v62, 0
    v_mov_b32 v63, 0
    v_mov_b32 v64, 0
    v_mov_b32 v65, 0
    v_mov_b32 v66, 0
    v_mov_b32 v67, 0
    s_waitcnt vmcnt(0)
    v_cndmask_b32 v28, v73, v72, s[32:33]
    v_cndmask_b32 v29, v75, v74, s[32:33]
    v_cndmask_b32 v30, v77, v76, s[32:33]
    v_cndmask_b32 v31, v79, v78, s[32:33]
    v_cndmask_b32 v32, v81, v80, s[32:33]
    v_cndmask_b32 v33, v83, v82, s[32:33]
    v_cndmask_b32 v34, v85, v84, s[32:33]
    v_cndmask_b32 v35, v87, v86, s[32:33]
    v_cndmask_b32 v36, v89, v88, s[32:33]
    v_cndmask_b32 v37, v91, v90, s[32:33]
    v_cndmask_b32 v38, v93, v92, s[32:33]
    v_cndmask_b32 v39, v95, v94, s[32:33]
    s_cmp_eq_u32 s5, 1
    s_cbranch_scc1 rec_gd1
    s_cmp_eq_u32 s5, 2
    s_cbranch_scc1 rec_gd2
    s_cmp_eq_u32 s5, 3
    s_cbranch_scc1 rec_gd3
    s_branch rec_gd0
rec_poll:
    s_mul_i32 s31, s30, 81920
    s_add_u32 s36, s48, s31
    s_addc_u32 s37, s49, 0
    s_mov_b32 s40, 0
    global_load_dwordx4 v[28:31], v5, s[36:37] offset:0 sc1
    global_load_dwordx4 v[32:35], v5, s[36:37] offset:1024 sc1
    global_load_dwordx4 v[36:39], v5, s[36:37] offset:2048 sc1
    v_mov_b32 v44, 0
    v_mov_b32 v45, 0
    v_mov_b32 v46, 0
    v_mov_b32 v47, 0
    v_mov_b32 v48, 0
    v_mov_b32 v49, 0
    v_mov_b32 v50, 0
    v_mov_b32 v51, 0
    v_mov_b32 v52, 0
    v_mov_b32 v53, 0
    v_mov_b32 v54, 0
    v_mov_b32 v55, 0
    v_mov_b32 v56, 0
    v_mov_b32 v57, 0
    v_mov_b32 v58, 0
    v_mov_b32 v59, 0
    v_mov_b32 v60, 0
    v_mov_b32 v61, 0
    v_mov_b32 v62, 0
    v_mov_b32 v63, 0
    v_mov_b32 v64, 0
    v_mov_b32 v65, 0
    v_mov_b32 v66, 0
    v_mov_b32 v67, 0
    s_cmp_eq_u32 s5, 1
    s_cbranch_scc1 rec_gp1
    s_cmp_eq_u32 s5, 2
    s_cbranch_scc1 rec_gp2
    s_cmp_eq_u32 s5, 3
    s_cbranch_scc1 rec_gp3
rec_gp0:
    s_add_u32 s40, s40, 1
    s_waitcnt vmcnt(0)
    v_max3_u32 v20, v28, v32, v36
    v_cmp_eq_u32 vcc, -1, v20
    s_cmp_ge_u32 s40, 16384
    s_cbranch_vccz rec_gd0
    s_cbranch_scc1 rec_gd0
    global_load_dwordx4 v[28:31], v5, s[36:37] offset:0 sc1
    global_load_dwordx4 v[32:35], v5, s[36:37] offset:1024 sc1
    global_load_dwordx4 v[36:39], v5, s[36:37] offset:2048 sc1
    s_branch rec_gp0
rec_gd0:
    ds_write_b128 v5, v[28:31] offset:0
    v_smfmac_f32_16x16x64_bf16 v[60:63], v[28:31], v[176:183], v7
    ds_write_b128 v5, v[32:35] offset:1024
    v_smfmac_f32_16x16x64_bf16 v[64:67], v[28:31], v[184:191], v7
    ds_write_b128 v5, v[36:39] offset:2048
    v_smfmac_f32_16x16x64_bf16 v[60:63], v[32:35], v[192:199], v7
    v_smfmac_f32_16x16x64_bf16 v[64:67], v[32:35], v[200:207], v7
    v_smfmac_f32_16x16x64_bf16 v[60:63], v[36:39], v[208:215], v7
    s_waitcnt lgkmcnt(0)
    s_barrier
    v_smfmac_f32_16x16x64_bf16 v[44:47], v[28:31], a[0:7], v7
    ds_read_b128 v[40:43], v4 offset:3072
    v_smfmac_f32_16x16x64_bf16 v[48:51], v[28:31], a[80:87], v7
    ds_read_b128 v[68:71], v4 offset:4096
    v_smfmac_f32_16x16x64_bf16 v[52:55], v[28:31], a[160:167], v7
    ds_read_b128 v[96:99], v4 offset:5120
    v_smfmac_f32_16x16x64_bf16 v[56:59], v[28:31], a[240:247], v7
    ds_read_b128 v[100:103], v4 offset:6144
    v_smfmac_f32_16x16x64_bf16 v[44:47], v[32:35], a[8:15], v7
    ds_read_b128 v[28:31], v4 offset:7168
    v_smfmac_f32_16x16x64_bf16 v[48:51], v[32:35], a[88:95], v7
    v_smfmac_f32_16x16x64_bf16 v[52:55], v[32:35], a[168:175], v7
    v_smfmac_f32_16x16x64_bf16 v[56:59], v[32:35], a[248:255], v7
    v_smfmac_f32_16x16x64_bf16 v[44:47], v[36:39], a[16:23], v7
    ds_read_b128 v[32:35], v4 offset:8192
    v_smfmac_f32_16x16x64_bf16 v[48:51], v[36:39], a[96:103], v7
    v_permlane32_swap_b32 v60, v64
    v_smfmac_f32_16x16x64_bf16 v[52:55], v[36:39], a[176:183], v7
    v_permlane32_swap_b32 v61, v65
    v_smfmac_f32_16x16x64_bf16 v[56:59], v[36:39], v[112:119], v7
    s_waitcnt lgkmcnt(5)
    v_permlane32_swap_b32 v62, v66
    v_smfmac_f32_16x16x64_bf16 v[44:47], v[40:43], a[24:31], v7
    ds_read_b128 v[36:39], v4 offset:9216
    v_permlane32_swap_b32 v63, v67
    v_smfmac_f32_16x16x64_bf16 v[48:51], v[40:43], a[104:111], v7
    ds_read_b128 v[72:75], v15 offset:0
    v_add_f32 v60, v60, v64
    v_smfmac_f32_16x16x64_bf16 v[52:55], v[40:43], a[184:191], v7
    ds_read_b128 v[76:79], v15 offset:1024
    v_add_f32 v61, v61, v65
    v_smfmac_f32_16x16x64_bf16 v[56:59], v[40:43], v[120:127], v7
    ds_read_b128 v[80:83], v15 offset:2048
    s_waitcnt lgkmcnt(8)
    v_add_f32 v62, v62, v66
    v_smfmac_f32_16x16x64_bf16 v[44:47], v[68:71], a[32:39], v7
    ds_read_b128 v[84:87], v15 offset:3072
    v_add_f32 v63, v63, v67
    v_smfmac_f32_16x16x64_bf16 v[48:51], v[68:71], a[112:119], v7
    ds_write_b128 v13, v[60:63]
    ds_read_b128 v[88:91], v15 offset:4096
    v_smfmac_f32_16x16x64_bf16 v[52:55], v[68:71], a[192:199], v7
    ds_read_b128 v[92:95], v15 offset:5120
    v_smfmac_f32_16x16x64_bf16 v[56:59], v[68:71], v[128:135], v7
    s_waitcnt lgkmcnt(11)
    v_smfmac_f32_16x16x64_bf16 v[44:47], v[96:99], a[40:47], v7
    v_smfmac_f32_16x16x64_bf16 v[48:51], v[96:99], a[120:127], v7
    v_smfmac_f32_16x16x64_bf16 v[52:55], v[96:99], a[200:207], v7
    v_smfmac_f32_16x16x64_bf16 v[56:59], v[96:99], v[136:143], v7
    s_waitcnt lgkmcnt(10)
    v_smfmac_f32_16x16x64_bf16 v[44:47], v[100:103], a[48:55], v7
    ds_read_b128 v[96:99], v15 offset:6144
    v_smfmac_f32_16x16x64_bf16 v[48:51], v[100:103], a[128:135], v7
    s_waitcnt lgkmcnt(10)
    v_smfmac_f32_16x16x64_bf16 v[44:47], v[28:31], a[56:63], v7
    s_lshl_b32 s31, s30, 2
    v_smfmac_f32_16x16x64_bf16 v[48:51], v[28:31], a[136:143], v7
    s_add_u32 s31, s31, s59
    s_waitcnt lgkmcnt(9)
    v_smfmac_f32_16x16x64_bf16 v[44:47], v[32:35], a[64:71], v7
    s_lshl_b32 s31, s31, 14
    v_smfmac_f32_16x16x64_bf16 v[48:51], v[32:35], a[144:151], v7
    s_add_u32 s46, s28, s31
    s_waitcnt lgkmcnt(8)
    v_smfmac_f32_16x16x64_bf16 v[44:47], v[36:39], a[72:79], v7
    s_addc_u32 s47, s29, 0
    v_smfmac_f32_16x16x64_bf16 v[48:51], v[36:39], a[152:159], v7
    s_lshl_b32 s31, s30, 16
    v_smfmac_f32_16x16x64_bf16 v[52:55], v[100:103], a[208:215], v7
    v_smfmac_f32_16x16x64_bf16 v[56:59], v[100:103], v[144:151], v7
    v_smfmac_f32_16x16x64_bf16 v[52:55], v[28:31], a[216:223], v7
    ds_read_b128 v[100:103], v15 offset:7168
    v_smfmac_f32_16x16x64_bf16 v[56:59], v[28:31], v[152:159], v7
    v_smfmac_f32_16x16x64_bf16 v[52:55], v[32:35], a[224:231], v7
    v_permlane32_swap_b32 v44, v48
    v_smfmac_f32_16x16x64_bf16 v[56:59], v[32:35], v[160:167], v7
    v_permlane32_swap_b32 v45, v49
    v_smfmac_f32_16x16x64_bf16 v[52:55], v[36:39], a[232:239], v7
    v_permlane32_swap_b32 v46, v50
    v_smfmac_f32_16x16x64_bf16 v[56:59], v[36:39], v[168:175], v7
    v_permlane32_swap_b32 v47, v51
    v_add_f32 v44, v44, v48
    v_add_f32 v45, v45, v49
    v_add_f32 v46, v46, v50
    v_add_f32 v47, v47, v51
    v_cvt_pk_bf16_f32 v44, v44, v45
    v_cvt_pk_bf16_f32 v45, v46, v47
    v_mov_b32 v20, 0
    v_permlane32_swap_b32 v52, v56
    v_permlane32_swap_b32 v53, v57
    v_permlane32_swap_b32 v54, v58
    v_permlane32_swap_b32 v55, v59
    v_pk_add_f32 v[52:53], v[52:53], v[56:57]
    v_pk_add_f32 v[54:55], v[54:55], v[58:59]
    v_cvt_pk_bf16_f32 v52, v52, v53
    v_cvt_pk_bf16_f32 v53, v54, v55
    ds_write2st64_b64 v11, v[44:45], v[52:53] offset1:4
    s_waitcnt lgkmcnt(0)
    s_barrier
    s_branch rec_sm0
rec_gp1:
    s_add_u32 s40, s40, 1
    s_waitcnt vmcnt(0)
    v_max3_u32 v20, v28, v32, v36
    v_cmp_eq_u32 vcc, -1, v20
    s_cmp_ge_u32 s40, 16384
    s_cbranch_vccz rec_gd1
    s_cbranch_scc1 rec_gd1
    global_load_dwordx4 v[28:31], v5, s[36:37] offset:0 sc1
    global_load_dwordx4 v[32:35], v5, s[36:37] offset:1024 sc1
    global_load_dwordx4 v[36:39], v5, s[36:37] offset:2048 sc1
    s_branch rec_gp1
rec_gd1:
    ds_write_b128 v5, v[32:35] offset:1024
    v_smfmac_f32_16x16x64_bf16 v[64:67], v[28:31], v[176:183], v7
    ds_write_b128 v5, v[36:39] offset:2048
    v_smfmac_f32_16x16x64_bf16 v[60:63], v[32:35], v[184:191], v7
    v_smfmac_f32_16x16x64_bf16 v[64:67], v[32:35], v[192:199], v7
    v_smfmac_f32_16x16x64_bf16 v[60:63], v[36:39], v[200:207], v7
    v_smfmac_f32_16x16x64_bf16 v[64:67], v[36:39], v[208:215], v7
    s_waitcnt lgkmcnt(0)
    s_barrier
    v_smfmac_f32_16x16x64_bf16 v[44:47], v[28:31], a[16:23], v7
    ds_read_b128 v[40:43], v4 offset:0
    v_smfmac_f32_16x16x64_bf16 v[48:51], v[28:31], a[96:103], v7
    ds_read_b128 v[68:71], v4 offset:1024
    v_smfmac_f32_16x16x64_bf16 v[52:55], v[28:31], a[176:183], v7
    ds_read_b128 v[96:99], v4 offset:5120
    v_smfmac_f32_16x16x64_bf16 v[56:59], v[28:31], v[112:119], v7
    ds_read_b128 v[100:103], v4 offset:6144
    v_smfmac_f32_16x16x64_bf16 v[44:47], v[32:35], a[24:31], v7
    ds_read_b128 v[28:31], v4 offset:7168
    v_smfmac_f32_16x16x64_bf16 v[48:51], v[32:35], a[104:111], v7
    v_smfmac_f32_16x16x64_bf16 v[52:55], v[32:35], a[184:191], v7
    v_smfmac_f32_16x16x64_bf16 v[56:59], v[32:35], v[120:127], v7
    v_smfmac_f32_16x16x64_bf16 v[44:47], v[36:39], a[32:39], v7
    ds_read_b128 v[32:35], v4 offset:8192
    v_smfmac_f32_16x16x64_bf16 v[48:51], v[36:39], a[112:119], v7
    v_permlane32_swap_b32 v60, v64
    v_smfmac_f32_16x16x64_bf16 v[52:55], v[36:39], a[192:199], v7
    v_permlane32_swap_b32 v61, v65
    v_smfmac_f32_16x16x64_bf16 v[56:59], v[36:39], v[128:135], v7
    s_waitcnt lgkmcnt(5)
    v_permlane32_swap_b32 v62, v66
    v_smfmac_f32_16x16x64_bf16 v[44:47], v[40:43], a[0:7], v7
    ds_read_b128 v[36:39], v4 offset:9216
    v_permlane32_swap_b32 v63, v67
    v_smfmac_f32_16x16x64_bf16 v[48:51], v[40:43], a[80:87], v7
    v_add_f32 v60, v60, v64
    v_smfmac_f32_16x16x64_bf16 v[52:55], v[40:43], a[160:167], v7
    v_add_f32 v61, v61, v65
    v_smfmac_f32_16x16x64_bf16 v[56:59], v[40:43], a[240:247], v7
    s_waitcnt lgkmcnt(5)
    v_add_f32 v62, v62, v66
    v_smfmac_f32_16x16x64_bf16 v[44:47], v[68:71], a[8:15], v7
    v_add_f32 v63, v63, v67
    v_smfmac_f32_16x16x64_bf16 v[48:51], v[68:71], a[88:95], v7
    v_smfmac_f32_16x16x64_bf16 v[52:55], v[68:71], a[168:175], v7
    v_smfmac_f32_16x16x64_bf16 v[56:59], v[68:71], a[248:255], v7
    ds_write_b128 v13, v[60:63]
    s_waitcnt lgkmcnt(5)
    v_smfmac_f32_16x16x64_bf16 v[44:47], v[96:99], a[40:47], v7
    v_smfmac_f32_16x16x64_bf16 v[48:51], v[96:99], a[120:127], v7
    v_smfmac_f32_16x16x64_bf16 v[52:55], v[96:99], a[200:207], v7
    v_smfmac_f32_16x16x64_bf16 v[56:59], v[96:99], v[136:143], v7
    s_waitcnt lgkmcnt(4)
    v_smfmac_f32_16x16x64_bf16 v[44:47], v[100:103], a[48:55], v7
    v_smfmac_f32_16x16x64_bf16 v[48:51], v[100:103], a[128:135], v7
    s_waitcnt lgkmcnt(3)
    v_smfmac_f32_16x16x64_bf16 v[44:47], v[28:31], a[56:63], v7
    s_lshl_b32 s31, s30, 2
    v_smfmac_f32_16x16x64_bf16 v[48:51], v[28:31], a[136:143], v7
    s_add_u32 s31, s31, s59
    s_waitcnt lgkmcnt(2)
    v_smfmac_f32_16x16x64_bf16 v[44:47], v[32:35], a[64:71], v7
    s_lshl_b32 s31, s31, 14
    v_smfmac_f32_16x16x64_bf16 v[48:51], v[32:35], a[144:151], v7
    s_add_u32 s46, s28, s31
    s_waitcnt lgkmcnt(1)
    v_smfmac_f32_16x16x64_bf16 v[44:47], v[36:39], a[72:79], v7
    s_addc_u32 s47, s29, 0
    v_smfmac_f32_16x16x64_bf16 v[48:51], v[36:39], a[152:159], v7
    s_lshl_b32 s31, s30, 16
    v_smfmac_f32_16x16x64_bf16 v[52:55], v[100:103], a[208:215], v7
    v_smfmac_f32_16x16x64_bf16 v[56:59], v[100:103], v[144:151], v7
    v_smfmac_f32_16x16x64_bf16 v[52:55], v[28:31], a[216:223], v7
    v_smfmac_f32_16x16x64_bf16 v[56:59], v[28:31], v[152:159], v7
    v_smfmac_f32_16x16x64_bf16 v[52:55], v[32:35], a[224:231], v7
    v_permlane32_swap_b32 v44, v48
    v_smfmac_f32_16x16x64_bf16 v[56:59], v[32:35], v[160:167], v7
    v_permlane32_swap_b32 v45, v49
    v_smfmac_f32_16x16x64_bf16 v[52:55], v[36:39], a[232:239], v7
    v_permlane32_swap_b32 v46, v50
    v_smfmac_f32_16x16x64_bf16 v[56:59], v[36:39], v[168:175], v7
    v_permlane32_swap_b32 v47, v51
    v_add_f32 v44, v44, v48
    v_add_f32 v45, v45, v49
    v_add_f32 v46, v46, v50
    v_add_f32 v47, v47, v51
    v_cvt_pk_bf16_f32 v44, v44, v45
    v_cvt_pk_bf16_f32 v45, v46, v47
    v_mov_b32 v20, 0
    v_permlane32_swap_b32 v52, v56
    v_permlane32_swap_b32 v53, v57
    v_permlane32_swap_b32 v54, v58
    v_permlane32_swap_b32 v55, v59
    v_pk_add_f32 v[52:53], v[52:53], v[56:57]
    v_pk_add_f32 v[54:55], v[54:55], v[58:59]
    v_cvt_pk_bf16_f32 v52, v52, v53
    v_cvt_pk_bf16_f32 v53, v54, v55
    ds_write2st64_b64 v11, v[44:45], v[52:53] offset1:4
    s_waitcnt lgkmcnt(0)
    s_barrier
    s_branch rec_sm1
rec_gp2:
    s_add_u32 s40, s40, 1
    s_waitcnt vmcnt(0)
    v_max3_u32 v20, v28, v32, v36
    v_cmp_eq_u32 vcc, -1, v20
    s_cmp_ge_u32 s40, 16384
    s_cbranch_vccz rec_gd2
    s_cbranch_scc1 rec_gd2
    global_load_dwordx4 v[28:31], v5, s[36:37] offset:0 sc1
    global_load_dwordx4 v[32:35], v5, s[36:37] offset:1024 sc1
    global_load_dwordx4 v[36:39], v5, s[36:37] offset:2048 sc1
    s_branch rec_gp2
rec_gd2:
    ds_write_b128 v5, v[28:31] offset:0
    v_smfmac_f32_16x16x64_bf16 v[60:63], v[28:31], v[176:183], v7
    ds_write_b128 v5, v[32:35] offset:1024
    v_smfmac_f32_16x16x64_bf16 v[64:67], v[28:31], v[184:191], v7
    ds_write_b128 v5, v[36:39] offset:2048
    v_smfmac_f32_16x16x64_bf16 v[60:63], v[32:35], v[192:199], v7
    v_smfmac_f32_16x16x64_bf16 v[64:67], v[32:35], v[200:207], v7
    v_smfmac_f32_16x16x64_bf16 v[60:63], v[36:39], v[208:215], v7
    s_waitcnt lgkmcnt(0)
    s_barrier
    v_smfmac_f32_16x16x64_bf16 v[44:47], v[28:31], a[40:47], v7
    ds_read_b128 v[40:43], v4 offset:0
    v_smfmac_f32_16x16x64_bf16 v[48:51], v[28:31], a[120:127], v7
    ds_read_b128 v[68:71], v4 offset:1024
    v_smfmac_f32_16x16x64_bf16 v[52:55], v[28:31], a[200:207], v7
    ds_read_b128 v[96:99], v4 offset:2048
    v_smfmac_f32_16x16x64_bf16 v[56:59], v[28:31], v[136:143], v7
    ds_read_b128 v[100:103], v4 offset:3072
    v_smfmac_f32_16x16x64_bf16 v[44:47], v[32:35], a[48:55], v7
    ds_read_b128 v[28:31], v4 offset:4096
    v_smfmac_f32_16x16x64_bf16 v[48:51], v[32:35], a[128:135], v7
    v_smfmac_f32_16x16x64_bf16 v[52:55], v[32:35], a[208:215], v7
    v_smfmac_f32_16x16x64_bf16 v[56:59], v[32:35], v[144:151], v7
    v_smfmac_f32_16x16x64_bf16 v[44:47], v[36:39], a[56:63], v7
    ds_read_b128 v[32:35], v4 offset:8192
    v_smfmac_f32_16x16x64_bf16 v[48:51], v[36:39], a[136:143], v7
    v_permlane32_swap_b32 v60, v64
    v_smfmac_f32_16x16x64_bf16 v[52:55], v[36:39], a[216:223], v7
    v_permlane32_swap_b32 v61, v65
    v_smfmac_f32_16x16x64_bf16 v[56:59], v[36:39], v[152:159], v7
    s_waitcnt lgkmcnt(5)
    v_permlane32_swap_b32 v62, v66
    v_smfmac_f32_16x16x64_bf16 v[44:47], v[40:43], a[0:7], v7
    ds_read_b128 v[36:39], v4 offset:9216
    v_permlane32_swap_b32 v63, v67
    v_smfmac_f32_16x16x64_bf16 v[48:51], v[40:43], a[80:87], v7
    v_add_f32 v60, v60, v64
    v_smfmac_f32_16x16x64_bf16 v[52:55], v[40:43], a[160:167], v7
    v_add_f32 v61, v61, v65
    v_smfmac_f32_16x16x64_bf16 v[56:59], v[40:43], a[240:247], v7
    s_waitcnt lgkmcnt(5)
    v_add_f32 v62, v62, v66
    v_smfmac_f32_16x16x64_bf16 v[44:47], v[68:71], a[8:15], v7
    v_add_f32 v63, v63, v67
    v_smfmac_f32_16x16x64_bf16 v[48:51], v[68:71], a[88:95], v7
    v_smfmac_f32_16x16x64_bf16 v[52:55], v[68:71], a[168:175], v7
    v_smfmac_f32_16x16x64_bf16 v[56:59], v[68:71], a[248:255], v7
    s_waitcnt lgkmcnt(4)
    v_smfmac_f32_16x16x64_bf16 v[44:47], v[96:99], a[16:23], v7
    v_smfmac_f32_16x16x64_bf16 v[48:51], v[96:99], a[96:103], v7
    ds_write_b128 v13, v[60:63]
    v_smfmac_f32_16x16x64_bf16 v[52:55], v[96:99], a[176:183], v7
    v_smfmac_f32_16x16x64_bf16 v[56:59], v[96:99], v[112:119], v7
    s_waitcnt lgkmcnt(4)
    v_smfmac_f32_16x16x64_bf16 v[44:47], v[100:103], a[24:31], v7
    v_smfmac_f32_16x16x64_bf16 v[48:51], v[100:103], a[104:111], v7
    s_waitcnt lgkmcnt(3)
    v_smfmac_f32_16x16x64_bf16 v[44:47], v[28:31], a[32:39], v7
    s_lshl_b32 s31, s30, 2
    v_smfmac_f32_16x16x64_bf16 v[48:51], v[28:31], a[112:119], v7
    s_add_u32 s31, s31, s59
    s_waitcnt lgkmcnt(2)
    v_smfmac_f32_16x16x64_bf16 v[44:47], v[32:35], a[64:71], v7
    s_lshl_b32 s31, s31, 14
    v_smfmac_f32_16x16x64_bf16 v[48:51], v[32:35], a[144:151], v7
    s_add_u32 s46, s28, s31
    s_waitcnt lgkmcnt(1)
    v_smfmac_f32_16x16x64_bf16 v[44:47], v[36:39], a[72:79], v7
    s_addc_u32 s47, s29, 0
    v_smfmac_f32_16x16x64_bf16 v[48:51], v[36:39], a[152:159], v7
    s_lshl_b32 s31, s30, 16
    v_smfmac_f32_16x16x64_bf16 v[52:55], v[100:103], a[184:191], v7
    v_smfmac_f32_16x16x64_bf16 v[56:59], v[100:103], v[120:127], v7
    v_smfmac_f32_16x16x64_bf16 v[52:55], v[28:31], a[192:199], v7
    v_smfmac_f32_16x16x64_bf16 v[56:59], v[28:31], v[128:135], v7
    v_smfmac_f32_16x16x64_bf16 v[52:55], v[32:35], a[224:231], v7
    v_permlane32_swap_b32 v44, v48
    v_smfmac_f32_16x16x64_bf16 v[56:59], v[32:35], v[160:167], v7
    v_permlane32_swap_b32 v45, v49
    v_smfmac_f32_16x16x64_bf16 v[52:55], v[36:39], a[232:239], v7
    v_permlane32_swap_b32 v46, v50
    v_smfmac_f32_16x16x64_bf16 v[56:59], v[36:39], v[168:175], v7
    v_permlane32_swap_b32 v47, v51
    v_add_f32 v44, v44, v48
    v_add_f32 v45, v45, v49
    v_add_f32 v46, v46, v50
    v_add_f32 v47, v47, v51
    v_cvt_pk_bf16_f32 v44, v44, v45
    v_cvt_pk_bf16_f32 v45, v46, v47
    v_mov_b32 v20, 0
    v_permlane32_swap_b32 v52, v56
    v_permlane32_swap_b32 v53, v57
    v_permlane32_swap_b32 v54, v58
    v_permlane32_swap_b32 v55, v59
    v_pk_add_f32 v[52:53], v[52:53], v[56:57]
    v_pk_add_f32 v[54:55], v[54:55], v[58:59]
    v_cvt_pk_bf16_f32 v52, v52, v53
    v_cvt_pk_bf16_f32 v53, v54, v55
    ds_write2st64_b64 v11, v[44:45], v[52:53] offset1:4
    s_waitcnt lgkmcnt(0)
    s_barrier
    s_branch rec_sm2
rec_gp3:
    s_add_u32 s40, s40, 1
    s_waitcnt vmcnt(0)
    v_max3_u32 v20, v28, v32, v36
    v_cmp_eq_u32 vcc, -1, v20
    s_cmp_ge_u32 s40, 16384
    s_cbranch_vccz rec_gd3
    s_cbranch_scc1 rec_gd3
    global_load_dwordx4 v[28:31], v5, s[36:37] offset:0 sc1
    global_load_dwordx4 v[32:35], v5, s[36:37] offset:1024 sc1
    global_load_dwordx4 v[36:39], v5, s[36:37] offset:2048 sc1
    s_branch rec_gp3
rec_gd3:
    ds_write_b128 v5, v[32:35] offset:1024
    v_smfmac_f32_16x16x64_bf16 v[64:67], v[28:31], v[176:183], v7
    ds_write_b128 v5, v[36:39] offset:2048
    v_smfmac_f32_16x16x64_bf16 v[60:63], v[32:35], v[184:191], v7
    v_smfmac_f32_16x16x64_bf16 v[64:67], v[32:35], v[192:199], v7
    v_smfmac_f32_16x16x64_bf16 v[60:63], v[36:39], v[200:207], v7
    v_smfmac_f32_16x16x64_bf16 v[64:67], v[36:39], v[208:215], v7
    s_waitcnt lgkmcnt(0)
    s_barrier
    v_smfmac_f32_16x16x64_bf16 v[44:47], v[28:31], a[56:63], v7
    ds_read_b128 v[40:43], v4 offset:0
    v_smfmac_f32_16x16x64_bf16 v[48:51], v[28:31], a[136:143], v7
    ds_read_b128 v[68:71], v4 offset:1024
    v_smfmac_f32_16x16x64_bf16 v[52:55], v[28:31], a[216:223], v7
    ds_read_b128 v[96:99], v4 offset:2048
    v_smfmac_f32_16x16x64_bf16 v[56:59], v[28:31], v[152:159], v7
    ds_read_b128 v[100:103], v4 offset:3072
    v_smfmac_f32_16x16x64_bf16 v[44:47], v[32:35], a[64:71], v7
    ds_read_b128 v[28:31], v4 offset:4096
    v_smfmac_f32_16x16x64_bf16 v[48:51], v[32:35], a[144:151], v7
    v_smfmac_f32_16x16x64_bf16 v[52:55], v[32:35], a[224:231], v7
    v_smfmac_f32_16x16x64_bf16 v[56:59], v[32:35], v[160:167], v7
    v_smfmac_f32_16x16x64_bf16 v[44:47], v[36:39], a[72:79], v7
    ds_read_b128 v[32:35], v4 offset:5120
    v_smfmac_f32_16x16x64_bf16 v[48:51], v[36:39], a[152:159], v7
    v_permlane32_swap_b32 v60, v64
    v_smfmac_f32_16x16x64_bf16 v[52:55], v[36:39], a[232:239], v7
    v_permlane32_swap_b32 v61, v65
    v_smfmac_f32_16x16x64_bf16 v[56:59], v[36:39], v[168:175], v7
    s_waitcnt lgkmcnt(5)
    v_permlane32_swap_b32 v62, v66
    v_smfmac_f32_16x16x64_bf16 v[44:47], v[40:43], a[0:7], v7
    ds_read_b128 v[36:39], v4 offset:6144
    v_permlane32_swap_b32 v63, v67
    v_smfmac_f32_16x16x64_bf16 v[48:51], v[40:43], a[80:87], v7
    v_add_f32 v60, v60, v64
    v_smfmac_f32_16x16x64_bf16 v[52:55], v[40:43], a[160:167], v7
    v_add_f32 v61, v61, v65
    v_smfmac_f32_16x16x64_bf16 v[56:59], v[40:43], a[240:247], v7
    s_waitcnt lgkmcnt(5)
    v_add_f32 v62, v62, v66
    v_smfmac_f32_16x16x64_bf16 v[44:47], v[68:71], a[8:15], v7
    v_add_f32 v63, v63, v67
    v_smfmac_f32_16x16x64_bf16 v[48:51], v[68:71], a[88:95], v7
    v_smfmac_f32_16x16x64_bf16 v[52:55], v[68:71], a[168:175], v7
    v_smfmac_f32_16x16x64_bf16 v[56:59], v[68:71], a[248:255], v7
    s_waitcnt lgkmcnt(4)
    v_smfmac_f32_16x16x64_bf16 v[44:47], v[96:99], a[16:23], v7
    v_smfmac_f32_16x16x64_bf16 v[48:51], v[96:99], a[96:103], v7
    v_smfmac_f32_16x16x64_bf16 v[52:55], v[96:99], a[176:183], v7
    v_smfmac_f32_16x16x64_bf16 v[56:59], v[96:99], v[112:119], v7
    ds_write_b128 v13, v[60:63]
    s_waitcnt lgkmcnt(4)
    v_smfmac_f32_16x16x64_bf16 v[44:47], v[100:103], a[24:31], v7
    v_smfmac_f32_16x16x64_bf16 v[48:51], v[100:103], a[104:111], v7
    s_waitcnt lgkmcnt(3)
    v_smfmac_f32_16x16x64_bf16 v[44:47], v[28:31], a[32:39], v7
    s_lshl_b32 s31, s30, 2
    v_smfmac_f32_16x16x64_bf16 v[48:51], v[28:31], a[112:119], v7
    s_add_u32 s31, s31, s59
    s_waitcnt lgkmcnt(2)
    v_smfmac_f32_16x16x64_bf16 v[44:47], v[32:35], a[40:47], v7
    s_lshl_b32 s31, s31, 14
    v_smfmac_f32_16x16x64_bf16 v[48:51], v[32:35], a[120:127], v7
    s_add_u32 s46, s28, s31
    s_waitcnt lgkmcnt(1)
    v_smfmac_f32_16x16x64_bf16 v[44:47], v[36:39], a[48:55], v7
    s_addc_u32 s47, s29, 0
    v_smfmac_f32_16x16x64_bf16 v[48:51], v[36:39], a[128:135], v7
    s_lshl_b32 s31, s30, 16
    v_smfmac_f32_16x16x64_bf16 v[52:55], v[100:103], a[184:191], v7
    v_smfmac_f32_16x16x64_bf16 v[56:59], v[100:103], v[120:127], v7
    v_smfmac_f32_16x16x64_bf16 v[52:55], v[28:31], a[192:199], v7
    v_smfmac_f32_16x16x64_bf16 v[56:59], v[28:31], v[128:135], v7
    v_smfmac_f32_16x16x64_bf16 v[52:55], v[32:35], a[200:207], v7
    v_permlane32_swap_b32 v44, v48
    v_smfmac_f32_16x16x64_bf16 v[56:59], v[32:35], v[136:143], v7
    v_permlane32_swap_b32 v45, v49
    v_smfmac_f32_16x16x64_bf16 v[52:55], v[36:39], a[208:215], v7
    v_permlane32_swap_b32 v46, v50
    v_smfmac_f32_16x16x64_bf16 v[56:59], v[36:39], v[144:151], v7
    v_permlane32_swap_b32 v47, v51
    v_add_f32 v44, v44, v48
    v_add_f32 v45, v45, v49
    v_add_f32 v46, v46, v50
    v_add_f32 v47, v47, v51
    v_cvt_pk_bf16_f32 v44, v44, v45
    v_cvt_pk_bf16_f32 v45, v46, v47
    v_mov_b32 v20, 0
    v_permlane32_swap_b32 v52, v56
    v_permlane32_swap_b32 v53, v57
    v_permlane32_swap_b32 v54, v58
    v_permlane32_swap_b32 v55, v59
    v_pk_add_f32 v[52:53], v[52:53], v[56:57]
    v_pk_add_f32 v[54:55], v[54:55], v[58:59]
    v_cvt_pk_bf16_f32 v52, v52, v53
    v_cvt_pk_bf16_f32 v53, v54, v55
    ds_write2st64_b64 v11, v[44:45], v[52:53] offset1:4
    s_waitcnt lgkmcnt(0)
    s_barrier
    s_branch rec_sm3
rec_sm1:
    ds_read_b64_tr_b16 v[28:29], v9
    ds_read_b64_tr_b16 v[30:31], v9 offset:256
    s_add_u32 s36, s22, s31
    s_addc_u32 s37, s23, 0
    s_mov_b64 exec, s[32:33]
    s_waitcnt lgkmcnt(0)
    global_store_dwordx4 v17, v[28:31], s[36:37] sc1
    s_mov_b64 exec, -1
    s_branch rec_smj
rec_sm3:
    v_mov_b32 v20, s30
    v_mov_b32 v21, 0
    s_mov_b64 exec, 1
    global_store_dword v21, v20, s[56:57] sc1
    s_mov_b64 exec, -1
    s_branch rec_smj
rec_sm2:
    ds_read_b128 v[28:31], v14 offset:0
    ds_read_b128 v[32:35], v14 offset:1024
    ds_read_b128 v[36:39], v14 offset:2048
    ds_read_b128 v[40:43], v14 offset:3072
    s_add_u32 s36, s24, s31
    s_addc_u32 s37, s25, 0
    s_waitcnt lgkmcnt(0)
    v_pk_add_f32 v[28:29], v[28:29], v[32:33]
    v_pk_add_f32 v[36:37], v[36:37], v[40:41]
    v_pk_add_f32 v[30:31], v[30:31], v[34:35]
    v_pk_add_f32 v[38:39], v[38:39], v[42:43]
    v_pk_add_f32 v[28:29], v[28:29], v[36:37]
    v_pk_add_f32 v[30:31], v[30:31], v[38:39]
    v_cvt_pk_bf16_f32 v32, v28, v29
    v_cvt_pk_bf16_f32 v33, v30, v31
    global_store_dwordx2 v18, v[32:33], s[36:37] sc1
rec_smj:
    s_cmp_ge_u32 s30, 63
    s_cbranch_scc1 rec_fin
    s_sleep 10
    s_branch rec_smp
rec_sm0:
    s_cmp_ge_u32 s30, 63
    s_cbranch_scc1 rec_fin
    ds_read_b64_tr_b16 v[28:29], v12 offset:0
    ds_read_b64_tr_b16 v[30:31], v12 offset:256
    ds_read_b64_tr_b16 v[32:33], v12 offset:512
    ds_read_b64_tr_b16 v[34:35], v12 offset:768
    ds_read_b64_tr_b16 v[36:37], v12 offset:1024
    ds_read_b64_tr_b16 v[38:39], v12 offset:1280
    ds_read_b64_tr_b16 v[40:41], v12 offset:1536
    ds_read_b64_tr_b16 v[42:43], v12 offset:1792
    s_waitcnt lgkmcnt(6)
    v_mfma_f32_16x16x32_bf16 v[64:67], v[72:75], v[28:31], 0
    ds_read_b64_tr_b16 v[44:45], v12 offset:2048
    v_mfma_f32_16x16x32_bf16 v[68:71], v[88:91], v[28:31], 0
    ds_read_b64_tr_b16 v[46:47], v12 offset:2304
    s_waitcnt lgkmcnt(6)
    v_mfma_f32_16x16x32_bf16 v[64:67], v[76:79], v[32:35], v[64:67]
    ds_read_b64_tr_b16 v[48:49], v12 offset:2560
    v_mfma_f32_16x16x32_bf16 v[68:71], v[92:95], v[32:35], v[68:71]
    ds_read_b64_tr_b16 v[50:51], v12 offset:2816
    s_waitcnt lgkmcnt(6)
    v_mfma_f32_16x16x32_bf16 v[64:67], v[80:83], v[36:39], v[64:67]
    ds_read_b64_tr_b16 v[52:53], v12 offset:3072
    v_mfma_f32_16x16x32_bf16 v[68:71], v[96:99], v[36:39], v[68:71]
    ds_read_b64_tr_b16 v[54:55], v12 offset:3328
    s_waitcnt lgkmcnt(6)
    v_mfma_f32_16x16x32_bf16 v[64:67], v[84:87], v[40:43], v[64:67]
    ds_read_b64_tr_b16 v[56:57], v12 offset:3584
    v_mfma_f32_16x16x32_bf16 v[68:71], v[100:103], v[40:43], v[68:71]
    ds_read_b64_tr_b16 v[58:59], v12 offset:3840
    s_waitcnt lgkmcnt(6)
    v_mfma_f32_16x16x32_bf16 v[60:63], v[44:47], v[28:31], 0
    ds_read_b128 v[88:91], v14 offset:0
    ds_read_b128 v[92:95], v14 offset:1024
    s_waitcnt lgkmcnt(6)
    v_mfma_f32_16x16x32_bf16 v[60:63], v[48:51], v[32:35], v[60:63]
    ds_read_b128 v[96:99], v14 offset:2048
    ds_read_b128 v[100:103], v14 offset:3072
    s_waitcnt lgkmcnt(6)
    v_mfma_f32_16x16x32_bf16 v[60:63], v[52:55], v[36:39], v[60:63]
    ds_read_b128 v[80:83], v16 offset:0
    ds_read_b128 v[84:87], v16 offset:1024
    s_waitcnt lgkmcnt(6)
    v_cndmask_b32 v64, v68, v64, s[32:33]
    v_cndmask_b32 v65, v69, v65, s[32:33]
    v_mfma_f32_16x16x32_bf16 v[60:63], v[56:59], v[40:43], v[60:63]
    s_waitcnt lgkmcnt(4)
    v_cndmask_b32 v66, v70, v66, s[32:33]
    v_cndmask_b32 v67, v71, v67, s[32:33]
    v_max3_f32 v20, v64, v65, v66
    v_max_f32 v20, v20, v67
    v_mov_b32 v33, 0
    v_pk_add_f32 v[88:89], v[88:89], v[92:93]
    v_max_f32_dpp v20, v20, v20 row_ror:8 row_mask:0xf bank_mask:0xf
    v_mov_b32 v21, v20
    v_max3_f32 v22, v60, v61, v62
    v_max_f32 v22, v22, v63
    v_permlane32_swap_b32 v20, v21
    v_max3_f32 v20, v20, v21, v22
    v_mov_b32 v21, v20
    v_cndmask_b32 v68, v61, v60, s[32:33]
    v_cndmask_b32 v69, v63, v62, s[32:33]
    v_permlane16_swap_b32 v20, v21
    v_max_f32 v20, v20, v21
    v_mul_f32 v20, s42, v20
    v_cndmask_b32 v68, v69, v68, s[34:35]
    v_fma_f32 v64, v64, s42, -v20
    v_fma_f32 v65, v65, s42, -v20
    v_fma_f32 v66, v66, s42, -v20
    v_fma_f32 v67, v67, s42, -v20
    v_fma_f32 v68, v68, s42, -v20
    s_waitcnt lgkmcnt(0)
    v_exp_f32 v64, v64
    v_exp_f32 v65, v65
    v_exp_f32 v66, v66
    v_exp_f32 v67, v67
    v_exp_f32 v68, v68
    v_add_f32 v20, v64, v65
    v_add_f32 v21, v66, v67
    v_add_f32 v20, v20, v21
    v_add_f32 v20, v20, v68
    v_pk_add_f32 v[90:91], v[90:91], v[94:95]
    v_pk_add_f32 v[96:97], v[96:97], v[100:101]
    v_add_f32_dpp v20, v20, v20 row_ror:8 row_mask:0xf bank_mask:0xf
    v_mov_b32 v21, v20
    v_pk_add_f32 v[98:99], v[98:99], v[102:103]
    v_pk_add_f32 v[88:89], v[88:89], v[96:97]
    v_permlane16_swap_b32 v20, v21
    v_add_f32 v20, v20, v21
    v_mov_b32 v21, v20
    v_pk_add_f32 v[90:91], v[90:91], v[98:99]
    v_cvt_pk_bf16_f32 v6, v88, v89
    v_permlane32_swap_b32 v20, v21
    v_add_f32 v20, v20, v21
    v_rcp_f32 v20, v20
    v_cvt_pk_bf16_f32 v8, v90, v91
    v_mul_f32 v68, v68, v20
    v_mul_f32 v64, v64, v20
    v_permlane32_swap_b32 v6, v8
    v_mul_f32 v65, v65, v20
    v_mov_b32_dpp v69, v68 row_ror:8 row_mask:0xf bank_mask:0xf
    v_cvt_pk_bf16_f32 v28, v64, v65
    v_cvt_pk_bf16_f32 v32, v68, v69
    v_mul_f32 v66, v66, v20
    v_mul_f32 v67, v67, v20
    v_mfma_f32_16x16x16_bf16 v[44:47], v[6:7], v[32:33], 0
    v_cvt_pk_bf16_f32 v29, v66, v67
    v_mfma_f32_16x16x16_bf16 v[48:51], v[8:9], v[32:33], 0
    v_mov_b32_dpp v30, v28 row_ror:8 row_mask:0xf bank_mask:0xf
    v_mov_b32_dpp v31, v29 row_ror:8 row_mask:0xf bank_mask:0xf
    s_nop 1
    v_mfma_f32_16x16x32_bf16 v[44:47], v[80:83], v[28:31], v[44:47]
    v_mfma_f32_16x16x32_bf16 v[48:51], v[84:87], v[28:31], v[48:51]
    s_mov_b64 exec, s[32:33]
    s_nop 5
    v_cvt_pk_bf16_f32 v76, v44, v45
    v_cvt_pk_bf16_f32 v77, v46, v47
    v_cvt_pk_bf16_f32 v78, v48, v49
    v_cvt_pk_bf16_f32 v79, v50, v51
    s_mov_b64 exec, s[32:33]
    global_store_dwordx4 v19, v[76:79], s[46:47]
    s_mov_b64 exec, -1
rec_smp:
    s_and_b32 s43, s58, 31
    s_cmp_ge_u32 s43, 20
    s_cbranch_scc1 rec_xno
    ds_read_b128 v[80:83], v24 offset:0
    ds_read_b128 v[84:87], v24 offset:1024
    ds_read_b128 v[88:91], v24 offset:2048
    ds_read_b128 v[92:95], v24 offset:3072
    v_mov_b32 v20, 0
    ds_read_b32 v21, v20 offset:17152
    s_lshl_b32 s31, s59, 10
    v_add_u32 v22, s31, v23
    s_add_u32 s31, s30, 1
    s_mul_i32 s31, s31, 81920
    s_lshl_b32 s41, s43, 9
    s_add_u32 s31, s31, s41
    s_add_u32 s44, s48, s31
    s_addc_u32 s45, s49, 0
    v_mov_b32 v60, 0
    v_mov_b32 v61, 0
    v_mov_b32 v62, 0
    v_mov_b32 v63, 0
    v_mov_b32 v64, 0
    v_mov_b32 v65, 0
    v_mov_b32 v66, 0
    v_mov_b32 v67, 0
    s_waitcnt lgkmcnt(0)
    v_readfirstlane_b32 s41, v21
    s_lshr_b32 s31, s30, 3
    s_lshr_b32 s41, s41, s31
    s_and_b32 s41, s41, 1
    s_lshl_b32 s41, s41, 13
    s_lshl_b32 s31, s30, 18
    s_add_u32 s31, s31, s41
    s_add_u32 s31, s31, s55
    s_add_u32 s50, s16, s31
    s_addc_u32 s51, s17, 0
    s_mov_b32 s40, 0
    global_load_dwordx4 v[28:31], v25, s[46:47] offset:0 sc1
    global_load_dwordx4 v[32:35], v25, s[46:47] offset:1024 sc1
    global_load_dwordx4 v[36:39], v25, s[46:47] offset:2048 sc1
    global_load_dwordx4 v[40:43], v25, s[46:47] offset:3072 sc1
rec_z1l:
    s_waitcnt vmcnt(0)
    v_max3_u32 v20, v28, v32, v36
    v_max_u32 v20, v40, v20
    v_cmp_eq_u32 vcc, -1, v20
    s_add_u32 s40, s40, 1
    s_cbranch_vccz rec_z1d0
    global_load_dwordx4 v[28:31], v25, s[46:47] offset:0 sc1
    global_load_dwordx4 v[32:35], v25, s[46:47] offset:1024 sc1
    global_load_dwordx4 v[36:39], v25, s[46:47] offset:2048 sc1
    global_load_dwordx4 v[40:43], v25, s[46:47] offset:3072 sc1
    s_cmp_lt_u32 s40, 16384
    s_cbranch_scc1 rec_z1l
    s_waitcnt vmcnt(0)
rec_z1d0:
rec_z1e:
    v_smfmac_f32_16x16x64_bf16 v[60:63], v[28:31], v[216:223], v7
    v_smfmac_f32_16x16x64_bf16 v[64:67], v[28:31], v[224:231], v7
    v_smfmac_f32_16x16x64_bf16 v[60:63], v[32:35], v[232:239], v7
    v_smfmac_f32_16x16x64_bf16 v[64:67], v[32:35], v[240:247], v7
    v_smfmac_f32_16x16x64_bf16 v[60:63], v[36:39], v[248:255], v7
    v_smfmac_f32_16x16x64_bf16 v[64:67], v[36:39], v[104:111], v7
    v_smfmac_f32_16x16x64_bf16 v[60:63], v[40:43], v[80:87], v7
    v_smfmac_f32_16x16x64_bf16 v[64:67], v[40:43], v[88:95], v7
    v_mov_b32 v20, 0
    v_mov_b32 v20, 0
    v_mov_b32 v20, 0
    v_mov_b32 v20, 0
    v_mov_b32 v20, 0
    v_mov_b32 v20, 0
    v_mov_b32 v20, 0
    v_mov_b32 v20, 0
    v_permlane32_swap_b32 v60, v64
    v_permlane32_swap_b32 v61, v65
    v_permlane32_swap_b32 v62, v66
    v_permlane32_swap_b32 v63, v67
    v_pk_add_f32 v[60:61], v[60:61], v[64:65]
    v_pk_add_f32 v[62:63], v[62:63], v[66:67]
    ds_write_b128 v26, v[60:63]
    s_waitcnt lgkmcnt(0)
    s_barrier
    s_cmp_ge_u32 s5, 2
    s_cbranch_scc1 rec_xw2
    ds_read2st64_b32 v[60:61], v27 offset0:0 offset1:6
    ds_read2st64_b32 v[62:63], v10 offset0:0 offset1:6
    ds_read2st64_b32 v[64:65], v27 offset0:12 offset1:18
    ds_read2st64_b32 v[66:67], v10 offset0:12 offset1:18
    s_waitcnt lgkmcnt(2)
    v_add_f32 v60, v60, v61
    v_add_f32 v61, v62, v63
    s_waitcnt lgkmcnt(0)
    v_add_f32 v64, v64, v65
    v_add_f32 v65, v66, v67
    v_add_f32 v60, v60, v64
    v_add_f32 v61, v61, v65
    global_store_dwordx2 v22, v[60:61], s[50:51] sc1
    v_lshrrev_b32 v22, 1, v23
    s_sleep 6
    s_mov_b32 s40, 0
    global_load_dwordx2 v[28:29], v23, s[50:51] offset:0 sc1
    global_load_dwordx2 v[30:31], v23, s[50:51] offset:1024 sc1
    global_load_dwordx2 v[32:33], v23, s[50:51] offset:2048 sc1
    global_load_dwordx2 v[34:35], v23, s[50:51] offset:3072 sc1
    s_sleep 3
    global_load_dwordx2 v[36:37], v23, s[50:51] offset:0 sc1
    global_load_dwordx2 v[38:39], v23, s[50:51] offset:1024 sc1
    global_load_dwordx2 v[40:41], v23, s[50:51] offset:2048 sc1
    global_load_dwordx2 v[42:43], v23, s[50:51] offset:3072 sc1
rec_z2l:
    s_waitcnt vmcnt(4)
    v_max3_u32 v20, v28, v30, v32
    v_max_u32 v20, v34, v20
    v_cmp_eq_u32 vcc, -1, v20
    s_add_u32 s40, s40, 1
    s_cbranch_vccz rec_z2d0
    global_load_dwordx2 v[28:29], v23, s[50:51] offset:0 sc1
    global_load_dwordx2 v[30:31], v23, s[50:51] offset:1024 sc1
    global_load_dwordx2 v[32:33], v23, s[50:51] offset:2048 sc1
    global_load_dwordx2 v[34:35], v23, s[50:51] offset:3072 sc1
    s_waitcnt vmcnt(4)
    v_max3_u32 v20, v36, v38, v40
    v_max_u32 v20, v42, v20
    v_cmp_eq_u32 vcc, -1, v20
    s_nop 0
    s_cbranch_vccz rec_z2d1
    global_load_dwordx2 v[36:37], v23, s[50:51] offset:0 sc1
    global_load_dwordx2 v[38:39], v23, s[50:51] offset:1024 sc1
    global_load_dwordx2 v[40:41], v23, s[50:51] offset:2048 sc1
    global_load_dwordx2 v[42:43], v23, s[50:51] offset:3072 sc1
    s_cmp_lt_u32 s40, 16384
    s_cbranch_scc1 rec_z2l
    s_waitcnt vmcnt(0)
rec_z2d1:
    v_add_f32 v36, v36, v40
    v_add_f32 v37, v37, v41
    v_add_f32 v38, v38, v42
    v_add_f32 v39, v39, v43
    v_add_f32 v36, v36, v38
    v_add_f32 v37, v37, v39
    v_cvt_pk_bf16_f32 v62, v36, v37
    s_branch rec_z2e
rec_z2d0:
    v_add_f32 v28, v28, v32
    v_add_f32 v29, v29, v33
    v_add_f32 v30, v30, v34
    v_add_f32 v31, v31, v35
    v_add_f32 v28, v28, v30
    v_add_f32 v29, v29, v31
    v_cvt_pk_bf16_f32 v62, v28, v29
rec_z2e:
    global_store_dword v22, v62, s[44:45]
    s_branch rec_next
rec_xno:
    s_barrier
rec_xw2:
    s_cmp_eq_u32 s5, 3
    s_cbranch_scc1 rec_kv3
    s_sleep 20
    s_branch rec_next
rec_kv3:
    s_cmp_lg_u32 s30, 7
    s_cbranch_scc1 rec_c2n
    v_mov_b32 v22, 0
    global_load_dwordx2 v[28:29], v22, s[52:53] offset:68 sc1
rec_c2n:
    s_add_u32 s43, s30, 1
    s_lshr_b32 s31, s43, 2
    s_cmp_lt_u32 s43, 2
    s_cselect_b32 s31, 19, s31
    s_bitcmp1_b32 s54, s31
    s_cbranch_scc1 rec_kvokb
    s_mov_b32 s40, 0
    v_and_b32 v21, 31, v1
    v_lshlrev_b32 v21, 2, v21
rec_kvpb:
    global_load_dword v20, v21, s[52:53] sc1
    s_add_u32 s40, s40, 1
    s_waitcnt vmcnt(0)
    v_and_b32 v20, 255, v20
    v_cmp_eq_u32 vcc, 64, v20
    s_and_b32 s54, vcc_lo, 589823
    s_cmp_ge_u32 s40, 16384
    s_cbranch_scc1 rec_kvokb
    s_bitcmp1_b32 s54, s31
    s_cbranch_scc1 rec_kvokb
    s_sleep 8
    s_branch rec_kvpb
rec_kvokb:
    s_lshl_b32 s31, s43, 18
    s_lshl_b32 s41, s3, 12
    s_add_u32 s41, s31, s41
    s_add_u32 s62, s18, s41
    s_addc_u32 s63, s19, 0
    v_lshlrev_b32 v20, 4, v1
    v_add_u32 v21, 0x20000, v20
    s_mov_b32 m0, 24320
    s_nop 0
    global_load_lds_dwordx4 v20, s[62:63] offset:0 sc1
    global_load_lds_dwordx4 v20, s[62:63] offset:1024 sc1
    global_load_lds_dwordx4 v20, s[62:63] offset:2048 sc1
    global_load_lds_dwordx4 v20, s[62:63] offset:3072 sc1
    s_mov_b32 m0, 28416
    s_nop 0
    global_load_lds_dwordx4 v21, s[62:63] offset:0 sc1
    global_load_lds_dwordx4 v21, s[62:63] offset:1024 sc1
    global_load_lds_dwordx4 v21, s[62:63] offset:2048 sc1
    global_load_lds_dwordx4 v21, s[62:63] offset:3072 sc1
    s_lshl_b32 s41, s58, 11
    s_add_u32 s31, s31, s41
    s_add_u32 s62, s20, s31
    s_addc_u32 s63, s21, 0
    s_mov_b32 m0, 33024
    s_nop 0
    global_load_lds_dwordx4 v20, s[62:63] offset:0 sc1
    global_load_lds_dwordx4 v20, s[62:63] offset:1024 sc1
    s_waitcnt vmcnt(0)
    s_cmp_lg_u32 s30, 7
    s_cbranch_scc1 rec_c2d
    s_mov_b32 s40, 0
    v_mov_b32 v21, 0
    v_readfirstlane_b32 s31, v28
    v_readfirstlane_b32 s41, v29
    v_mov_b32 v20, v29
    s_cmp_lt_u32 s31, 128
    s_cbranch_scc1 rec_c2l
    s_cmp_ge_u32 s41, 67328
    s_cbranch_scc1 rec_c3w
rec_c2l:
    global_load_dword v20, v21, s[52:53] offset:68 sc1
    s_add_u32 s40, s40, 1
    s_waitcnt vmcnt(0)
    v_readfirstlane_b32 s31, v20
    s_cmp_ge_u32 s40, 16384
    s_cbranch_scc1 rec_c2d
    s_cmp_lt_u32 s31, 128
    s_cbranch_scc1 rec_c2l
rec_c3l:
    global_load_dword v20, v21, s[52:53] offset:72 sc1
    s_add_u32 s40, s40, 1
    s_waitcnt vmcnt(0)
    v_readfirstlane_b32 s31, v20
    s_cmp_ge_u32 s40, 16384
    s_cbranch_scc1 rec_c2d
    s_cmp_lt_u32 s31, 67328
    s_cbranch_scc1 rec_c3l
rec_c3w:
    ds_write_b32 v21, v20 offset:17152
rec_c2d:
rec_next:
    s_add_u32 s30, s30, 1
    s_branch rec_loop
rec_fin:
    s_waitcnt vmcnt(0) lgkmcnt(0)
    s_barrier
    s_cmp_lg_u32 s5, 0
    s_cbranch_scc1 rec_end
    v_mov_b32 v20, 64
    v_mov_b32 v21, 0
    s_mov_b64 exec, 1
    global_store_dword v21, v20, s[56:57] sc1
    s_waitcnt vmcnt(0)
rec_end:
    s_endpgm
mega_worker:
    s_mov_b32 s100, s58
    s_load_dwordx2 s[6:7], s[0:1], 112
    s_load_dwordx2 s[98:99], s[0:1], 104
    v_lshrrev_b32 v1, 6, v0
    v_mov_b32 v4, -1
    v_mov_b32 v5, -1
    v_mov_b32 v6, -1
    v_mov_b32 v7, -1
    v_readfirstlane_b32 s3, v1
    s_waitcnt lgkmcnt(0)
    s_lshr_b32 s11, s100, 1
    s_xor_b32 s11, s11, s100
    s_bitcmp1_b32 s11, 1
    s_cbranch_scc1 clr_sg_n
    s_lshr_b32 s11, s100, 3
    s_lshl_b32 s11, s11, 2
    s_and_b32 s12, s100, 3
    s_add_u32 s11, s11, s12
    s_lshr_b32 s12, s11, 3
    s_and_b32 s13, s11, 7
    v_lshlrev_b32 v1, 4, v0
    s_mul_i32 s10, s12, 81920
    s_add_u32 s10, s10, 83968000
    s_add_u32 s14, s13, 0
    s_lshl_b32 s14, s14, 12
    s_add_u32 s14, s14, s10
    s_add_u32 s8, s6, s14
    s_addc_u32 s9, s7, 0
    global_store_dwordx4 v1, v[4:7], s[8:9] sc1
    s_add_u32 s14, s13, 8
    s_min_u32 s14, s14, 9
    s_lshl_b32 s14, s14, 12
    s_add_u32 s14, s14, s10
    s_add_u32 s8, s6, s14
    s_addc_u32 s9, s7, 0
    global_store_dwordx4 v1, v[4:7], s[8:9] sc1
    s_mul_i32 s10, s12, 65536
    s_add_u32 s10, s10, 96468992
    s_add_u32 s14, s13, 0
    s_lshl_b32 s14, s14, 12
    s_add_u32 s14, s14, s10
    s_add_u32 s8, s6, s14
    s_addc_u32 s9, s7, 0
    global_store_dwordx4 v1, v[4:7], s[8:9] sc1
    s_add_u32 s14, s13, 8
    s_lshl_b32 s14, s14, 12
    s_add_u32 s14, s14, s10
    s_add_u32 s8, s6, s14
    s_addc_u32 s9, s7, 0
    global_store_dwordx4 v1, v[4:7], s[8:9] sc1
    s_mul_i32 s10, s12, 262144
    s_add_u32 s10, s10, 134217728
    s_sub_u32 s14, 0, s6
    s_and_b32 s14, s14, 0x1fffff
    s_add_u32 s10, s10, s14
    s_add_u32 s14, s13, 0
    s_lshl_b32 s14, s14, 12
    s_add_u32 s14, s14, s10
    s_add_u32 s8, s6, s14
    s_addc_u32 s9, s7, 0
    global_store_dwordx4 v1, v[4:7], s[8:9] sc1
    s_add_u32 s14, s13, 8
    s_lshl_b32 s14, s14, 12
    s_add_u32 s14, s14, s10
    s_add_u32 s8, s6, s14
    s_addc_u32 s9, s7, 0
    global_store_dwordx4 v1, v[4:7], s[8:9] sc1
    s_add_u32 s14, s13, 16
    s_lshl_b32 s14, s14, 12
    s_add_u32 s14, s14, s10
    s_add_u32 s8, s6, s14
    s_addc_u32 s9, s7, 0
    global_store_dwordx4 v1, v[4:7], s[8:9] sc1
    s_add_u32 s14, s13, 24
    s_lshl_b32 s14, s14, 12
    s_add_u32 s14, s14, s10
    s_add_u32 s8, s6, s14
    s_addc_u32 s9, s7, 0
    global_store_dwordx4 v1, v[4:7], s[8:9] sc1
    s_add_u32 s14, s13, 32
    s_lshl_b32 s14, s14, 12
    s_add_u32 s14, s14, s10
    s_add_u32 s8, s6, s14
    s_addc_u32 s9, s7, 0
    global_store_dwordx4 v1, v[4:7], s[8:9] sc1
    s_lshl_b32 s10, s11, 3
    s_add_u32 s10, s10, 117440512
    s_add_u32 s8, s6, s10
    s_addc_u32 s9, s7, 0
    v_mov_b32 v1, 0
    v_mov_b32 v2, 0
    v_mov_b32 v3, 0
    s_cmp_lg_u32 s3, 0
    s_cbranch_scc1 clr_np
    s_mov_b64 exec, 1
    global_store_dwordx2 v1, v[2:3], s[8:9] sc1
    s_mov_b64 exec, -1
clr_np:
    s_waitcnt vmcnt(0)
    s_barrier
    s_mov_b32 s10, 64
    s_cmp_lg_u32 s3, 0
    s_cbranch_scc1 clr_sg_n
    v_mov_b32 v4, 1
    v_mov_b32 v5, s10
    s_mov_b64 exec, 1
    global_atomic_add v5, v4, s[98:99] sc1
    s_mov_b64 exec, -1
clr_sg_n:
    s_load_dwordx2 s[6:7], s[0:1], 0
    s_load_dwordx4 s[8:11], s[0:1], 16
    s_load_dwordx2 s[12:13], s[0:1], 32
    s_load_dwordx2 s[14:15], s[0:1], 64
    s_load_dwordx2 s[16:17], s[0:1], 72
    s_load_dwordx2 s[18:19], s[0:1], 112
    v_lshrrev_b32 v4, 6, v0
    v_and_b32 v3, 63, v0
    v_readfirstlane_b32 s3, v4
    v_and_b32 v1, 15, v0
    v_lshrrev_b32 v2, 4, v3
    s_cmp_eq_u32 s3, 0
    s_cselect_b32 s48, 1, 0
    s_mov_b32 s49, 0
    v_mov_b32 v18, 68
    v_mov_b32 v19, 2
    s_mov_b64 s[60:61], 0
    s_mov_b64 s[56:57], 0
    s_and_b32 s31, s100, 1
    s_bfe_u32 s5, s100, 0x20001
    s_lshr_b32 s4, s100, 3
    s_lshl_b32 s4, s4, 2
    s_add_u32 s4, s4, s3
    s_lshl_b32 s64, s3, 10
    s_waitcnt lgkmcnt(0)
    s_and_b32 s40, s100, 0x76
    s_cmp_lg_u32 s40, 0x76
    s_cbranch_scc1 g1_go
    s_lshl_b32 s26, s31, 2
    s_add_u32 s26, s26, s3
    s_cmp_lg_u32 s100, 126
    s_cbranch_scc1 g1_wc0
    s_cmp_lg_u32 s26, 0
    s_cbranch_scc1 g1_wc0
    s_sub_u32 s29, 0, s18
    s_and_b32 s29, s29, 0x1fffff
    s_add_u32 s29, s29, 134414336
    s_lshl_b32 s40, s26, 21
    s_add_u32 s29, s29, s40
    s_mov_b64 s[50:51], -1
    s_mov_b32 s28, 0
    s_mov_b64 exec, 1
g1_wcl0:
    s_and_b32 s40, s28, 3
    s_lshl_b32 s40, s40, 14
    s_lshr_b32 s41, s28, 2
    s_lshl_b32 s41, s41, 8
    s_add_u32 s40, s40, s41
    s_add_u32 s40, s40, s29
    v_mov_b32 v5, s40
    v_add_u32 v6, 8192, v5
    s_waitcnt vmcnt(0)
    s_memtime s[70:71]
    s_waitcnt lgkmcnt(0)
    global_load_dword v4, v5, s[18:19] sc1
    s_waitcnt vmcnt(0)
    s_memtime s[72:73]
    s_waitcnt lgkmcnt(0)
    global_load_dword v4, v6, s[18:19] sc1
    s_waitcnt vmcnt(0)
    s_memtime s[74:75]
    s_waitcnt lgkmcnt(0)
    s_sub_u32 s74, s74, s72
    s_sub_u32 s72, s72, s70
    s_min_u32 s50, s50, s72
    s_min_u32 s51, s51, s74
    s_add_u32 s28, s28, 1
    s_cmp_lt_u32 s28, 8
    s_cbranch_scc1 g1_wcl0
    s_cmp_gt_u32 s51, s50
    s_cselect_b32 s41, 1, 0
    s_lshl_b32 s41, s41, s26
    s_add_u32 s41, s41, 65536
    v_mov_b32 v4, s41
    v_mov_b32 v5, 72
    global_atomic_add v5, v4, s[98:99] sc1
    s_waitcnt vmcnt(0)
    s_mov_b64 exec, -1
g1_wc0:
    v_mov_b32 v196, -1
    v_mov_b32 v197, -1
    v_mov_b32 v198, -1
    v_mov_b32 v199, -1
    v_lshlrev_b32 v200, 4, v0
    s_lshr_b32 s43, s100, 3
    s_and_b32 s43, s43, 1
    s_lshl_b32 s43, s43, 2
    s_and_b32 s42, s100, 3
    s_add_u32 s43, s43, s42
    s_lshr_b32 s42, s100, 4
    s_add_u32 s42, s42, 8
    s_mul_i32 s40, s42, 81920
    s_add_u32 s40, s40, 83968000
    s_add_u32 s41, s43, 0
    s_lshl_b32 s41, s41, 12
    s_add_u32 s41, s41, s40
    s_add_u32 s52, s18, s41
    s_addc_u32 s53, s19, 0
    global_store_dwordx4 v200, v[196:199], s[52:53] sc1
    s_add_u32 s41, s43, 8
    s_min_u32 s41, s41, 9
    s_lshl_b32 s41, s41, 12
    s_add_u32 s41, s41, s40
    s_add_u32 s52, s18, s41
    s_addc_u32 s53, s19, 0
    global_store_dwordx4 v200, v[196:199], s[52:53] sc1
    s_mul_i32 s40, s42, 65536
    s_add_u32 s40, s40, 96468992
    s_add_u32 s41, s43, 0
    s_lshl_b32 s41, s41, 12
    s_add_u32 s41, s41, s40
    s_add_u32 s52, s18, s41
    s_addc_u32 s53, s19, 0
    global_store_dwordx4 v200, v[196:199], s[52:53] sc1
    s_add_u32 s41, s43, 8
    s_lshl_b32 s41, s41, 12
    s_add_u32 s41, s41, s40
    s_add_u32 s52, s18, s41
    s_addc_u32 s53, s19, 0
    global_store_dwordx4 v200, v[196:199], s[52:53] sc1
    s_mul_i32 s40, s42, 262144
    s_add_u32 s40, s40, 134217728
    s_sub_u32 s41, 0, s18
    s_and_b32 s41, s41, 0x1fffff
    s_add_u32 s40, s40, s41
    s_add_u32 s41, s43, 0
    s_lshl_b32 s41, s41, 12
    s_add_u32 s41, s41, s40
    s_add_u32 s52, s18, s41
    s_addc_u32 s53, s19, 0
    global_store_dwordx4 v200, v[196:199], s[52:53] sc1
    s_add_u32 s41, s43, 8
    s_lshl_b32 s41, s41, 12
    s_add_u32 s41, s41, s40
    s_add_u32 s52, s18, s41
    s_addc_u32 s53, s19, 0
    global_store_dwordx4 v200, v[196:199], s[52:53] sc1
    s_add_u32 s41, s43, 16
    s_lshl_b32 s41, s41, 12
    s_add_u32 s41, s41, s40
    s_add_u32 s52, s18, s41
    s_addc_u32 s53, s19, 0
    global_store_dwordx4 v200, v[196:199], s[52:53] sc1
    s_add_u32 s41, s43, 24
    s_lshl_b32 s41, s41, 12
    s_add_u32 s41, s41, s40
    s_add_u32 s52, s18, s41
    s_addc_u32 s53, s19, 0
    global_store_dwordx4 v200, v[196:199], s[52:53] sc1
    s_add_u32 s41, s43, 32
    s_lshl_b32 s41, s41, 12
    s_add_u32 s41, s41, s40
    s_add_u32 s52, s18, s41
    s_addc_u32 s53, s19, 0
    global_store_dwordx4 v200, v[196:199], s[52:53] sc1
    s_lshr_b32 s42, s100, 4
    s_add_u32 s42, s42, 16
    s_mul_i32 s40, s42, 81920
    s_add_u32 s40, s40, 83968000
    s_add_u32 s41, s43, 0
    s_lshl_b32 s41, s41, 12
    s_add_u32 s41, s41, s40
    s_add_u32 s52, s18, s41
    s_addc_u32 s53, s19, 0
    global_store_dwordx4 v200, v[196:199], s[52:53] sc1
    s_add_u32 s41, s43, 8
    s_min_u32 s41, s41, 9
    s_lshl_b32 s41, s41, 12
    s_add_u32 s41, s41, s40
    s_add_u32 s52, s18, s41
    s_addc_u32 s53, s19, 0
    global_store_dwordx4 v200, v[196:199], s[52:53] sc1
    s_mul_i32 s40, s42, 65536
    s_add_u32 s40, s40, 96468992
    s_add_u32 s41, s43, 0
    s_lshl_b32 s41, s41, 12
    s_add_u32 s41, s41, s40
    s_add_u32 s52, s18, s41
    s_addc_u32 s53, s19, 0
    global_store_dwordx4 v200, v[196:199], s[52:53] sc1
    s_add_u32 s41, s43, 8
    s_lshl_b32 s41, s41, 12
    s_add_u32 s41, s41, s40
    s_add_u32 s52, s18, s41
    s_addc_u32 s53, s19, 0
    global_store_dwordx4 v200, v[196:199], s[52:53] sc1
    s_mul_i32 s40, s42, 262144
    s_add_u32 s40, s40, 134217728
    s_sub_u32 s41, 0, s18
    s_and_b32 s41, s41, 0x1fffff
    s_add_u32 s40, s40, s41
    s_add_u32 s41, s43, 0
    s_lshl_b32 s41, s41, 12
    s_add_u32 s41, s41, s40
    s_add_u32 s52, s18, s41
    s_addc_u32 s53, s19, 0
    global_store_dwordx4 v200, v[196:199], s[52:53] sc1
    s_add_u32 s41, s43, 8
    s_lshl_b32 s41, s41, 12
    s_add_u32 s41, s41, s40
    s_add_u32 s52, s18, s41
    s_addc_u32 s53, s19, 0
    global_store_dwordx4 v200, v[196:199], s[52:53] sc1
    s_add_u32 s41, s43, 16
    s_lshl_b32 s41, s41, 12
    s_add_u32 s41, s41, s40
    s_add_u32 s52, s18, s41
    s_addc_u32 s53, s19, 0
    global_store_dwordx4 v200, v[196:199], s[52:53] sc1
    s_add_u32 s41, s43, 24
    s_lshl_b32 s41, s41, 12
    s_add_u32 s41, s41, s40
    s_add_u32 s52, s18, s41
    s_addc_u32 s53, s19, 0
    global_store_dwordx4 v200, v[196:199], s[52:53] sc1
    s_add_u32 s41, s43, 32
    s_lshl_b32 s41, s41, 12
    s_add_u32 s41, s41, s40
    s_add_u32 s52, s18, s41
    s_addc_u32 s53, s19, 0
    global_store_dwordx4 v200, v[196:199], s[52:53] sc1
    s_lshr_b32 s42, s100, 4
    s_add_u32 s42, s42, 24
    s_mul_i32 s40, s42, 81920
    s_add_u32 s40, s40, 83968000
    s_add_u32 s41, s43, 0
    s_lshl_b32 s41, s41, 12
    s_add_u32 s41, s41, s40
    s_add_u32 s52, s18, s41
    s_addc_u32 s53, s19, 0
    global_store_dwordx4 v200, v[196:199], s[52:53] sc1
    s_add_u32 s41, s43, 8
    s_min_u32 s41, s41, 9
    s_lshl_b32 s41, s41, 12
    s_add_u32 s41, s41, s40
    s_add_u32 s52, s18, s41
    s_addc_u32 s53, s19, 0
    global_store_dwordx4 v200, v[196:199], s[52:53] sc1
    s_mul_i32 s40, s42, 65536
    s_add_u32 s40, s40, 96468992
    s_add_u32 s41, s43, 0
    s_lshl_b32 s41, s41, 12
    s_add_u32 s41, s41, s40
    s_add_u32 s52, s18, s41
    s_addc_u32 s53, s19, 0
    global_store_dwordx4 v200, v[196:199], s[52:53] sc1
    s_add_u32 s41, s43, 8
    s_lshl_b32 s41, s41, 12
    s_add_u32 s41, s41, s40
    s_add_u32 s52, s18, s41
    s_addc_u32 s53, s19, 0
    global_store_dwordx4 v200, v[196:199], s[52:53] sc1
    s_mul_i32 s40, s42, 262144
    s_add_u32 s40, s40, 134217728
    s_sub_u32 s41, 0, s18
    s_and_b32 s41, s41, 0x1fffff
    s_add_u32 s40, s40, s41
    s_add_u32 s41, s43, 0
    s_lshl_b32 s41, s41, 12
    s_add_u32 s41, s41, s40
    s_add_u32 s52, s18, s41
    s_addc_u32 s53, s19, 0
    global_store_dwordx4 v200, v[196:199], s[52:53] sc1
    s_add_u32 s41, s43, 8
    s_lshl_b32 s41, s41, 12
    s_add_u32 s41, s41, s40
    s_add_u32 s52, s18, s41
    s_addc_u32 s53, s19, 0
    global_store_dwordx4 v200, v[196:199], s[52:53] sc1
    s_add_u32 s41, s43, 16
    s_lshl_b32 s41, s41, 12
    s_add_u32 s41, s41, s40
    s_add_u32 s52, s18, s41
    s_addc_u32 s53, s19, 0
    global_store_dwordx4 v200, v[196:199], s[52:53] sc1
    s_add_u32 s41, s43, 24
    s_lshl_b32 s41, s41, 12
    s_add_u32 s41, s41, s40
    s_add_u32 s52, s18, s41
    s_addc_u32 s53, s19, 0
    global_store_dwordx4 v200, v[196:199], s[52:53] sc1
    s_add_u32 s41, s43, 32
    s_lshl_b32 s41, s41, 12
    s_add_u32 s41, s41, s40
    s_add_u32 s52, s18, s41
    s_addc_u32 s53, s19, 0
    global_store_dwordx4 v200, v[196:199], s[52:53] sc1
    s_lshr_b32 s42, s100, 4
    s_add_u32 s42, s42, 32
    s_mul_i32 s40, s42, 81920
    s_add_u32 s40, s40, 83968000
    s_add_u32 s41, s43, 0
    s_lshl_b32 s41, s41, 12
    s_add_u32 s41, s41, s40
    s_add_u32 s52, s18, s41
    s_addc_u32 s53, s19, 0
    global_store_dwordx4 v200, v[196:199], s[52:53] sc1
    s_add_u32 s41, s43, 8
    s_min_u32 s41, s41, 9
    s_lshl_b32 s41, s41, 12
    s_add_u32 s41, s41, s40
    s_add_u32 s52, s18, s41
    s_addc_u32 s53, s19, 0
    global_store_dwordx4 v200, v[196:199], s[52:53] sc1
    s_mul_i32 s40, s42, 65536
    s_add_u32 s40, s40, 96468992
    s_add_u32 s41, s43, 0
    s_lshl_b32 s41, s41, 12
    s_add_u32 s41, s41, s40
    s_add_u32 s52, s18, s41
    s_addc_u32 s53, s19, 0
    global_store_dwordx4 v200, v[196:199], s[52:53] sc1
    s_add_u32 s41, s43, 8
    s_lshl_b32 s41, s41, 12
    s_add_u32 s41, s41, s40
    s_add_u32 s52, s18, s41
    s_addc_u32 s53, s19, 0
    global_store_dwordx4 v200, v[196:199], s[52:53] sc1
    s_mul_i32 s40, s42, 262144
    s_add_u32 s40, s40, 134217728
    s_sub_u32 s41, 0, s18
    s_and_b32 s41, s41, 0x1fffff
    s_add_u32 s40, s40, s41
    s_add_u32 s41, s43, 0
    s_lshl_b32 s41, s41, 12
    s_add_u32 s41, s41, s40
    s_add_u32 s52, s18, s41
    s_addc_u32 s53, s19, 0
    global_store_dwordx4 v200, v[196:199], s[52:53] sc1
    s_add_u32 s41, s43, 8
    s_lshl_b32 s41, s41, 12
    s_add_u32 s41, s41, s40
    s_add_u32 s52, s18, s41
    s_addc_u32 s53, s19, 0
    global_store_dwordx4 v200, v[196:199], s[52:53] sc1
    s_add_u32 s41, s43, 16
    s_lshl_b32 s41, s41, 12
    s_add_u32 s41, s41, s40
    s_add_u32 s52, s18, s41
    s_addc_u32 s53, s19, 0
    global_store_dwordx4 v200, v[196:199], s[52:53] sc1
    s_add_u32 s41, s43, 24
    s_lshl_b32 s41, s41, 12
    s_add_u32 s41, s41, s40
    s_add_u32 s52, s18, s41
    s_addc_u32 s53, s19, 0
    global_store_dwordx4 v200, v[196:199], s[52:53] sc1
    s_add_u32 s41, s43, 32
    s_lshl_b32 s41, s41, 12
    s_add_u32 s41, s41, s40
    s_add_u32 s52, s18, s41
    s_addc_u32 s53, s19, 0
    global_store_dwordx4 v200, v[196:199], s[52:53] sc1
    s_lshr_b32 s42, s100, 4
    s_add_u32 s42, s42, 40
    s_mul_i32 s40, s42, 81920
    s_add_u32 s40, s40, 83968000
    s_add_u32 s41, s43, 0
    s_lshl_b32 s41, s41, 12
    s_add_u32 s41, s41, s40
    s_add_u32 s52, s18, s41
    s_addc_u32 s53, s19, 0
    global_store_dwordx4 v200, v[196:199], s[52:53] sc1
    s_add_u32 s41, s43, 8
    s_min_u32 s41, s41, 9
    s_lshl_b32 s41, s41, 12
    s_add_u32 s41, s41, s40
    s_add_u32 s52, s18, s41
    s_addc_u32 s53, s19, 0
    global_store_dwordx4 v200, v[196:199], s[52:53] sc1
    s_mul_i32 s40, s42, 65536
    s_add_u32 s40, s40, 96468992
    s_add_u32 s41, s43, 0
    s_lshl_b32 s41, s41, 12
    s_add_u32 s41, s41, s40
    s_add_u32 s52, s18, s41
    s_addc_u32 s53, s19, 0
    global_store_dwordx4 v200, v[196:199], s[52:53] sc1
    s_add_u32 s41, s43, 8
    s_lshl_b32 s41, s41, 12
    s_add_u32 s41, s41, s40
    s_add_u32 s52, s18, s41
    s_addc_u32 s53, s19, 0
    global_store_dwordx4 v200, v[196:199], s[52:53] sc1
    s_mul_i32 s40, s42, 262144
    s_add_u32 s40, s40, 134217728
    s_sub_u32 s41, 0, s18
    s_and_b32 s41, s41, 0x1fffff
    s_add_u32 s40, s40, s41
    s_add_u32 s41, s43, 0
    s_lshl_b32 s41, s41, 12
    s_add_u32 s41, s41, s40
    s_add_u32 s52, s18, s41
    s_addc_u32 s53, s19, 0
    global_store_dwordx4 v200, v[196:199], s[52:53] sc1
    s_add_u32 s41, s43, 8
    s_lshl_b32 s41, s41, 12
    s_add_u32 s41, s41, s40
    s_add_u32 s52, s18, s41
    s_addc_u32 s53, s19, 0
    global_store_dwordx4 v200, v[196:199], s[52:53] sc1
    s_add_u32 s41, s43, 16
    s_lshl_b32 s41, s41, 12
    s_add_u32 s41, s41, s40
    s_add_u32 s52, s18, s41
    s_addc_u32 s53, s19, 0
    global_store_dwordx4 v200, v[196:199], s[52:53] sc1
    s_add_u32 s41, s43, 24
    s_lshl_b32 s41, s41, 12
    s_add_u32 s41, s41, s40
    s_add_u32 s52, s18, s41
    s_addc_u32 s53, s19, 0
    global_store_dwordx4 v200, v[196:199], s[52:53] sc1
    s_add_u32 s41, s43, 32
    s_lshl_b32 s41, s41, 12
    s_add_u32 s41, s41, s40
    s_add_u32 s52, s18, s41
    s_addc_u32 s53, s19, 0
    global_store_dwordx4 v200, v[196:199], s[52:53] sc1
    s_lshr_b32 s42, s100, 4
    s_add_u32 s42, s42, 48
    s_mul_i32 s40, s42, 81920
    s_add_u32 s40, s40, 83968000
    s_add_u32 s41, s43, 0
    s_lshl_b32 s41, s41, 12
    s_add_u32 s41, s41, s40
    s_add_u32 s52, s18, s41
    s_addc_u32 s53, s19, 0
    global_store_dwordx4 v200, v[196:199], s[52:53] sc1
    s_add_u32 s41, s43, 8
    s_min_u32 s41, s41, 9
    s_lshl_b32 s41, s41, 12
    s_add_u32 s41, s41, s40
    s_add_u32 s52, s18, s41
    s_addc_u32 s53, s19, 0
    global_store_dwordx4 v200, v[196:199], s[52:53] sc1
    s_mul_i32 s40, s42, 65536
    s_add_u32 s40, s40, 96468992
    s_add_u32 s41, s43, 0
    s_lshl_b32 s41, s41, 12
    s_add_u32 s41, s41, s40
    s_add_u32 s52, s18, s41
    s_addc_u32 s53, s19, 0
    global_store_dwordx4 v200, v[196:199], s[52:53] sc1
    s_add_u32 s41, s43, 8
    s_lshl_b32 s41, s41, 12
    s_add_u32 s41, s41, s40
    s_add_u32 s52, s18, s41
    s_addc_u32 s53, s19, 0
    global_store_dwordx4 v200, v[196:199], s[52:53] sc1
    s_mul_i32 s40, s42, 262144
    s_add_u32 s40, s40, 134217728
    s_sub_u32 s41, 0, s18
    s_and_b32 s41, s41, 0x1fffff
    s_add_u32 s40, s40, s41
    s_add_u32 s41, s43, 0
    s_lshl_b32 s41, s41, 12
    s_add_u32 s41, s41, s40
    s_add_u32 s52, s18, s41
    s_addc_u32 s53, s19, 0
    global_store_dwordx4 v200, v[196:199], s[52:53] sc1
    s_add_u32 s41, s43, 8
    s_lshl_b32 s41, s41, 12
    s_add_u32 s41, s41, s40
    s_add_u32 s52, s18, s41
    s_addc_u32 s53, s19, 0
    global_store_dwordx4 v200, v[196:199], s[52:53] sc1
    s_add_u32 s41, s43, 16
    s_lshl_b32 s41, s41, 12
    s_add_u32 s41, s41, s40
    s_add_u32 s52, s18, s41
    s_addc_u32 s53, s19, 0
    global_store_dwordx4 v200, v[196:199], s[52:53] sc1
    s_add_u32 s41, s43, 24
    s_lshl_b32 s41, s41, 12
    s_add_u32 s41, s41, s40
    s_add_u32 s52, s18, s41
    s_addc_u32 s53, s19, 0
    global_store_dwordx4 v200, v[196:199], s[52:53] sc1
    s_add_u32 s41, s43, 32
    s_lshl_b32 s41, s41, 12
    s_add_u32 s41, s41, s40
    s_add_u32 s52, s18, s41
    s_addc_u32 s53, s19, 0
    global_store_dwordx4 v200, v[196:199], s[52:53] sc1
    s_lshr_b32 s42, s100, 4
    s_add_u32 s42, s42, 56
    s_mul_i32 s40, s42, 81920
    s_add_u32 s40, s40, 83968000
    s_add_u32 s41, s43, 0
    s_lshl_b32 s41, s41, 12
    s_add_u32 s41, s41, s40
    s_add_u32 s52, s18, s41
    s_addc_u32 s53, s19, 0
    global_store_dwordx4 v200, v[196:199], s[52:53] sc1
    s_add_u32 s41, s43, 8
    s_min_u32 s41, s41, 9
    s_lshl_b32 s41, s41, 12
    s_add_u32 s41, s41, s40
    s_add_u32 s52, s18, s41
    s_addc_u32 s53, s19, 0
    global_store_dwordx4 v200, v[196:199], s[52:53] sc1
    s_mul_i32 s40, s42, 65536
    s_add_u32 s40, s40, 96468992
    s_add_u32 s41, s43, 0
    s_lshl_b32 s41, s41, 12
    s_add_u32 s41, s41, s40
    s_add_u32 s52, s18, s41
    s_addc_u32 s53, s19, 0
    global_store_dwordx4 v200, v[196:199], s[52:53] sc1
    s_add_u32 s41, s43, 8
    s_lshl_b32 s41, s41, 12
    s_add_u32 s41, s41, s40
    s_add_u32 s52, s18, s41
    s_addc_u32 s53, s19, 0
    global_store_dwordx4 v200, v[196:199], s[52:53] sc1
    s_mul_i32 s40, s42, 262144
    s_add_u32 s40, s40, 134217728
    s_sub_u32 s41, 0, s18
    s_and_b32 s41, s41, 0x1fffff
    s_add_u32 s40, s40, s41
    s_add_u32 s41, s43, 0
    s_lshl_b32 s41, s41, 12
    s_add_u32 s41, s41, s40
    s_add_u32 s52, s18, s41
    s_addc_u32 s53, s19, 0
    global_store_dwordx4 v200, v[196:199], s[52:53] sc1
    s_add_u32 s41, s43, 8
    s_lshl_b32 s41, s41, 12
    s_add_u32 s41, s41, s40
    s_add_u32 s52, s18, s41
    s_addc_u32 s53, s19, 0
    global_store_dwordx4 v200, v[196:199], s[52:53] sc1
    s_add_u32 s41, s43, 16
    s_lshl_b32 s41, s41, 12
    s_add_u32 s41, s41, s40
    s_add_u32 s52, s18, s41
    s_addc_u32 s53, s19, 0
    global_store_dwordx4 v200, v[196:199], s[52:53] sc1
    s_add_u32 s41, s43, 24
    s_lshl_b32 s41, s41, 12
    s_add_u32 s41, s41, s40
    s_add_u32 s52, s18, s41
    s_addc_u32 s53, s19, 0
    global_store_dwordx4 v200, v[196:199], s[52:53] sc1
    s_add_u32 s41, s43, 32
    s_lshl_b32 s41, s41, 12
    s_add_u32 s41, s41, s40
    s_add_u32 s52, s18, s41
    s_addc_u32 s53, s19, 0
    global_store_dwordx4 v200, v[196:199], s[52:53] sc1
    s_and_b32 s42, s43, 7
    s_lshl_b32 s42, s42, 13
    s_bitcmp1_b32 s100, 4
    s_cselect_b32 s40, 4194304, 0
    s_add_u32 s40, s40, 79429632
    s_add_u32 s40, s40, s42
    s_lshr_b32 s42, s100, 5
    s_lshl_b32 s42, s42, 16
    s_add_u32 s40, s40, s42
    s_add_u32 s52, s18, s40
    s_addc_u32 s53, s19, 0
    global_store_dwordx4 v200, v[196:199], s[52:53] sc1
    s_add_u32 s52, s52, 4096
    s_addc_u32 s53, s53, 0
    global_store_dwordx4 v200, v[196:199], s[52:53] sc1
    s_waitcnt vmcnt(0)
    s_barrier
    s_mov_b64 exec, s[48:49]
    global_atomic_add v18, v19, s[98:99] sc1
    s_mov_b64 exec, -1
    s_bitcmp1_b32 s100, 3
    s_cbranch_scc1 g1_end
    s_cmp_eq_u32 s26, 0
    s_cbranch_scc1 g1_end
    s_sub_u32 s29, 0, s18
    s_and_b32 s29, s29, 0x1fffff
    s_add_u32 s29, s29, 134414336
    s_lshl_b32 s40, s26, 21
    s_add_u32 s29, s29, s40
    s_mov_b64 s[50:51], -1
    s_mov_b32 s28, 0
    s_mov_b64 exec, 1
g1_wcl1:
    s_and_b32 s40, s28, 3
    s_lshl_b32 s40, s40, 14
    s_lshr_b32 s41, s28, 2
    s_lshl_b32 s41, s41, 8
    s_add_u32 s40, s40, s41
    s_add_u32 s40, s40, s29
    v_mov_b32 v5, s40
    v_add_u32 v6, 8192, v5
    s_waitcnt vmcnt(0)
    s_memtime s[70:71]
    s_waitcnt lgkmcnt(0)
    global_load_dword v4, v5, s[18:19] sc1
    s_waitcnt vmcnt(0)
    s_memtime s[72:73]
    s_waitcnt lgkmcnt(0)
    global_load_dword v4, v6, s[18:19] sc1
    s_waitcnt vmcnt(0)
    s_memtime s[74:75]
    s_waitcnt lgkmcnt(0)
    s_sub_u32 s74, s74, s72
    s_sub_u32 s72, s72, s70
    s_min_u32 s50, s50, s72
    s_min_u32 s51, s51, s74
    s_add_u32 s28, s28, 1
    s_cmp_lt_u32 s28, 16
    s_cbranch_scc1 g1_wcl1
    s_cmp_gt_u32 s51, s50
    s_cselect_b32 s41, 1, 0
    s_lshl_b32 s41, s41, s26
    s_add_u32 s41, s41, 256
    v_mov_b32 v4, s41
    v_mov_b32 v5, 72
    global_atomic_add v5, v4, s[98:99] sc1
    s_waitcnt vmcnt(0)
    s_mov_b64 exec, -1
    s_branch g1_end
g1_go:
    s_mov_b32 s20, s6
    s_and_b32 s21, s7, 0xffff
    s_mov_b32 s22, 2621440
    s_mov_b32 s23, 0x00020000
    v_lshrrev_b32 v4, 3, v3
    v_and_b32 v5, 7, v3
    v_xor_b32 v6, v5, v4
    v_mul_u32_u24 v9, 1280, v4
    v_lshl_add_u32 v9, v6, 4, v9
    s_mul_i32 s40, s3, 10240
    v_add_u32 v9, s40, v9
    s_mov_b32 s26, 0
    s_mov_b32 s27, s64
    s_min_u32 s29, s26, 31
    s_lshl_b32 s29, s29, 1
    s_add_u32 s29, s29, s31
    s_mul_i32 s29, s29, 40960
    s_add_u32 m0, s27, 0
    s_add_u32 s43, s29, 0
    buffer_load_dwordx4 v9, s[20:23], s43 offen lds
    s_add_u32 m0, s27, 4096
    s_add_u32 s43, s29, 128
    buffer_load_dwordx4 v9, s[20:23], s43 offen lds
    s_add_u32 m0, s27, 8192
    s_add_u32 s43, s29, 256
    buffer_load_dwordx4 v9, s[20:23], s43 offen lds
    s_add_u32 m0, s27, 12288
    s_add_u32 s43, s29, 384
    buffer_load_dwordx4 v9, s[20:23], s43 offen lds
    s_add_u32 m0, s27, 16384
    s_add_u32 s43, s29, 512
    buffer_load_dwordx4 v9, s[20:23], s43 offen lds
    s_add_u32 m0, s27, 20480
    s_add_u32 s43, s29, 640
    buffer_load_dwordx4 v9, s[20:23], s43 offen lds
    s_add_u32 m0, s27, 24576
    s_add_u32 s43, s29, 768
    buffer_load_dwordx4 v9, s[20:23], s43 offen lds
    s_add_u32 m0, s27, 28672
    s_add_u32 s43, s29, 896
    buffer_load_dwordx4 v9, s[20:23], s43 offen lds
    s_add_u32 m0, s27, 32768
    s_add_u32 s43, s29, 1024
    buffer_load_dwordx4 v9, s[20:23], s43 offen lds
    s_add_u32 m0, s27, 36864
    s_add_u32 s43, s29, 1152
    buffer_load_dwordx4 v9, s[20:23], s43 offen lds
    v_and_b32 v6, 3, v4
    v_lshlrev_b32 v6, 1, v6
    v_xor_b32 v5, v5, v6
    s_mov_b32 s25, 0
    v_mov_b32 v193, 0
    s_cmp_eq_u32 s5, 3
    s_cbranch_scc1 g1_dg
    s_cmp_eq_u32 s5, 1
    s_cselect_b32 s52, s10, s8
    s_cselect_b32 s53, s11, s9
    s_cmp_eq_u32 s5, 2
    s_cselect_b32 s52, s12, s52
    s_cselect_b32 s53, s13, s53
    s_mov_b32 s24, 65536
    s_lshl_b32 s40, s4, 7
    v_lshlrev_b32 v192, 13, v4
    v_lshl_add_u32 v192, v5, 4, v192
    v_add_u32 v192, s40, v192
    v_lshl_add_u64 v[20:21], v[192:193], 0, s[52:53]
    s_branch g1_dd
g1_dg:
    s_min_u32 s4, s4, 53
    s_mov_b32 s24, 27648
    v_and_b32 v6, 2, v5
    v_cmp_eq_u32 s[44:45], 0, v6
    v_mul_u32_u24 v192, 3456, v4
    v_lshrrev_b32 v6, 2, v5
    v_lshl_add_u32 v192, v6, 5, v192
    v_and_b32 v6, 1, v5
    v_lshl_add_u32 v192, v6, 4, v192
    s_lshl_b32 s40, s4, 6
    v_add_u32 v192, s40, v192
    v_mov_b32 v188, s16
    v_mov_b32 v189, s17
    v_mov_b32 v190, s14
    v_mov_b32 v191, s15
    v_cndmask_b32 v188, v188, v190, s[44:45]
    v_cndmask_b32 v189, v189, v191, s[44:45]
    v_lshl_add_u64 v[20:21], v[192:193], 0, v[188:189]
g1_dd:
    s_mul_i32 s42, s3, 30720
    s_add_u32 s42, s42, 40960
    v_lshrrev_b32 v4, 2, v1
    v_lshl_add_u32 v5, v2, 3, v4
    v_lshlrev_b32 v5, 7, v5
    v_lshl_add_u32 v5, v4, 5, v5
    v_and_b32 v6, 3, v1
    v_lshl_add_u32 v5, v6, 3, v5
    v_add_u32 v22, s42, v5
    v_xor_b32 v23, 32, v22
    v_xor_b32 v24, 64, v22
    v_xor_b32 v25, 96, v22
    s_add_u32 m0, s42, 0
    s_nop 0
    global_load_lds_dwordx4 v[20:21], off
    v_lshl_add_u64 v[20:21], v[20:21], 0, s[24:25]
    s_add_u32 m0, s42, 1024
    s_nop 0
    global_load_lds_dwordx4 v[20:21], off
    v_lshl_add_u64 v[20:21], v[20:21], 0, s[24:25]
    s_add_u32 m0, s42, 2048
    s_nop 0
    global_load_lds_dwordx4 v[20:21], off
    v_lshl_add_u64 v[20:21], v[20:21], 0, s[24:25]
    s_add_u32 m0, s42, 3072
    s_nop 0
    global_load_lds_dwordx4 v[20:21], off
    v_lshl_add_u64 v[20:21], v[20:21], 0, s[24:25]
    s_add_u32 m0, s42, 4096
    s_nop 0
    global_load_lds_dwordx4 v[20:21], off
    v_lshl_add_u64 v[20:21], v[20:21], 0, s[24:25]
    s_add_u32 m0, s42, 5120
    s_nop 0
    global_load_lds_dwordx4 v[20:21], off
    v_lshl_add_u64 v[20:21], v[20:21], 0, s[24:25]
    s_add_u32 m0, s42, 6144
    s_nop 0
    global_load_lds_dwordx4 v[20:21], off
    v_lshl_add_u64 v[20:21], v[20:21], 0, s[24:25]
    s_add_u32 m0, s42, 7168
    s_nop 0
    global_load_lds_dwordx4 v[20:21], off
    v_lshl_add_u64 v[20:21], v[20:21], 0, s[24:25]
    s_add_u32 m0, s42, 8192
    s_nop 0
    global_load_lds_dwordx4 v[20:21], off
    v_lshl_add_u64 v[20:21], v[20:21], 0, s[24:25]
    s_add_u32 m0, s42, 9216
    s_nop 0
    global_load_lds_dwordx4 v[20:21], off
    v_lshl_add_u64 v[20:21], v[20:21], 0, s[24:25]
    s_add_u32 m0, s42, 10240
    s_nop 0
    global_load_lds_dwordx4 v[20:21], off
    v_lshl_add_u64 v[20:21], v[20:21], 0, s[24:25]
    s_add_u32 m0, s42, 11264
    s_nop 0
    global_load_lds_dwordx4 v[20:21], off
    v_lshl_add_u64 v[20:21], v[20:21], 0, s[24:25]
    s_add_u32 m0, s42, 12288
    s_nop 0
    global_load_lds_dwordx4 v[20:21], off
    v_lshl_add_u64 v[20:21], v[20:21], 0, s[24:25]
    s_add_u32 m0, s42, 13312
    s_nop 0
    global_load_lds_dwordx4 v[20:21], off
    v_lshl_add_u64 v[20:21], v[20:21], 0, s[24:25]
    s_add_u32 m0, s42, 14336
    s_nop 0
    global_load_lds_dwordx4 v[20:21], off
    v_lshl_add_u64 v[20:21], v[20:21], 0, s[24:25]
    s_add_u32 m0, s42, 15360
    s_nop 0
    global_load_lds_dwordx4 v[20:21], off
    v_lshl_add_u64 v[20:21], v[20:21], 0, s[24:25]
    s_add_u32 m0, s42, 16384
    s_nop 0
    global_load_lds_dwordx4 v[20:21], off
    v_lshl_add_u64 v[20:21], v[20:21], 0, s[24:25]
    s_add_u32 m0, s42, 17408
    s_nop 0
    global_load_lds_dwordx4 v[20:21], off
    v_lshl_add_u64 v[20:21], v[20:21], 0, s[24:25]
    s_add_u32 m0, s42, 18432
    s_nop 0
    global_load_lds_dwordx4 v[20:21], off
    v_lshl_add_u64 v[20:21], v[20:21], 0, s[24:25]
    s_add_u32 m0, s42, 19456
    s_nop 0
    global_load_lds_dwordx4 v[20:21], off
    v_lshl_add_u64 v[20:21], v[20:21], 0, s[24:25]
    s_add_u32 m0, s42, 20480
    s_nop 0
    global_load_lds_dwordx4 v[20:21], off
    v_lshl_add_u64 v[20:21], v[20:21], 0, s[24:25]
    s_add_u32 m0, s42, 21504
    s_nop 0
    global_load_lds_dwordx4 v[20:21], off
    v_lshl_add_u64 v[20:21], v[20:21], 0, s[24:25]
    s_add_u32 m0, s42, 22528
    s_nop 0
    global_load_lds_dwordx4 v[20:21], off
    v_lshl_add_u64 v[20:21], v[20:21], 0, s[24:25]
    s_add_u32 m0, s42, 23552
    s_nop 0
    global_load_lds_dwordx4 v[20:21], off
    v_lshl_add_u64 v[20:21], v[20:21], 0, s[24:25]
    s_add_u32 m0, s42, 24576
    s_nop 0
    global_load_lds_dwordx4 v[20:21], off
    v_lshl_add_u64 v[20:21], v[20:21], 0, s[24:25]
    s_add_u32 m0, s42, 25600
    s_nop 0
    global_load_lds_dwordx4 v[20:21], off
    v_lshl_add_u64 v[20:21], v[20:21], 0, s[24:25]
    s_add_u32 m0, s42, 26624
    s_nop 0
    global_load_lds_dwordx4 v[20:21], off
    v_lshl_add_u64 v[20:21], v[20:21], 0, s[24:25]
    s_add_u32 m0, s42, 27648
    s_nop 0
    global_load_lds_dwordx4 v[20:21], off
    v_lshl_add_u64 v[20:21], v[20:21], 0, s[24:25]
    v_and_b32 v4, 7, v1
    v_xor_b32 v4, v4, v2
    v_lshlrev_b32 v4, 4, v4
    v_lshl_add_u32 v10, v1, 7, v4
    v_xor_b32 v11, 64, v10
    v_mov_b32 v12, v10
    v_mov_b32 v13, v11
    s_mov_b32 s28, 40960
    s_mov_b32 s54, 3222493025
    s_mov_b32 s55, 1027024659
    v_lshlrev_b32 v7, 4, v3
    s_cmp_eq_u32 s5, 2
    s_cbranch_scc1 g1_sV
    s_cmp_lg_u32 s5, 1
    s_cbranch_scc1 g1_sN
    s_waitcnt vmcnt(24)
    s_barrier
    ds_read_b128 v[28:31], v12 offset:0
    ds_read_b128 v[32:35], v12 offset:2048
    ds_read_b64_tr_b16 a[0:1], v22 offset:0
    ds_read_b64_tr_b16 a[2:3], v22 offset:512
    ds_read_b64_tr_b16 a[4:5], v23 offset:0
    ds_read_b64_tr_b16 a[6:7], v23 offset:512
    ds_read_b64_tr_b16 a[8:9], v24 offset:0
    ds_read_b64_tr_b16 a[10:11], v24 offset:512
    ds_read_b64_tr_b16 a[12:13], v25 offset:0
    ds_read_b64_tr_b16 a[14:15], v25 offset:512
    s_waitcnt lgkmcnt(0)
    s_add_u32 m0, s42, 0
    s_nop 0
    global_load_lds_dwordx4 v[20:21], off
    v_lshl_add_u64 v[20:21], v[20:21], 0, s[24:25]
    s_add_u32 m0, s42, 1024
    s_nop 0
    global_load_lds_dwordx4 v[20:21], off
    v_lshl_add_u64 v[20:21], v[20:21], 0, s[24:25]
    s_add_u32 m0, s42, 2048
    s_nop 0
    global_load_lds_dwordx4 v[20:21], off
    v_lshl_add_u64 v[20:21], v[20:21], 0, s[24:25]
    s_add_u32 m0, s42, 3072
    s_nop 0
    global_load_lds_dwordx4 v[20:21], off
    v_lshl_add_u64 v[20:21], v[20:21], 0, s[24:25]
    v_mfma_f32_16x16x32_bf16 v[60:63], a[0:3], v[28:31], 0
    v_mfma_f32_16x16x32_bf16 v[64:67], a[4:7], v[28:31], 0
    v_mfma_f32_16x16x32_bf16 v[68:71], a[8:11], v[28:31], 0
    v_mfma_f32_16x16x32_bf16 v[72:75], a[12:15], v[28:31], 0
    v_mfma_f32_16x16x32_bf16 v[76:79], a[0:3], v[32:35], 0
    v_mfma_f32_16x16x32_bf16 v[80:83], a[4:7], v[32:35], 0
    v_mfma_f32_16x16x32_bf16 v[84:87], a[8:11], v[32:35], 0
    v_mfma_f32_16x16x32_bf16 v[88:91], a[12:15], v[32:35], 0
    s_waitcnt vmcnt(24)
    ds_read_b128 v[36:39], v13 offset:0
    ds_read_b128 v[40:43], v13 offset:2048
    ds_read_b64_tr_b16 a[16:17], v22 offset:4096
    ds_read_b64_tr_b16 a[18:19], v22 offset:4608
    ds_read_b64_tr_b16 a[20:21], v23 offset:4096
    ds_read_b64_tr_b16 a[22:23], v23 offset:4608
    ds_read_b64_tr_b16 a[24:25], v24 offset:4096
    ds_read_b64_tr_b16 a[26:27], v24 offset:4608
    ds_read_b64_tr_b16 a[28:29], v25 offset:4096
    ds_read_b64_tr_b16 a[30:31], v25 offset:4608
    s_waitcnt lgkmcnt(0)
    s_add_u32 m0, s42, 4096
    s_nop 0
    global_load_lds_dwordx4 v[20:21], off
    v_lshl_add_u64 v[20:21], v[20:21], 0, s[24:25]
    s_add_u32 m0, s42, 5120
    s_nop 0
    global_load_lds_dwordx4 v[20:21], off
    v_lshl_add_u64 v[20:21], v[20:21], 0, s[24:25]
    s_add_u32 m0, s42, 6144
    s_nop 0
    global_load_lds_dwordx4 v[20:21], off
    v_lshl_add_u64 v[20:21], v[20:21], 0, s[24:25]
    s_add_u32 m0, s42, 7168
    s_nop 0
    global_load_lds_dwordx4 v[20:21], off
    v_lshl_add_u64 v[20:21], v[20:21], 0, s[24:25]
    v_mfma_f32_16x16x32_bf16 v[60:63], a[16:19], v[36:39], v[60:63]
    v_mfma_f32_16x16x32_bf16 v[64:67], a[20:23], v[36:39], v[64:67]
    v_mfma_f32_16x16x32_bf16 v[68:71], a[24:27], v[36:39], v[68:71]
    v_mfma_f32_16x16x32_bf16 v[72:75], a[28:31], v[36:39], v[72:75]
    v_mfma_f32_16x16x32_bf16 v[76:79], a[16:19], v[40:43], v[76:79]
    v_mfma_f32_16x16x32_bf16 v[80:83], a[20:23], v[40:43], v[80:83]
    v_mfma_f32_16x16x32_bf16 v[84:87], a[24:27], v[40:43], v[84:87]
    v_mfma_f32_16x16x32_bf16 v[88:91], a[28:31], v[40:43], v[88:91]
    s_waitcnt vmcnt(24)
    ds_read_b128 v[44:47], v12 offset:4096
    ds_read_b128 v[48:51], v12 offset:6144
    ds_read_b64_tr_b16 a[32:33], v22 offset:8192
    ds_read_b64_tr_b16 a[34:35], v22 offset:8704
    ds_read_b64_tr_b16 a[36:37], v23 offset:8192
    ds_read_b64_tr_b16 a[38:39], v23 offset:8704
    ds_read_b64_tr_b16 a[40:41], v24 offset:8192
    ds_read_b64_tr_b16 a[42:43], v24 offset:8704
    ds_read_b64_tr_b16 a[44:45], v25 offset:8192
    ds_read_b64_tr_b16 a[46:47], v25 offset:8704
    s_waitcnt lgkmcnt(0)
    s_add_u32 m0, s42, 8192
    s_nop 0
    global_load_lds_dwordx4 v[20:21], off
    v_lshl_add_u64 v[20:21], v[20:21], 0, s[24:25]
    s_add_u32 m0, s42, 9216
    s_nop 0
    global_load_lds_dwordx4 v[20:21], off
    v_lshl_add_u64 v[20:21], v[20:21], 0, s[24:25]
    s_add_u32 m0, s42, 10240
    s_nop 0
    global_load_lds_dwordx4 v[20:21], off
    v_lshl_add_u64 v[20:21], v[20:21], 0, s[24:25]
    s_add_u32 m0, s42, 11264
    s_nop 0
    global_load_lds_dwordx4 v[20:21], off
    v_lshl_add_u64 v[20:21], v[20:21], 0, s[24:25]
    v_mfma_f32_16x16x32_bf16 v[60:63], a[32:35], v[44:47], v[60:63]
    v_mfma_f32_16x16x32_bf16 v[64:67], a[36:39], v[44:47], v[64:67]
    v_mfma_f32_16x16x32_bf16 v[68:71], a[40:43], v[44:47], v[68:71]
    v_mfma_f32_16x16x32_bf16 v[72:75], a[44:47], v[44:47], v[72:75]
    v_mfma_f32_16x16x32_bf16 v[76:79], a[32:35], v[48:51], v[76:79]
    v_mfma_f32_16x16x32_bf16 v[80:83], a[36:39], v[48:51], v[80:83]
    v_mfma_f32_16x16x32_bf16 v[84:87], a[40:43], v[48:51], v[84:87]
    v_mfma_f32_16x16x32_bf16 v[88:91], a[44:47], v[48:51], v[88:91]
    s_waitcnt vmcnt(24)
    ds_read_b128 v[52:55], v13 offset:4096
    ds_read_b128 v[56:59], v13 offset:6144
    ds_read_b64_tr_b16 a[48:49], v22 offset:12288
    ds_read_b64_tr_b16 a[50:51], v22 offset:12800
    ds_read_b64_tr_b16 a[52:53], v23 offset:12288
    ds_read_b64_tr_b16 a[54:55], v23 offset:12800
    ds_read_b64_tr_b16 a[56:57], v24 offset:12288
    ds_read_b64_tr_b16 a[58:59], v24 offset:12800
    ds_read_b64_tr_b16 a[60:61], v25 offset:12288
    ds_read_b64_tr_b16 a[62:63], v25 offset:12800
    s_waitcnt lgkmcnt(0)
    s_add_u32 m0, s42, 12288
    s_nop 0
    global_load_lds_dwordx4 v[20:21], off
    v_lshl_add_u64 v[20:21], v[20:21], 0, s[24:25]
    s_add_u32 m0, s42, 13312
    s_nop 0
    global_load_lds_dwordx4 v[20:21], off
    v_lshl_add_u64 v[20:21], v[20:21], 0, s[24:25]
    s_add_u32 m0, s42, 14336
    s_nop 0
    global_load_lds_dwordx4 v[20:21], off
    v_lshl_add_u64 v[20:21], v[20:21], 0, s[24:25]
    s_add_u32 m0, s42, 15360
    s_nop 0
    global_load_lds_dwordx4 v[20:21], off
    v_lshl_add_u64 v[20:21], v[20:21], 0, s[24:25]
    v_mfma_f32_16x16x32_bf16 v[60:63], a[48:51], v[52:55], v[60:63]
    v_mfma_f32_16x16x32_bf16 v[64:67], a[52:55], v[52:55], v[64:67]
    v_mfma_f32_16x16x32_bf16 v[68:71], a[56:59], v[52:55], v[68:71]
    v_mfma_f32_16x16x32_bf16 v[72:75], a[60:63], v[52:55], v[72:75]
    v_mfma_f32_16x16x32_bf16 v[76:79], a[48:51], v[56:59], v[76:79]
    v_mfma_f32_16x16x32_bf16 v[80:83], a[52:55], v[56:59], v[80:83]
    v_mfma_f32_16x16x32_bf16 v[84:87], a[56:59], v[56:59], v[84:87]
    v_mfma_f32_16x16x32_bf16 v[88:91], a[60:63], v[56:59], v[88:91]
    s_waitcnt vmcnt(24)
    ds_read_b128 v[28:31], v12 offset:8192
    ds_read_b128 v[32:35], v12 offset:10240
    ds_read_b64_tr_b16 a[64:65], v22 offset:16384
    ds_read_b64_tr_b16 a[66:67], v22 offset:16896
    ds_read_b64_tr_b16 a[68:69], v23 offset:16384
    ds_read_b64_tr_b16 a[70:71], v23 offset:16896
    ds_read_b64_tr_b16 a[72:73], v24 offset:16384
    ds_read_b64_tr_b16 a[74:75], v24 offset:16896
    ds_read_b64_tr_b16 a[76:77], v25 offset:16384
    ds_read_b64_tr_b16 a[78:79], v25 offset:16896
    s_waitcnt lgkmcnt(0)
    s_add_u32 m0, s42, 16384
    s_nop 0
    global_load_lds_dwordx4 v[20:21], off
    v_lshl_add_u64 v[20:21], v[20:21], 0, s[24:25]
    s_add_u32 m0, s42, 17408
    s_nop 0
    global_load_lds_dwordx4 v[20:21], off
    v_lshl_add_u64 v[20:21], v[20:21], 0, s[24:25]
    s_add_u32 m0, s42, 18432
    s_nop 0
    global_load_lds_dwordx4 v[20:21], off
    v_lshl_add_u64 v[20:21], v[20:21], 0, s[24:25]
    s_add_u32 m0, s42, 19456
    s_nop 0
    global_load_lds_dwordx4 v[20:21], off
    v_lshl_add_u64 v[20:21], v[20:21], 0, s[24:25]
    v_mfma_f32_16x16x32_bf16 v[60:63], a[64:67], v[28:31], v[60:63]
    v_mfma_f32_16x16x32_bf16 v[64:67], a[68:71], v[28:31], v[64:67]
    v_mfma_f32_16x16x32_bf16 v[68:71], a[72:75], v[28:31], v[68:71]
    v_mfma_f32_16x16x32_bf16 v[72:75], a[76:79], v[28:31], v[72:75]
    v_mfma_f32_16x16x32_bf16 v[76:79], a[64:67], v[32:35], v[76:79]
    v_mfma_f32_16x16x32_bf16 v[80:83], a[68:71], v[32:35], v[80:83]
    v_mfma_f32_16x16x32_bf16 v[84:87], a[72:75], v[32:35], v[84:87]
    v_mfma_f32_16x16x32_bf16 v[88:91], a[76:79], v[32:35], v[88:91]
    s_waitcnt vmcnt(24)
    ds_read_b128 v[36:39], v13 offset:8192
    ds_read_b128 v[40:43], v13 offset:10240
    ds_read_b64_tr_b16 a[80:81], v22 offset:20480
    ds_read_b64_tr_b16 a[82:83], v22 offset:20992
    ds_read_b64_tr_b16 a[84:85], v23 offset:20480
    ds_read_b64_tr_b16 a[86:87], v23 offset:20992
    ds_read_b64_tr_b16 a[88:89], v24 offset:20480
    ds_read_b64_tr_b16 a[90:91], v24 offset:20992
    ds_read_b64_tr_b16 a[92:93], v25 offset:20480
    ds_read_b64_tr_b16 a[94:95], v25 offset:20992
    s_waitcnt lgkmcnt(0)
    s_add_u32 m0, s42, 20480
    s_nop 0
    global_load_lds_dwordx4 v[20:21], off
    v_lshl_add_u64 v[20:21], v[20:21], 0, s[24:25]
    s_add_u32 m0, s42, 21504
    s_nop 0
    global_load_lds_dwordx4 v[20:21], off
    v_lshl_add_u64 v[20:21], v[20:21], 0, s[24:25]
    s_add_u32 m0, s42, 22528
    s_nop 0
    global_load_lds_dwordx4 v[20:21], off
    v_lshl_add_u64 v[20:21], v[20:21], 0, s[24:25]
    s_add_u32 m0, s42, 23552
    s_nop 0
    global_load_lds_dwordx4 v[20:21], off
    v_lshl_add_u64 v[20:21], v[20:21], 0, s[24:25]
    v_mfma_f32_16x16x32_bf16 v[60:63], a[80:83], v[36:39], v[60:63]
    v_mfma_f32_16x16x32_bf16 v[64:67], a[84:87], v[36:39], v[64:67]
    v_mfma_f32_16x16x32_bf16 v[68:71], a[88:91], v[36:39], v[68:71]
    v_mfma_f32_16x16x32_bf16 v[72:75], a[92:95], v[36:39], v[72:75]
    v_mfma_f32_16x16x32_bf16 v[76:79], a[80:83], v[40:43], v[76:79]
    v_mfma_f32_16x16x32_bf16 v[80:83], a[84:87], v[40:43], v[80:83]
    v_mfma_f32_16x16x32_bf16 v[84:87], a[88:91], v[40:43], v[84:87]
    v_mfma_f32_16x16x32_bf16 v[88:91], a[92:95], v[40:43], v[88:91]
    s_waitcnt vmcnt(24)
    ds_read_b128 v[44:47], v12 offset:12288
    ds_read_b128 v[48:51], v12 offset:14336
    ds_read_b64_tr_b16 a[96:97], v22 offset:24576
    ds_read_b64_tr_b16 a[98:99], v22 offset:25088
    ds_read_b64_tr_b16 a[100:101], v23 offset:24576
    ds_read_b64_tr_b16 a[102:103], v23 offset:25088
    ds_read_b64_tr_b16 a[104:105], v24 offset:24576
    ds_read_b64_tr_b16 a[106:107], v24 offset:25088
    ds_read_b64_tr_b16 a[108:109], v25 offset:24576
    ds_read_b64_tr_b16 a[110:111], v25 offset:25088
    s_waitcnt lgkmcnt(0)
    s_add_u32 m0, s42, 24576
    s_nop 0
    global_load_lds_dwordx4 v[20:21], off
    v_lshl_add_u64 v[20:21], v[20:21], 0, s[24:25]
    s_add_u32 m0, s42, 25600
    s_nop 0
    global_load_lds_dwordx4 v[20:21], off
    v_lshl_add_u64 v[20:21], v[20:21], 0, s[24:25]
    s_add_u32 m0, s42, 26624
    s_nop 0
    global_load_lds_dwordx4 v[20:21], off
    v_lshl_add_u64 v[20:21], v[20:21], 0, s[24:25]
    s_add_u32 m0, s42, 27648
    s_nop 0
    global_load_lds_dwordx4 v[20:21], off
    v_lshl_add_u64 v[20:21], v[20:21], 0, s[24:25]
    v_mfma_f32_16x16x32_bf16 v[60:63], a[96:99], v[44:47], v[60:63]
    v_mfma_f32_16x16x32_bf16 v[64:67], a[100:103], v[44:47], v[64:67]
    v_mfma_f32_16x16x32_bf16 v[68:71], a[104:107], v[44:47], v[68:71]
    v_mfma_f32_16x16x32_bf16 v[72:75], a[108:111], v[44:47], v[72:75]
    v_mfma_f32_16x16x32_bf16 v[76:79], a[96:99], v[48:51], v[76:79]
    v_mfma_f32_16x16x32_bf16 v[80:83], a[100:103], v[48:51], v[80:83]
    v_mfma_f32_16x16x32_bf16 v[84:87], a[104:107], v[48:51], v[84:87]
    v_mfma_f32_16x16x32_bf16 v[88:91], a[108:111], v[48:51], v[88:91]
    s_waitcnt vmcnt(24)
    ds_read_b128 v[52:55], v13 offset:12288
    ds_read_b128 v[56:59], v13 offset:14336
    ds_read_b64_tr_b16 a[112:113], v22 offset:0
    ds_read_b64_tr_b16 a[114:115], v22 offset:512
    ds_read_b64_tr_b16 a[116:117], v23 offset:0
    ds_read_b64_tr_b16 a[118:119], v23 offset:512
    ds_read_b64_tr_b16 a[120:121], v24 offset:0
    ds_read_b64_tr_b16 a[122:123], v24 offset:512
    ds_read_b64_tr_b16 a[124:125], v25 offset:0
    ds_read_b64_tr_b16 a[126:127], v25 offset:512
    s_waitcnt lgkmcnt(0)
    s_add_u32 m0, s42, 0
    s_nop 0
    global_load_lds_dwordx4 v[20:21], off
    v_lshl_add_u64 v[20:21], v[20:21], 0, s[24:25]
    s_add_u32 m0, s42, 1024
    s_nop 0
    global_load_lds_dwordx4 v[20:21], off
    v_lshl_add_u64 v[20:21], v[20:21], 0, s[24:25]
    s_add_u32 m0, s42, 2048
    s_nop 0
    global_load_lds_dwordx4 v[20:21], off
    v_lshl_add_u64 v[20:21], v[20:21], 0, s[24:25]
    s_add_u32 m0, s42, 3072
    s_nop 0
    global_load_lds_dwordx4 v[20:21], off
    v_lshl_add_u64 v[20:21], v[20:21], 0, s[24:25]
    v_mfma_f32_16x16x32_bf16 v[60:63], a[112:115], v[52:55], v[60:63]
    v_mfma_f32_16x16x32_bf16 v[64:67], a[116:119], v[52:55], v[64:67]
    v_mfma_f32_16x16x32_bf16 v[68:71], a[120:123], v[52:55], v[68:71]
    v_mfma_f32_16x16x32_bf16 v[72:75], a[124:127], v[52:55], v[72:75]
    v_mfma_f32_16x16x32_bf16 v[76:79], a[112:115], v[56:59], v[76:79]
    v_mfma_f32_16x16x32_bf16 v[80:83], a[116:119], v[56:59], v[80:83]
    v_mfma_f32_16x16x32_bf16 v[84:87], a[120:123], v[56:59], v[84:87]
    v_mfma_f32_16x16x32_bf16 v[88:91], a[124:127], v[56:59], v[88:91]
    s_waitcnt vmcnt(24)
    ds_read_b128 v[28:31], v12 offset:16384
    ds_read_b128 v[32:35], v12 offset:18432
    ds_read_b64_tr_b16 a[128:129], v22 offset:4096
    ds_read_b64_tr_b16 a[130:131], v22 offset:4608
    ds_read_b64_tr_b16 a[132:133], v23 offset:4096
    ds_read_b64_tr_b16 a[134:135], v23 offset:4608
    ds_read_b64_tr_b16 a[136:137], v24 offset:4096
    ds_read_b64_tr_b16 a[138:139], v24 offset:4608
    ds_read_b64_tr_b16 a[140:141], v25 offset:4096
    ds_read_b64_tr_b16 a[142:143], v25 offset:4608
    s_waitcnt lgkmcnt(0)
    s_add_u32 m0, s42, 4096
    s_nop 0
    global_load_lds_dwordx4 v[20:21], off
    v_lshl_add_u64 v[20:21], v[20:21], 0, s[24:25]
    s_add_u32 m0, s42, 5120
    s_nop 0
    global_load_lds_dwordx4 v[20:21], off
    v_lshl_add_u64 v[20:21], v[20:21], 0, s[24:25]
    s_add_u32 m0, s42, 6144
    s_nop 0
    global_load_lds_dwordx4 v[20:21], off
    v_lshl_add_u64 v[20:21], v[20:21], 0, s[24:25]
    s_add_u32 m0, s42, 7168
    s_nop 0
    global_load_lds_dwordx4 v[20:21], off
    v_lshl_add_u64 v[20:21], v[20:21], 0, s[24:25]
    v_mfma_f32_16x16x32_bf16 v[60:63], a[128:131], v[28:31], v[60:63]
    v_mfma_f32_16x16x32_bf16 v[64:67], a[132:135], v[28:31], v[64:67]
    v_mfma_f32_16x16x32_bf16 v[68:71], a[136:139], v[28:31], v[68:71]
    v_mfma_f32_16x16x32_bf16 v[72:75], a[140:143], v[28:31], v[72:75]
    v_mfma_f32_16x16x32_bf16 v[76:79], a[128:131], v[32:35], v[76:79]
    v_mfma_f32_16x16x32_bf16 v[80:83], a[132:135], v[32:35], v[80:83]
    v_mfma_f32_16x16x32_bf16 v[84:87], a[136:139], v[32:35], v[84:87]
    v_mfma_f32_16x16x32_bf16 v[88:91], a[140:143], v[32:35], v[88:91]
    s_waitcnt vmcnt(24)
    ds_read_b128 v[36:39], v13 offset:16384
    ds_read_b128 v[40:43], v13 offset:18432
    ds_read_b64_tr_b16 a[144:145], v22 offset:8192
    ds_read_b64_tr_b16 a[146:147], v22 offset:8704
    ds_read_b64_tr_b16 a[148:149], v23 offset:8192
    ds_read_b64_tr_b16 a[150:151], v23 offset:8704
    ds_read_b64_tr_b16 a[152:153], v24 offset:8192
    ds_read_b64_tr_b16 a[154:155], v24 offset:8704
    ds_read_b64_tr_b16 a[156:157], v25 offset:8192
    ds_read_b64_tr_b16 a[158:159], v25 offset:8704
    s_waitcnt lgkmcnt(0)
    s_add_u32 m0, s42, 8192
    s_nop 0
    global_load_lds_dwordx4 v[20:21], off
    v_lshl_add_u64 v[20:21], v[20:21], 0, s[24:25]
    s_add_u32 m0, s42, 9216
    s_nop 0
    global_load_lds_dwordx4 v[20:21], off
    v_lshl_add_u64 v[20:21], v[20:21], 0, s[24:25]
    s_add_u32 m0, s42, 10240
    s_nop 0
    global_load_lds_dwordx4 v[20:21], off
    v_lshl_add_u64 v[20:21], v[20:21], 0, s[24:25]
    s_add_u32 m0, s42, 11264
    s_nop 0
    global_load_lds_dwordx4 v[20:21], off
    v_lshl_add_u64 v[20:21], v[20:21], 0, s[24:25]
    v_mfma_f32_16x16x32_bf16 v[60:63], a[144:147], v[36:39], v[60:63]
    v_mfma_f32_16x16x32_bf16 v[64:67], a[148:151], v[36:39], v[64:67]
    v_mfma_f32_16x16x32_bf16 v[68:71], a[152:155], v[36:39], v[68:71]
    v_mfma_f32_16x16x32_bf16 v[72:75], a[156:159], v[36:39], v[72:75]
    v_mfma_f32_16x16x32_bf16 v[76:79], a[144:147], v[40:43], v[76:79]
    v_mfma_f32_16x16x32_bf16 v[80:83], a[148:151], v[40:43], v[80:83]
    v_mfma_f32_16x16x32_bf16 v[84:87], a[152:155], v[40:43], v[84:87]
    v_mfma_f32_16x16x32_bf16 v[88:91], a[156:159], v[40:43], v[88:91]
    s_waitcnt vmcnt(24)
    ds_read_b128 v[44:47], v12 offset:20480
    ds_read_b128 v[48:51], v12 offset:22528
    ds_read_b64_tr_b16 a[160:161], v22 offset:12288
    ds_read_b64_tr_b16 a[162:163], v22 offset:12800
    ds_read_b64_tr_b16 a[164:165], v23 offset:12288
    ds_read_b64_tr_b16 a[166:167], v23 offset:12800
    ds_read_b64_tr_b16 a[168:169], v24 offset:12288
    ds_read_b64_tr_b16 a[170:171], v24 offset:12800
    ds_read_b64_tr_b16 a[172:173], v25 offset:12288
    ds_read_b64_tr_b16 a[174:175], v25 offset:12800
    s_waitcnt lgkmcnt(0)
    s_add_u32 m0, s42, 12288
    s_nop 0
    global_load_lds_dwordx4 v[20:21], off
    v_lshl_add_u64 v[20:21], v[20:21], 0, s[24:25]
    s_add_u32 m0, s42, 13312
    s_nop 0
    global_load_lds_dwordx4 v[20:21], off
    v_lshl_add_u64 v[20:21], v[20:21], 0, s[24:25]
    s_add_u32 m0, s42, 14336
    s_nop 0
    global_load_lds_dwordx4 v[20:21], off
    v_lshl_add_u64 v[20:21], v[20:21], 0, s[24:25]
    s_add_u32 m0, s42, 15360
    s_nop 0
    global_load_lds_dwordx4 v[20:21], off
    v_lshl_add_u64 v[20:21], v[20:21], 0, s[24:25]
    v_mfma_f32_16x16x32_bf16 v[60:63], a[160:163], v[44:47], v[60:63]
    v_mfma_f32_16x16x32_bf16 v[64:67], a[164:167], v[44:47], v[64:67]
    v_mfma_f32_16x16x32_bf16 v[68:71], a[168:171], v[44:47], v[68:71]
    v_mfma_f32_16x16x32_bf16 v[72:75], a[172:175], v[44:47], v[72:75]
    v_mfma_f32_16x16x32_bf16 v[76:79], a[160:163], v[48:51], v[76:79]
    v_mfma_f32_16x16x32_bf16 v[80:83], a[164:167], v[48:51], v[80:83]
    v_mfma_f32_16x16x32_bf16 v[84:87], a[168:171], v[48:51], v[84:87]
    v_mfma_f32_16x16x32_bf16 v[88:91], a[172:175], v[48:51], v[88:91]
    s_waitcnt vmcnt(24)
    ds_read_b128 v[52:55], v13 offset:20480
    ds_read_b128 v[56:59], v13 offset:22528
    ds_read_b64_tr_b16 a[176:177], v22 offset:16384
    ds_read_b64_tr_b16 a[178:179], v22 offset:16896
    ds_read_b64_tr_b16 a[180:181], v23 offset:16384
    ds_read_b64_tr_b16 a[182:183], v23 offset:16896
    ds_read_b64_tr_b16 a[184:185], v24 offset:16384
    ds_read_b64_tr_b16 a[186:187], v24 offset:16896
    ds_read_b64_tr_b16 a[188:189], v25 offset:16384
    ds_read_b64_tr_b16 a[190:191], v25 offset:16896
    s_waitcnt lgkmcnt(0)
    s_add_u32 m0, s42, 16384
    s_nop 0
    global_load_lds_dwordx4 v[20:21], off
    v_lshl_add_u64 v[20:21], v[20:21], 0, s[24:25]
    s_add_u32 m0, s42, 17408
    s_nop 0
    global_load_lds_dwordx4 v[20:21], off
    v_lshl_add_u64 v[20:21], v[20:21], 0, s[24:25]
    s_add_u32 m0, s42, 18432
    s_nop 0
    global_load_lds_dwordx4 v[20:21], off
    v_lshl_add_u64 v[20:21], v[20:21], 0, s[24:25]
    s_add_u32 m0, s42, 19456
    s_nop 0
    global_load_lds_dwordx4 v[20:21], off
    v_lshl_add_u64 v[20:21], v[20:21], 0, s[24:25]
    v_mfma_f32_16x16x32_bf16 v[60:63], a[176:179], v[52:55], v[60:63]
    v_mfma_f32_16x16x32_bf16 v[64:67], a[180:183], v[52:55], v[64:67]
    v_mfma_f32_16x16x32_bf16 v[68:71], a[184:187], v[52:55], v[68:71]
    v_mfma_f32_16x16x32_bf16 v[72:75], a[188:191], v[52:55], v[72:75]
    v_mfma_f32_16x16x32_bf16 v[76:79], a[176:179], v[56:59], v[76:79]
    v_mfma_f32_16x16x32_bf16 v[80:83], a[180:183], v[56:59], v[80:83]
    v_mfma_f32_16x16x32_bf16 v[84:87], a[184:187], v[56:59], v[84:87]
    v_mfma_f32_16x16x32_bf16 v[88:91], a[188:191], v[56:59], v[88:91]
    s_waitcnt vmcnt(24)
    ds_read_b128 v[28:31], v12 offset:24576
    ds_read_b128 v[32:35], v12 offset:26624
    ds_read_b64_tr_b16 a[192:193], v22 offset:20480
    ds_read_b64_tr_b16 a[194:195], v22 offset:20992
    ds_read_b64_tr_b16 a[196:197], v23 offset:20480
    ds_read_b64_tr_b16 a[198:199], v23 offset:20992
    ds_read_b64_tr_b16 a[200:201], v24 offset:20480
    ds_read_b64_tr_b16 a[202:203], v24 offset:20992
    ds_read_b64_tr_b16 a[204:205], v25 offset:20480
    ds_read_b64_tr_b16 a[206:207], v25 offset:20992
    s_waitcnt lgkmcnt(0)
    s_add_u32 m0, s42, 20480
    s_nop 0
    global_load_lds_dwordx4 v[20:21], off
    v_lshl_add_u64 v[20:21], v[20:21], 0, s[24:25]
    s_add_u32 m0, s42, 21504
    s_nop 0
    global_load_lds_dwordx4 v[20:21], off
    v_lshl_add_u64 v[20:21], v[20:21], 0, s[24:25]
    s_add_u32 m0, s42, 22528
    s_nop 0
    global_load_lds_dwordx4 v[20:21], off
    v_lshl_add_u64 v[20:21], v[20:21], 0, s[24:25]
    s_add_u32 m0, s42, 23552
    s_nop 0
    global_load_lds_dwordx4 v[20:21], off
    v_lshl_add_u64 v[20:21], v[20:21], 0, s[24:25]
    v_mfma_f32_16x16x32_bf16 v[60:63], a[192:195], v[28:31], v[60:63]
    v_mfma_f32_16x16x32_bf16 v[64:67], a[196:199], v[28:31], v[64:67]
    v_mfma_f32_16x16x32_bf16 v[68:71], a[200:203], v[28:31], v[68:71]
    v_mfma_f32_16x16x32_bf16 v[72:75], a[204:207], v[28:31], v[72:75]
    v_mfma_f32_16x16x32_bf16 v[76:79], a[192:195], v[32:35], v[76:79]
    v_mfma_f32_16x16x32_bf16 v[80:83], a[196:199], v[32:35], v[80:83]
    v_mfma_f32_16x16x32_bf16 v[84:87], a[200:203], v[32:35], v[84:87]
    v_mfma_f32_16x16x32_bf16 v[88:91], a[204:207], v[32:35], v[88:91]
    s_waitcnt vmcnt(24)
    ds_read_b128 v[36:39], v13 offset:24576
    ds_read_b128 v[40:43], v13 offset:26624
    ds_read_b64_tr_b16 a[208:209], v22 offset:24576
    ds_read_b64_tr_b16 a[210:211], v22 offset:25088
    ds_read_b64_tr_b16 a[212:213], v23 offset:24576
    ds_read_b64_tr_b16 a[214:215], v23 offset:25088
    ds_read_b64_tr_b16 a[216:217], v24 offset:24576
    ds_read_b64_tr_b16 a[218:219], v24 offset:25088
    ds_read_b64_tr_b16 a[220:221], v25 offset:24576
    ds_read_b64_tr_b16 a[222:223], v25 offset:25088
    s_waitcnt lgkmcnt(0)
    v_mfma_f32_16x16x32_bf16 v[60:63], a[208:211], v[36:39], v[60:63]
    v_mfma_f32_16x16x32_bf16 v[64:67], a[212:215], v[36:39], v[64:67]
    v_mfma_f32_16x16x32_bf16 v[68:71], a[216:219], v[36:39], v[68:71]
    v_mfma_f32_16x16x32_bf16 v[72:75], a[220:223], v[36:39], v[72:75]
    v_mfma_f32_16x16x32_bf16 v[76:79], a[208:211], v[40:43], v[76:79]
    v_mfma_f32_16x16x32_bf16 v[80:83], a[212:215], v[40:43], v[80:83]
    v_mfma_f32_16x16x32_bf16 v[84:87], a[216:219], v[40:43], v[84:87]
    v_mfma_f32_16x16x32_bf16 v[88:91], a[220:223], v[40:43], v[88:91]
    s_waitcnt vmcnt(20)
    ds_read_b128 v[44:47], v12 offset:28672
    ds_read_b128 v[48:51], v12 offset:30720
    ds_read_b64_tr_b16 a[224:225], v22 offset:0
    ds_read_b64_tr_b16 a[226:227], v22 offset:512
    ds_read_b64_tr_b16 a[228:229], v23 offset:0
    ds_read_b64_tr_b16 a[230:231], v23 offset:512
    ds_read_b64_tr_b16 a[232:233], v24 offset:0
    ds_read_b64_tr_b16 a[234:235], v24 offset:512
    ds_read_b64_tr_b16 a[236:237], v25 offset:0
    ds_read_b64_tr_b16 a[238:239], v25 offset:512
    s_waitcnt lgkmcnt(0)
    v_mfma_f32_16x16x32_bf16 v[60:63], a[224:227], v[44:47], v[60:63]
    v_mfma_f32_16x16x32_bf16 v[64:67], a[228:231], v[44:47], v[64:67]
    v_mfma_f32_16x16x32_bf16 v[68:71], a[232:235], v[44:47], v[68:71]
    v_mfma_f32_16x16x32_bf16 v[72:75], a[236:239], v[44:47], v[72:75]
    v_mfma_f32_16x16x32_bf16 v[76:79], a[224:227], v[48:51], v[76:79]
    v_mfma_f32_16x16x32_bf16 v[80:83], a[228:231], v[48:51], v[80:83]
    v_mfma_f32_16x16x32_bf16 v[84:87], a[232:235], v[48:51], v[84:87]
    v_mfma_f32_16x16x32_bf16 v[88:91], a[236:239], v[48:51], v[88:91]
    s_waitcnt vmcnt(16)
    ds_read_b128 v[52:55], v13 offset:28672
    ds_read_b128 v[56:59], v13 offset:30720
    ds_read_b64_tr_b16 a[240:241], v22 offset:4096
    ds_read_b64_tr_b16 a[242:243], v22 offset:4608
    ds_read_b64_tr_b16 a[244:245], v23 offset:4096
    ds_read_b64_tr_b16 a[246:247], v23 offset:4608
    ds_read_b64_tr_b16 a[248:249], v24 offset:4096
    ds_read_b64_tr_b16 a[250:251], v24 offset:4608
    ds_read_b64_tr_b16 a[252:253], v25 offset:4096
    ds_read_b64_tr_b16 a[254:255], v25 offset:4608
    s_waitcnt lgkmcnt(0)
    v_mfma_f32_16x16x32_bf16 v[60:63], a[240:243], v[52:55], v[60:63]
    v_mfma_f32_16x16x32_bf16 v[64:67], a[244:247], v[52:55], v[64:67]
    v_mfma_f32_16x16x32_bf16 v[68:71], a[248:251], v[52:55], v[68:71]
    v_mfma_f32_16x16x32_bf16 v[72:75], a[252:255], v[52:55], v[72:75]
    v_mfma_f32_16x16x32_bf16 v[76:79], a[240:243], v[56:59], v[76:79]
    v_mfma_f32_16x16x32_bf16 v[80:83], a[244:247], v[56:59], v[80:83]
    v_mfma_f32_16x16x32_bf16 v[84:87], a[248:251], v[56:59], v[84:87]
    v_mfma_f32_16x16x32_bf16 v[88:91], a[252:255], v[56:59], v[88:91]
    s_waitcnt vmcnt(12)
    ds_read_b128 v[28:31], v12 offset:32768
    ds_read_b128 v[32:35], v12 offset:34816
    ds_read_b64_tr_b16 v[124:125], v22 offset:8192
    ds_read_b64_tr_b16 v[126:127], v22 offset:8704
    ds_read_b64_tr_b16 v[128:129], v23 offset:8192
    ds_read_b64_tr_b16 v[130:131], v23 offset:8704
    ds_read_b64_tr_b16 v[132:133], v24 offset:8192
    ds_read_b64_tr_b16 v[134:135], v24 offset:8704
    ds_read_b64_tr_b16 v[136:137], v25 offset:8192
    ds_read_b64_tr_b16 v[138:139], v25 offset:8704
    s_waitcnt lgkmcnt(0)
    v_mfma_f32_16x16x32_bf16 v[60:63], v[124:127], v[28:31], v[60:63]
    v_mfma_f32_16x16x32_bf16 v[64:67], v[128:131], v[28:31], v[64:67]
    v_mfma_f32_16x16x32_bf16 v[68:71], v[132:135], v[28:31], v[68:71]
    v_mfma_f32_16x16x32_bf16 v[72:75], v[136:139], v[28:31], v[72:75]
    v_mfma_f32_16x16x32_bf16 v[76:79], v[124:127], v[32:35], v[76:79]
    v_mfma_f32_16x16x32_bf16 v[80:83], v[128:131], v[32:35], v[80:83]
    v_mfma_f32_16x16x32_bf16 v[84:87], v[132:135], v[32:35], v[84:87]
    v_mfma_f32_16x16x32_bf16 v[88:91], v[136:139], v[32:35], v[88:91]
    s_waitcnt vmcnt(8)
    ds_read_b128 v[36:39], v13 offset:32768
    ds_read_b128 v[40:43], v13 offset:34816
    ds_read_b64_tr_b16 v[140:141], v22 offset:12288
    ds_read_b64_tr_b16 v[142:143], v22 offset:12800
    ds_read_b64_tr_b16 v[144:145], v23 offset:12288
    ds_read_b64_tr_b16 v[146:147], v23 offset:12800
    ds_read_b64_tr_b16 v[148:149], v24 offset:12288
    ds_read_b64_tr_b16 v[150:151], v24 offset:12800
    ds_read_b64_tr_b16 v[152:153], v25 offset:12288
    ds_read_b64_tr_b16 v[154:155], v25 offset:12800
    s_waitcnt lgkmcnt(0)
    v_mfma_f32_16x16x32_bf16 v[60:63], v[140:143], v[36:39], v[60:63]
    v_mfma_f32_16x16x32_bf16 v[64:67], v[144:147], v[36:39], v[64:67]
    v_mfma_f32_16x16x32_bf16 v[68:71], v[148:151], v[36:39], v[68:71]
    v_mfma_f32_16x16x32_bf16 v[72:75], v[152:155], v[36:39], v[72:75]
    v_mfma_f32_16x16x32_bf16 v[76:79], v[140:143], v[40:43], v[76:79]
    v_mfma_f32_16x16x32_bf16 v[80:83], v[144:147], v[40:43], v[80:83]
    v_mfma_f32_16x16x32_bf16 v[84:87], v[148:151], v[40:43], v[84:87]
    v_mfma_f32_16x16x32_bf16 v[88:91], v[152:155], v[40:43], v[88:91]
    s_waitcnt vmcnt(4)
    ds_read_b128 v[44:47], v12 offset:36864
    ds_read_b128 v[48:51], v12 offset:38912
    ds_read_b64_tr_b16 v[156:157], v22 offset:16384
    ds_read_b64_tr_b16 v[158:159], v22 offset:16896
    ds_read_b64_tr_b16 v[160:161], v23 offset:16384
    ds_read_b64_tr_b16 v[162:163], v23 offset:16896
    ds_read_b64_tr_b16 v[164:165], v24 offset:16384
    ds_read_b64_tr_b16 v[166:167], v24 offset:16896
    ds_read_b64_tr_b16 v[168:169], v25 offset:16384
    ds_read_b64_tr_b16 v[170:171], v25 offset:16896
    s_waitcnt lgkmcnt(0)
    v_mfma_f32_16x16x32_bf16 v[60:63], v[156:159], v[44:47], v[60:63]
    v_mfma_f32_16x16x32_bf16 v[64:67], v[160:163], v[44:47], v[64:67]
    v_mfma_f32_16x16x32_bf16 v[68:71], v[164:167], v[44:47], v[68:71]
    v_mfma_f32_16x16x32_bf16 v[72:75], v[168:171], v[44:47], v[72:75]
    v_mfma_f32_16x16x32_bf16 v[76:79], v[156:159], v[48:51], v[76:79]
    v_mfma_f32_16x16x32_bf16 v[80:83], v[160:163], v[48:51], v[80:83]
    v_mfma_f32_16x16x32_bf16 v[84:87], v[164:167], v[48:51], v[84:87]
    v_mfma_f32_16x16x32_bf16 v[88:91], v[168:171], v[48:51], v[88:91]
    s_waitcnt vmcnt(0)
    ds_read_b128 v[52:55], v13 offset:36864
    ds_read_b128 v[56:59], v13 offset:38912
    ds_read_b64_tr_b16 v[172:173], v22 offset:20480
    ds_read_b64_tr_b16 v[174:175], v22 offset:20992
    ds_read_b64_tr_b16 v[176:177], v23 offset:20480
    ds_read_b64_tr_b16 v[178:179], v23 offset:20992
    ds_read_b64_tr_b16 v[180:181], v24 offset:20480
    ds_read_b64_tr_b16 v[182:183], v24 offset:20992
    ds_read_b64_tr_b16 v[184:185], v25 offset:20480
    ds_read_b64_tr_b16 v[186:187], v25 offset:20992
    s_waitcnt lgkmcnt(0)
    v_mfma_f32_16x16x32_bf16 v[60:63], v[172:175], v[52:55], v[60:63]
    v_mfma_f32_16x16x32_bf16 v[64:67], v[176:179], v[52:55], v[64:67]
    v_mfma_f32_16x16x32_bf16 v[68:71], v[180:183], v[52:55], v[68:71]
    v_mfma_f32_16x16x32_bf16 v[72:75], v[184:187], v[52:55], v[72:75]
    v_mfma_f32_16x16x32_bf16 v[76:79], v[172:175], v[56:59], v[76:79]
    v_mfma_f32_16x16x32_bf16 v[80:83], v[176:179], v[56:59], v[80:83]
    v_mfma_f32_16x16x32_bf16 v[84:87], v[180:183], v[56:59], v[84:87]
    v_mfma_f32_16x16x32_bf16 v[88:91], v[184:187], v[56:59], v[88:91]
    s_waitcnt lgkmcnt(0)
    s_barrier
    s_branch g1_Q
g1_sV:
    s_waitcnt vmcnt(24)
    s_barrier
    ds_read_b128 v[28:31], v12 offset:0
    ds_read_b128 v[32:35], v12 offset:2048
    ds_read_b64_tr_b16 a[0:1], v22 offset:0
    ds_read_b64_tr_b16 a[2:3], v22 offset:512
    ds_read_b64_tr_b16 a[4:5], v23 offset:0
    ds_read_b64_tr_b16 a[6:7], v23 offset:512
    ds_read_b64_tr_b16 a[8:9], v24 offset:0
    ds_read_b64_tr_b16 a[10:11], v24 offset:512
    ds_read_b64_tr_b16 a[12:13], v25 offset:0
    ds_read_b64_tr_b16 a[14:15], v25 offset:512
    s_waitcnt lgkmcnt(0)
    s_add_u32 m0, s42, 0
    s_nop 0
    global_load_lds_dwordx4 v[20:21], off
    v_lshl_add_u64 v[20:21], v[20:21], 0, s[24:25]
    s_add_u32 m0, s42, 1024
    s_nop 0
    global_load_lds_dwordx4 v[20:21], off
    v_lshl_add_u64 v[20:21], v[20:21], 0, s[24:25]
    s_add_u32 m0, s42, 2048
    s_nop 0
    global_load_lds_dwordx4 v[20:21], off
    v_lshl_add_u64 v[20:21], v[20:21], 0, s[24:25]
    s_add_u32 m0, s42, 3072
    s_nop 0
    global_load_lds_dwordx4 v[20:21], off
    v_lshl_add_u64 v[20:21], v[20:21], 0, s[24:25]
    v_mfma_f32_16x16x32_bf16 v[60:63], v[28:31], a[0:3], 0
    v_mfma_f32_16x16x32_bf16 v[64:67], v[28:31], a[4:7], 0
    v_mfma_f32_16x16x32_bf16 v[68:71], v[28:31], a[8:11], 0
    v_mfma_f32_16x16x32_bf16 v[72:75], v[28:31], a[12:15], 0
    v_mfma_f32_16x16x32_bf16 v[76:79], v[32:35], a[0:3], 0
    v_mfma_f32_16x16x32_bf16 v[80:83], v[32:35], a[4:7], 0
    v_mfma_f32_16x16x32_bf16 v[84:87], v[32:35], a[8:11], 0
    v_mfma_f32_16x16x32_bf16 v[88:91], v[32:35], a[12:15], 0
    s_waitcnt vmcnt(24)
    ds_read_b128 v[36:39], v13 offset:0
    ds_read_b128 v[40:43], v13 offset:2048
    ds_read_b64_tr_b16 a[16:17], v22 offset:4096
    ds_read_b64_tr_b16 a[18:19], v22 offset:4608
    ds_read_b64_tr_b16 a[20:21], v23 offset:4096
    ds_read_b64_tr_b16 a[22:23], v23 offset:4608
    ds_read_b64_tr_b16 a[24:25], v24 offset:4096
    ds_read_b64_tr_b16 a[26:27], v24 offset:4608
    ds_read_b64_tr_b16 a[28:29], v25 offset:4096
    ds_read_b64_tr_b16 a[30:31], v25 offset:4608
    s_waitcnt lgkmcnt(0)
    s_add_u32 m0, s42, 4096
    s_nop 0
    global_load_lds_dwordx4 v[20:21], off
    v_lshl_add_u64 v[20:21], v[20:21], 0, s[24:25]
    s_add_u32 m0, s42, 5120
    s_nop 0
    global_load_lds_dwordx4 v[20:21], off
    v_lshl_add_u64 v[20:21], v[20:21], 0, s[24:25]
    s_add_u32 m0, s42, 6144
    s_nop 0
    global_load_lds_dwordx4 v[20:21], off
    v_lshl_add_u64 v[20:21], v[20:21], 0, s[24:25]
    s_add_u32 m0, s42, 7168
    s_nop 0
    global_load_lds_dwordx4 v[20:21], off
    v_lshl_add_u64 v[20:21], v[20:21], 0, s[24:25]
    v_mfma_f32_16x16x32_bf16 v[60:63], v[36:39], a[16:19], v[60:63]
    v_mfma_f32_16x16x32_bf16 v[64:67], v[36:39], a[20:23], v[64:67]
    v_mfma_f32_16x16x32_bf16 v[68:71], v[36:39], a[24:27], v[68:71]
    v_mfma_f32_16x16x32_bf16 v[72:75], v[36:39], a[28:31], v[72:75]
    v_mfma_f32_16x16x32_bf16 v[76:79], v[40:43], a[16:19], v[76:79]
    v_mfma_f32_16x16x32_bf16 v[80:83], v[40:43], a[20:23], v[80:83]
    v_mfma_f32_16x16x32_bf16 v[84:87], v[40:43], a[24:27], v[84:87]
    v_mfma_f32_16x16x32_bf16 v[88:91], v[40:43], a[28:31], v[88:91]
    s_waitcnt vmcnt(24)
    ds_read_b128 v[44:47], v12 offset:4096
    ds_read_b128 v[48:51], v12 offset:6144
    ds_read_b64_tr_b16 a[32:33], v22 offset:8192
    ds_read_b64_tr_b16 a[34:35], v22 offset:8704
    ds_read_b64_tr_b16 a[36:37], v23 offset:8192
    ds_read_b64_tr_b16 a[38:39], v23 offset:8704
    ds_read_b64_tr_b16 a[40:41], v24 offset:8192
    ds_read_b64_tr_b16 a[42:43], v24 offset:8704
    ds_read_b64_tr_b16 a[44:45], v25 offset:8192
    ds_read_b64_tr_b16 a[46:47], v25 offset:8704
    s_waitcnt lgkmcnt(0)
    s_add_u32 m0, s42, 8192
    s_nop 0
    global_load_lds_dwordx4 v[20:21], off
    v_lshl_add_u64 v[20:21], v[20:21], 0, s[24:25]
    s_add_u32 m0, s42, 9216
    s_nop 0
    global_load_lds_dwordx4 v[20:21], off
    v_lshl_add_u64 v[20:21], v[20:21], 0, s[24:25]
    s_add_u32 m0, s42, 10240
    s_nop 0
    global_load_lds_dwordx4 v[20:21], off
    v_lshl_add_u64 v[20:21], v[20:21], 0, s[24:25]
    s_add_u32 m0, s42, 11264
    s_nop 0
    global_load_lds_dwordx4 v[20:21], off
    v_lshl_add_u64 v[20:21], v[20:21], 0, s[24:25]
    v_mfma_f32_16x16x32_bf16 v[60:63], v[44:47], a[32:35], v[60:63]
    v_mfma_f32_16x16x32_bf16 v[64:67], v[44:47], a[36:39], v[64:67]
    v_mfma_f32_16x16x32_bf16 v[68:71], v[44:47], a[40:43], v[68:71]
    v_mfma_f32_16x16x32_bf16 v[72:75], v[44:47], a[44:47], v[72:75]
    v_mfma_f32_16x16x32_bf16 v[76:79], v[48:51], a[32:35], v[76:79]
    v_mfma_f32_16x16x32_bf16 v[80:83], v[48:51], a[36:39], v[80:83]
    v_mfma_f32_16x16x32_bf16 v[84:87], v[48:51], a[40:43], v[84:87]
    v_mfma_f32_16x16x32_bf16 v[88:91], v[48:51], a[44:47], v[88:91]
    s_waitcnt vmcnt(24)
    ds_read_b128 v[52:55], v13 offset:4096
    ds_read_b128 v[56:59], v13 offset:6144
    ds_read_b64_tr_b16 a[48:49], v22 offset:12288
    ds_read_b64_tr_b16 a[50:51], v22 offset:12800
    ds_read_b64_tr_b16 a[52:53], v23 offset:12288
    ds_read_b64_tr_b16 a[54:55], v23 offset:12800
    ds_read_b64_tr_b16 a[56:57], v24 offset:12288
    ds_read_b64_tr_b16 a[58:59], v24 offset:12800
    ds_read_b64_tr_b16 a[60:61], v25 offset:12288
    ds_read_b64_tr_b16 a[62:63], v25 offset:12800
    s_waitcnt lgkmcnt(0)
    s_add_u32 m0, s42, 12288
    s_nop 0
    global_load_lds_dwordx4 v[20:21], off
    v_lshl_add_u64 v[20:21], v[20:21], 0, s[24:25]
    s_add_u32 m0, s42, 13312
    s_nop 0
    global_load_lds_dwordx4 v[20:21], off
    v_lshl_add_u64 v[20:21], v[20:21], 0, s[24:25]
    s_add_u32 m0, s42, 14336
    s_nop 0
    global_load_lds_dwordx4 v[20:21], off
    v_lshl_add_u64 v[20:21], v[20:21], 0, s[24:25]
    s_add_u32 m0, s42, 15360
    s_nop 0
    global_load_lds_dwordx4 v[20:21], off
    v_lshl_add_u64 v[20:21], v[20:21], 0, s[24:25]
    v_mfma_f32_16x16x32_bf16 v[60:63], v[52:55], a[48:51], v[60:63]
    v_mfma_f32_16x16x32_bf16 v[64:67], v[52:55], a[52:55], v[64:67]
    v_mfma_f32_16x16x32_bf16 v[68:71], v[52:55], a[56:59], v[68:71]
    v_mfma_f32_16x16x32_bf16 v[72:75], v[52:55], a[60:63], v[72:75]
    v_mfma_f32_16x16x32_bf16 v[76:79], v[56:59], a[48:51], v[76:79]
    v_mfma_f32_16x16x32_bf16 v[80:83], v[56:59], a[52:55], v[80:83]
    v_mfma_f32_16x16x32_bf16 v[84:87], v[56:59], a[56:59], v[84:87]
    v_mfma_f32_16x16x32_bf16 v[88:91], v[56:59], a[60:63], v[88:91]
    s_waitcnt vmcnt(24)
    ds_read_b128 v[28:31], v12 offset:8192
    ds_read_b128 v[32:35], v12 offset:10240
    ds_read_b64_tr_b16 a[64:65], v22 offset:16384
    ds_read_b64_tr_b16 a[66:67], v22 offset:16896
    ds_read_b64_tr_b16 a[68:69], v23 offset:16384
    ds_read_b64_tr_b16 a[70:71], v23 offset:16896
    ds_read_b64_tr_b16 a[72:73], v24 offset:16384
    ds_read_b64_tr_b16 a[74:75], v24 offset:16896
    ds_read_b64_tr_b16 a[76:77], v25 offset:16384
    ds_read_b64_tr_b16 a[78:79], v25 offset:16896
    s_waitcnt lgkmcnt(0)
    s_add_u32 m0, s42, 16384
    s_nop 0
    global_load_lds_dwordx4 v[20:21], off
    v_lshl_add_u64 v[20:21], v[20:21], 0, s[24:25]
    s_add_u32 m0, s42, 17408
    s_nop 0
    global_load_lds_dwordx4 v[20:21], off
    v_lshl_add_u64 v[20:21], v[20:21], 0, s[24:25]
    s_add_u32 m0, s42, 18432
    s_nop 0
    global_load_lds_dwordx4 v[20:21], off
    v_lshl_add_u64 v[20:21], v[20:21], 0, s[24:25]
    s_add_u32 m0, s42, 19456
    s_nop 0
    global_load_lds_dwordx4 v[20:21], off
    v_lshl_add_u64 v[20:21], v[20:21], 0, s[24:25]
    v_mfma_f32_16x16x32_bf16 v[60:63], v[28:31], a[64:67], v[60:63]
    v_mfma_f32_16x16x32_bf16 v[64:67], v[28:31], a[68:71], v[64:67]
    v_mfma_f32_16x16x32_bf16 v[68:71], v[28:31], a[72:75], v[68:71]
    v_mfma_f32_16x16x32_bf16 v[72:75], v[28:31], a[76:79], v[72:75]
    v_mfma_f32_16x16x32_bf16 v[76:79], v[32:35], a[64:67], v[76:79]
    v_mfma_f32_16x16x32_bf16 v[80:83], v[32:35], a[68:71], v[80:83]
    v_mfma_f32_16x16x32_bf16 v[84:87], v[32:35], a[72:75], v[84:87]
    v_mfma_f32_16x16x32_bf16 v[88:91], v[32:35], a[76:79], v[88:91]
    s_waitcnt vmcnt(24)
    ds_read_b128 v[36:39], v13 offset:8192
    ds_read_b128 v[40:43], v13 offset:10240
    ds_read_b64_tr_b16 a[80:81], v22 offset:20480
    ds_read_b64_tr_b16 a[82:83], v22 offset:20992
    ds_read_b64_tr_b16 a[84:85], v23 offset:20480
    ds_read_b64_tr_b16 a[86:87], v23 offset:20992
    ds_read_b64_tr_b16 a[88:89], v24 offset:20480
    ds_read_b64_tr_b16 a[90:91], v24 offset:20992
    ds_read_b64_tr_b16 a[92:93], v25 offset:20480
    ds_read_b64_tr_b16 a[94:95], v25 offset:20992
    s_waitcnt lgkmcnt(0)
    s_add_u32 m0, s42, 20480
    s_nop 0
    global_load_lds_dwordx4 v[20:21], off
    v_lshl_add_u64 v[20:21], v[20:21], 0, s[24:25]
    s_add_u32 m0, s42, 21504
    s_nop 0
    global_load_lds_dwordx4 v[20:21], off
    v_lshl_add_u64 v[20:21], v[20:21], 0, s[24:25]
    s_add_u32 m0, s42, 22528
    s_nop 0
    global_load_lds_dwordx4 v[20:21], off
    v_lshl_add_u64 v[20:21], v[20:21], 0, s[24:25]
    s_add_u32 m0, s42, 23552
    s_nop 0
    global_load_lds_dwordx4 v[20:21], off
    v_lshl_add_u64 v[20:21], v[20:21], 0, s[24:25]
    v_mfma_f32_16x16x32_bf16 v[60:63], v[36:39], a[80:83], v[60:63]
    v_mfma_f32_16x16x32_bf16 v[64:67], v[36:39], a[84:87], v[64:67]
    v_mfma_f32_16x16x32_bf16 v[68:71], v[36:39], a[88:91], v[68:71]
    v_mfma_f32_16x16x32_bf16 v[72:75], v[36:39], a[92:95], v[72:75]
    v_mfma_f32_16x16x32_bf16 v[76:79], v[40:43], a[80:83], v[76:79]
    v_mfma_f32_16x16x32_bf16 v[80:83], v[40:43], a[84:87], v[80:83]
    v_mfma_f32_16x16x32_bf16 v[84:87], v[40:43], a[88:91], v[84:87]
    v_mfma_f32_16x16x32_bf16 v[88:91], v[40:43], a[92:95], v[88:91]
    s_waitcnt vmcnt(24)
    ds_read_b128 v[44:47], v12 offset:12288
    ds_read_b128 v[48:51], v12 offset:14336
    ds_read_b64_tr_b16 a[96:97], v22 offset:24576
    ds_read_b64_tr_b16 a[98:99], v22 offset:25088
    ds_read_b64_tr_b16 a[100:101], v23 offset:24576
    ds_read_b64_tr_b16 a[102:103], v23 offset:25088
    ds_read_b64_tr_b16 a[104:105], v24 offset:24576
    ds_read_b64_tr_b16 a[106:107], v24 offset:25088
    ds_read_b64_tr_b16 a[108:109], v25 offset:24576
    ds_read_b64_tr_b16 a[110:111], v25 offset:25088
    s_waitcnt lgkmcnt(0)
    s_add_u32 m0, s42, 24576
    s_nop 0
    global_load_lds_dwordx4 v[20:21], off
    v_lshl_add_u64 v[20:21], v[20:21], 0, s[24:25]
    s_add_u32 m0, s42, 25600
    s_nop 0
    global_load_lds_dwordx4 v[20:21], off
    v_lshl_add_u64 v[20:21], v[20:21], 0, s[24:25]
    s_add_u32 m0, s42, 26624
    s_nop 0
    global_load_lds_dwordx4 v[20:21], off
    v_lshl_add_u64 v[20:21], v[20:21], 0, s[24:25]
    s_add_u32 m0, s42, 27648
    s_nop 0
    global_load_lds_dwordx4 v[20:21], off
    v_lshl_add_u64 v[20:21], v[20:21], 0, s[24:25]
    v_mfma_f32_16x16x32_bf16 v[60:63], v[44:47], a[96:99], v[60:63]
    v_mfma_f32_16x16x32_bf16 v[64:67], v[44:47], a[100:103], v[64:67]
    v_mfma_f32_16x16x32_bf16 v[68:71], v[44:47], a[104:107], v[68:71]
    v_mfma_f32_16x16x32_bf16 v[72:75], v[44:47], a[108:111], v[72:75]
    v_mfma_f32_16x16x32_bf16 v[76:79], v[48:51], a[96:99], v[76:79]
    v_mfma_f32_16x16x32_bf16 v[80:83], v[48:51], a[100:103], v[80:83]
    v_mfma_f32_16x16x32_bf16 v[84:87], v[48:51], a[104:107], v[84:87]
    v_mfma_f32_16x16x32_bf16 v[88:91], v[48:51], a[108:111], v[88:91]
    s_waitcnt vmcnt(24)
    ds_read_b128 v[52:55], v13 offset:12288
    ds_read_b128 v[56:59], v13 offset:14336
    ds_read_b64_tr_b16 a[112:113], v22 offset:0
    ds_read_b64_tr_b16 a[114:115], v22 offset:512
    ds_read_b64_tr_b16 a[116:117], v23 offset:0
    ds_read_b64_tr_b16 a[118:119], v23 offset:512
    ds_read_b64_tr_b16 a[120:121], v24 offset:0
    ds_read_b64_tr_b16 a[122:123], v24 offset:512
    ds_read_b64_tr_b16 a[124:125], v25 offset:0
    ds_read_b64_tr_b16 a[126:127], v25 offset:512
    s_waitcnt lgkmcnt(0)
    s_add_u32 m0, s42, 0
    s_nop 0
    global_load_lds_dwordx4 v[20:21], off
    v_lshl_add_u64 v[20:21], v[20:21], 0, s[24:25]
    s_add_u32 m0, s42, 1024
    s_nop 0
    global_load_lds_dwordx4 v[20:21], off
    v_lshl_add_u64 v[20:21], v[20:21], 0, s[24:25]
    s_add_u32 m0, s42, 2048
    s_nop 0
    global_load_lds_dwordx4 v[20:21], off
    v_lshl_add_u64 v[20:21], v[20:21], 0, s[24:25]
    s_add_u32 m0, s42, 3072
    s_nop 0
    global_load_lds_dwordx4 v[20:21], off
    v_lshl_add_u64 v[20:21], v[20:21], 0, s[24:25]
    v_mfma_f32_16x16x32_bf16 v[60:63], v[52:55], a[112:115], v[60:63]
    v_mfma_f32_16x16x32_bf16 v[64:67], v[52:55], a[116:119], v[64:67]
    v_mfma_f32_16x16x32_bf16 v[68:71], v[52:55], a[120:123], v[68:71]
    v_mfma_f32_16x16x32_bf16 v[72:75], v[52:55], a[124:127], v[72:75]
    v_mfma_f32_16x16x32_bf16 v[76:79], v[56:59], a[112:115], v[76:79]
    v_mfma_f32_16x16x32_bf16 v[80:83], v[56:59], a[116:119], v[80:83]
    v_mfma_f32_16x16x32_bf16 v[84:87], v[56:59], a[120:123], v[84:87]
    v_mfma_f32_16x16x32_bf16 v[88:91], v[56:59], a[124:127], v[88:91]
    s_waitcnt vmcnt(24)
    ds_read_b128 v[28:31], v12 offset:16384
    ds_read_b128 v[32:35], v12 offset:18432
    ds_read_b64_tr_b16 a[128:129], v22 offset:4096
    ds_read_b64_tr_b16 a[130:131], v22 offset:4608
    ds_read_b64_tr_b16 a[132:133], v23 offset:4096
    ds_read_b64_tr_b16 a[134:135], v23 offset:4608
    ds_read_b64_tr_b16 a[136:137], v24 offset:4096
    ds_read_b64_tr_b16 a[138:139], v24 offset:4608
    ds_read_b64_tr_b16 a[140:141], v25 offset:4096
    ds_read_b64_tr_b16 a[142:143], v25 offset:4608
    s_waitcnt lgkmcnt(0)
    s_add_u32 m0, s42, 4096
    s_nop 0
    global_load_lds_dwordx4 v[20:21], off
    v_lshl_add_u64 v[20:21], v[20:21], 0, s[24:25]
    s_add_u32 m0, s42, 5120
    s_nop 0
    global_load_lds_dwordx4 v[20:21], off
    v_lshl_add_u64 v[20:21], v[20:21], 0, s[24:25]
    s_add_u32 m0, s42, 6144
    s_nop 0
    global_load_lds_dwordx4 v[20:21], off
    v_lshl_add_u64 v[20:21], v[20:21], 0, s[24:25]
    s_add_u32 m0, s42, 7168
    s_nop 0
    global_load_lds_dwordx4 v[20:21], off
    v_lshl_add_u64 v[20:21], v[20:21], 0, s[24:25]
    v_mfma_f32_16x16x32_bf16 v[60:63], v[28:31], a[128:131], v[60:63]
    v_mfma_f32_16x16x32_bf16 v[64:67], v[28:31], a[132:135], v[64:67]
    v_mfma_f32_16x16x32_bf16 v[68:71], v[28:31], a[136:139], v[68:71]
    v_mfma_f32_16x16x32_bf16 v[72:75], v[28:31], a[140:143], v[72:75]
    v_mfma_f32_16x16x32_bf16 v[76:79], v[32:35], a[128:131], v[76:79]
    v_mfma_f32_16x16x32_bf16 v[80:83], v[32:35], a[132:135], v[80:83]
    v_mfma_f32_16x16x32_bf16 v[84:87], v[32:35], a[136:139], v[84:87]
    v_mfma_f32_16x16x32_bf16 v[88:91], v[32:35], a[140:143], v[88:91]
    s_waitcnt vmcnt(24)
    ds_read_b128 v[36:39], v13 offset:16384
    ds_read_b128 v[40:43], v13 offset:18432
    ds_read_b64_tr_b16 a[144:145], v22 offset:8192
    ds_read_b64_tr_b16 a[146:147], v22 offset:8704
    ds_read_b64_tr_b16 a[148:149], v23 offset:8192
    ds_read_b64_tr_b16 a[150:151], v23 offset:8704
    ds_read_b64_tr_b16 a[152:153], v24 offset:8192
    ds_read_b64_tr_b16 a[154:155], v24 offset:8704
    ds_read_b64_tr_b16 a[156:157], v25 offset:8192
    ds_read_b64_tr_b16 a[158:159], v25 offset:8704
    s_waitcnt lgkmcnt(0)
    s_add_u32 m0, s42, 8192
    s_nop 0
    global_load_lds_dwordx4 v[20:21], off
    v_lshl_add_u64 v[20:21], v[20:21], 0, s[24:25]
    s_add_u32 m0, s42, 9216
    s_nop 0
    global_load_lds_dwordx4 v[20:21], off
    v_lshl_add_u64 v[20:21], v[20:21], 0, s[24:25]
    s_add_u32 m0, s42, 10240
    s_nop 0
    global_load_lds_dwordx4 v[20:21], off
    v_lshl_add_u64 v[20:21], v[20:21], 0, s[24:25]
    s_add_u32 m0, s42, 11264
    s_nop 0
    global_load_lds_dwordx4 v[20:21], off
    v_lshl_add_u64 v[20:21], v[20:21], 0, s[24:25]
    v_mfma_f32_16x16x32_bf16 v[60:63], v[36:39], a[144:147], v[60:63]
    v_mfma_f32_16x16x32_bf16 v[64:67], v[36:39], a[148:151], v[64:67]
    v_mfma_f32_16x16x32_bf16 v[68:71], v[36:39], a[152:155], v[68:71]
    v_mfma_f32_16x16x32_bf16 v[72:75], v[36:39], a[156:159], v[72:75]
    v_mfma_f32_16x16x32_bf16 v[76:79], v[40:43], a[144:147], v[76:79]
    v_mfma_f32_16x16x32_bf16 v[80:83], v[40:43], a[148:151], v[80:83]
    v_mfma_f32_16x16x32_bf16 v[84:87], v[40:43], a[152:155], v[84:87]
    v_mfma_f32_16x16x32_bf16 v[88:91], v[40:43], a[156:159], v[88:91]
    s_waitcnt vmcnt(24)
    ds_read_b128 v[44:47], v12 offset:20480
    ds_read_b128 v[48:51], v12 offset:22528
    ds_read_b64_tr_b16 a[160:161], v22 offset:12288
    ds_read_b64_tr_b16 a[162:163], v22 offset:12800
    ds_read_b64_tr_b16 a[164:165], v23 offset:12288
    ds_read_b64_tr_b16 a[166:167], v23 offset:12800
    ds_read_b64_tr_b16 a[168:169], v24 offset:12288
    ds_read_b64_tr_b16 a[170:171], v24 offset:12800
    ds_read_b64_tr_b16 a[172:173], v25 offset:12288
    ds_read_b64_tr_b16 a[174:175], v25 offset:12800
    s_waitcnt lgkmcnt(0)
    s_add_u32 m0, s42, 12288
    s_nop 0
    global_load_lds_dwordx4 v[20:21], off
    v_lshl_add_u64 v[20:21], v[20:21], 0, s[24:25]
    s_add_u32 m0, s42, 13312
    s_nop 0
    global_load_lds_dwordx4 v[20:21], off
    v_lshl_add_u64 v[20:21], v[20:21], 0, s[24:25]
    s_add_u32 m0, s42, 14336
    s_nop 0
    global_load_lds_dwordx4 v[20:21], off
    v_lshl_add_u64 v[20:21], v[20:21], 0, s[24:25]
    s_add_u32 m0, s42, 15360
    s_nop 0
    global_load_lds_dwordx4 v[20:21], off
    v_lshl_add_u64 v[20:21], v[20:21], 0, s[24:25]
    v_mfma_f32_16x16x32_bf16 v[60:63], v[44:47], a[160:163], v[60:63]
    v_mfma_f32_16x16x32_bf16 v[64:67], v[44:47], a[164:167], v[64:67]
    v_mfma_f32_16x16x32_bf16 v[68:71], v[44:47], a[168:171], v[68:71]
    v_mfma_f32_16x16x32_bf16 v[72:75], v[44:47], a[172:175], v[72:75]
    v_mfma_f32_16x16x32_bf16 v[76:79], v[48:51], a[160:163], v[76:79]
    v_mfma_f32_16x16x32_bf16 v[80:83], v[48:51], a[164:167], v[80:83]
    v_mfma_f32_16x16x32_bf16 v[84:87], v[48:51], a[168:171], v[84:87]
    v_mfma_f32_16x16x32_bf16 v[88:91], v[48:51], a[172:175], v[88:91]
    s_waitcnt vmcnt(24)
    ds_read_b128 v[52:55], v13 offset:20480
    ds_read_b128 v[56:59], v13 offset:22528
    ds_read_b64_tr_b16 a[176:177], v22 offset:16384
    ds_read_b64_tr_b16 a[178:179], v22 offset:16896
    ds_read_b64_tr_b16 a[180:181], v23 offset:16384
    ds_read_b64_tr_b16 a[182:183], v23 offset:16896
    ds_read_b64_tr_b16 a[184:185], v24 offset:16384
    ds_read_b64_tr_b16 a[186:187], v24 offset:16896
    ds_read_b64_tr_b16 a[188:189], v25 offset:16384
    ds_read_b64_tr_b16 a[190:191], v25 offset:16896
    s_waitcnt lgkmcnt(0)
    s_add_u32 m0, s42, 16384
    s_nop 0
    global_load_lds_dwordx4 v[20:21], off
    v_lshl_add_u64 v[20:21], v[20:21], 0, s[24:25]
    s_add_u32 m0, s42, 17408
    s_nop 0
    global_load_lds_dwordx4 v[20:21], off
    v_lshl_add_u64 v[20:21], v[20:21], 0, s[24:25]
    s_add_u32 m0, s42, 18432
    s_nop 0
    global_load_lds_dwordx4 v[20:21], off
    v_lshl_add_u64 v[20:21], v[20:21], 0, s[24:25]
    s_add_u32 m0, s42, 19456
    s_nop 0
    global_load_lds_dwordx4 v[20:21], off
    v_lshl_add_u64 v[20:21], v[20:21], 0, s[24:25]
    v_mfma_f32_16x16x32_bf16 v[60:63], v[52:55], a[176:179], v[60:63]
    v_mfma_f32_16x16x32_bf16 v[64:67], v[52:55], a[180:183], v[64:67]
    v_mfma_f32_16x16x32_bf16 v[68:71], v[52:55], a[184:187], v[68:71]
    v_mfma_f32_16x16x32_bf16 v[72:75], v[52:55], a[188:191], v[72:75]
    v_mfma_f32_16x16x32_bf16 v[76:79], v[56:59], a[176:179], v[76:79]
    v_mfma_f32_16x16x32_bf16 v[80:83], v[56:59], a[180:183], v[80:83]
    v_mfma_f32_16x16x32_bf16 v[84:87], v[56:59], a[184:187], v[84:87]
    v_mfma_f32_16x16x32_bf16 v[88:91], v[56:59], a[188:191], v[88:91]
    s_waitcnt vmcnt(24)
    ds_read_b128 v[28:31], v12 offset:24576
    ds_read_b128 v[32:35], v12 offset:26624
    ds_read_b64_tr_b16 a[192:193], v22 offset:20480
    ds_read_b64_tr_b16 a[194:195], v22 offset:20992
    ds_read_b64_tr_b16 a[196:197], v23 offset:20480
    ds_read_b64_tr_b16 a[198:199], v23 offset:20992
    ds_read_b64_tr_b16 a[200:201], v24 offset:20480
    ds_read_b64_tr_b16 a[202:203], v24 offset:20992
    ds_read_b64_tr_b16 a[204:205], v25 offset:20480
    ds_read_b64_tr_b16 a[206:207], v25 offset:20992
    s_waitcnt lgkmcnt(0)
    s_add_u32 m0, s42, 20480
    s_nop 0
    global_load_lds_dwordx4 v[20:21], off
    v_lshl_add_u64 v[20:21], v[20:21], 0, s[24:25]
    s_add_u32 m0, s42, 21504
    s_nop 0
    global_load_lds_dwordx4 v[20:21], off
    v_lshl_add_u64 v[20:21], v[20:21], 0, s[24:25]
    s_add_u32 m0, s42, 22528
    s_nop 0
    global_load_lds_dwordx4 v[20:21], off
    v_lshl_add_u64 v[20:21], v[20:21], 0, s[24:25]
    s_add_u32 m0, s42, 23552
    s_nop 0
    global_load_lds_dwordx4 v[20:21], off
    v_lshl_add_u64 v[20:21], v[20:21], 0, s[24:25]
    v_mfma_f32_16x16x32_bf16 v[60:63], v[28:31], a[192:195], v[60:63]
    v_mfma_f32_16x16x32_bf16 v[64:67], v[28:31], a[196:199], v[64:67]
    v_mfma_f32_16x16x32_bf16 v[68:71], v[28:31], a[200:203], v[68:71]
    v_mfma_f32_16x16x32_bf16 v[72:75], v[28:31], a[204:207], v[72:75]
    v_mfma_f32_16x16x32_bf16 v[76:79], v[32:35], a[192:195], v[76:79]
    v_mfma_f32_16x16x32_bf16 v[80:83], v[32:35], a[196:199], v[80:83]
    v_mfma_f32_16x16x32_bf16 v[84:87], v[32:35], a[200:203], v[84:87]
    v_mfma_f32_16x16x32_bf16 v[88:91], v[32:35], a[204:207], v[88:91]
    s_waitcnt vmcnt(24)
    ds_read_b128 v[36:39], v13 offset:24576
    ds_read_b128 v[40:43], v13 offset:26624
    ds_read_b64_tr_b16 a[208:209], v22 offset:24576
    ds_read_b64_tr_b16 a[210:211], v22 offset:25088
    ds_read_b64_tr_b16 a[212:213], v23 offset:24576
    ds_read_b64_tr_b16 a[214:215], v23 offset:25088
    ds_read_b64_tr_b16 a[216:217], v24 offset:24576
    ds_read_b64_tr_b16 a[218:219], v24 offset:25088
    ds_read_b64_tr_b16 a[220:221], v25 offset:24576
    ds_read_b64_tr_b16 a[222:223], v25 offset:25088
    s_waitcnt lgkmcnt(0)
    v_mfma_f32_16x16x32_bf16 v[60:63], v[36:39], a[208:211], v[60:63]
    v_mfma_f32_16x16x32_bf16 v[64:67], v[36:39], a[212:215], v[64:67]
    v_mfma_f32_16x16x32_bf16 v[68:71], v[36:39], a[216:219], v[68:71]
    v_mfma_f32_16x16x32_bf16 v[72:75], v[36:39], a[220:223], v[72:75]
    v_mfma_f32_16x16x32_bf16 v[76:79], v[40:43], a[208:211], v[76:79]
    v_mfma_f32_16x16x32_bf16 v[80:83], v[40:43], a[212:215], v[80:83]
    v_mfma_f32_16x16x32_bf16 v[84:87], v[40:43], a[216:219], v[84:87]
    v_mfma_f32_16x16x32_bf16 v[88:91], v[40:43], a[220:223], v[88:91]
    s_waitcnt vmcnt(20)
    ds_read_b128 v[44:47], v12 offset:28672
    ds_read_b128 v[48:51], v12 offset:30720
    ds_read_b64_tr_b16 a[224:225], v22 offset:0
    ds_read_b64_tr_b16 a[226:227], v22 offset:512
    ds_read_b64_tr_b16 a[228:229], v23 offset:0
    ds_read_b64_tr_b16 a[230:231], v23 offset:512
    ds_read_b64_tr_b16 a[232:233], v24 offset:0
    ds_read_b64_tr_b16 a[234:235], v24 offset:512
    ds_read_b64_tr_b16 a[236:237], v25 offset:0
    ds_read_b64_tr_b16 a[238:239], v25 offset:512
    s_waitcnt lgkmcnt(0)
    v_mfma_f32_16x16x32_bf16 v[60:63], v[44:47], a[224:227], v[60:63]
    v_mfma_f32_16x16x32_bf16 v[64:67], v[44:47], a[228:231], v[64:67]
    v_mfma_f32_16x16x32_bf16 v[68:71], v[44:47], a[232:235], v[68:71]
    v_mfma_f32_16x16x32_bf16 v[72:75], v[44:47], a[236:239], v[72:75]
    v_mfma_f32_16x16x32_bf16 v[76:79], v[48:51], a[224:227], v[76:79]
    v_mfma_f32_16x16x32_bf16 v[80:83], v[48:51], a[228:231], v[80:83]
    v_mfma_f32_16x16x32_bf16 v[84:87], v[48:51], a[232:235], v[84:87]
    v_mfma_f32_16x16x32_bf16 v[88:91], v[48:51], a[236:239], v[88:91]
    s_waitcnt vmcnt(16)
    ds_read_b128 v[52:55], v13 offset:28672
    ds_read_b128 v[56:59], v13 offset:30720
    ds_read_b64_tr_b16 a[240:241], v22 offset:4096
    ds_read_b64_tr_b16 a[242:243], v22 offset:4608
    ds_read_b64_tr_b16 a[244:245], v23 offset:4096
    ds_read_b64_tr_b16 a[246:247], v23 offset:4608
    ds_read_b64_tr_b16 a[248:249], v24 offset:4096
    ds_read_b64_tr_b16 a[250:251], v24 offset:4608
    ds_read_b64_tr_b16 a[252:253], v25 offset:4096
    ds_read_b64_tr_b16 a[254:255], v25 offset:4608
    s_waitcnt lgkmcnt(0)
    v_mfma_f32_16x16x32_bf16 v[60:63], v[52:55], a[240:243], v[60:63]
    v_mfma_f32_16x16x32_bf16 v[64:67], v[52:55], a[244:247], v[64:67]
    v_mfma_f32_16x16x32_bf16 v[68:71], v[52:55], a[248:251], v[68:71]
    v_mfma_f32_16x16x32_bf16 v[72:75], v[52:55], a[252:255], v[72:75]
    v_mfma_f32_16x16x32_bf16 v[76:79], v[56:59], a[240:243], v[76:79]
    v_mfma_f32_16x16x32_bf16 v[80:83], v[56:59], a[244:247], v[80:83]
    v_mfma_f32_16x16x32_bf16 v[84:87], v[56:59], a[248:251], v[84:87]
    v_mfma_f32_16x16x32_bf16 v[88:91], v[56:59], a[252:255], v[88:91]
    s_waitcnt vmcnt(12)
    ds_read_b128 v[28:31], v12 offset:32768
    ds_read_b128 v[32:35], v12 offset:34816
    ds_read_b64_tr_b16 v[124:125], v22 offset:8192
    ds_read_b64_tr_b16 v[126:127], v22 offset:8704
    ds_read_b64_tr_b16 v[128:129], v23 offset:8192
    ds_read_b64_tr_b16 v[130:131], v23 offset:8704
    ds_read_b64_tr_b16 v[132:133], v24 offset:8192
    ds_read_b64_tr_b16 v[134:135], v24 offset:8704
    ds_read_b64_tr_b16 v[136:137], v25 offset:8192
    ds_read_b64_tr_b16 v[138:139], v25 offset:8704
    s_waitcnt lgkmcnt(0)
    v_mfma_f32_16x16x32_bf16 v[60:63], v[28:31], v[124:127], v[60:63]
    v_mfma_f32_16x16x32_bf16 v[64:67], v[28:31], v[128:131], v[64:67]
    v_mfma_f32_16x16x32_bf16 v[68:71], v[28:31], v[132:135], v[68:71]
    v_mfma_f32_16x16x32_bf16 v[72:75], v[28:31], v[136:139], v[72:75]
    v_mfma_f32_16x16x32_bf16 v[76:79], v[32:35], v[124:127], v[76:79]
    v_mfma_f32_16x16x32_bf16 v[80:83], v[32:35], v[128:131], v[80:83]
    v_mfma_f32_16x16x32_bf16 v[84:87], v[32:35], v[132:135], v[84:87]
    v_mfma_f32_16x16x32_bf16 v[88:91], v[32:35], v[136:139], v[88:91]
    s_waitcnt vmcnt(8)
    ds_read_b128 v[36:39], v13 offset:32768
    ds_read_b128 v[40:43], v13 offset:34816
    ds_read_b64_tr_b16 v[140:141], v22 offset:12288
    ds_read_b64_tr_b16 v[142:143], v22 offset:12800
    ds_read_b64_tr_b16 v[144:145], v23 offset:12288
    ds_read_b64_tr_b16 v[146:147], v23 offset:12800
    ds_read_b64_tr_b16 v[148:149], v24 offset:12288
    ds_read_b64_tr_b16 v[150:151], v24 offset:12800
    ds_read_b64_tr_b16 v[152:153], v25 offset:12288
    ds_read_b64_tr_b16 v[154:155], v25 offset:12800
    s_waitcnt lgkmcnt(0)
    v_mfma_f32_16x16x32_bf16 v[60:63], v[36:39], v[140:143], v[60:63]
    v_mfma_f32_16x16x32_bf16 v[64:67], v[36:39], v[144:147], v[64:67]
    v_mfma_f32_16x16x32_bf16 v[68:71], v[36:39], v[148:151], v[68:71]
    v_mfma_f32_16x16x32_bf16 v[72:75], v[36:39], v[152:155], v[72:75]
    v_mfma_f32_16x16x32_bf16 v[76:79], v[40:43], v[140:143], v[76:79]
    v_mfma_f32_16x16x32_bf16 v[80:83], v[40:43], v[144:147], v[80:83]
    v_mfma_f32_16x16x32_bf16 v[84:87], v[40:43], v[148:151], v[84:87]
    v_mfma_f32_16x16x32_bf16 v[88:91], v[40:43], v[152:155], v[88:91]
    s_waitcnt vmcnt(4)
    ds_read_b128 v[44:47], v12 offset:36864
    ds_read_b128 v[48:51], v12 offset:38912
    ds_read_b64_tr_b16 v[156:157], v22 offset:16384
    ds_read_b64_tr_b16 v[158:159], v22 offset:16896
    ds_read_b64_tr_b16 v[160:161], v23 offset:16384
    ds_read_b64_tr_b16 v[162:163], v23 offset:16896
    ds_read_b64_tr_b16 v[164:165], v24 offset:16384
    ds_read_b64_tr_b16 v[166:167], v24 offset:16896
    ds_read_b64_tr_b16 v[168:169], v25 offset:16384
    ds_read_b64_tr_b16 v[170:171], v25 offset:16896
    s_waitcnt lgkmcnt(0)
    v_mfma_f32_16x16x32_bf16 v[60:63], v[44:47], v[156:159], v[60:63]
    v_mfma_f32_16x16x32_bf16 v[64:67], v[44:47], v[160:163], v[64:67]
    v_mfma_f32_16x16x32_bf16 v[68:71], v[44:47], v[164:167], v[68:71]
    v_mfma_f32_16x16x32_bf16 v[72:75], v[44:47], v[168:171], v[72:75]
    v_mfma_f32_16x16x32_bf16 v[76:79], v[48:51], v[156:159], v[76:79]
    v_mfma_f32_16x16x32_bf16 v[80:83], v[48:51], v[160:163], v[80:83]
    v_mfma_f32_16x16x32_bf16 v[84:87], v[48:51], v[164:167], v[84:87]
    v_mfma_f32_16x16x32_bf16 v[88:91], v[48:51], v[168:171], v[88:91]
    s_waitcnt vmcnt(0)
    ds_read_b128 v[52:55], v13 offset:36864
    ds_read_b128 v[56:59], v13 offset:38912
    ds_read_b64_tr_b16 v[172:173], v22 offset:20480
    ds_read_b64_tr_b16 v[174:175], v22 offset:20992
    ds_read_b64_tr_b16 v[176:177], v23 offset:20480
    ds_read_b64_tr_b16 v[178:179], v23 offset:20992
    ds_read_b64_tr_b16 v[180:181], v24 offset:20480
    ds_read_b64_tr_b16 v[182:183], v24 offset:20992
    ds_read_b64_tr_b16 v[184:185], v25 offset:20480
    ds_read_b64_tr_b16 v[186:187], v25 offset:20992
    s_waitcnt lgkmcnt(0)
    v_mfma_f32_16x16x32_bf16 v[60:63], v[52:55], v[172:175], v[60:63]
    v_mfma_f32_16x16x32_bf16 v[64:67], v[52:55], v[176:179], v[64:67]
    v_mfma_f32_16x16x32_bf16 v[68:71], v[52:55], v[180:183], v[68:71]
    v_mfma_f32_16x16x32_bf16 v[72:75], v[52:55], v[184:187], v[72:75]
    v_mfma_f32_16x16x32_bf16 v[76:79], v[56:59], v[172:175], v[76:79]
    v_mfma_f32_16x16x32_bf16 v[80:83], v[56:59], v[176:179], v[80:83]
    v_mfma_f32_16x16x32_bf16 v[84:87], v[56:59], v[180:183], v[84:87]
    v_mfma_f32_16x16x32_bf16 v[88:91], v[56:59], v[184:187], v[88:91]
    s_waitcnt lgkmcnt(0)
    s_barrier
    s_branch g1_T
g1_sN:
    s_waitcnt vmcnt(24)
    ds_read_b64_tr_b16 a[0:1], v22 offset:0
    ds_read_b64_tr_b16 a[2:3], v22 offset:512
    ds_read_b64_tr_b16 a[4:5], v23 offset:0
    ds_read_b64_tr_b16 a[6:7], v23 offset:512
    ds_read_b64_tr_b16 a[8:9], v24 offset:0
    ds_read_b64_tr_b16 a[10:11], v24 offset:512
    ds_read_b64_tr_b16 a[12:13], v25 offset:0
    ds_read_b64_tr_b16 a[14:15], v25 offset:512
    s_waitcnt lgkmcnt(0)
    s_add_u32 m0, s42, 0
    s_nop 0
    global_load_lds_dwordx4 v[20:21], off
    v_lshl_add_u64 v[20:21], v[20:21], 0, s[24:25]
    s_add_u32 m0, s42, 1024
    s_nop 0
    global_load_lds_dwordx4 v[20:21], off
    v_lshl_add_u64 v[20:21], v[20:21], 0, s[24:25]
    s_add_u32 m0, s42, 2048
    s_nop 0
    global_load_lds_dwordx4 v[20:21], off
    v_lshl_add_u64 v[20:21], v[20:21], 0, s[24:25]
    s_add_u32 m0, s42, 3072
    s_nop 0
    global_load_lds_dwordx4 v[20:21], off
    v_lshl_add_u64 v[20:21], v[20:21], 0, s[24:25]
    s_waitcnt vmcnt(24)
    ds_read_b64_tr_b16 a[16:17], v22 offset:4096
    ds_read_b64_tr_b16 a[18:19], v22 offset:4608
    ds_read_b64_tr_b16 a[20:21], v23 offset:4096
    ds_read_b64_tr_b16 a[22:23], v23 offset:4608
    ds_read_b64_tr_b16 a[24:25], v24 offset:4096
    ds_read_b64_tr_b16 a[26:27], v24 offset:4608
    ds_read_b64_tr_b16 a[28:29], v25 offset:4096
    ds_read_b64_tr_b16 a[30:31], v25 offset:4608
    s_waitcnt lgkmcnt(0)
    s_add_u32 m0, s42, 4096
    s_nop 0
    global_load_lds_dwordx4 v[20:21], off
    v_lshl_add_u64 v[20:21], v[20:21], 0, s[24:25]
    s_add_u32 m0, s42, 5120
    s_nop 0
    global_load_lds_dwordx4 v[20:21], off
    v_lshl_add_u64 v[20:21], v[20:21], 0, s[24:25]
    s_add_u32 m0, s42, 6144
    s_nop 0
    global_load_lds_dwordx4 v[20:21], off
    v_lshl_add_u64 v[20:21], v[20:21], 0, s[24:25]
    s_add_u32 m0, s42, 7168
    s_nop 0
    global_load_lds_dwordx4 v[20:21], off
    v_lshl_add_u64 v[20:21], v[20:21], 0, s[24:25]
    s_waitcnt vmcnt(24)
    ds_read_b64_tr_b16 a[32:33], v22 offset:8192
    ds_read_b64_tr_b16 a[34:35], v22 offset:8704
    ds_read_b64_tr_b16 a[36:37], v23 offset:8192
    ds_read_b64_tr_b16 a[38:39], v23 offset:8704
    ds_read_b64_tr_b16 a[40:41], v24 offset:8192
    ds_read_b64_tr_b16 a[42:43], v24 offset:8704
    ds_read_b64_tr_b16 a[44:45], v25 offset:8192
    ds_read_b64_tr_b16 a[46:47], v25 offset:8704
    s_waitcnt lgkmcnt(0)
    s_add_u32 m0, s42, 8192
    s_nop 0
    global_load_lds_dwordx4 v[20:21], off
    v_lshl_add_u64 v[20:21], v[20:21], 0, s[24:25]
    s_add_u32 m0, s42, 9216
    s_nop 0
    global_load_lds_dwordx4 v[20:21], off
    v_lshl_add_u64 v[20:21], v[20:21], 0, s[24:25]
    s_add_u32 m0, s42, 10240
    s_nop 0
    global_load_lds_dwordx4 v[20:21], off
    v_lshl_add_u64 v[20:21], v[20:21], 0, s[24:25]
    s_add_u32 m0, s42, 11264
    s_nop 0
    global_load_lds_dwordx4 v[20:21], off
    v_lshl_add_u64 v[20:21], v[20:21], 0, s[24:25]
    s_waitcnt vmcnt(24)
    ds_read_b64_tr_b16 a[48:49], v22 offset:12288
    ds_read_b64_tr_b16 a[50:51], v22 offset:12800
    ds_read_b64_tr_b16 a[52:53], v23 offset:12288
    ds_read_b64_tr_b16 a[54:55], v23 offset:12800
    ds_read_b64_tr_b16 a[56:57], v24 offset:12288
    ds_read_b64_tr_b16 a[58:59], v24 offset:12800
    ds_read_b64_tr_b16 a[60:61], v25 offset:12288
    ds_read_b64_tr_b16 a[62:63], v25 offset:12800
    s_waitcnt lgkmcnt(0)
    s_add_u32 m0, s42, 12288
    s_nop 0
    global_load_lds_dwordx4 v[20:21], off
    v_lshl_add_u64 v[20:21], v[20:21], 0, s[24:25]
    s_add_u32 m0, s42, 13312
    s_nop 0
    global_load_lds_dwordx4 v[20:21], off
    v_lshl_add_u64 v[20:21], v[20:21], 0, s[24:25]
    s_add_u32 m0, s42, 14336
    s_nop 0
    global_load_lds_dwordx4 v[20:21], off
    v_lshl_add_u64 v[20:21], v[20:21], 0, s[24:25]
    s_add_u32 m0, s42, 15360
    s_nop 0
    global_load_lds_dwordx4 v[20:21], off
    v_lshl_add_u64 v[20:21], v[20:21], 0, s[24:25]
    s_waitcnt vmcnt(24)
    ds_read_b64_tr_b16 a[64:65], v22 offset:16384
    ds_read_b64_tr_b16 a[66:67], v22 offset:16896
    ds_read_b64_tr_b16 a[68:69], v23 offset:16384
    ds_read_b64_tr_b16 a[70:71], v23 offset:16896
    ds_read_b64_tr_b16 a[72:73], v24 offset:16384
    ds_read_b64_tr_b16 a[74:75], v24 offset:16896
    ds_read_b64_tr_b16 a[76:77], v25 offset:16384
    ds_read_b64_tr_b16 a[78:79], v25 offset:16896
    s_waitcnt lgkmcnt(0)
    s_add_u32 m0, s42, 16384
    s_nop 0
    global_load_lds_dwordx4 v[20:21], off
    v_lshl_add_u64 v[20:21], v[20:21], 0, s[24:25]
    s_add_u32 m0, s42, 17408
    s_nop 0
    global_load_lds_dwordx4 v[20:21], off
    v_lshl_add_u64 v[20:21], v[20:21], 0, s[24:25]
    s_add_u32 m0, s42, 18432
    s_nop 0
    global_load_lds_dwordx4 v[20:21], off
    v_lshl_add_u64 v[20:21], v[20:21], 0, s[24:25]
    s_add_u32 m0, s42, 19456
    s_nop 0
    global_load_lds_dwordx4 v[20:21], off
    v_lshl_add_u64 v[20:21], v[20:21], 0, s[24:25]
    s_waitcnt vmcnt(24)
    ds_read_b64_tr_b16 a[80:81], v22 offset:20480
    ds_read_b64_tr_b16 a[82:83], v22 offset:20992
    ds_read_b64_tr_b16 a[84:85], v23 offset:20480
    ds_read_b64_tr_b16 a[86:87], v23 offset:20992
    ds_read_b64_tr_b16 a[88:89], v24 offset:20480
    ds_read_b64_tr_b16 a[90:91], v24 offset:20992
    ds_read_b64_tr_b16 a[92:93], v25 offset:20480
    ds_read_b64_tr_b16 a[94:95], v25 offset:20992
    s_waitcnt lgkmcnt(0)
    s_add_u32 m0, s42, 20480
    s_nop 0
    global_load_lds_dwordx4 v[20:21], off
    v_lshl_add_u64 v[20:21], v[20:21], 0, s[24:25]
    s_add_u32 m0, s42, 21504
    s_nop 0
    global_load_lds_dwordx4 v[20:21], off
    v_lshl_add_u64 v[20:21], v[20:21], 0, s[24:25]
    s_add_u32 m0, s42, 22528
    s_nop 0
    global_load_lds_dwordx4 v[20:21], off
    v_lshl_add_u64 v[20:21], v[20:21], 0, s[24:25]
    s_add_u32 m0, s42, 23552
    s_nop 0
    global_load_lds_dwordx4 v[20:21], off
    v_lshl_add_u64 v[20:21], v[20:21], 0, s[24:25]
    s_waitcnt vmcnt(24)
    ds_read_b64_tr_b16 a[96:97], v22 offset:24576
    ds_read_b64_tr_b16 a[98:99], v22 offset:25088
    ds_read_b64_tr_b16 a[100:101], v23 offset:24576
    ds_read_b64_tr_b16 a[102:103], v23 offset:25088
    ds_read_b64_tr_b16 a[104:105], v24 offset:24576
    ds_read_b64_tr_b16 a[106:107], v24 offset:25088
    ds_read_b64_tr_b16 a[108:109], v25 offset:24576
    ds_read_b64_tr_b16 a[110:111], v25 offset:25088
    s_waitcnt lgkmcnt(0)
    s_add_u32 m0, s42, 24576
    s_nop 0
    global_load_lds_dwordx4 v[20:21], off
    v_lshl_add_u64 v[20:21], v[20:21], 0, s[24:25]
    s_add_u32 m0, s42, 25600
    s_nop 0
    global_load_lds_dwordx4 v[20:21], off
    v_lshl_add_u64 v[20:21], v[20:21], 0, s[24:25]
    s_add_u32 m0, s42, 26624
    s_nop 0
    global_load_lds_dwordx4 v[20:21], off
    v_lshl_add_u64 v[20:21], v[20:21], 0, s[24:25]
    s_add_u32 m0, s42, 27648
    s_nop 0
    global_load_lds_dwordx4 v[20:21], off
    v_lshl_add_u64 v[20:21], v[20:21], 0, s[24:25]
    s_waitcnt vmcnt(24)
    ds_read_b64_tr_b16 a[112:113], v22 offset:0
    ds_read_b64_tr_b16 a[114:115], v22 offset:512
    ds_read_b64_tr_b16 a[116:117], v23 offset:0
    ds_read_b64_tr_b16 a[118:119], v23 offset:512
    ds_read_b64_tr_b16 a[120:121], v24 offset:0
    ds_read_b64_tr_b16 a[122:123], v24 offset:512
    ds_read_b64_tr_b16 a[124:125], v25 offset:0
    ds_read_b64_tr_b16 a[126:127], v25 offset:512
    s_waitcnt lgkmcnt(0)
    s_add_u32 m0, s42, 0
    s_nop 0
    global_load_lds_dwordx4 v[20:21], off
    v_lshl_add_u64 v[20:21], v[20:21], 0, s[24:25]
    s_add_u32 m0, s42, 1024
    s_nop 0
    global_load_lds_dwordx4 v[20:21], off
    v_lshl_add_u64 v[20:21], v[20:21], 0, s[24:25]
    s_add_u32 m0, s42, 2048
    s_nop 0
    global_load_lds_dwordx4 v[20:21], off
    v_lshl_add_u64 v[20:21], v[20:21], 0, s[24:25]
    s_add_u32 m0, s42, 3072
    s_nop 0
    global_load_lds_dwordx4 v[20:21], off
    v_lshl_add_u64 v[20:21], v[20:21], 0, s[24:25]
    s_waitcnt vmcnt(24)
    ds_read_b64_tr_b16 a[128:129], v22 offset:4096
    ds_read_b64_tr_b16 a[130:131], v22 offset:4608
    ds_read_b64_tr_b16 a[132:133], v23 offset:4096
    ds_read_b64_tr_b16 a[134:135], v23 offset:4608
    ds_read_b64_tr_b16 a[136:137], v24 offset:4096
    ds_read_b64_tr_b16 a[138:139], v24 offset:4608
    ds_read_b64_tr_b16 a[140:141], v25 offset:4096
    ds_read_b64_tr_b16 a[142:143], v25 offset:4608
    s_waitcnt lgkmcnt(0)
    s_add_u32 m0, s42, 4096
    s_nop 0
    global_load_lds_dwordx4 v[20:21], off
    v_lshl_add_u64 v[20:21], v[20:21], 0, s[24:25]
    s_add_u32 m0, s42, 5120
    s_nop 0
    global_load_lds_dwordx4 v[20:21], off
    v_lshl_add_u64 v[20:21], v[20:21], 0, s[24:25]
    s_add_u32 m0, s42, 6144
    s_nop 0
    global_load_lds_dwordx4 v[20:21], off
    v_lshl_add_u64 v[20:21], v[20:21], 0, s[24:25]
    s_add_u32 m0, s42, 7168
    s_nop 0
    global_load_lds_dwordx4 v[20:21], off
    v_lshl_add_u64 v[20:21], v[20:21], 0, s[24:25]
    s_waitcnt vmcnt(24)
    ds_read_b64_tr_b16 a[144:145], v22 offset:8192
    ds_read_b64_tr_b16 a[146:147], v22 offset:8704
    ds_read_b64_tr_b16 a[148:149], v23 offset:8192
    ds_read_b64_tr_b16 a[150:151], v23 offset:8704
    ds_read_b64_tr_b16 a[152:153], v24 offset:8192
    ds_read_b64_tr_b16 a[154:155], v24 offset:8704
    ds_read_b64_tr_b16 a[156:157], v25 offset:8192
    ds_read_b64_tr_b16 a[158:159], v25 offset:8704
    s_waitcnt lgkmcnt(0)
    s_add_u32 m0, s42, 8192
    s_nop 0
    global_load_lds_dwordx4 v[20:21], off
    v_lshl_add_u64 v[20:21], v[20:21], 0, s[24:25]
    s_add_u32 m0, s42, 9216
    s_nop 0
    global_load_lds_dwordx4 v[20:21], off
    v_lshl_add_u64 v[20:21], v[20:21], 0, s[24:25]
    s_add_u32 m0, s42, 10240
    s_nop 0
    global_load_lds_dwordx4 v[20:21], off
    v_lshl_add_u64 v[20:21], v[20:21], 0, s[24:25]
    s_add_u32 m0, s42, 11264
    s_nop 0
    global_load_lds_dwordx4 v[20:21], off
    v_lshl_add_u64 v[20:21], v[20:21], 0, s[24:25]
    s_waitcnt vmcnt(24)
    ds_read_b64_tr_b16 a[160:161], v22 offset:12288
    ds_read_b64_tr_b16 a[162:163], v22 offset:12800
    ds_read_b64_tr_b16 a[164:165], v23 offset:12288
    ds_read_b64_tr_b16 a[166:167], v23 offset:12800
    ds_read_b64_tr_b16 a[168:169], v24 offset:12288
    ds_read_b64_tr_b16 a[170:171], v24 offset:12800
    ds_read_b64_tr_b16 a[172:173], v25 offset:12288
    ds_read_b64_tr_b16 a[174:175], v25 offset:12800
    s_waitcnt lgkmcnt(0)
    s_add_u32 m0, s42, 12288
    s_nop 0
    global_load_lds_dwordx4 v[20:21], off
    v_lshl_add_u64 v[20:21], v[20:21], 0, s[24:25]
    s_add_u32 m0, s42, 13312
    s_nop 0
    global_load_lds_dwordx4 v[20:21], off
    v_lshl_add_u64 v[20:21], v[20:21], 0, s[24:25]
    s_add_u32 m0, s42, 14336
    s_nop 0
    global_load_lds_dwordx4 v[20:21], off
    v_lshl_add_u64 v[20:21], v[20:21], 0, s[24:25]
    s_add_u32 m0, s42, 15360
    s_nop 0
    global_load_lds_dwordx4 v[20:21], off
    v_lshl_add_u64 v[20:21], v[20:21], 0, s[24:25]
    s_waitcnt vmcnt(24)
    ds_read_b64_tr_b16 a[176:177], v22 offset:16384
    ds_read_b64_tr_b16 a[178:179], v22 offset:16896
    ds_read_b64_tr_b16 a[180:181], v23 offset:16384
    ds_read_b64_tr_b16 a[182:183], v23 offset:16896
    ds_read_b64_tr_b16 a[184:185], v24 offset:16384
    ds_read_b64_tr_b16 a[186:187], v24 offset:16896
    ds_read_b64_tr_b16 a[188:189], v25 offset:16384
    ds_read_b64_tr_b16 a[190:191], v25 offset:16896
    s_waitcnt lgkmcnt(0)
    s_add_u32 m0, s42, 16384
    s_nop 0
    global_load_lds_dwordx4 v[20:21], off
    v_lshl_add_u64 v[20:21], v[20:21], 0, s[24:25]
    s_add_u32 m0, s42, 17408
    s_nop 0
    global_load_lds_dwordx4 v[20:21], off
    v_lshl_add_u64 v[20:21], v[20:21], 0, s[24:25]
    s_add_u32 m0, s42, 18432
    s_nop 0
    global_load_lds_dwordx4 v[20:21], off
    v_lshl_add_u64 v[20:21], v[20:21], 0, s[24:25]
    s_add_u32 m0, s42, 19456
    s_nop 0
    global_load_lds_dwordx4 v[20:21], off
    v_lshl_add_u64 v[20:21], v[20:21], 0, s[24:25]
    s_waitcnt vmcnt(24)
    ds_read_b64_tr_b16 a[192:193], v22 offset:20480
    ds_read_b64_tr_b16 a[194:195], v22 offset:20992
    ds_read_b64_tr_b16 a[196:197], v23 offset:20480
    ds_read_b64_tr_b16 a[198:199], v23 offset:20992
    ds_read_b64_tr_b16 a[200:201], v24 offset:20480
    ds_read_b64_tr_b16 a[202:203], v24 offset:20992
    ds_read_b64_tr_b16 a[204:205], v25 offset:20480
    ds_read_b64_tr_b16 a[206:207], v25 offset:20992
    s_waitcnt lgkmcnt(0)
    s_add_u32 m0, s42, 20480
    s_nop 0
    global_load_lds_dwordx4 v[20:21], off
    v_lshl_add_u64 v[20:21], v[20:21], 0, s[24:25]
    s_add_u32 m0, s42, 21504
    s_nop 0
    global_load_lds_dwordx4 v[20:21], off
    v_lshl_add_u64 v[20:21], v[20:21], 0, s[24:25]
    s_add_u32 m0, s42, 22528
    s_nop 0
    global_load_lds_dwordx4 v[20:21], off
    v_lshl_add_u64 v[20:21], v[20:21], 0, s[24:25]
    s_add_u32 m0, s42, 23552
    s_nop 0
    global_load_lds_dwordx4 v[20:21], off
    v_lshl_add_u64 v[20:21], v[20:21], 0, s[24:25]
    s_waitcnt vmcnt(24)
    ds_read_b64_tr_b16 a[208:209], v22 offset:24576
    ds_read_b64_tr_b16 a[210:211], v22 offset:25088
    ds_read_b64_tr_b16 a[212:213], v23 offset:24576
    ds_read_b64_tr_b16 a[214:215], v23 offset:25088
    ds_read_b64_tr_b16 a[216:217], v24 offset:24576
    ds_read_b64_tr_b16 a[218:219], v24 offset:25088
    ds_read_b64_tr_b16 a[220:221], v25 offset:24576
    ds_read_b64_tr_b16 a[222:223], v25 offset:25088
    s_waitcnt vmcnt(20)
    ds_read_b64_tr_b16 a[224:225], v22 offset:0
    ds_read_b64_tr_b16 a[226:227], v22 offset:512
    ds_read_b64_tr_b16 a[228:229], v23 offset:0
    ds_read_b64_tr_b16 a[230:231], v23 offset:512
    ds_read_b64_tr_b16 a[232:233], v24 offset:0
    ds_read_b64_tr_b16 a[234:235], v24 offset:512
    ds_read_b64_tr_b16 a[236:237], v25 offset:0
    ds_read_b64_tr_b16 a[238:239], v25 offset:512
    s_waitcnt vmcnt(16)
    ds_read_b64_tr_b16 a[240:241], v22 offset:4096
    ds_read_b64_tr_b16 a[242:243], v22 offset:4608
    ds_read_b64_tr_b16 a[244:245], v23 offset:4096
    ds_read_b64_tr_b16 a[246:247], v23 offset:4608
    ds_read_b64_tr_b16 a[248:249], v24 offset:4096
    ds_read_b64_tr_b16 a[250:251], v24 offset:4608
    ds_read_b64_tr_b16 a[252:253], v25 offset:4096
    ds_read_b64_tr_b16 a[254:255], v25 offset:4608
    s_waitcnt vmcnt(12)
    ds_read_b64_tr_b16 v[124:125], v22 offset:8192
    ds_read_b64_tr_b16 v[126:127], v22 offset:8704
    ds_read_b64_tr_b16 v[128:129], v23 offset:8192
    ds_read_b64_tr_b16 v[130:131], v23 offset:8704
    ds_read_b64_tr_b16 v[132:133], v24 offset:8192
    ds_read_b64_tr_b16 v[134:135], v24 offset:8704
    ds_read_b64_tr_b16 v[136:137], v25 offset:8192
    ds_read_b64_tr_b16 v[138:139], v25 offset:8704
    s_waitcnt vmcnt(8)
    ds_read_b64_tr_b16 v[140:141], v22 offset:12288
    ds_read_b64_tr_b16 v[142:143], v22 offset:12800
    ds_read_b64_tr_b16 v[144:145], v23 offset:12288
    ds_read_b64_tr_b16 v[146:147], v23 offset:12800
    ds_read_b64_tr_b16 v[148:149], v24 offset:12288
    ds_read_b64_tr_b16 v[150:151], v24 offset:12800
    ds_read_b64_tr_b16 v[152:153], v25 offset:12288
    ds_read_b64_tr_b16 v[154:155], v25 offset:12800
    s_waitcnt vmcnt(4)
    ds_read_b64_tr_b16 v[156:157], v22 offset:16384
    ds_read_b64_tr_b16 v[158:159], v22 offset:16896
    ds_read_b64_tr_b16 v[160:161], v23 offset:16384
    ds_read_b64_tr_b16 v[162:163], v23 offset:16896
    ds_read_b64_tr_b16 v[164:165], v24 offset:16384
    ds_read_b64_tr_b16 v[166:167], v24 offset:16896
    ds_read_b64_tr_b16 v[168:169], v25 offset:16384
    ds_read_b64_tr_b16 v[170:171], v25 offset:16896
    s_waitcnt vmcnt(0)
    ds_read_b64_tr_b16 v[172:173], v22 offset:20480
    ds_read_b64_tr_b16 v[174:175], v22 offset:20992
    ds_read_b64_tr_b16 v[176:177], v23 offset:20480
    ds_read_b64_tr_b16 v[178:179], v23 offset:20992
    ds_read_b64_tr_b16 v[180:181], v24 offset:20480
    ds_read_b64_tr_b16 v[182:183], v24 offset:20992
    ds_read_b64_tr_b16 v[184:185], v25 offset:20480
    ds_read_b64_tr_b16 v[186:187], v25 offset:20992
    s_waitcnt lgkmcnt(0)
    s_barrier
    v_mov_b32 v196, -1
    v_mov_b32 v197, -1
    v_mov_b32 v198, -1
    v_mov_b32 v199, -1
    v_lshlrev_b32 v200, 4, v0
    s_lshr_b32 s43, s100, 3
    s_and_b32 s43, s43, 1
    s_lshl_b32 s43, s43, 2
    s_and_b32 s42, s100, 3
    s_add_u32 s43, s43, s42
    s_lshr_b32 s42, s100, 4
    s_add_u32 s42, s42, 8
    s_mul_i32 s40, s42, 81920
    s_add_u32 s40, s40, 83968000
    s_add_u32 s41, s43, 0
    s_lshl_b32 s41, s41, 12
    s_add_u32 s41, s41, s40
    s_add_u32 s52, s18, s41
    s_addc_u32 s53, s19, 0
    global_store_dwordx4 v200, v[196:199], s[52:53] sc1
    s_add_u32 s41, s43, 8
    s_min_u32 s41, s41, 9
    s_lshl_b32 s41, s41, 12
    s_add_u32 s41, s41, s40
    s_add_u32 s52, s18, s41
    s_addc_u32 s53, s19, 0
    global_store_dwordx4 v200, v[196:199], s[52:53] sc1
    s_mul_i32 s40, s42, 65536
    s_add_u32 s40, s40, 96468992
    s_add_u32 s41, s43, 0
    s_lshl_b32 s41, s41, 12
    s_add_u32 s41, s41, s40
    s_add_u32 s52, s18, s41
    s_addc_u32 s53, s19, 0
    global_store_dwordx4 v200, v[196:199], s[52:53] sc1
    s_add_u32 s41, s43, 8
    s_lshl_b32 s41, s41, 12
    s_add_u32 s41, s41, s40
    s_add_u32 s52, s18, s41
    s_addc_u32 s53, s19, 0
    global_store_dwordx4 v200, v[196:199], s[52:53] sc1
    s_mul_i32 s40, s42, 262144
    s_add_u32 s40, s40, 134217728
    s_sub_u32 s41, 0, s18
    s_and_b32 s41, s41, 0x1fffff
    s_add_u32 s40, s40, s41
    s_add_u32 s41, s43, 0
    s_lshl_b32 s41, s41, 12
    s_add_u32 s41, s41, s40
    s_add_u32 s52, s18, s41
    s_addc_u32 s53, s19, 0
    global_store_dwordx4 v200, v[196:199], s[52:53] sc1
    s_add_u32 s41, s43, 8
    s_lshl_b32 s41, s41, 12
    s_add_u32 s41, s41, s40
    s_add_u32 s52, s18, s41
    s_addc_u32 s53, s19, 0
    global_store_dwordx4 v200, v[196:199], s[52:53] sc1
    s_add_u32 s41, s43, 16
    s_lshl_b32 s41, s41, 12
    s_add_u32 s41, s41, s40
    s_add_u32 s52, s18, s41
    s_addc_u32 s53, s19, 0
    global_store_dwordx4 v200, v[196:199], s[52:53] sc1
    s_add_u32 s41, s43, 24
    s_lshl_b32 s41, s41, 12
    s_add_u32 s41, s41, s40
    s_add_u32 s52, s18, s41
    s_addc_u32 s53, s19, 0
    global_store_dwordx4 v200, v[196:199], s[52:53] sc1
    s_add_u32 s41, s43, 32
    s_lshl_b32 s41, s41, 12
    s_add_u32 s41, s41, s40
    s_add_u32 s52, s18, s41
    s_addc_u32 s53, s19, 0
    global_store_dwordx4 v200, v[196:199], s[52:53] sc1
    s_lshr_b32 s42, s100, 4
    s_add_u32 s42, s42, 16
    s_mul_i32 s40, s42, 81920
    s_add_u32 s40, s40, 83968000
    s_add_u32 s41, s43, 0
    s_lshl_b32 s41, s41, 12
    s_add_u32 s41, s41, s40
    s_add_u32 s52, s18, s41
    s_addc_u32 s53, s19, 0
    global_store_dwordx4 v200, v[196:199], s[52:53] sc1
    s_add_u32 s41, s43, 8
    s_min_u32 s41, s41, 9
    s_lshl_b32 s41, s41, 12
    s_add_u32 s41, s41, s40
    s_add_u32 s52, s18, s41
    s_addc_u32 s53, s19, 0
    global_store_dwordx4 v200, v[196:199], s[52:53] sc1
    s_mul_i32 s40, s42, 65536
    s_add_u32 s40, s40, 96468992
    s_add_u32 s41, s43, 0
    s_lshl_b32 s41, s41, 12
    s_add_u32 s41, s41, s40
    s_add_u32 s52, s18, s41
    s_addc_u32 s53, s19, 0
    global_store_dwordx4 v200, v[196:199], s[52:53] sc1
    s_add_u32 s41, s43, 8
    s_lshl_b32 s41, s41, 12
    s_add_u32 s41, s41, s40
    s_add_u32 s52, s18, s41
    s_addc_u32 s53, s19, 0
    global_store_dwordx4 v200, v[196:199], s[52:53] sc1
    s_mul_i32 s40, s42, 262144
    s_add_u32 s40, s40, 134217728
    s_sub_u32 s41, 0, s18
    s_and_b32 s41, s41, 0x1fffff
    s_add_u32 s40, s40, s41
    s_add_u32 s41, s43, 0
    s_lshl_b32 s41, s41, 12
    s_add_u32 s41, s41, s40
    s_add_u32 s52, s18, s41
    s_addc_u32 s53, s19, 0
    global_store_dwordx4 v200, v[196:199], s[52:53] sc1
    s_add_u32 s41, s43, 8
    s_lshl_b32 s41, s41, 12
    s_add_u32 s41, s41, s40
    s_add_u32 s52, s18, s41
    s_addc_u32 s53, s19, 0
    global_store_dwordx4 v200, v[196:199], s[52:53] sc1
    s_add_u32 s41, s43, 16
    s_lshl_b32 s41, s41, 12
    s_add_u32 s41, s41, s40
    s_add_u32 s52, s18, s41
    s_addc_u32 s53, s19, 0
    global_store_dwordx4 v200, v[196:199], s[52:53] sc1
    s_add_u32 s41, s43, 24
    s_lshl_b32 s41, s41, 12
    s_add_u32 s41, s41, s40
    s_add_u32 s52, s18, s41
    s_addc_u32 s53, s19, 0
    global_store_dwordx4 v200, v[196:199], s[52:53] sc1
    s_add_u32 s41, s43, 32
    s_lshl_b32 s41, s41, 12
    s_add_u32 s41, s41, s40
    s_add_u32 s52, s18, s41
    s_addc_u32 s53, s19, 0
    global_store_dwordx4 v200, v[196:199], s[52:53] sc1
    s_lshr_b32 s42, s100, 4
    s_add_u32 s42, s42, 24
    s_mul_i32 s40, s42, 81920
    s_add_u32 s40, s40, 83968000
    s_add_u32 s41, s43, 0
    s_lshl_b32 s41, s41, 12
    s_add_u32 s41, s41, s40
    s_add_u32 s52, s18, s41
    s_addc_u32 s53, s19, 0
    global_store_dwordx4 v200, v[196:199], s[52:53] sc1
    s_add_u32 s41, s43, 8
    s_min_u32 s41, s41, 9
    s_lshl_b32 s41, s41, 12
    s_add_u32 s41, s41, s40
    s_add_u32 s52, s18, s41
    s_addc_u32 s53, s19, 0
    global_store_dwordx4 v200, v[196:199], s[52:53] sc1
    s_mul_i32 s40, s42, 65536
    s_add_u32 s40, s40, 96468992
    s_add_u32 s41, s43, 0
    s_lshl_b32 s41, s41, 12
    s_add_u32 s41, s41, s40
    s_add_u32 s52, s18, s41
    s_addc_u32 s53, s19, 0
    global_store_dwordx4 v200, v[196:199], s[52:53] sc1
    s_add_u32 s41, s43, 8
    s_lshl_b32 s41, s41, 12
    s_add_u32 s41, s41, s40
    s_add_u32 s52, s18, s41
    s_addc_u32 s53, s19, 0
    global_store_dwordx4 v200, v[196:199], s[52:53] sc1
    s_mul_i32 s40, s42, 262144
    s_add_u32 s40, s40, 134217728
    s_sub_u32 s41, 0, s18
    s_and_b32 s41, s41, 0x1fffff
    s_add_u32 s40, s40, s41
    s_add_u32 s41, s43, 0
    s_lshl_b32 s41, s41, 12
    s_add_u32 s41, s41, s40
    s_add_u32 s52, s18, s41
    s_addc_u32 s53, s19, 0
    global_store_dwordx4 v200, v[196:199], s[52:53] sc1
    s_add_u32 s41, s43, 8
    s_lshl_b32 s41, s41, 12
    s_add_u32 s41, s41, s40
    s_add_u32 s52, s18, s41
    s_addc_u32 s53, s19, 0
    global_store_dwordx4 v200, v[196:199], s[52:53] sc1
    s_add_u32 s41, s43, 16
    s_lshl_b32 s41, s41, 12
    s_add_u32 s41, s41, s40
    s_add_u32 s52, s18, s41
    s_addc_u32 s53, s19, 0
    global_store_dwordx4 v200, v[196:199], s[52:53] sc1
    s_add_u32 s41, s43, 24
    s_lshl_b32 s41, s41, 12
    s_add_u32 s41, s41, s40
    s_add_u32 s52, s18, s41
    s_addc_u32 s53, s19, 0
    global_store_dwordx4 v200, v[196:199], s[52:53] sc1
    s_add_u32 s41, s43, 32
    s_lshl_b32 s41, s41, 12
    s_add_u32 s41, s41, s40
    s_add_u32 s52, s18, s41
    s_addc_u32 s53, s19, 0
    global_store_dwordx4 v200, v[196:199], s[52:53] sc1
    s_lshr_b32 s42, s100, 4
    s_add_u32 s42, s42, 32
    s_mul_i32 s40, s42, 81920
    s_add_u32 s40, s40, 83968000
    s_add_u32 s41, s43, 0
    s_lshl_b32 s41, s41, 12
    s_add_u32 s41, s41, s40
    s_add_u32 s52, s18, s41
    s_addc_u32 s53, s19, 0
    global_store_dwordx4 v200, v[196:199], s[52:53] sc1
    s_add_u32 s41, s43, 8
    s_min_u32 s41, s41, 9
    s_lshl_b32 s41, s41, 12
    s_add_u32 s41, s41, s40
    s_add_u32 s52, s18, s41
    s_addc_u32 s53, s19, 0
    global_store_dwordx4 v200, v[196:199], s[52:53] sc1
    s_mul_i32 s40, s42, 65536
    s_add_u32 s40, s40, 96468992
    s_add_u32 s41, s43, 0
    s_lshl_b32 s41, s41, 12
    s_add_u32 s41, s41, s40
    s_add_u32 s52, s18, s41
    s_addc_u32 s53, s19, 0
    global_store_dwordx4 v200, v[196:199], s[52:53] sc1
    s_add_u32 s41, s43, 8
    s_lshl_b32 s41, s41, 12
    s_add_u32 s41, s41, s40
    s_add_u32 s52, s18, s41
    s_addc_u32 s53, s19, 0
    global_store_dwordx4 v200, v[196:199], s[52:53] sc1
    s_mul_i32 s40, s42, 262144
    s_add_u32 s40, s40, 134217728
    s_sub_u32 s41, 0, s18
    s_and_b32 s41, s41, 0x1fffff
    s_add_u32 s40, s40, s41
    s_add_u32 s41, s43, 0
    s_lshl_b32 s41, s41, 12
    s_add_u32 s41, s41, s40
    s_add_u32 s52, s18, s41
    s_addc_u32 s53, s19, 0
    global_store_dwordx4 v200, v[196:199], s[52:53] sc1
    s_add_u32 s41, s43, 8
    s_lshl_b32 s41, s41, 12
    s_add_u32 s41, s41, s40
    s_add_u32 s52, s18, s41
    s_addc_u32 s53, s19, 0
    global_store_dwordx4 v200, v[196:199], s[52:53] sc1
    s_add_u32 s41, s43, 16
    s_lshl_b32 s41, s41, 12
    s_add_u32 s41, s41, s40
    s_add_u32 s52, s18, s41
    s_addc_u32 s53, s19, 0
    global_store_dwordx4 v200, v[196:199], s[52:53] sc1
    s_add_u32 s41, s43, 24
    s_lshl_b32 s41, s41, 12
    s_add_u32 s41, s41, s40
    s_add_u32 s52, s18, s41
    s_addc_u32 s53, s19, 0
    global_store_dwordx4 v200, v[196:199], s[52:53] sc1
    s_add_u32 s41, s43, 32
    s_lshl_b32 s41, s41, 12
    s_add_u32 s41, s41, s40
    s_add_u32 s52, s18, s41
    s_addc_u32 s53, s19, 0
    global_store_dwordx4 v200, v[196:199], s[52:53] sc1
    s_lshr_b32 s42, s100, 4
    s_add_u32 s42, s42, 40
    s_mul_i32 s40, s42, 81920
    s_add_u32 s40, s40, 83968000
    s_add_u32 s41, s43, 0
    s_lshl_b32 s41, s41, 12
    s_add_u32 s41, s41, s40
    s_add_u32 s52, s18, s41
    s_addc_u32 s53, s19, 0
    global_store_dwordx4 v200, v[196:199], s[52:53] sc1
    s_add_u32 s41, s43, 8
    s_min_u32 s41, s41, 9
    s_lshl_b32 s41, s41, 12
    s_add_u32 s41, s41, s40
    s_add_u32 s52, s18, s41
    s_addc_u32 s53, s19, 0
    global_store_dwordx4 v200, v[196:199], s[52:53] sc1
    s_mul_i32 s40, s42, 65536
    s_add_u32 s40, s40, 96468992
    s_add_u32 s41, s43, 0
    s_lshl_b32 s41, s41, 12
    s_add_u32 s41, s41, s40
    s_add_u32 s52, s18, s41
    s_addc_u32 s53, s19, 0
    global_store_dwordx4 v200, v[196:199], s[52:53] sc1
    s_add_u32 s41, s43, 8
    s_lshl_b32 s41, s41, 12
    s_add_u32 s41, s41, s40
    s_add_u32 s52, s18, s41
    s_addc_u32 s53, s19, 0
    global_store_dwordx4 v200, v[196:199], s[52:53] sc1
    s_mul_i32 s40, s42, 262144
    s_add_u32 s40, s40, 134217728
    s_sub_u32 s41, 0, s18
    s_and_b32 s41, s41, 0x1fffff
    s_add_u32 s40, s40, s41
    s_add_u32 s41, s43, 0
    s_lshl_b32 s41, s41, 12
    s_add_u32 s41, s41, s40
    s_add_u32 s52, s18, s41
    s_addc_u32 s53, s19, 0
    global_store_dwordx4 v200, v[196:199], s[52:53] sc1
    s_add_u32 s41, s43, 8
    s_lshl_b32 s41, s41, 12
    s_add_u32 s41, s41, s40
    s_add_u32 s52, s18, s41
    s_addc_u32 s53, s19, 0
    global_store_dwordx4 v200, v[196:199], s[52:53] sc1
    s_add_u32 s41, s43, 16
    s_lshl_b32 s41, s41, 12
    s_add_u32 s41, s41, s40
    s_add_u32 s52, s18, s41
    s_addc_u32 s53, s19, 0
    global_store_dwordx4 v200, v[196:199], s[52:53] sc1
    s_add_u32 s41, s43, 24
    s_lshl_b32 s41, s41, 12
    s_add_u32 s41, s41, s40
    s_add_u32 s52, s18, s41
    s_addc_u32 s53, s19, 0
    global_store_dwordx4 v200, v[196:199], s[52:53] sc1
    s_add_u32 s41, s43, 32
    s_lshl_b32 s41, s41, 12
    s_add_u32 s41, s41, s40
    s_add_u32 s52, s18, s41
    s_addc_u32 s53, s19, 0
    global_store_dwordx4 v200, v[196:199], s[52:53] sc1
    s_lshr_b32 s42, s100, 4
    s_add_u32 s42, s42, 48
    s_mul_i32 s40, s42, 81920
    s_add_u32 s40, s40, 83968000
    s_add_u32 s41, s43, 0
    s_lshl_b32 s41, s41, 12
    s_add_u32 s41, s41, s40
    s_add_u32 s52, s18, s41
    s_addc_u32 s53, s19, 0
    global_store_dwordx4 v200, v[196:199], s[52:53] sc1
    s_add_u32 s41, s43, 8
    s_min_u32 s41, s41, 9
    s_lshl_b32 s41, s41, 12
    s_add_u32 s41, s41, s40
    s_add_u32 s52, s18, s41
    s_addc_u32 s53, s19, 0
    global_store_dwordx4 v200, v[196:199], s[52:53] sc1
    s_mul_i32 s40, s42, 65536
    s_add_u32 s40, s40, 96468992
    s_add_u32 s41, s43, 0
    s_lshl_b32 s41, s41, 12
    s_add_u32 s41, s41, s40
    s_add_u32 s52, s18, s41
    s_addc_u32 s53, s19, 0
    global_store_dwordx4 v200, v[196:199], s[52:53] sc1
    s_add_u32 s41, s43, 8
    s_lshl_b32 s41, s41, 12
    s_add_u32 s41, s41, s40
    s_add_u32 s52, s18, s41
    s_addc_u32 s53, s19, 0
    global_store_dwordx4 v200, v[196:199], s[52:53] sc1
    s_mul_i32 s40, s42, 262144
    s_add_u32 s40, s40, 134217728
    s_sub_u32 s41, 0, s18
    s_and_b32 s41, s41, 0x1fffff
    s_add_u32 s40, s40, s41
    s_add_u32 s41, s43, 0
    s_lshl_b32 s41, s41, 12
    s_add_u32 s41, s41, s40
    s_add_u32 s52, s18, s41
    s_addc_u32 s53, s19, 0
    global_store_dwordx4 v200, v[196:199], s[52:53] sc1
    s_add_u32 s41, s43, 8
    s_lshl_b32 s41, s41, 12
    s_add_u32 s41, s41, s40
    s_add_u32 s52, s18, s41
    s_addc_u32 s53, s19, 0
    global_store_dwordx4 v200, v[196:199], s[52:53] sc1
    s_add_u32 s41, s43, 16
    s_lshl_b32 s41, s41, 12
    s_add_u32 s41, s41, s40
    s_add_u32 s52, s18, s41
    s_addc_u32 s53, s19, 0
    global_store_dwordx4 v200, v[196:199], s[52:53] sc1
    s_add_u32 s41, s43, 24
    s_lshl_b32 s41, s41, 12
    s_add_u32 s41, s41, s40
    s_add_u32 s52, s18, s41
    s_addc_u32 s53, s19, 0
    global_store_dwordx4 v200, v[196:199], s[52:53] sc1
    s_add_u32 s41, s43, 32
    s_lshl_b32 s41, s41, 12
    s_add_u32 s41, s41, s40
    s_add_u32 s52, s18, s41
    s_addc_u32 s53, s19, 0
    global_store_dwordx4 v200, v[196:199], s[52:53] sc1
    s_lshr_b32 s42, s100, 4
    s_add_u32 s42, s42, 56
    s_mul_i32 s40, s42, 81920
    s_add_u32 s40, s40, 83968000
    s_add_u32 s41, s43, 0
    s_lshl_b32 s41, s41, 12
    s_add_u32 s41, s41, s40
    s_add_u32 s52, s18, s41
    s_addc_u32 s53, s19, 0
    global_store_dwordx4 v200, v[196:199], s[52:53] sc1
    s_add_u32 s41, s43, 8
    s_min_u32 s41, s41, 9
    s_lshl_b32 s41, s41, 12
    s_add_u32 s41, s41, s40
    s_add_u32 s52, s18, s41
    s_addc_u32 s53, s19, 0
    global_store_dwordx4 v200, v[196:199], s[52:53] sc1
    s_mul_i32 s40, s42, 65536
    s_add_u32 s40, s40, 96468992
    s_add_u32 s41, s43, 0
    s_lshl_b32 s41, s41, 12
    s_add_u32 s41, s41, s40
    s_add_u32 s52, s18, s41
    s_addc_u32 s53, s19, 0
    global_store_dwordx4 v200, v[196:199], s[52:53] sc1
    s_add_u32 s41, s43, 8
    s_lshl_b32 s41, s41, 12
    s_add_u32 s41, s41, s40
    s_add_u32 s52, s18, s41
    s_addc_u32 s53, s19, 0
    global_store_dwordx4 v200, v[196:199], s[52:53] sc1
    s_mul_i32 s40, s42, 262144
    s_add_u32 s40, s40, 134217728
    s_sub_u32 s41, 0, s18
    s_and_b32 s41, s41, 0x1fffff
    s_add_u32 s40, s40, s41
    s_add_u32 s41, s43, 0
    s_lshl_b32 s41, s41, 12
    s_add_u32 s41, s41, s40
    s_add_u32 s52, s18, s41
    s_addc_u32 s53, s19, 0
    global_store_dwordx4 v200, v[196:199], s[52:53] sc1
    s_add_u32 s41, s43, 8
    s_lshl_b32 s41, s41, 12
    s_add_u32 s41, s41, s40
    s_add_u32 s52, s18, s41
    s_addc_u32 s53, s19, 0
    global_store_dwordx4 v200, v[196:199], s[52:53] sc1
    s_add_u32 s41, s43, 16
    s_lshl_b32 s41, s41, 12
    s_add_u32 s41, s41, s40
    s_add_u32 s52, s18, s41
    s_addc_u32 s53, s19, 0
    global_store_dwordx4 v200, v[196:199], s[52:53] sc1
    s_add_u32 s41, s43, 24
    s_lshl_b32 s41, s41, 12
    s_add_u32 s41, s41, s40
    s_add_u32 s52, s18, s41
    s_addc_u32 s53, s19, 0
    global_store_dwordx4 v200, v[196:199], s[52:53] sc1
    s_add_u32 s41, s43, 32
    s_lshl_b32 s41, s41, 12
    s_add_u32 s41, s41, s40
    s_add_u32 s52, s18, s41
    s_addc_u32 s53, s19, 0
    global_store_dwordx4 v200, v[196:199], s[52:53] sc1
    s_and_b32 s42, s43, 7
    s_lshl_b32 s42, s42, 13
    s_bitcmp1_b32 s100, 4
    s_cselect_b32 s40, 4194304, 0
    s_add_u32 s40, s40, 79429632
    s_add_u32 s40, s40, s42
    s_lshr_b32 s42, s100, 5
    s_lshl_b32 s42, s42, 16
    s_add_u32 s40, s40, s42
    s_add_u32 s52, s18, s40
    s_addc_u32 s53, s19, 0
    global_store_dwordx4 v200, v[196:199], s[52:53] sc1
    s_add_u32 s52, s52, 4096
    s_addc_u32 s53, s53, 0
    global_store_dwordx4 v200, v[196:199], s[52:53] sc1
    s_mov_b64 s[60:61], s[48:49]
    s_mov_b32 s26, 1
    s_add_u32 s27, s27, 40960
    s_cmp_ge_u32 s27, 163840
    s_cselect_b32 s43, 163840, 0
    s_sub_u32 s27, s27, s43
    s_min_u32 s29, s26, 31
    s_lshl_b32 s29, s29, 1
    s_add_u32 s29, s29, s31
    s_mul_i32 s29, s29, 40960
    s_add_u32 m0, s27, 0
    s_add_u32 s43, s29, 0
    buffer_load_dwordx4 v9, s[20:23], s43 offen lds
    s_add_u32 m0, s27, 4096
    s_add_u32 s43, s29, 128
    buffer_load_dwordx4 v9, s[20:23], s43 offen lds
    s_add_u32 m0, s27, 8192
    s_add_u32 s43, s29, 256
    buffer_load_dwordx4 v9, s[20:23], s43 offen lds
    s_add_u32 m0, s27, 12288
    s_add_u32 s43, s29, 384
    buffer_load_dwordx4 v9, s[20:23], s43 offen lds
    s_add_u32 m0, s27, 16384
    s_add_u32 s43, s29, 512
    buffer_load_dwordx4 v9, s[20:23], s43 offen lds
    s_add_u32 m0, s27, 20480
    s_add_u32 s43, s29, 640
    buffer_load_dwordx4 v9, s[20:23], s43 offen lds
    s_add_u32 m0, s27, 24576
    s_add_u32 s43, s29, 768
    buffer_load_dwordx4 v9, s[20:23], s43 offen lds
    s_add_u32 m0, s27, 28672
    s_add_u32 s43, s29, 896
    buffer_load_dwordx4 v9, s[20:23], s43 offen lds
    s_add_u32 m0, s27, 32768
    s_add_u32 s43, s29, 1024
    buffer_load_dwordx4 v9, s[20:23], s43 offen lds
    s_add_u32 m0, s27, 36864
    s_add_u32 s43, s29, 1152
    buffer_load_dwordx4 v9, s[20:23], s43 offen lds
    s_mov_b32 s26, 2
    s_add_u32 s27, s27, 40960
    s_cmp_ge_u32 s27, 163840
    s_cselect_b32 s43, 163840, 0
    s_sub_u32 s27, s27, s43
    s_min_u32 s29, s26, 31
    s_lshl_b32 s29, s29, 1
    s_add_u32 s29, s29, s31
    s_mul_i32 s29, s29, 40960
    s_add_u32 m0, s27, 0
    s_add_u32 s43, s29, 0
    buffer_load_dwordx4 v9, s[20:23], s43 offen lds
    s_add_u32 m0, s27, 4096
    s_add_u32 s43, s29, 128
    buffer_load_dwordx4 v9, s[20:23], s43 offen lds
    s_add_u32 m0, s27, 8192
    s_add_u32 s43, s29, 256
    buffer_load_dwordx4 v9, s[20:23], s43 offen lds
    s_add_u32 m0, s27, 12288
    s_add_u32 s43, s29, 384
    buffer_load_dwordx4 v9, s[20:23], s43 offen lds
    s_add_u32 m0, s27, 16384
    s_add_u32 s43, s29, 512
    buffer_load_dwordx4 v9, s[20:23], s43 offen lds
    s_add_u32 m0, s27, 20480
    s_add_u32 s43, s29, 640
    buffer_load_dwordx4 v9, s[20:23], s43 offen lds
    s_add_u32 m0, s27, 24576
    s_add_u32 s43, s29, 768
    buffer_load_dwordx4 v9, s[20:23], s43 offen lds
    s_add_u32 m0, s27, 28672
    s_add_u32 s43, s29, 896
    buffer_load_dwordx4 v9, s[20:23], s43 offen lds
    s_add_u32 m0, s27, 32768
    s_add_u32 s43, s29, 1024
    buffer_load_dwordx4 v9, s[20:23], s43 offen lds
    s_add_u32 m0, s27, 36864
    s_add_u32 s43, s29, 1152
    buffer_load_dwordx4 v9, s[20:23], s43 offen lds
    s_mov_b32 s26, 0
    ds_read_b128 v[28:31], v12 offset:0
    ds_read_b128 v[32:35], v12 offset:2048
    ds_read_b128 v[36:39], v13 offset:0
    ds_read_b128 v[40:43], v13 offset:2048
    s_waitcnt vmcnt(10)
    s_cmp_eq_u32 s5, 3
    s_cbranch_scc1 g1_G
    s_cmp_eq_u32 s5, 2
    s_cbranch_scc1 g1_T
g1_Q:
    v_add_u32 v8, 0x20000, v7
    s_lshl_b32 s40, s5, 24
    s_lshl_b32 s41, s31, 18
    s_add_u32 s40, s40, s41
    s_lshl_b32 s41, s4, 11
    s_add_u32 s40, s40, s41
    s_add_u32 s62, s18, s40
    s_addc_u32 s63, s19, 0
    s_mov_b64 s[50:51], s[62:63]
    s_mov_b32 s65, 0x40000
    s_cmp_eq_u32 s5, 0
    s_cselect_b32 s40, 256, 1
    v_mov_b32 v16, s40
    s_mov_b32 s30, -4
    s_cmp_eq_u32 s5, 0
    s_cbranch_scc1 g1_ql
    s_nop 7
    v_cvt_pk_bf16_f32 v60, v60, v61
    v_cvt_pk_bf16_f32 v61, v62, v63
    v_cvt_pk_bf16_f32 v62, v64, v65
    v_cvt_pk_bf16_f32 v63, v66, v67
    global_store_dwordx4 v7, v[60:63], s[50:51] offset:0 sc1
    v_cvt_pk_bf16_f32 v68, v68, v69
    v_cvt_pk_bf16_f32 v69, v70, v71
    v_cvt_pk_bf16_f32 v70, v72, v73
    v_cvt_pk_bf16_f32 v71, v74, v75
    global_store_dwordx4 v7, v[68:71], s[50:51] offset:1024 sc1
    v_cvt_pk_bf16_f32 v76, v76, v77
    v_cvt_pk_bf16_f32 v77, v78, v79
    v_cvt_pk_bf16_f32 v78, v80, v81
    v_cvt_pk_bf16_f32 v79, v82, v83
    global_store_dwordx4 v8, v[76:79], s[50:51] offset:0 sc1
    v_cvt_pk_bf16_f32 v84, v84, v85
    v_cvt_pk_bf16_f32 v85, v86, v87
    v_cvt_pk_bf16_f32 v86, v88, v89
    v_cvt_pk_bf16_f32 v87, v90, v91
    global_store_dwordx4 v8, v[84:87], s[50:51] offset:1024 sc1
    s_mov_b32 s26, 1
    s_add_u32 s27, s27, 40960
    s_cmp_ge_u32 s27, 163840
    s_cselect_b32 s43, 163840, 0
    s_sub_u32 s27, s27, s43
    s_min_u32 s29, s26, 31
    s_lshl_b32 s29, s29, 1
    s_add_u32 s29, s29, s31
    s_mul_i32 s29, s29, 40960
    s_add_u32 m0, s27, 0
    s_add_u32 s43, s29, 0
    buffer_load_dwordx4 v9, s[20:23], s43 offen lds
    s_add_u32 m0, s27, 4096
    s_add_u32 s43, s29, 128
    buffer_load_dwordx4 v9, s[20:23], s43 offen lds
    s_add_u32 m0, s27, 8192
    s_add_u32 s43, s29, 256
    buffer_load_dwordx4 v9, s[20:23], s43 offen lds
    s_add_u32 m0, s27, 12288
    s_add_u32 s43, s29, 384
    buffer_load_dwordx4 v9, s[20:23], s43 offen lds
    s_add_u32 m0, s27, 16384
    s_add_u32 s43, s29, 512
    buffer_load_dwordx4 v9, s[20:23], s43 offen lds
    s_add_u32 m0, s27, 20480
    s_add_u32 s43, s29, 640
    buffer_load_dwordx4 v9, s[20:23], s43 offen lds
    s_add_u32 m0, s27, 24576
    s_add_u32 s43, s29, 768
    buffer_load_dwordx4 v9, s[20:23], s43 offen lds
    s_add_u32 m0, s27, 28672
    s_add_u32 s43, s29, 896
    buffer_load_dwordx4 v9, s[20:23], s43 offen lds
    s_add_u32 m0, s27, 32768
    s_add_u32 s43, s29, 1024
    buffer_load_dwordx4 v9, s[20:23], s43 offen lds
    s_add_u32 m0, s27, 36864
    s_add_u32 s43, s29, 1152
    buffer_load_dwordx4 v9, s[20:23], s43 offen lds
    s_mov_b32 s26, 2
    s_add_u32 s27, s27, 40960
    s_cmp_ge_u32 s27, 163840
    s_cselect_b32 s43, 163840, 0
    s_sub_u32 s27, s27, s43
    s_min_u32 s29, s26, 31
    s_lshl_b32 s29, s29, 1
    s_add_u32 s29, s29, s31
    s_mul_i32 s29, s29, 40960
    s_add_u32 m0, s27, 0
    s_add_u32 s43, s29, 0
    buffer_load_dwordx4 v9, s[20:23], s43 offen lds
    s_add_u32 m0, s27, 4096
    s_add_u32 s43, s29, 128
    buffer_load_dwordx4 v9, s[20:23], s43 offen lds
    s_add_u32 m0, s27, 8192
    s_add_u32 s43, s29, 256
    buffer_load_dwordx4 v9, s[20:23], s43 offen lds
    s_add_u32 m0, s27, 12288
    s_add_u32 s43, s29, 384
    buffer_load_dwordx4 v9, s[20:23], s43 offen lds
    s_add_u32 m0, s27, 16384
    s_add_u32 s43, s29, 512
    buffer_load_dwordx4 v9, s[20:23], s43 offen lds
    s_add_u32 m0, s27, 20480
    s_add_u32 s43, s29, 640
    buffer_load_dwordx4 v9, s[20:23], s43 offen lds
    s_add_u32 m0, s27, 24576
    s_add_u32 s43, s29, 768
    buffer_load_dwordx4 v9, s[20:23], s43 offen lds
    s_add_u32 m0, s27, 28672
    s_add_u32 s43, s29, 896
    buffer_load_dwordx4 v9, s[20:23], s43 offen lds
    s_add_u32 m0, s27, 32768
    s_add_u32 s43, s29, 1024
    buffer_load_dwordx4 v9, s[20:23], s43 offen lds
    s_add_u32 m0, s27, 36864
    s_add_u32 s43, s29, 1152
    buffer_load_dwordx4 v9, s[20:23], s43 offen lds
    s_mov_b32 s26, 3
    s_add_u32 s27, s27, 40960
    s_cmp_ge_u32 s27, 163840
    s_cselect_b32 s43, 163840, 0
    s_sub_u32 s27, s27, s43
    s_min_u32 s29, s26, 31
    s_lshl_b32 s29, s29, 1
    s_add_u32 s29, s29, s31
    s_mul_i32 s29, s29, 40960
    s_add_u32 m0, s27, 0
    s_add_u32 s43, s29, 0
    buffer_load_dwordx4 v9, s[20:23], s43 offen lds
    s_add_u32 m0, s27, 4096
    s_add_u32 s43, s29, 128
    buffer_load_dwordx4 v9, s[20:23], s43 offen lds
    s_add_u32 m0, s27, 8192
    s_add_u32 s43, s29, 256
    buffer_load_dwordx4 v9, s[20:23], s43 offen lds
    s_add_u32 m0, s27, 12288
    s_add_u32 s43, s29, 384
    buffer_load_dwordx4 v9, s[20:23], s43 offen lds
    s_add_u32 m0, s27, 16384
    s_add_u32 s43, s29, 512
    buffer_load_dwordx4 v9, s[20:23], s43 offen lds
    s_add_u32 m0, s27, 20480
    s_add_u32 s43, s29, 640
    buffer_load_dwordx4 v9, s[20:23], s43 offen lds
    s_add_u32 m0, s27, 24576
    s_add_u32 s43, s29, 768
    buffer_load_dwordx4 v9, s[20:23], s43 offen lds
    s_add_u32 m0, s27, 28672
    s_add_u32 s43, s29, 896
    buffer_load_dwordx4 v9, s[20:23], s43 offen lds
    s_add_u32 m0, s27, 32768
    s_add_u32 s43, s29, 1024
    buffer_load_dwordx4 v9, s[20:23], s43 offen lds
    s_add_u32 m0, s27, 36864
    s_add_u32 s43, s29, 1152
    buffer_load_dwordx4 v9, s[20:23], s43 offen lds
    s_mov_b32 s26, 1
    v_add_u32 v14, s28, v10
    v_add_u32 v15, s28, v11
    s_add_u32 s28, s28, 40960
    s_cmp_ge_u32 s28, 163840
    s_cselect_b32 s43, 163840, 0
    s_sub_u32 s28, s28, s43
    s_lshl_b32 s40, s65, 1
    s_add_u32 s62, s62, s40
    s_addc_u32 s63, s63, 0
    v_mov_b32 v17, 76
    s_waitcnt vmcnt(30)
    s_barrier
    s_mov_b64 exec, s[48:49]
    global_atomic_add v17, v16, s[98:99] sc1
    s_mov_b64 exec, -1
    s_waitcnt vmcnt(20)
    s_barrier
    ds_read_b128 v[28:31], v14 offset:0
    ds_read_b128 v[32:35], v14 offset:2048
    ds_read_b128 v[36:39], v15 offset:0
    ds_read_b128 v[40:43], v15 offset:2048
    s_branch g1_qm
g1_ql:
    s_waitcnt lgkmcnt(2)
    v_mfma_f32_16x16x32_bf16 v[60:63], a[0:3], v[28:31], 0
    ds_read_b128 v[44:47], v12 offset:4096
    v_mfma_f32_16x16x32_bf16 v[64:67], a[4:7], v[28:31], 0
    ds_read_b128 v[48:51], v12 offset:6144
    v_mfma_f32_16x16x32_bf16 v[68:71], a[8:11], v[28:31], 0
    v_mfma_f32_16x16x32_bf16 v[72:75], a[12:15], v[28:31], 0
    s_waitcnt vmcnt(10)
    s_barrier
    v_mfma_f32_16x16x32_bf16 v[76:79], a[0:3], v[32:35], 0
    v_mfma_f32_16x16x32_bf16 v[80:83], a[4:7], v[32:35], 0
    v_mfma_f32_16x16x32_bf16 v[84:87], a[8:11], v[32:35], 0
    v_add_u32 v14, s28, v10
    v_add_u32 v15, s28, v11
    s_add_u32 s28, s28, 40960
    s_cmp_ge_u32 s28, 163840
    s_cselect_b32 s43, 163840, 0
    s_sub_u32 s28, s28, s43
    v_mfma_f32_16x16x32_bf16 v[88:91], a[12:15], v[32:35], 0
    s_waitcnt lgkmcnt(2)
    s_add_u32 s27, s27, 40960
    s_cmp_ge_u32 s27, 163840
    s_cselect_b32 s43, 163840, 0
    s_sub_u32 s27, s27, s43
    s_add_u32 s40, s26, 3
    s_min_u32 s29, s40, 31
    s_lshl_b32 s29, s29, 1
    s_add_u32 s29, s29, s31
    s_mul_i32 s29, s29, 40960
    v_mfma_f32_16x16x32_bf16 v[60:63], a[16:19], v[36:39], v[60:63]
    ds_read_b128 v[52:55], v13 offset:4096
    v_cvt_pk_bf16_f32 v92, v92, v93
    v_cvt_pk_bf16_f32 v93, v94, v95
    v_mfma_f32_16x16x32_bf16 v[64:67], a[20:23], v[36:39], v[64:67]
    ds_read_b128 v[56:59], v13 offset:6144
    v_cvt_pk_bf16_f32 v94, v96, v97
    v_cvt_pk_bf16_f32 v95, v98, v99
    v_mfma_f32_16x16x32_bf16 v[68:71], a[24:27], v[36:39], v[68:71]
    s_mov_b64 exec, s[56:57]
    global_store_dwordx4 v7, v[92:95], s[50:51] offset:0 sc1
    s_mov_b64 exec, -1
    v_cvt_pk_bf16_f32 v100, v100, v101
    v_mfma_f32_16x16x32_bf16 v[72:75], a[28:31], v[36:39], v[72:75]
    v_cvt_pk_bf16_f32 v101, v102, v103
    v_cvt_pk_bf16_f32 v102, v104, v105
    v_mfma_f32_16x16x32_bf16 v[76:79], a[16:19], v[40:43], v[76:79]
    v_cvt_pk_bf16_f32 v103, v106, v107
    s_mov_b64 exec, s[56:57]
    global_store_dwordx4 v7, v[100:103], s[50:51] offset:1024 sc1
    s_mov_b64 exec, -1
    v_mfma_f32_16x16x32_bf16 v[80:83], a[20:23], v[40:43], v[80:83]
    v_cvt_pk_bf16_f32 v108, v108, v109
    v_cvt_pk_bf16_f32 v109, v110, v111
    v_mfma_f32_16x16x32_bf16 v[84:87], a[24:27], v[40:43], v[84:87]
    v_cvt_pk_bf16_f32 v110, v112, v113
    v_cvt_pk_bf16_f32 v111, v114, v115
    v_mfma_f32_16x16x32_bf16 v[88:91], a[28:31], v[40:43], v[88:91]
    s_waitcnt lgkmcnt(2)
    s_mov_b64 exec, s[56:57]
    global_store_dwordx4 v8, v[108:111], s[50:51] offset:0 sc1
    s_mov_b64 exec, -1
    v_cvt_pk_bf16_f32 v116, v116, v117
    v_mfma_f32_16x16x32_bf16 v[60:63], a[32:35], v[44:47], v[60:63]
    ds_read_b128 v[28:31], v12 offset:8192
    v_cvt_pk_bf16_f32 v117, v118, v119
    v_cvt_pk_bf16_f32 v118, v120, v121
    v_mfma_f32_16x16x32_bf16 v[64:67], a[36:39], v[44:47], v[64:67]
    ds_read_b128 v[32:35], v12 offset:10240
    v_cvt_pk_bf16_f32 v119, v122, v123
    s_mov_b64 exec, s[56:57]
    global_store_dwordx4 v8, v[116:119], s[50:51] offset:1024 sc1
    s_mov_b64 exec, -1
    v_mfma_f32_16x16x32_bf16 v[68:71], a[40:43], v[44:47], v[68:71]
    v_mfma_f32_16x16x32_bf16 v[72:75], a[44:47], v[44:47], v[72:75]
    s_add_u32 m0, s27, 0
    s_add_u32 s43, s29, 0
    buffer_load_dwordx4 v9, s[20:23], s43 offen lds
    v_mfma_f32_16x16x32_bf16 v[76:79], a[32:35], v[48:51], v[76:79]
    v_mfma_f32_16x16x32_bf16 v[80:83], a[36:39], v[48:51], v[80:83]
    s_add_u32 m0, s27, 4096
    s_add_u32 s43, s29, 128
    buffer_load_dwordx4 v9, s[20:23], s43 offen lds
    v_mfma_f32_16x16x32_bf16 v[84:87], a[40:43], v[48:51], v[84:87]
    v_mfma_f32_16x16x32_bf16 v[88:91], a[44:47], v[48:51], v[88:91]
    s_waitcnt lgkmcnt(2)
    s_add_u32 m0, s27, 8192
    s_add_u32 s43, s29, 256
    buffer_load_dwordx4 v9, s[20:23], s43 offen lds
    v_mfma_f32_16x16x32_bf16 v[60:63], a[48:51], v[52:55], v[60:63]
    ds_read_b128 v[36:39], v13 offset:8192
    v_mfma_f32_16x16x32_bf16 v[64:67], a[52:55], v[52:55], v[64:67]
    ds_read_b128 v[40:43], v13 offset:10240
    s_add_u32 m0, s27, 12288
    s_add_u32 s43, s29, 384
    buffer_load_dwordx4 v9, s[20:23], s43 offen lds
    v_mfma_f32_16x16x32_bf16 v[68:71], a[56:59], v[52:55], v[68:71]
    v_mfma_f32_16x16x32_bf16 v[72:75], a[60:63], v[52:55], v[72:75]
    s_add_u32 m0, s27, 16384
    s_add_u32 s43, s29, 512
    buffer_load_dwordx4 v9, s[20:23], s43 offen lds
    v_mfma_f32_16x16x32_bf16 v[76:79], a[48:51], v[56:59], v[76:79]
    v_mfma_f32_16x16x32_bf16 v[80:83], a[52:55], v[56:59], v[80:83]
    s_add_u32 m0, s27, 20480
    s_add_u32 s43, s29, 640
    buffer_load_dwordx4 v9, s[20:23], s43 offen lds
    v_mfma_f32_16x16x32_bf16 v[84:87], a[56:59], v[56:59], v[84:87]
    v_mfma_f32_16x16x32_bf16 v[88:91], a[60:63], v[56:59], v[88:91]
    s_waitcnt lgkmcnt(2)
    s_add_u32 m0, s27, 24576
    s_add_u32 s43, s29, 768
    buffer_load_dwordx4 v9, s[20:23], s43 offen lds
    v_mfma_f32_16x16x32_bf16 v[60:63], a[64:67], v[28:31], v[60:63]
    ds_read_b128 v[44:47], v12 offset:12288
    v_mfma_f32_16x16x32_bf16 v[64:67], a[68:71], v[28:31], v[64:67]
    ds_read_b128 v[48:51], v12 offset:14336
    s_add_u32 m0, s27, 28672
    s_add_u32 s43, s29, 896
    buffer_load_dwordx4 v9, s[20:23], s43 offen lds
    v_mfma_f32_16x16x32_bf16 v[68:71], a[72:75], v[28:31], v[68:71]
    v_mfma_f32_16x16x32_bf16 v[72:75], a[76:79], v[28:31], v[72:75]
    s_add_u32 m0, s27, 32768
    s_add_u32 s43, s29, 1024
    buffer_load_dwordx4 v9, s[20:23], s43 offen lds
    v_mfma_f32_16x16x32_bf16 v[76:79], a[64:67], v[32:35], v[76:79]
    v_mfma_f32_16x16x32_bf16 v[80:83], a[68:71], v[32:35], v[80:83]
    s_add_u32 m0, s27, 36864
    s_add_u32 s43, s29, 1152
    buffer_load_dwordx4 v9, s[20:23], s43 offen lds
    v_mfma_f32_16x16x32_bf16 v[84:87], a[72:75], v[32:35], v[84:87]
    v_mfma_f32_16x16x32_bf16 v[88:91], a[76:79], v[32:35], v[88:91]
    s_waitcnt lgkmcnt(2)
    v_mfma_f32_16x16x32_bf16 v[60:63], a[80:83], v[36:39], v[60:63]
    ds_read_b128 v[52:55], v13 offset:12288
    v_mfma_f32_16x16x32_bf16 v[64:67], a[84:87], v[36:39], v[64:67]
    ds_read_b128 v[56:59], v13 offset:14336
    v_mfma_f32_16x16x32_bf16 v[68:71], a[88:91], v[36:39], v[68:71]
    v_mfma_f32_16x16x32_bf16 v[72:75], a[92:95], v[36:39], v[72:75]
    v_mfma_f32_16x16x32_bf16 v[76:79], a[80:83], v[40:43], v[76:79]
    v_mfma_f32_16x16x32_bf16 v[80:83], a[84:87], v[40:43], v[80:83]
    v_mfma_f32_16x16x32_bf16 v[84:87], a[88:91], v[40:43], v[84:87]
    v_mfma_f32_16x16x32_bf16 v[88:91], a[92:95], v[40:43], v[88:91]
    s_waitcnt lgkmcnt(2)
    v_mfma_f32_16x16x32_bf16 v[60:63], a[96:99], v[44:47], v[60:63]
    ds_read_b128 v[28:31], v12 offset:16384
    v_mfma_f32_16x16x32_bf16 v[64:67], a[100:103], v[44:47], v[64:67]
    ds_read_b128 v[32:35], v12 offset:18432
    v_mfma_f32_16x16x32_bf16 v[68:71], a[104:107], v[44:47], v[68:71]
    v_mfma_f32_16x16x32_bf16 v[72:75], a[108:111], v[44:47], v[72:75]
    v_mfma_f32_16x16x32_bf16 v[76:79], a[96:99], v[48:51], v[76:79]
    v_mfma_f32_16x16x32_bf16 v[80:83], a[100:103], v[48:51], v[80:83]
    v_mfma_f32_16x16x32_bf16 v[84:87], a[104:107], v[48:51], v[84:87]
    v_mfma_f32_16x16x32_bf16 v[88:91], a[108:111], v[48:51], v[88:91]
    s_waitcnt lgkmcnt(2)
    v_mfma_f32_16x16x32_bf16 v[60:63], a[112:115], v[52:55], v[60:63]
    ds_read_b128 v[36:39], v13 offset:16384
    v_mfma_f32_16x16x32_bf16 v[64:67], a[116:119], v[52:55], v[64:67]
    ds_read_b128 v[40:43], v13 offset:18432
    v_mfma_f32_16x16x32_bf16 v[68:71], a[120:123], v[52:55], v[68:71]
    v_mfma_f32_16x16x32_bf16 v[72:75], a[124:127], v[52:55], v[72:75]
    v_mfma_f32_16x16x32_bf16 v[76:79], a[112:115], v[56:59], v[76:79]
    v_mfma_f32_16x16x32_bf16 v[80:83], a[116:119], v[56:59], v[80:83]
    v_mfma_f32_16x16x32_bf16 v[84:87], a[120:123], v[56:59], v[84:87]
    v_mfma_f32_16x16x32_bf16 v[88:91], a[124:127], v[56:59], v[88:91]
    s_waitcnt lgkmcnt(2)
    v_mfma_f32_16x16x32_bf16 v[60:63], a[128:131], v[28:31], v[60:63]
    ds_read_b128 v[44:47], v12 offset:20480
    v_mfma_f32_16x16x32_bf16 v[64:67], a[132:135], v[28:31], v[64:67]
    ds_read_b128 v[48:51], v12 offset:22528
    v_mfma_f32_16x16x32_bf16 v[68:71], a[136:139], v[28:31], v[68:71]
    v_mfma_f32_16x16x32_bf16 v[72:75], a[140:143], v[28:31], v[72:75]
    v_mfma_f32_16x16x32_bf16 v[76:79], a[128:131], v[32:35], v[76:79]
    v_mfma_f32_16x16x32_bf16 v[80:83], a[132:135], v[32:35], v[80:83]
    v_mfma_f32_16x16x32_bf16 v[84:87], a[136:139], v[32:35], v[84:87]
    v_mfma_f32_16x16x32_bf16 v[88:91], a[140:143], v[32:35], v[88:91]
    s_waitcnt lgkmcnt(2)
    v_mfma_f32_16x16x32_bf16 v[60:63], a[144:147], v[36:39], v[60:63]
    ds_read_b128 v[52:55], v13 offset:20480
    v_mfma_f32_16x16x32_bf16 v[64:67], a[148:151], v[36:39], v[64:67]
    ds_read_b128 v[56:59], v13 offset:22528
    v_mfma_f32_16x16x32_bf16 v[68:71], a[152:155], v[36:39], v[68:71]
    v_mfma_f32_16x16x32_bf16 v[72:75], a[156:159], v[36:39], v[72:75]
    v_mfma_f32_16x16x32_bf16 v[76:79], a[144:147], v[40:43], v[76:79]
    v_mfma_f32_16x16x32_bf16 v[80:83], a[148:151], v[40:43], v[80:83]
    v_mfma_f32_16x16x32_bf16 v[84:87], a[152:155], v[40:43], v[84:87]
    v_mfma_f32_16x16x32_bf16 v[88:91], a[156:159], v[40:43], v[88:91]
    s_waitcnt lgkmcnt(2)
    v_mfma_f32_16x16x32_bf16 v[60:63], a[160:163], v[44:47], v[60:63]
    ds_read_b128 v[28:31], v12 offset:24576
    v_mfma_f32_16x16x32_bf16 v[64:67], a[164:167], v[44:47], v[64:67]
    ds_read_b128 v[32:35], v12 offset:26624
    v_mfma_f32_16x16x32_bf16 v[68:71], a[168:171], v[44:47], v[68:71]
    v_mfma_f32_16x16x32_bf16 v[72:75], a[172:175], v[44:47], v[72:75]
    v_mfma_f32_16x16x32_bf16 v[76:79], a[160:163], v[48:51], v[76:79]
    v_mfma_f32_16x16x32_bf16 v[80:83], a[164:167], v[48:51], v[80:83]
    v_mfma_f32_16x16x32_bf16 v[84:87], a[168:171], v[48:51], v[84:87]
    v_mfma_f32_16x16x32_bf16 v[88:91], a[172:175], v[48:51], v[88:91]
    s_waitcnt lgkmcnt(2)
    v_mfma_f32_16x16x32_bf16 v[60:63], a[176:179], v[52:55], v[60:63]
    ds_read_b128 v[36:39], v13 offset:24576
    v_mfma_f32_16x16x32_bf16 v[64:67], a[180:183], v[52:55], v[64:67]
    ds_read_b128 v[40:43], v13 offset:26624
    v_mfma_f32_16x16x32_bf16 v[68:71], a[184:187], v[52:55], v[68:71]
    v_mfma_f32_16x16x32_bf16 v[72:75], a[188:191], v[52:55], v[72:75]
    v_mfma_f32_16x16x32_bf16 v[76:79], a[176:179], v[56:59], v[76:79]
    v_mfma_f32_16x16x32_bf16 v[80:83], a[180:183], v[56:59], v[80:83]
    v_mfma_f32_16x16x32_bf16 v[84:87], a[184:187], v[56:59], v[84:87]
    v_mfma_f32_16x16x32_bf16 v[88:91], a[188:191], v[56:59], v[88:91]
    s_waitcnt lgkmcnt(2)
    v_mfma_f32_16x16x32_bf16 v[60:63], a[192:195], v[28:31], v[60:63]
    ds_read_b128 v[44:47], v12 offset:28672
    v_mfma_f32_16x16x32_bf16 v[64:67], a[196:199], v[28:31], v[64:67]
    ds_read_b128 v[48:51], v12 offset:30720
    v_mfma_f32_16x16x32_bf16 v[68:71], a[200:203], v[28:31], v[68:71]
    v_mfma_f32_16x16x32_bf16 v[72:75], a[204:207], v[28:31], v[72:75]
    v_mfma_f32_16x16x32_bf16 v[76:79], a[192:195], v[32:35], v[76:79]
    v_mfma_f32_16x16x32_bf16 v[80:83], a[196:199], v[32:35], v[80:83]
    v_mfma_f32_16x16x32_bf16 v[84:87], a[200:203], v[32:35], v[84:87]
    v_mfma_f32_16x16x32_bf16 v[88:91], a[204:207], v[32:35], v[88:91]
    s_waitcnt lgkmcnt(2)
    v_mfma_f32_16x16x32_bf16 v[60:63], a[208:211], v[36:39], v[60:63]
    ds_read_b128 v[52:55], v13 offset:28672
    v_mfma_f32_16x16x32_bf16 v[64:67], a[212:215], v[36:39], v[64:67]
    ds_read_b128 v[56:59], v13 offset:30720
    v_mfma_f32_16x16x32_bf16 v[68:71], a[216:219], v[36:39], v[68:71]
    v_mfma_f32_16x16x32_bf16 v[72:75], a[220:223], v[36:39], v[72:75]
    v_mfma_f32_16x16x32_bf16 v[76:79], a[208:211], v[40:43], v[76:79]
    v_mfma_f32_16x16x32_bf16 v[80:83], a[212:215], v[40:43], v[80:83]
    v_mfma_f32_16x16x32_bf16 v[84:87], a[216:219], v[40:43], v[84:87]
    v_mfma_f32_16x16x32_bf16 v[88:91], a[220:223], v[40:43], v[88:91]
    s_waitcnt lgkmcnt(2)
    v_mfma_f32_16x16x32_bf16 v[60:63], a[224:227], v[44:47], v[60:63]
    ds_read_b128 v[28:31], v12 offset:32768
    v_mfma_f32_16x16x32_bf16 v[64:67], a[228:231], v[44:47], v[64:67]
    ds_read_b128 v[32:35], v12 offset:34816
    v_mfma_f32_16x16x32_bf16 v[68:71], a[232:235], v[44:47], v[68:71]
    v_mfma_f32_16x16x32_bf16 v[72:75], a[236:239], v[44:47], v[72:75]
    v_mfma_f32_16x16x32_bf16 v[76:79], a[224:227], v[48:51], v[76:79]
    v_mfma_f32_16x16x32_bf16 v[80:83], a[228:231], v[48:51], v[80:83]
    v_mfma_f32_16x16x32_bf16 v[84:87], a[232:235], v[48:51], v[84:87]
    v_mfma_f32_16x16x32_bf16 v[88:91], a[236:239], v[48:51], v[88:91]
    s_waitcnt lgkmcnt(2)
    v_mfma_f32_16x16x32_bf16 v[60:63], a[240:243], v[52:55], v[60:63]
    ds_read_b128 v[36:39], v13 offset:32768
    v_mfma_f32_16x16x32_bf16 v[64:67], a[244:247], v[52:55], v[64:67]
    ds_read_b128 v[40:43], v13 offset:34816
    v_mfma_f32_16x16x32_bf16 v[68:71], a[248:251], v[52:55], v[68:71]
    v_mfma_f32_16x16x32_bf16 v[72:75], a[252:255], v[52:55], v[72:75]
    v_mfma_f32_16x16x32_bf16 v[76:79], a[240:243], v[56:59], v[76:79]
    v_mfma_f32_16x16x32_bf16 v[80:83], a[244:247], v[56:59], v[80:83]
    v_mfma_f32_16x16x32_bf16 v[84:87], a[248:251], v[56:59], v[84:87]
    v_mfma_f32_16x16x32_bf16 v[88:91], a[252:255], v[56:59], v[88:91]
    s_waitcnt lgkmcnt(2)
    v_mfma_f32_16x16x32_bf16 v[60:63], v[124:127], v[28:31], v[60:63]
    ds_read_b128 v[44:47], v12 offset:36864
    v_mfma_f32_16x16x32_bf16 v[64:67], v[128:131], v[28:31], v[64:67]
    ds_read_b128 v[48:51], v12 offset:38912
    v_mfma_f32_16x16x32_bf16 v[68:71], v[132:135], v[28:31], v[68:71]
    v_mfma_f32_16x16x32_bf16 v[72:75], v[136:139], v[28:31], v[72:75]
    v_mfma_f32_16x16x32_bf16 v[76:79], v[124:127], v[32:35], v[76:79]
    v_mfma_f32_16x16x32_bf16 v[80:83], v[128:131], v[32:35], v[80:83]
    v_mfma_f32_16x16x32_bf16 v[84:87], v[132:135], v[32:35], v[84:87]
    v_mfma_f32_16x16x32_bf16 v[88:91], v[136:139], v[32:35], v[88:91]
    s_waitcnt lgkmcnt(2)
    v_mfma_f32_16x16x32_bf16 v[60:63], v[140:143], v[36:39], v[60:63]
    ds_read_b128 v[52:55], v13 offset:36864
    v_mfma_f32_16x16x32_bf16 v[64:67], v[144:147], v[36:39], v[64:67]
    ds_read_b128 v[56:59], v13 offset:38912
    v_mfma_f32_16x16x32_bf16 v[68:71], v[148:151], v[36:39], v[68:71]
    v_mfma_f32_16x16x32_bf16 v[72:75], v[152:155], v[36:39], v[72:75]
    v_mfma_f32_16x16x32_bf16 v[76:79], v[140:143], v[40:43], v[76:79]
    v_mfma_f32_16x16x32_bf16 v[80:83], v[144:147], v[40:43], v[80:83]
    v_mfma_f32_16x16x32_bf16 v[84:87], v[148:151], v[40:43], v[84:87]
    v_mfma_f32_16x16x32_bf16 v[88:91], v[152:155], v[40:43], v[88:91]
    s_waitcnt lgkmcnt(2)
    v_mfma_f32_16x16x32_bf16 v[60:63], v[156:159], v[44:47], v[60:63]
    ds_read_b128 v[28:31], v14 offset:0
    v_mfma_f32_16x16x32_bf16 v[64:67], v[160:163], v[44:47], v[64:67]
    ds_read_b128 v[32:35], v14 offset:2048
    v_mfma_f32_16x16x32_bf16 v[68:71], v[164:167], v[44:47], v[68:71]
    v_mfma_f32_16x16x32_bf16 v[72:75], v[168:171], v[44:47], v[72:75]
    v_mfma_f32_16x16x32_bf16 v[76:79], v[156:159], v[48:51], v[76:79]
    v_mfma_f32_16x16x32_bf16 v[80:83], v[160:163], v[48:51], v[80:83]
    v_mfma_f32_16x16x32_bf16 v[84:87], v[164:167], v[48:51], v[84:87]
    v_mfma_f32_16x16x32_bf16 v[88:91], v[168:171], v[48:51], v[88:91]
    s_waitcnt lgkmcnt(2)
    v_mfma_f32_16x16x32_bf16 v[60:63], v[172:175], v[52:55], v[60:63]
    ds_read_b128 v[36:39], v15 offset:0
    v_mfma_f32_16x16x32_bf16 v[64:67], v[176:179], v[52:55], v[64:67]
    ds_read_b128 v[40:43], v15 offset:2048
    v_mfma_f32_16x16x32_bf16 v[68:71], v[180:183], v[52:55], v[68:71]
    v_mfma_f32_16x16x32_bf16 v[72:75], v[184:187], v[52:55], v[72:75]
    v_mfma_f32_16x16x32_bf16 v[76:79], v[172:175], v[56:59], v[76:79]
    s_add_u32 s50, s62, 0
    s_addc_u32 s51, s63, 0
    s_mul_i32 s40, s65, 2
    s_add_u32 s62, s62, s40
    s_addc_u32 s63, s63, 0
    s_add_u32 s26, s26, 1
    s_mov_b64 s[56:57], -1
    v_mfma_f32_16x16x32_bf16 v[80:83], v[176:179], v[56:59], v[80:83]
    v_mfma_f32_16x16x32_bf16 v[84:87], v[180:183], v[56:59], v[84:87]
    v_mfma_f32_16x16x32_bf16 v[88:91], v[184:187], v[56:59], v[88:91]
g1_qm:
    s_waitcnt lgkmcnt(2)
    v_mfma_f32_16x16x32_bf16 v[92:95], a[0:3], v[28:31], 0
    ds_read_b128 v[44:47], v14 offset:4096
    v_mfma_f32_16x16x32_bf16 v[96:99], a[4:7], v[28:31], 0
    ds_read_b128 v[48:51], v14 offset:6144
    v_mfma_f32_16x16x32_bf16 v[100:103], a[8:11], v[28:31], 0
    v_mfma_f32_16x16x32_bf16 v[104:107], a[12:15], v[28:31], 0
    s_waitcnt vmcnt(10)
    s_barrier
    v_mfma_f32_16x16x32_bf16 v[108:111], a[0:3], v[32:35], 0
    s_cmp_ge_i32 s30, 4
    s_cselect_b64 s[46:47], s[48:49], 0
    v_mov_b32 v17, s30
    s_add_u32 s30, s30, 4
    s_mov_b64 exec, s[46:47]
    global_atomic_add v17, v16, s[98:99] sc1
    s_mov_b64 exec, -1
    v_mfma_f32_16x16x32_bf16 v[112:115], a[4:7], v[32:35], 0
    s_mov_b64 exec, s[60:61]
    global_atomic_add v18, v19, s[98:99] sc1
    s_mov_b64 exec, -1
    s_mov_b64 s[60:61], 0
    v_mfma_f32_16x16x32_bf16 v[116:119], a[8:11], v[32:35], 0
    v_add_u32 v12, s28, v10
    v_add_u32 v13, s28, v11
    s_add_u32 s28, s28, 40960
    s_cmp_ge_u32 s28, 163840
    s_cselect_b32 s43, 163840, 0
    s_sub_u32 s28, s28, s43
    v_mfma_f32_16x16x32_bf16 v[120:123], a[12:15], v[32:35], 0
    s_waitcnt lgkmcnt(2)
    s_add_u32 s27, s27, 40960
    s_cmp_ge_u32 s27, 163840
    s_cselect_b32 s43, 163840, 0
    s_sub_u32 s27, s27, s43
    s_add_u32 s40, s26, 3
    s_min_u32 s29, s40, 31
    s_lshl_b32 s29, s29, 1
    s_add_u32 s29, s29, s31
    s_mul_i32 s29, s29, 40960
    v_mfma_f32_16x16x32_bf16 v[92:95], a[16:19], v[36:39], v[92:95]
    ds_read_b128 v[52:55], v15 offset:4096
    v_cvt_pk_bf16_f32 v60, v60, v61
    v_cvt_pk_bf16_f32 v61, v62, v63
    v_mfma_f32_16x16x32_bf16 v[96:99], a[20:23], v[36:39], v[96:99]
    ds_read_b128 v[56:59], v15 offset:6144
    v_cvt_pk_bf16_f32 v62, v64, v65
    v_cvt_pk_bf16_f32 v63, v66, v67
    v_mfma_f32_16x16x32_bf16 v[100:103], a[24:27], v[36:39], v[100:103]
    s_mov_b64 exec, s[56:57]
    global_store_dwordx4 v7, v[60:63], s[50:51] offset:0 sc1
    s_mov_b64 exec, -1
    v_cvt_pk_bf16_f32 v68, v68, v69
    v_mfma_f32_16x16x32_bf16 v[104:107], a[28:31], v[36:39], v[104:107]
    v_cvt_pk_bf16_f32 v69, v70, v71
    v_cvt_pk_bf16_f32 v70, v72, v73
    v_mfma_f32_16x16x32_bf16 v[108:111], a[16:19], v[40:43], v[108:111]
    v_cvt_pk_bf16_f32 v71, v74, v75
    s_mov_b64 exec, s[56:57]
    global_store_dwordx4 v7, v[68:71], s[50:51] offset:1024 sc1
    s_mov_b64 exec, -1
    v_mfma_f32_16x16x32_bf16 v[112:115], a[20:23], v[40:43], v[112:115]
    v_cvt_pk_bf16_f32 v76, v76, v77
    v_cvt_pk_bf16_f32 v77, v78, v79
    v_mfma_f32_16x16x32_bf16 v[116:119], a[24:27], v[40:43], v[116:119]
    v_cvt_pk_bf16_f32 v78, v80, v81
    v_cvt_pk_bf16_f32 v79, v82, v83
    v_mfma_f32_16x16x32_bf16 v[120:123], a[28:31], v[40:43], v[120:123]
    s_waitcnt lgkmcnt(2)
    s_mov_b64 exec, s[56:57]
    global_store_dwordx4 v8, v[76:79], s[50:51] offset:0 sc1
    s_mov_b64 exec, -1
    v_cvt_pk_bf16_f32 v84, v84, v85
    v_mfma_f32_16x16x32_bf16 v[92:95], a[32:35], v[44:47], v[92:95]
    ds_read_b128 v[28:31], v14 offset:8192
    v_cvt_pk_bf16_f32 v85, v86, v87
    v_cvt_pk_bf16_f32 v86, v88, v89
    v_mfma_f32_16x16x32_bf16 v[96:99], a[36:39], v[44:47], v[96:99]
    ds_read_b128 v[32:35], v14 offset:10240
    v_cvt_pk_bf16_f32 v87, v90, v91
    s_mov_b64 exec, s[56:57]
    global_store_dwordx4 v8, v[84:87], s[50:51] offset:1024 sc1
    s_mov_b64 exec, -1
    v_mfma_f32_16x16x32_bf16 v[100:103], a[40:43], v[44:47], v[100:103]
    v_mfma_f32_16x16x32_bf16 v[104:107], a[44:47], v[44:47], v[104:107]
    s_add_u32 m0, s27, 0
    s_add_u32 s43, s29, 0
    buffer_load_dwordx4 v9, s[20:23], s43 offen lds
    v_mfma_f32_16x16x32_bf16 v[108:111], a[32:35], v[48:51], v[108:111]
    v_mfma_f32_16x16x32_bf16 v[112:115], a[36:39], v[48:51], v[112:115]
    s_add_u32 m0, s27, 4096
    s_add_u32 s43, s29, 128
    buffer_load_dwordx4 v9, s[20:23], s43 offen lds
    v_mfma_f32_16x16x32_bf16 v[116:119], a[40:43], v[48:51], v[116:119]
    v_mfma_f32_16x16x32_bf16 v[120:123], a[44:47], v[48:51], v[120:123]
    s_waitcnt lgkmcnt(2)
    s_add_u32 m0, s27, 8192
    s_add_u32 s43, s29, 256
    buffer_load_dwordx4 v9, s[20:23], s43 offen lds
    v_mfma_f32_16x16x32_bf16 v[92:95], a[48:51], v[52:55], v[92:95]
    ds_read_b128 v[36:39], v15 offset:8192
    v_mfma_f32_16x16x32_bf16 v[96:99], a[52:55], v[52:55], v[96:99]
    ds_read_b128 v[40:43], v15 offset:10240
    s_add_u32 m0, s27, 12288
    s_add_u32 s43, s29, 384
    buffer_load_dwordx4 v9, s[20:23], s43 offen lds
    v_mfma_f32_16x16x32_bf16 v[100:103], a[56:59], v[52:55], v[100:103]
    v_mfma_f32_16x16x32_bf16 v[104:107], a[60:63], v[52:55], v[104:107]
    s_add_u32 m0, s27, 16384
    s_add_u32 s43, s29, 512
    buffer_load_dwordx4 v9, s[20:23], s43 offen lds
    v_mfma_f32_16x16x32_bf16 v[108:111], a[48:51], v[56:59], v[108:111]
    v_mfma_f32_16x16x32_bf16 v[112:115], a[52:55], v[56:59], v[112:115]
    s_add_u32 m0, s27, 20480
    s_add_u32 s43, s29, 640
    buffer_load_dwordx4 v9, s[20:23], s43 offen lds
    v_mfma_f32_16x16x32_bf16 v[116:119], a[56:59], v[56:59], v[116:119]
    v_mfma_f32_16x16x32_bf16 v[120:123], a[60:63], v[56:59], v[120:123]
    s_waitcnt lgkmcnt(2)
    s_add_u32 m0, s27, 24576
    s_add_u32 s43, s29, 768
    buffer_load_dwordx4 v9, s[20:23], s43 offen lds
    v_mfma_f32_16x16x32_bf16 v[92:95], a[64:67], v[28:31], v[92:95]
    ds_read_b128 v[44:47], v14 offset:12288
    v_mfma_f32_16x16x32_bf16 v[96:99], a[68:71], v[28:31], v[96:99]
    ds_read_b128 v[48:51], v14 offset:14336
    s_add_u32 m0, s27, 28672
    s_add_u32 s43, s29, 896
    buffer_load_dwordx4 v9, s[20:23], s43 offen lds
    v_mfma_f32_16x16x32_bf16 v[100:103], a[72:75], v[28:31], v[100:103]
    v_mfma_f32_16x16x32_bf16 v[104:107], a[76:79], v[28:31], v[104:107]
    s_add_u32 m0, s27, 32768
    s_add_u32 s43, s29, 1024
    buffer_load_dwordx4 v9, s[20:23], s43 offen lds
    v_mfma_f32_16x16x32_bf16 v[108:111], a[64:67], v[32:35], v[108:111]
    v_mfma_f32_16x16x32_bf16 v[112:115], a[68:71], v[32:35], v[112:115]
    s_add_u32 m0, s27, 36864
    s_add_u32 s43, s29, 1152
    buffer_load_dwordx4 v9, s[20:23], s43 offen lds
    v_mfma_f32_16x16x32_bf16 v[116:119], a[72:75], v[32:35], v[116:119]
    v_mfma_f32_16x16x32_bf16 v[120:123], a[76:79], v[32:35], v[120:123]
    s_waitcnt lgkmcnt(2)
    v_mfma_f32_16x16x32_bf16 v[92:95], a[80:83], v[36:39], v[92:95]
    ds_read_b128 v[52:55], v15 offset:12288
    v_mfma_f32_16x16x32_bf16 v[96:99], a[84:87], v[36:39], v[96:99]
    ds_read_b128 v[56:59], v15 offset:14336
    v_mfma_f32_16x16x32_bf16 v[100:103], a[88:91], v[36:39], v[100:103]
    v_mfma_f32_16x16x32_bf16 v[104:107], a[92:95], v[36:39], v[104:107]
    v_mfma_f32_16x16x32_bf16 v[108:111], a[80:83], v[40:43], v[108:111]
    v_mfma_f32_16x16x32_bf16 v[112:115], a[84:87], v[40:43], v[112:115]
    v_mfma_f32_16x16x32_bf16 v[116:119], a[88:91], v[40:43], v[116:119]
    v_mfma_f32_16x16x32_bf16 v[120:123], a[92:95], v[40:43], v[120:123]
    s_waitcnt lgkmcnt(2)
    v_mfma_f32_16x16x32_bf16 v[92:95], a[96:99], v[44:47], v[92:95]
    ds_read_b128 v[28:31], v14 offset:16384
    v_mfma_f32_16x16x32_bf16 v[96:99], a[100:103], v[44:47], v[96:99]
    ds_read_b128 v[32:35], v14 offset:18432
    v_mfma_f32_16x16x32_bf16 v[100:103], a[104:107], v[44:47], v[100:103]
    v_mfma_f32_16x16x32_bf16 v[104:107], a[108:111], v[44:47], v[104:107]
    v_mfma_f32_16x16x32_bf16 v[108:111], a[96:99], v[48:51], v[108:111]
    v_mfma_f32_16x16x32_bf16 v[112:115], a[100:103], v[48:51], v[112:115]
    v_mfma_f32_16x16x32_bf16 v[116:119], a[104:107], v[48:51], v[116:119]
    v_mfma_f32_16x16x32_bf16 v[120:123], a[108:111], v[48:51], v[120:123]
    s_waitcnt lgkmcnt(2)
    v_mfma_f32_16x16x32_bf16 v[92:95], a[112:115], v[52:55], v[92:95]
    ds_read_b128 v[36:39], v15 offset:16384
    v_mfma_f32_16x16x32_bf16 v[96:99], a[116:119], v[52:55], v[96:99]
    ds_read_b128 v[40:43], v15 offset:18432
    v_mfma_f32_16x16x32_bf16 v[100:103], a[120:123], v[52:55], v[100:103]
    v_mfma_f32_16x16x32_bf16 v[104:107], a[124:127], v[52:55], v[104:107]
    v_mfma_f32_16x16x32_bf16 v[108:111], a[112:115], v[56:59], v[108:111]
    v_mfma_f32_16x16x32_bf16 v[112:115], a[116:119], v[56:59], v[112:115]
    v_mfma_f32_16x16x32_bf16 v[116:119], a[120:123], v[56:59], v[116:119]
    v_mfma_f32_16x16x32_bf16 v[120:123], a[124:127], v[56:59], v[120:123]
    s_waitcnt lgkmcnt(2)
    v_mfma_f32_16x16x32_bf16 v[92:95], a[128:131], v[28:31], v[92:95]
    ds_read_b128 v[44:47], v14 offset:20480
    v_mfma_f32_16x16x32_bf16 v[96:99], a[132:135], v[28:31], v[96:99]
    ds_read_b128 v[48:51], v14 offset:22528
    v_mfma_f32_16x16x32_bf16 v[100:103], a[136:139], v[28:31], v[100:103]
    v_mfma_f32_16x16x32_bf16 v[104:107], a[140:143], v[28:31], v[104:107]
    v_mfma_f32_16x16x32_bf16 v[108:111], a[128:131], v[32:35], v[108:111]
    v_mfma_f32_16x16x32_bf16 v[112:115], a[132:135], v[32:35], v[112:115]
    v_mfma_f32_16x16x32_bf16 v[116:119], a[136:139], v[32:35], v[116:119]
    v_mfma_f32_16x16x32_bf16 v[120:123], a[140:143], v[32:35], v[120:123]
    s_waitcnt lgkmcnt(2)
    v_mfma_f32_16x16x32_bf16 v[92:95], a[144:147], v[36:39], v[92:95]
    ds_read_b128 v[52:55], v15 offset:20480
    v_mfma_f32_16x16x32_bf16 v[96:99], a[148:151], v[36:39], v[96:99]
    ds_read_b128 v[56:59], v15 offset:22528
    v_mfma_f32_16x16x32_bf16 v[100:103], a[152:155], v[36:39], v[100:103]
    v_mfma_f32_16x16x32_bf16 v[104:107], a[156:159], v[36:39], v[104:107]
    v_mfma_f32_16x16x32_bf16 v[108:111], a[144:147], v[40:43], v[108:111]
    v_mfma_f32_16x16x32_bf16 v[112:115], a[148:151], v[40:43], v[112:115]
    v_mfma_f32_16x16x32_bf16 v[116:119], a[152:155], v[40:43], v[116:119]
    v_mfma_f32_16x16x32_bf16 v[120:123], a[156:159], v[40:43], v[120:123]
    s_waitcnt lgkmcnt(2)
    v_mfma_f32_16x16x32_bf16 v[92:95], a[160:163], v[44:47], v[92:95]
    ds_read_b128 v[28:31], v14 offset:24576
    v_mfma_f32_16x16x32_bf16 v[96:99], a[164:167], v[44:47], v[96:99]
    ds_read_b128 v[32:35], v14 offset:26624
    v_mfma_f32_16x16x32_bf16 v[100:103], a[168:171], v[44:47], v[100:103]
    v_mfma_f32_16x16x32_bf16 v[104:107], a[172:175], v[44:47], v[104:107]
    v_mfma_f32_16x16x32_bf16 v[108:111], a[160:163], v[48:51], v[108:111]
    v_mfma_f32_16x16x32_bf16 v[112:115], a[164:167], v[48:51], v[112:115]
    v_mfma_f32_16x16x32_bf16 v[116:119], a[168:171], v[48:51], v[116:119]
    v_mfma_f32_16x16x32_bf16 v[120:123], a[172:175], v[48:51], v[120:123]
    s_waitcnt lgkmcnt(2)
    v_mfma_f32_16x16x32_bf16 v[92:95], a[176:179], v[52:55], v[92:95]
    ds_read_b128 v[36:39], v15 offset:24576
    v_mfma_f32_16x16x32_bf16 v[96:99], a[180:183], v[52:55], v[96:99]
    ds_read_b128 v[40:43], v15 offset:26624
    v_mfma_f32_16x16x32_bf16 v[100:103], a[184:187], v[52:55], v[100:103]
    v_mfma_f32_16x16x32_bf16 v[104:107], a[188:191], v[52:55], v[104:107]
    v_mfma_f32_16x16x32_bf16 v[108:111], a[176:179], v[56:59], v[108:111]
    v_mfma_f32_16x16x32_bf16 v[112:115], a[180:183], v[56:59], v[112:115]
    v_mfma_f32_16x16x32_bf16 v[116:119], a[184:187], v[56:59], v[116:119]
    v_mfma_f32_16x16x32_bf16 v[120:123], a[188:191], v[56:59], v[120:123]
    s_waitcnt lgkmcnt(2)
    v_mfma_f32_16x16x32_bf16 v[92:95], a[192:195], v[28:31], v[92:95]
    ds_read_b128 v[44:47], v14 offset:28672
    v_mfma_f32_16x16x32_bf16 v[96:99], a[196:199], v[28:31], v[96:99]
    ds_read_b128 v[48:51], v14 offset:30720
    v_mfma_f32_16x16x32_bf16 v[100:103], a[200:203], v[28:31], v[100:103]
    v_mfma_f32_16x16x32_bf16 v[104:107], a[204:207], v[28:31], v[104:107]
    v_mfma_f32_16x16x32_bf16 v[108:111], a[192:195], v[32:35], v[108:111]
    v_mfma_f32_16x16x32_bf16 v[112:115], a[196:199], v[32:35], v[112:115]
    v_mfma_f32_16x16x32_bf16 v[116:119], a[200:203], v[32:35], v[116:119]
    v_mfma_f32_16x16x32_bf16 v[120:123], a[204:207], v[32:35], v[120:123]
    s_waitcnt lgkmcnt(2)
    v_mfma_f32_16x16x32_bf16 v[92:95], a[208:211], v[36:39], v[92:95]
    ds_read_b128 v[52:55], v15 offset:28672
    v_mfma_f32_16x16x32_bf16 v[96:99], a[212:215], v[36:39], v[96:99]
    ds_read_b128 v[56:59], v15 offset:30720
    v_mfma_f32_16x16x32_bf16 v[100:103], a[216:219], v[36:39], v[100:103]
    v_mfma_f32_16x16x32_bf16 v[104:107], a[220:223], v[36:39], v[104:107]
    v_mfma_f32_16x16x32_bf16 v[108:111], a[208:211], v[40:43], v[108:111]
    v_mfma_f32_16x16x32_bf16 v[112:115], a[212:215], v[40:43], v[112:115]
    v_mfma_f32_16x16x32_bf16 v[116:119], a[216:219], v[40:43], v[116:119]
    v_mfma_f32_16x16x32_bf16 v[120:123], a[220:223], v[40:43], v[120:123]
    s_waitcnt lgkmcnt(2)
    v_mfma_f32_16x16x32_bf16 v[92:95], a[224:227], v[44:47], v[92:95]
    ds_read_b128 v[28:31], v14 offset:32768
    v_mfma_f32_16x16x32_bf16 v[96:99], a[228:231], v[44:47], v[96:99]
    ds_read_b128 v[32:35], v14 offset:34816
    v_mfma_f32_16x16x32_bf16 v[100:103], a[232:235], v[44:47], v[100:103]
    v_mfma_f32_16x16x32_bf16 v[104:107], a[236:239], v[44:47], v[104:107]
    v_mfma_f32_16x16x32_bf16 v[108:111], a[224:227], v[48:51], v[108:111]
    v_mfma_f32_16x16x32_bf16 v[112:115], a[228:231], v[48:51], v[112:115]
    v_mfma_f32_16x16x32_bf16 v[116:119], a[232:235], v[48:51], v[116:119]
    v_mfma_f32_16x16x32_bf16 v[120:123], a[236:239], v[48:51], v[120:123]
    s_waitcnt lgkmcnt(2)
    v_mfma_f32_16x16x32_bf16 v[92:95], a[240:243], v[52:55], v[92:95]
    ds_read_b128 v[36:39], v15 offset:32768
    v_mfma_f32_16x16x32_bf16 v[96:99], a[244:247], v[52:55], v[96:99]
    ds_read_b128 v[40:43], v15 offset:34816
    v_mfma_f32_16x16x32_bf16 v[100:103], a[248:251], v[52:55], v[100:103]
    v_mfma_f32_16x16x32_bf16 v[104:107], a[252:255], v[52:55], v[104:107]
    v_mfma_f32_16x16x32_bf16 v[108:111], a[240:243], v[56:59], v[108:111]
    v_mfma_f32_16x16x32_bf16 v[112:115], a[244:247], v[56:59], v[112:115]
    v_mfma_f32_16x16x32_bf16 v[116:119], a[248:251], v[56:59], v[116:119]
    v_mfma_f32_16x16x32_bf16 v[120:123], a[252:255], v[56:59], v[120:123]
    s_waitcnt lgkmcnt(2)
    v_mfma_f32_16x16x32_bf16 v[92:95], v[124:127], v[28:31], v[92:95]
    ds_read_b128 v[44:47], v14 offset:36864
    v_mfma_f32_16x16x32_bf16 v[96:99], v[128:131], v[28:31], v[96:99]
    ds_read_b128 v[48:51], v14 offset:38912
    v_mfma_f32_16x16x32_bf16 v[100:103], v[132:135], v[28:31], v[100:103]
    v_mfma_f32_16x16x32_bf16 v[104:107], v[136:139], v[28:31], v[104:107]
    v_mfma_f32_16x16x32_bf16 v[108:111], v[124:127], v[32:35], v[108:111]
    v_mfma_f32_16x16x32_bf16 v[112:115], v[128:131], v[32:35], v[112:115]
    v_mfma_f32_16x16x32_bf16 v[116:119], v[132:135], v[32:35], v[116:119]
    v_mfma_f32_16x16x32_bf16 v[120:123], v[136:139], v[32:35], v[120:123]
    s_waitcnt lgkmcnt(2)
    v_mfma_f32_16x16x32_bf16 v[92:95], v[140:143], v[36:39], v[92:95]
    ds_read_b128 v[52:55], v15 offset:36864
    v_mfma_f32_16x16x32_bf16 v[96:99], v[144:147], v[36:39], v[96:99]
    ds_read_b128 v[56:59], v15 offset:38912
    v_mfma_f32_16x16x32_bf16 v[100:103], v[148:151], v[36:39], v[100:103]
    v_mfma_f32_16x16x32_bf16 v[104:107], v[152:155], v[36:39], v[104:107]
    v_mfma_f32_16x16x32_bf16 v[108:111], v[140:143], v[40:43], v[108:111]
    v_mfma_f32_16x16x32_bf16 v[112:115], v[144:147], v[40:43], v[112:115]
    v_mfma_f32_16x16x32_bf16 v[116:119], v[148:151], v[40:43], v[116:119]
    v_mfma_f32_16x16x32_bf16 v[120:123], v[152:155], v[40:43], v[120:123]
    s_waitcnt lgkmcnt(2)
    v_mfma_f32_16x16x32_bf16 v[92:95], v[156:159], v[44:47], v[92:95]
    ds_read_b128 v[28:31], v12 offset:0
    v_mfma_f32_16x16x32_bf16 v[96:99], v[160:163], v[44:47], v[96:99]
    ds_read_b128 v[32:35], v12 offset:2048
    v_mfma_f32_16x16x32_bf16 v[100:103], v[164:167], v[44:47], v[100:103]
    v_mfma_f32_16x16x32_bf16 v[104:107], v[168:171], v[44:47], v[104:107]
    v_mfma_f32_16x16x32_bf16 v[108:111], v[156:159], v[48:51], v[108:111]
    v_mfma_f32_16x16x32_bf16 v[112:115], v[160:163], v[48:51], v[112:115]
    v_mfma_f32_16x16x32_bf16 v[116:119], v[164:167], v[48:51], v[116:119]
    v_mfma_f32_16x16x32_bf16 v[120:123], v[168:171], v[48:51], v[120:123]
    s_waitcnt lgkmcnt(2)
    v_mfma_f32_16x16x32_bf16 v[92:95], v[172:175], v[52:55], v[92:95]
    ds_read_b128 v[36:39], v13 offset:0
    v_mfma_f32_16x16x32_bf16 v[96:99], v[176:179], v[52:55], v[96:99]
    ds_read_b128 v[40:43], v13 offset:2048
    v_mfma_f32_16x16x32_bf16 v[100:103], v[180:183], v[52:55], v[100:103]
    v_mfma_f32_16x16x32_bf16 v[104:107], v[184:187], v[52:55], v[104:107]
    v_mfma_f32_16x16x32_bf16 v[108:111], v[172:175], v[56:59], v[108:111]
    s_add_u32 s50, s62, 0
    s_addc_u32 s51, s63, 0
    s_mul_i32 s40, s65, 2
    s_add_u32 s62, s62, s40
    s_addc_u32 s63, s63, 0
    s_add_u32 s26, s26, 1
    s_mov_b64 s[56:57], -1
    v_mfma_f32_16x16x32_bf16 v[112:115], v[176:179], v[56:59], v[112:115]
    v_mfma_f32_16x16x32_bf16 v[116:119], v[180:183], v[56:59], v[116:119]
    v_mfma_f32_16x16x32_bf16 v[120:123], v[184:187], v[56:59], v[120:123]
    s_cmp_lg_u32 s26, 2
    s_cbranch_scc1 g1_qe
    s_nop 7
    v_cvt_pk_bf16_f32 v92, v92, v93
    v_cvt_pk_bf16_f32 v93, v94, v95
    v_cvt_pk_bf16_f32 v94, v96, v97
    v_cvt_pk_bf16_f32 v95, v98, v99
    global_store_dwordx4 v7, v[92:95], s[50:51] offset:0 sc1
    v_cvt_pk_bf16_f32 v100, v100, v101
    v_cvt_pk_bf16_f32 v101, v102, v103
    v_cvt_pk_bf16_f32 v102, v104, v105
    v_cvt_pk_bf16_f32 v103, v106, v107
    global_store_dwordx4 v7, v[100:103], s[50:51] offset:1024 sc1
    v_cvt_pk_bf16_f32 v108, v108, v109
    v_cvt_pk_bf16_f32 v109, v110, v111
    v_cvt_pk_bf16_f32 v110, v112, v113
    v_cvt_pk_bf16_f32 v111, v114, v115
    global_store_dwordx4 v8, v[108:111], s[50:51] offset:0 sc1
    v_cvt_pk_bf16_f32 v116, v116, v117
    v_cvt_pk_bf16_f32 v117, v118, v119
    v_cvt_pk_bf16_f32 v118, v120, v121
    v_cvt_pk_bf16_f32 v119, v122, v123
    global_store_dwordx4 v8, v[116:119], s[50:51] offset:1024 sc1
    s_mov_b64 s[56:57], 0
    v_mov_b32 v17, 0
    s_waitcnt vmcnt(0)
    s_barrier
    s_mov_b64 exec, s[48:49]
    global_atomic_add v17, v16, s[98:99] sc1
    s_mov_b64 exec, -1
g1_qe:
    s_cmp_lt_u32 s26, 32
    s_cbranch_scc1 g1_ql
    s_nop 7
    v_cvt_pk_bf16_f32 v92, v92, v93
    v_cvt_pk_bf16_f32 v93, v94, v95
    v_cvt_pk_bf16_f32 v94, v96, v97
    v_cvt_pk_bf16_f32 v95, v98, v99
    global_store_dwordx4 v7, v[92:95], s[50:51] offset:0 sc1
    v_cvt_pk_bf16_f32 v100, v100, v101
    v_cvt_pk_bf16_f32 v101, v102, v103
    v_cvt_pk_bf16_f32 v102, v104, v105
    v_cvt_pk_bf16_f32 v103, v106, v107
    global_store_dwordx4 v7, v[100:103], s[50:51] offset:1024 sc1
    v_cvt_pk_bf16_f32 v108, v108, v109
    v_cvt_pk_bf16_f32 v109, v110, v111
    v_cvt_pk_bf16_f32 v110, v112, v113
    v_cvt_pk_bf16_f32 v111, v114, v115
    global_store_dwordx4 v8, v[108:111], s[50:51] offset:0 sc1
    v_cvt_pk_bf16_f32 v116, v116, v117
    v_cvt_pk_bf16_f32 v117, v118, v119
    v_cvt_pk_bf16_f32 v118, v120, v121
    v_cvt_pk_bf16_f32 v119, v122, v123
    global_store_dwordx4 v8, v[116:119], s[50:51] offset:1024 sc1
    s_waitcnt vmcnt(0) lgkmcnt(0)
    s_barrier
    s_cmp_ge_i32 s30, 0
    s_cselect_b64 s[46:47], s[48:49], 0
    v_mov_b32 v17, s30
    s_add_u32 s30, s30, 4
    s_mov_b64 exec, s[46:47]
    global_atomic_add v17, v16, s[98:99] sc1
    s_mov_b64 exec, -1
    s_branch g1_end
g1_T:
    s_lshl_b32 s40, s31, 18
    s_lshl_b32 s41, s4, 12
    s_add_u32 s40, s40, s41
    s_add_u32 s40, s40, 33554432
    s_add_u32 s62, s18, s40
    s_addc_u32 s63, s19, 0
    s_mov_b64 s[50:51], s[62:63]
    s_mov_b32 s65, 0x40000
    v_mov_b32 v16, 1
    s_mov_b32 s30, -4
    s_nop 7
    v_cvt_pk_bf16_f32 v60, v60, v61
    v_cvt_pk_bf16_f32 v61, v62, v63
    v_cvt_pk_bf16_f32 v62, v76, v77
    v_cvt_pk_bf16_f32 v63, v78, v79
    global_store_dwordx4 v7, v[60:63], s[50:51] offset:0 sc1
    v_cvt_pk_bf16_f32 v64, v64, v65
    v_cvt_pk_bf16_f32 v65, v66, v67
    v_cvt_pk_bf16_f32 v66, v80, v81
    v_cvt_pk_bf16_f32 v67, v82, v83
    global_store_dwordx4 v7, v[64:67], s[50:51] offset:1024 sc1
    v_cvt_pk_bf16_f32 v68, v68, v69
    v_cvt_pk_bf16_f32 v69, v70, v71
    v_cvt_pk_bf16_f32 v70, v84, v85
    v_cvt_pk_bf16_f32 v71, v86, v87
    global_store_dwordx4 v7, v[68:71], s[50:51] offset:2048 sc1
    v_cvt_pk_bf16_f32 v72, v72, v73
    v_cvt_pk_bf16_f32 v73, v74, v75
    v_cvt_pk_bf16_f32 v74, v88, v89
    v_cvt_pk_bf16_f32 v75, v90, v91
    global_store_dwordx4 v7, v[72:75], s[50:51] offset:3072 sc1
    s_mov_b32 s26, 1
    s_add_u32 s27, s27, 40960
    s_cmp_ge_u32 s27, 163840
    s_cselect_b32 s43, 163840, 0
    s_sub_u32 s27, s27, s43
    s_min_u32 s29, s26, 31
    s_lshl_b32 s29, s29, 1
    s_add_u32 s29, s29, s31
    s_mul_i32 s29, s29, 40960
    s_add_u32 m0, s27, 0
    s_add_u32 s43, s29, 0
    buffer_load_dwordx4 v9, s[20:23], s43 offen lds
    s_add_u32 m0, s27, 4096
    s_add_u32 s43, s29, 128
    buffer_load_dwordx4 v9, s[20:23], s43 offen lds
    s_add_u32 m0, s27, 8192
    s_add_u32 s43, s29, 256
    buffer_load_dwordx4 v9, s[20:23], s43 offen lds
    s_add_u32 m0, s27, 12288
    s_add_u32 s43, s29, 384
    buffer_load_dwordx4 v9, s[20:23], s43 offen lds
    s_add_u32 m0, s27, 16384
    s_add_u32 s43, s29, 512
    buffer_load_dwordx4 v9, s[20:23], s43 offen lds
    s_add_u32 m0, s27, 20480
    s_add_u32 s43, s29, 640
    buffer_load_dwordx4 v9, s[20:23], s43 offen lds
    s_add_u32 m0, s27, 24576
    s_add_u32 s43, s29, 768
    buffer_load_dwordx4 v9, s[20:23], s43 offen lds
    s_add_u32 m0, s27, 28672
    s_add_u32 s43, s29, 896
    buffer_load_dwordx4 v9, s[20:23], s43 offen lds
    s_add_u32 m0, s27, 32768
    s_add_u32 s43, s29, 1024
    buffer_load_dwordx4 v9, s[20:23], s43 offen lds
    s_add_u32 m0, s27, 36864
    s_add_u32 s43, s29, 1152
    buffer_load_dwordx4 v9, s[20:23], s43 offen lds
    s_mov_b32 s26, 2
    s_add_u32 s27, s27, 40960
    s_cmp_ge_u32 s27, 163840
    s_cselect_b32 s43, 163840, 0
    s_sub_u32 s27, s27, s43
    s_min_u32 s29, s26, 31
    s_lshl_b32 s29, s29, 1
    s_add_u32 s29, s29, s31
    s_mul_i32 s29, s29, 40960
    s_add_u32 m0, s27, 0
    s_add_u32 s43, s29, 0
    buffer_load_dwordx4 v9, s[20:23], s43 offen lds
    s_add_u32 m0, s27, 4096
    s_add_u32 s43, s29, 128
    buffer_load_dwordx4 v9, s[20:23], s43 offen lds
    s_add_u32 m0, s27, 8192
    s_add_u32 s43, s29, 256
    buffer_load_dwordx4 v9, s[20:23], s43 offen lds
    s_add_u32 m0, s27, 12288
    s_add_u32 s43, s29, 384
    buffer_load_dwordx4 v9, s[20:23], s43 offen lds
    s_add_u32 m0, s27, 16384
    s_add_u32 s43, s29, 512
    buffer_load_dwordx4 v9, s[20:23], s43 offen lds
    s_add_u32 m0, s27, 20480
    s_add_u32 s43, s29, 640
    buffer_load_dwordx4 v9, s[20:23], s43 offen lds
    s_add_u32 m0, s27, 24576
    s_add_u32 s43, s29, 768
    buffer_load_dwordx4 v9, s[20:23], s43 offen lds
    s_add_u32 m0, s27, 28672
    s_add_u32 s43, s29, 896
    buffer_load_dwordx4 v9, s[20:23], s43 offen lds
    s_add_u32 m0, s27, 32768
    s_add_u32 s43, s29, 1024
    buffer_load_dwordx4 v9, s[20:23], s43 offen lds
    s_add_u32 m0, s27, 36864
    s_add_u32 s43, s29, 1152
    buffer_load_dwordx4 v9, s[20:23], s43 offen lds
    s_mov_b32 s26, 3
    s_add_u32 s27, s27, 40960
    s_cmp_ge_u32 s27, 163840
    s_cselect_b32 s43, 163840, 0
    s_sub_u32 s27, s27, s43
    s_min_u32 s29, s26, 31
    s_lshl_b32 s29, s29, 1
    s_add_u32 s29, s29, s31
    s_mul_i32 s29, s29, 40960
    s_add_u32 m0, s27, 0
    s_add_u32 s43, s29, 0
    buffer_load_dwordx4 v9, s[20:23], s43 offen lds
    s_add_u32 m0, s27, 4096
    s_add_u32 s43, s29, 128
    buffer_load_dwordx4 v9, s[20:23], s43 offen lds
    s_add_u32 m0, s27, 8192
    s_add_u32 s43, s29, 256
    buffer_load_dwordx4 v9, s[20:23], s43 offen lds
    s_add_u32 m0, s27, 12288
    s_add_u32 s43, s29, 384
    buffer_load_dwordx4 v9, s[20:23], s43 offen lds
    s_add_u32 m0, s27, 16384
    s_add_u32 s43, s29, 512
    buffer_load_dwordx4 v9, s[20:23], s43 offen lds
    s_add_u32 m0, s27, 20480
    s_add_u32 s43, s29, 640
    buffer_load_dwordx4 v9, s[20:23], s43 offen lds
    s_add_u32 m0, s27, 24576
    s_add_u32 s43, s29, 768
    buffer_load_dwordx4 v9, s[20:23], s43 offen lds
    s_add_u32 m0, s27, 28672
    s_add_u32 s43, s29, 896
    buffer_load_dwordx4 v9, s[20:23], s43 offen lds
    s_add_u32 m0, s27, 32768
    s_add_u32 s43, s29, 1024
    buffer_load_dwordx4 v9, s[20:23], s43 offen lds
    s_add_u32 m0, s27, 36864
    s_add_u32 s43, s29, 1152
    buffer_load_dwordx4 v9, s[20:23], s43 offen lds
    s_mov_b32 s26, 1
    v_add_u32 v14, s28, v10
    v_add_u32 v15, s28, v11
    s_add_u32 s28, s28, 40960
    s_cmp_ge_u32 s28, 163840
    s_cselect_b32 s43, 163840, 0
    s_sub_u32 s28, s28, s43
    s_lshl_b32 s40, s65, 1
    s_add_u32 s62, s62, s40
    s_addc_u32 s63, s63, 0
    v_mov_b32 v17, 76
    s_waitcnt vmcnt(30)
    s_barrier
    s_mov_b64 exec, s[48:49]
    global_atomic_add v17, v16, s[98:99] sc1
    s_mov_b64 exec, -1
    s_waitcnt vmcnt(20)
    s_barrier
    ds_read_b128 v[28:31], v14 offset:0
    ds_read_b128 v[32:35], v14 offset:2048
    ds_read_b128 v[36:39], v15 offset:0
    ds_read_b128 v[40:43], v15 offset:2048
    s_branch g1_vm
g1_vl:
    s_waitcnt lgkmcnt(2)
    v_mfma_f32_16x16x32_bf16 v[60:63], v[28:31], a[0:3], 0
    ds_read_b128 v[44:47], v12 offset:4096
    v_mfma_f32_16x16x32_bf16 v[64:67], v[28:31], a[4:7], 0
    ds_read_b128 v[48:51], v12 offset:6144
    v_mfma_f32_16x16x32_bf16 v[68:71], v[28:31], a[8:11], 0
    v_mfma_f32_16x16x32_bf16 v[72:75], v[28:31], a[12:15], 0
    s_waitcnt vmcnt(10)
    s_barrier
    v_mfma_f32_16x16x32_bf16 v[76:79], v[32:35], a[0:3], 0
    v_mfma_f32_16x16x32_bf16 v[80:83], v[32:35], a[4:7], 0
    v_mfma_f32_16x16x32_bf16 v[84:87], v[32:35], a[8:11], 0
    v_add_u32 v14, s28, v10
    v_add_u32 v15, s28, v11
    s_add_u32 s28, s28, 40960
    s_cmp_ge_u32 s28, 163840
    s_cselect_b32 s43, 163840, 0
    s_sub_u32 s28, s28, s43
    v_mfma_f32_16x16x32_bf16 v[88:91], v[32:35], a[12:15], 0
    s_waitcnt lgkmcnt(2)
    s_add_u32 s27, s27, 40960
    s_cmp_ge_u32 s27, 163840
    s_cselect_b32 s43, 163840, 0
    s_sub_u32 s27, s27, s43
    s_add_u32 s40, s26, 3
    s_min_u32 s29, s40, 31
    s_lshl_b32 s29, s29, 1
    s_add_u32 s29, s29, s31
    s_mul_i32 s29, s29, 40960
    v_mfma_f32_16x16x32_bf16 v[60:63], v[36:39], a[16:19], v[60:63]
    ds_read_b128 v[52:55], v13 offset:4096
    v_cvt_pk_bf16_f32 v92, v92, v93
    v_cvt_pk_bf16_f32 v93, v94, v95
    v_mfma_f32_16x16x32_bf16 v[64:67], v[36:39], a[20:23], v[64:67]
    ds_read_b128 v[56:59], v13 offset:6144
    v_cvt_pk_bf16_f32 v94, v108, v109
    v_cvt_pk_bf16_f32 v95, v110, v111
    v_mfma_f32_16x16x32_bf16 v[68:71], v[36:39], a[24:27], v[68:71]
    s_mov_b64 exec, s[56:57]
    global_store_dwordx4 v7, v[92:95], s[50:51] offset:0 sc1
    s_mov_b64 exec, -1
    v_cvt_pk_bf16_f32 v96, v96, v97
    v_mfma_f32_16x16x32_bf16 v[72:75], v[36:39], a[28:31], v[72:75]
    v_cvt_pk_bf16_f32 v97, v98, v99
    v_cvt_pk_bf16_f32 v98, v112, v113
    v_mfma_f32_16x16x32_bf16 v[76:79], v[40:43], a[16:19], v[76:79]
    v_cvt_pk_bf16_f32 v99, v114, v115
    s_mov_b64 exec, s[56:57]
    global_store_dwordx4 v7, v[96:99], s[50:51] offset:1024 sc1
    s_mov_b64 exec, -1
    v_mfma_f32_16x16x32_bf16 v[80:83], v[40:43], a[20:23], v[80:83]
    v_cvt_pk_bf16_f32 v100, v100, v101
    v_cvt_pk_bf16_f32 v101, v102, v103
    v_mfma_f32_16x16x32_bf16 v[84:87], v[40:43], a[24:27], v[84:87]
    v_cvt_pk_bf16_f32 v102, v116, v117
    v_cvt_pk_bf16_f32 v103, v118, v119
    v_mfma_f32_16x16x32_bf16 v[88:91], v[40:43], a[28:31], v[88:91]
    s_waitcnt lgkmcnt(2)
    s_mov_b64 exec, s[56:57]
    global_store_dwordx4 v7, v[100:103], s[50:51] offset:2048 sc1
    s_mov_b64 exec, -1
    v_cvt_pk_bf16_f32 v104, v104, v105
    v_mfma_f32_16x16x32_bf16 v[60:63], v[44:47], a[32:35], v[60:63]
    ds_read_b128 v[28:31], v12 offset:8192
    v_cvt_pk_bf16_f32 v105, v106, v107
    v_cvt_pk_bf16_f32 v106, v120, v121
    v_mfma_f32_16x16x32_bf16 v[64:67], v[44:47], a[36:39], v[64:67]
    ds_read_b128 v[32:35], v12 offset:10240
    v_cvt_pk_bf16_f32 v107, v122, v123
    s_mov_b64 exec, s[56:57]
    global_store_dwordx4 v7, v[104:107], s[50:51] offset:3072 sc1
    s_mov_b64 exec, -1
    v_mfma_f32_16x16x32_bf16 v[68:71], v[44:47], a[40:43], v[68:71]
    v_mfma_f32_16x16x32_bf16 v[72:75], v[44:47], a[44:47], v[72:75]
    s_add_u32 m0, s27, 0
    s_add_u32 s43, s29, 0
    buffer_load_dwordx4 v9, s[20:23], s43 offen lds
    v_mfma_f32_16x16x32_bf16 v[76:79], v[48:51], a[32:35], v[76:79]
    v_mfma_f32_16x16x32_bf16 v[80:83], v[48:51], a[36:39], v[80:83]
    s_add_u32 m0, s27, 4096
    s_add_u32 s43, s29, 128
    buffer_load_dwordx4 v9, s[20:23], s43 offen lds
    v_mfma_f32_16x16x32_bf16 v[84:87], v[48:51], a[40:43], v[84:87]
    v_mfma_f32_16x16x32_bf16 v[88:91], v[48:51], a[44:47], v[88:91]
    s_waitcnt lgkmcnt(2)
    s_add_u32 m0, s27, 8192
    s_add_u32 s43, s29, 256
    buffer_load_dwordx4 v9, s[20:23], s43 offen lds
    v_mfma_f32_16x16x32_bf16 v[60:63], v[52:55], a[48:51], v[60:63]
    ds_read_b128 v[36:39], v13 offset:8192
    v_mfma_f32_16x16x32_bf16 v[64:67], v[52:55], a[52:55], v[64:67]
    ds_read_b128 v[40:43], v13 offset:10240
    s_add_u32 m0, s27, 12288
    s_add_u32 s43, s29, 384
    buffer_load_dwordx4 v9, s[20:23], s43 offen lds
    v_mfma_f32_16x16x32_bf16 v[68:71], v[52:55], a[56:59], v[68:71]
    v_mfma_f32_16x16x32_bf16 v[72:75], v[52:55], a[60:63], v[72:75]
    s_add_u32 m0, s27, 16384
    s_add_u32 s43, s29, 512
    buffer_load_dwordx4 v9, s[20:23], s43 offen lds
    v_mfma_f32_16x16x32_bf16 v[76:79], v[56:59], a[48:51], v[76:79]
    v_mfma_f32_16x16x32_bf16 v[80:83], v[56:59], a[52:55], v[80:83]
    s_add_u32 m0, s27, 20480
    s_add_u32 s43, s29, 640
    buffer_load_dwordx4 v9, s[20:23], s43 offen lds
    v_mfma_f32_16x16x32_bf16 v[84:87], v[56:59], a[56:59], v[84:87]
    v_mfma_f32_16x16x32_bf16 v[88:91], v[56:59], a[60:63], v[88:91]
    s_waitcnt lgkmcnt(2)
    s_add_u32 m0, s27, 24576
    s_add_u32 s43, s29, 768
    buffer_load_dwordx4 v9, s[20:23], s43 offen lds
    v_mfma_f32_16x16x32_bf16 v[60:63], v[28:31], a[64:67], v[60:63]
    ds_read_b128 v[44:47], v12 offset:12288
    v_mfma_f32_16x16x32_bf16 v[64:67], v[28:31], a[68:71], v[64:67]
    ds_read_b128 v[48:51], v12 offset:14336
    s_add_u32 m0, s27, 28672
    s_add_u32 s43, s29, 896
    buffer_load_dwordx4 v9, s[20:23], s43 offen lds
    v_mfma_f32_16x16x32_bf16 v[68:71], v[28:31], a[72:75], v[68:71]
    v_mfma_f32_16x16x32_bf16 v[72:75], v[28:31], a[76:79], v[72:75]
    s_add_u32 m0, s27, 32768
    s_add_u32 s43, s29, 1024
    buffer_load_dwordx4 v9, s[20:23], s43 offen lds
    v_mfma_f32_16x16x32_bf16 v[76:79], v[32:35], a[64:67], v[76:79]
    v_mfma_f32_16x16x32_bf16 v[80:83], v[32:35], a[68:71], v[80:83]
    s_add_u32 m0, s27, 36864
    s_add_u32 s43, s29, 1152
    buffer_load_dwordx4 v9, s[20:23], s43 offen lds
    v_mfma_f32_16x16x32_bf16 v[84:87], v[32:35], a[72:75], v[84:87]
    v_mfma_f32_16x16x32_bf16 v[88:91], v[32:35], a[76:79], v[88:91]
    s_waitcnt lgkmcnt(2)
    v_mfma_f32_16x16x32_bf16 v[60:63], v[36:39], a[80:83], v[60:63]
    ds_read_b128 v[52:55], v13 offset:12288
    v_mfma_f32_16x16x32_bf16 v[64:67], v[36:39], a[84:87], v[64:67]
    ds_read_b128 v[56:59], v13 offset:14336
    v_mfma_f32_16x16x32_bf16 v[68:71], v[36:39], a[88:91], v[68:71]
    v_mfma_f32_16x16x32_bf16 v[72:75], v[36:39], a[92:95], v[72:75]
    v_mfma_f32_16x16x32_bf16 v[76:79], v[40:43], a[80:83], v[76:79]
    v_mfma_f32_16x16x32_bf16 v[80:83], v[40:43], a[84:87], v[80:83]
    v_mfma_f32_16x16x32_bf16 v[84:87], v[40:43], a[88:91], v[84:87]
    v_mfma_f32_16x16x32_bf16 v[88:91], v[40:43], a[92:95], v[88:91]
    s_waitcnt lgkmcnt(2)
    v_mfma_f32_16x16x32_bf16 v[60:63], v[44:47], a[96:99], v[60:63]
    ds_read_b128 v[28:31], v12 offset:16384
    v_mfma_f32_16x16x32_bf16 v[64:67], v[44:47], a[100:103], v[64:67]
    ds_read_b128 v[32:35], v12 offset:18432
    v_mfma_f32_16x16x32_bf16 v[68:71], v[44:47], a[104:107], v[68:71]
    v_mfma_f32_16x16x32_bf16 v[72:75], v[44:47], a[108:111], v[72:75]
    v_mfma_f32_16x16x32_bf16 v[76:79], v[48:51], a[96:99], v[76:79]
    v_mfma_f32_16x16x32_bf16 v[80:83], v[48:51], a[100:103], v[80:83]
    v_mfma_f32_16x16x32_bf16 v[84:87], v[48:51], a[104:107], v[84:87]
    v_mfma_f32_16x16x32_bf16 v[88:91], v[48:51], a[108:111], v[88:91]
    s_waitcnt lgkmcnt(2)
    v_mfma_f32_16x16x32_bf16 v[60:63], v[52:55], a[112:115], v[60:63]
    ds_read_b128 v[36:39], v13 offset:16384
    v_mfma_f32_16x16x32_bf16 v[64:67], v[52:55], a[116:119], v[64:67]
    ds_read_b128 v[40:43], v13 offset:18432
    v_mfma_f32_16x16x32_bf16 v[68:71], v[52:55], a[120:123], v[68:71]
    v_mfma_f32_16x16x32_bf16 v[72:75], v[52:55], a[124:127], v[72:75]
    v_mfma_f32_16x16x32_bf16 v[76:79], v[56:59], a[112:115], v[76:79]
    v_mfma_f32_16x16x32_bf16 v[80:83], v[56:59], a[116:119], v[80:83]
    v_mfma_f32_16x16x32_bf16 v[84:87], v[56:59], a[120:123], v[84:87]
    v_mfma_f32_16x16x32_bf16 v[88:91], v[56:59], a[124:127], v[88:91]
    s_waitcnt lgkmcnt(2)
    v_mfma_f32_16x16x32_bf16 v[60:63], v[28:31], a[128:131], v[60:63]
    ds_read_b128 v[44:47], v12 offset:20480
    v_mfma_f32_16x16x32_bf16 v[64:67], v[28:31], a[132:135], v[64:67]
    ds_read_b128 v[48:51], v12 offset:22528
    v_mfma_f32_16x16x32_bf16 v[68:71], v[28:31], a[136:139], v[68:71]
    v_mfma_f32_16x16x32_bf16 v[72:75], v[28:31], a[140:143], v[72:75]
    v_mfma_f32_16x16x32_bf16 v[76:79], v[32:35], a[128:131], v[76:79]
    v_mfma_f32_16x16x32_bf16 v[80:83], v[32:35], a[132:135], v[80:83]
    v_mfma_f32_16x16x32_bf16 v[84:87], v[32:35], a[136:139], v[84:87]
    v_mfma_f32_16x16x32_bf16 v[88:91], v[32:35], a[140:143], v[88:91]
    s_waitcnt lgkmcnt(2)
    v_mfma_f32_16x16x32_bf16 v[60:63], v[36:39], a[144:147], v[60:63]
    ds_read_b128 v[52:55], v13 offset:20480
    v_mfma_f32_16x16x32_bf16 v[64:67], v[36:39], a[148:151], v[64:67]
    ds_read_b128 v[56:59], v13 offset:22528
    v_mfma_f32_16x16x32_bf16 v[68:71], v[36:39], a[152:155], v[68:71]
    v_mfma_f32_16x16x32_bf16 v[72:75], v[36:39], a[156:159], v[72:75]
    v_mfma_f32_16x16x32_bf16 v[76:79], v[40:43], a[144:147], v[76:79]
    v_mfma_f32_16x16x32_bf16 v[80:83], v[40:43], a[148:151], v[80:83]
    v_mfma_f32_16x16x32_bf16 v[84:87], v[40:43], a[152:155], v[84:87]
    v_mfma_f32_16x16x32_bf16 v[88:91], v[40:43], a[156:159], v[88:91]
    s_waitcnt lgkmcnt(2)
    v_mfma_f32_16x16x32_bf16 v[60:63], v[44:47], a[160:163], v[60:63]
    ds_read_b128 v[28:31], v12 offset:24576
    v_mfma_f32_16x16x32_bf16 v[64:67], v[44:47], a[164:167], v[64:67]
    ds_read_b128 v[32:35], v12 offset:26624
    v_mfma_f32_16x16x32_bf16 v[68:71], v[44:47], a[168:171], v[68:71]
    v_mfma_f32_16x16x32_bf16 v[72:75], v[44:47], a[172:175], v[72:75]
    v_mfma_f32_16x16x32_bf16 v[76:79], v[48:51], a[160:163], v[76:79]
    v_mfma_f32_16x16x32_bf16 v[80:83], v[48:51], a[164:167], v[80:83]
    v_mfma_f32_16x16x32_bf16 v[84:87], v[48:51], a[168:171], v[84:87]
    v_mfma_f32_16x16x32_bf16 v[88:91], v[48:51], a[172:175], v[88:91]
    s_waitcnt lgkmcnt(2)
    v_mfma_f32_16x16x32_bf16 v[60:63], v[52:55], a[176:179], v[60:63]
    ds_read_b128 v[36:39], v13 offset:24576
    v_mfma_f32_16x16x32_bf16 v[64:67], v[52:55], a[180:183], v[64:67]
    ds_read_b128 v[40:43], v13 offset:26624
    v_mfma_f32_16x16x32_bf16 v[68:71], v[52:55], a[184:187], v[68:71]
    v_mfma_f32_16x16x32_bf16 v[72:75], v[52:55], a[188:191], v[72:75]
    v_mfma_f32_16x16x32_bf16 v[76:79], v[56:59], a[176:179], v[76:79]
    v_mfma_f32_16x16x32_bf16 v[80:83], v[56:59], a[180:183], v[80:83]
    v_mfma_f32_16x16x32_bf16 v[84:87], v[56:59], a[184:187], v[84:87]
    v_mfma_f32_16x16x32_bf16 v[88:91], v[56:59], a[188:191], v[88:91]
    s_waitcnt lgkmcnt(2)
    v_mfma_f32_16x16x32_bf16 v[60:63], v[28:31], a[192:195], v[60:63]
    ds_read_b128 v[44:47], v12 offset:28672
    v_mfma_f32_16x16x32_bf16 v[64:67], v[28:31], a[196:199], v[64:67]
    ds_read_b128 v[48:51], v12 offset:30720
    v_mfma_f32_16x16x32_bf16 v[68:71], v[28:31], a[200:203], v[68:71]
    v_mfma_f32_16x16x32_bf16 v[72:75], v[28:31], a[204:207], v[72:75]
    v_mfma_f32_16x16x32_bf16 v[76:79], v[32:35], a[192:195], v[76:79]
    v_mfma_f32_16x16x32_bf16 v[80:83], v[32:35], a[196:199], v[80:83]
    v_mfma_f32_16x16x32_bf16 v[84:87], v[32:35], a[200:203], v[84:87]
    v_mfma_f32_16x16x32_bf16 v[88:91], v[32:35], a[204:207], v[88:91]
    s_waitcnt lgkmcnt(2)
    v_mfma_f32_16x16x32_bf16 v[60:63], v[36:39], a[208:211], v[60:63]
    ds_read_b128 v[52:55], v13 offset:28672
    v_mfma_f32_16x16x32_bf16 v[64:67], v[36:39], a[212:215], v[64:67]
    ds_read_b128 v[56:59], v13 offset:30720
    v_mfma_f32_16x16x32_bf16 v[68:71], v[36:39], a[216:219], v[68:71]
    v_mfma_f32_16x16x32_bf16 v[72:75], v[36:39], a[220:223], v[72:75]
    v_mfma_f32_16x16x32_bf16 v[76:79], v[40:43], a[208:211], v[76:79]
    v_mfma_f32_16x16x32_bf16 v[80:83], v[40:43], a[212:215], v[80:83]
    v_mfma_f32_16x16x32_bf16 v[84:87], v[40:43], a[216:219], v[84:87]
    v_mfma_f32_16x16x32_bf16 v[88:91], v[40:43], a[220:223], v[88:91]
    s_waitcnt lgkmcnt(2)
    v_mfma_f32_16x16x32_bf16 v[60:63], v[44:47], a[224:227], v[60:63]
    ds_read_b128 v[28:31], v12 offset:32768
    v_mfma_f32_16x16x32_bf16 v[64:67], v[44:47], a[228:231], v[64:67]
    ds_read_b128 v[32:35], v12 offset:34816
    v_mfma_f32_16x16x32_bf16 v[68:71], v[44:47], a[232:235], v[68:71]
    v_mfma_f32_16x16x32_bf16 v[72:75], v[44:47], a[236:239], v[72:75]
    v_mfma_f32_16x16x32_bf16 v[76:79], v[48:51], a[224:227], v[76:79]
    v_mfma_f32_16x16x32_bf16 v[80:83], v[48:51], a[228:231], v[80:83]
    v_mfma_f32_16x16x32_bf16 v[84:87], v[48:51], a[232:235], v[84:87]
    v_mfma_f32_16x16x32_bf16 v[88:91], v[48:51], a[236:239], v[88:91]
    s_waitcnt lgkmcnt(2)
    v_mfma_f32_16x16x32_bf16 v[60:63], v[52:55], a[240:243], v[60:63]
    ds_read_b128 v[36:39], v13 offset:32768
    v_mfma_f32_16x16x32_bf16 v[64:67], v[52:55], a[244:247], v[64:67]
    ds_read_b128 v[40:43], v13 offset:34816
    v_mfma_f32_16x16x32_bf16 v[68:71], v[52:55], a[248:251], v[68:71]
    v_mfma_f32_16x16x32_bf16 v[72:75], v[52:55], a[252:255], v[72:75]
    v_mfma_f32_16x16x32_bf16 v[76:79], v[56:59], a[240:243], v[76:79]
    v_mfma_f32_16x16x32_bf16 v[80:83], v[56:59], a[244:247], v[80:83]
    v_mfma_f32_16x16x32_bf16 v[84:87], v[56:59], a[248:251], v[84:87]
    v_mfma_f32_16x16x32_bf16 v[88:91], v[56:59], a[252:255], v[88:91]
    s_waitcnt lgkmcnt(2)
    v_mfma_f32_16x16x32_bf16 v[60:63], v[28:31], v[124:127], v[60:63]
    ds_read_b128 v[44:47], v12 offset:36864
    v_mfma_f32_16x16x32_bf16 v[64:67], v[28:31], v[128:131], v[64:67]
    ds_read_b128 v[48:51], v12 offset:38912
    v_mfma_f32_16x16x32_bf16 v[68:71], v[28:31], v[132:135], v[68:71]
    v_mfma_f32_16x16x32_bf16 v[72:75], v[28:31], v[136:139], v[72:75]
    v_mfma_f32_16x16x32_bf16 v[76:79], v[32:35], v[124:127], v[76:79]
    v_mfma_f32_16x16x32_bf16 v[80:83], v[32:35], v[128:131], v[80:83]
    v_mfma_f32_16x16x32_bf16 v[84:87], v[32:35], v[132:135], v[84:87]
    v_mfma_f32_16x16x32_bf16 v[88:91], v[32:35], v[136:139], v[88:91]
    s_waitcnt lgkmcnt(2)
    v_mfma_f32_16x16x32_bf16 v[60:63], v[36:39], v[140:143], v[60:63]
    ds_read_b128 v[52:55], v13 offset:36864
    v_mfma_f32_16x16x32_bf16 v[64:67], v[36:39], v[144:147], v[64:67]
    ds_read_b128 v[56:59], v13 offset:38912
    v_mfma_f32_16x16x32_bf16 v[68:71], v[36:39], v[148:151], v[68:71]
    v_mfma_f32_16x16x32_bf16 v[72:75], v[36:39], v[152:155], v[72:75]
    v_mfma_f32_16x16x32_bf16 v[76:79], v[40:43], v[140:143], v[76:79]
    v_mfma_f32_16x16x32_bf16 v[80:83], v[40:43], v[144:147], v[80:83]
    v_mfma_f32_16x16x32_bf16 v[84:87], v[40:43], v[148:151], v[84:87]
    v_mfma_f32_16x16x32_bf16 v[88:91], v[40:43], v[152:155], v[88:91]
    s_waitcnt lgkmcnt(2)
    v_mfma_f32_16x16x32_bf16 v[60:63], v[44:47], v[156:159], v[60:63]
    ds_read_b128 v[28:31], v14 offset:0
    v_mfma_f32_16x16x32_bf16 v[64:67], v[44:47], v[160:163], v[64:67]
    ds_read_b128 v[32:35], v14 offset:2048
    v_mfma_f32_16x16x32_bf16 v[68:71], v[44:47], v[164:167], v[68:71]
    v_mfma_f32_16x16x32_bf16 v[72:75], v[44:47], v[168:171], v[72:75]
    v_mfma_f32_16x16x32_bf16 v[76:79], v[48:51], v[156:159], v[76:79]
    v_mfma_f32_16x16x32_bf16 v[80:83], v[48:51], v[160:163], v[80:83]
    v_mfma_f32_16x16x32_bf16 v[84:87], v[48:51], v[164:167], v[84:87]
    v_mfma_f32_16x16x32_bf16 v[88:91], v[48:51], v[168:171], v[88:91]
    s_waitcnt lgkmcnt(2)
    v_mfma_f32_16x16x32_bf16 v[60:63], v[52:55], v[172:175], v[60:63]
    ds_read_b128 v[36:39], v15 offset:0
    v_mfma_f32_16x16x32_bf16 v[64:67], v[52:55], v[176:179], v[64:67]
    ds_read_b128 v[40:43], v15 offset:2048
    v_mfma_f32_16x16x32_bf16 v[68:71], v[52:55], v[180:183], v[68:71]
    v_mfma_f32_16x16x32_bf16 v[72:75], v[52:55], v[184:187], v[72:75]
    v_mfma_f32_16x16x32_bf16 v[76:79], v[56:59], v[172:175], v[76:79]
    s_add_u32 s50, s62, 0
    s_addc_u32 s51, s63, 0
    s_mul_i32 s40, s65, 2
    s_add_u32 s62, s62, s40
    s_addc_u32 s63, s63, 0
    s_add_u32 s26, s26, 1
    s_mov_b64 s[56:57], -1
    v_mfma_f32_16x16x32_bf16 v[80:83], v[56:59], v[176:179], v[80:83]
    v_mfma_f32_16x16x32_bf16 v[84:87], v[56:59], v[180:183], v[84:87]
    v_mfma_f32_16x16x32_bf16 v[88:91], v[56:59], v[184:187], v[88:91]
g1_vm:
    s_waitcnt lgkmcnt(2)
    v_mfma_f32_16x16x32_bf16 v[92:95], v[28:31], a[0:3], 0
    ds_read_b128 v[44:47], v14 offset:4096
    v_mfma_f32_16x16x32_bf16 v[96:99], v[28:31], a[4:7], 0
    ds_read_b128 v[48:51], v14 offset:6144
    v_mfma_f32_16x16x32_bf16 v[100:103], v[28:31], a[8:11], 0
    v_mfma_f32_16x16x32_bf16 v[104:107], v[28:31], a[12:15], 0
    s_waitcnt vmcnt(10)
    s_barrier
    v_mfma_f32_16x16x32_bf16 v[108:111], v[32:35], a[0:3], 0
    s_cmp_ge_i32 s30, 4
    s_cselect_b64 s[46:47], s[48:49], 0
    v_mov_b32 v17, s30
    s_add_u32 s30, s30, 4
    s_mov_b64 exec, s[46:47]
    global_atomic_add v17, v16, s[98:99] sc1
    s_mov_b64 exec, -1
    v_mfma_f32_16x16x32_bf16 v[112:115], v[32:35], a[4:7], 0
    s_mov_b64 exec, s[60:61]
    global_atomic_add v18, v19, s[98:99] sc1
    s_mov_b64 exec, -1
    s_mov_b64 s[60:61], 0
    v_mfma_f32_16x16x32_bf16 v[116:119], v[32:35], a[8:11], 0
    v_add_u32 v12, s28, v10
    v_add_u32 v13, s28, v11
    s_add_u32 s28, s28, 40960
    s_cmp_ge_u32 s28, 163840
    s_cselect_b32 s43, 163840, 0
    s_sub_u32 s28, s28, s43
    v_mfma_f32_16x16x32_bf16 v[120:123], v[32:35], a[12:15], 0
    s_waitcnt lgkmcnt(2)
    s_add_u32 s27, s27, 40960
    s_cmp_ge_u32 s27, 163840
    s_cselect_b32 s43, 163840, 0
    s_sub_u32 s27, s27, s43
    s_add_u32 s40, s26, 3
    s_min_u32 s29, s40, 31
    s_lshl_b32 s29, s29, 1
    s_add_u32 s29, s29, s31
    s_mul_i32 s29, s29, 40960
    v_mfma_f32_16x16x32_bf16 v[92:95], v[36:39], a[16:19], v[92:95]
    ds_read_b128 v[52:55], v15 offset:4096
    v_cvt_pk_bf16_f32 v60, v60, v61
    v_cvt_pk_bf16_f32 v61, v62, v63
    v_mfma_f32_16x16x32_bf16 v[96:99], v[36:39], a[20:23], v[96:99]
    ds_read_b128 v[56:59], v15 offset:6144
    v_cvt_pk_bf16_f32 v62, v76, v77
    v_cvt_pk_bf16_f32 v63, v78, v79
    v_mfma_f32_16x16x32_bf16 v[100:103], v[36:39], a[24:27], v[100:103]
    s_mov_b64 exec, s[56:57]
    global_store_dwordx4 v7, v[60:63], s[50:51] offset:0 sc1
    s_mov_b64 exec, -1
    v_cvt_pk_bf16_f32 v64, v64, v65
    v_mfma_f32_16x16x32_bf16 v[104:107], v[36:39], a[28:31], v[104:107]
    v_cvt_pk_bf16_f32 v65, v66, v67
    v_cvt_pk_bf16_f32 v66, v80, v81
    v_mfma_f32_16x16x32_bf16 v[108:111], v[40:43], a[16:19], v[108:111]
    v_cvt_pk_bf16_f32 v67, v82, v83
    s_mov_b64 exec, s[56:57]
    global_store_dwordx4 v7, v[64:67], s[50:51] offset:1024 sc1
    s_mov_b64 exec, -1
    v_mfma_f32_16x16x32_bf16 v[112:115], v[40:43], a[20:23], v[112:115]
    v_cvt_pk_bf16_f32 v68, v68, v69
    v_cvt_pk_bf16_f32 v69, v70, v71
    v_mfma_f32_16x16x32_bf16 v[116:119], v[40:43], a[24:27], v[116:119]
    v_cvt_pk_bf16_f32 v70, v84, v85
    v_cvt_pk_bf16_f32 v71, v86, v87
    v_mfma_f32_16x16x32_bf16 v[120:123], v[40:43], a[28:31], v[120:123]
    s_waitcnt lgkmcnt(2)
    s_mov_b64 exec, s[56:57]
    global_store_dwordx4 v7, v[68:71], s[50:51] offset:2048 sc1
    s_mov_b64 exec, -1
    v_cvt_pk_bf16_f32 v72, v72, v73
    v_mfma_f32_16x16x32_bf16 v[92:95], v[44:47], a[32:35], v[92:95]
    ds_read_b128 v[28:31], v14 offset:8192
    v_cvt_pk_bf16_f32 v73, v74, v75
    v_cvt_pk_bf16_f32 v74, v88, v89
    v_mfma_f32_16x16x32_bf16 v[96:99], v[44:47], a[36:39], v[96:99]
    ds_read_b128 v[32:35], v14 offset:10240
    v_cvt_pk_bf16_f32 v75, v90, v91
    s_mov_b64 exec, s[56:57]
    global_store_dwordx4 v7, v[72:75], s[50:51] offset:3072 sc1
    s_mov_b64 exec, -1
    v_mfma_f32_16x16x32_bf16 v[100:103], v[44:47], a[40:43], v[100:103]
    v_mfma_f32_16x16x32_bf16 v[104:107], v[44:47], a[44:47], v[104:107]
    s_add_u32 m0, s27, 0
    s_add_u32 s43, s29, 0
    buffer_load_dwordx4 v9, s[20:23], s43 offen lds
    v_mfma_f32_16x16x32_bf16 v[108:111], v[48:51], a[32:35], v[108:111]
    v_mfma_f32_16x16x32_bf16 v[112:115], v[48:51], a[36:39], v[112:115]
    s_add_u32 m0, s27, 4096
    s_add_u32 s43, s29, 128
    buffer_load_dwordx4 v9, s[20:23], s43 offen lds
    v_mfma_f32_16x16x32_bf16 v[116:119], v[48:51], a[40:43], v[116:119]
    v_mfma_f32_16x16x32_bf16 v[120:123], v[48:51], a[44:47], v[120:123]
    s_waitcnt lgkmcnt(2)
    s_add_u32 m0, s27, 8192
    s_add_u32 s43, s29, 256
    buffer_load_dwordx4 v9, s[20:23], s43 offen lds
    v_mfma_f32_16x16x32_bf16 v[92:95], v[52:55], a[48:51], v[92:95]
    ds_read_b128 v[36:39], v15 offset:8192
    v_mfma_f32_16x16x32_bf16 v[96:99], v[52:55], a[52:55], v[96:99]
    ds_read_b128 v[40:43], v15 offset:10240
    s_add_u32 m0, s27, 12288
    s_add_u32 s43, s29, 384
    buffer_load_dwordx4 v9, s[20:23], s43 offen lds
    v_mfma_f32_16x16x32_bf16 v[100:103], v[52:55], a[56:59], v[100:103]
    v_mfma_f32_16x16x32_bf16 v[104:107], v[52:55], a[60:63], v[104:107]
    s_add_u32 m0, s27, 16384
    s_add_u32 s43, s29, 512
    buffer_load_dwordx4 v9, s[20:23], s43 offen lds
    v_mfma_f32_16x16x32_bf16 v[108:111], v[56:59], a[48:51], v[108:111]
    v_mfma_f32_16x16x32_bf16 v[112:115], v[56:59], a[52:55], v[112:115]
    s_add_u32 m0, s27, 20480
    s_add_u32 s43, s29, 640
    buffer_load_dwordx4 v9, s[20:23], s43 offen lds
    v_mfma_f32_16x16x32_bf16 v[116:119], v[56:59], a[56:59], v[116:119]
    v_mfma_f32_16x16x32_bf16 v[120:123], v[56:59], a[60:63], v[120:123]
    s_waitcnt lgkmcnt(2)
    s_add_u32 m0, s27, 24576
    s_add_u32 s43, s29, 768
    buffer_load_dwordx4 v9, s[20:23], s43 offen lds
    v_mfma_f32_16x16x32_bf16 v[92:95], v[28:31], a[64:67], v[92:95]
    ds_read_b128 v[44:47], v14 offset:12288
    v_mfma_f32_16x16x32_bf16 v[96:99], v[28:31], a[68:71], v[96:99]
    ds_read_b128 v[48:51], v14 offset:14336
    s_add_u32 m0, s27, 28672
    s_add_u32 s43, s29, 896
    buffer_load_dwordx4 v9, s[20:23], s43 offen lds
    v_mfma_f32_16x16x32_bf16 v[100:103], v[28:31], a[72:75], v[100:103]
    v_mfma_f32_16x16x32_bf16 v[104:107], v[28:31], a[76:79], v[104:107]
    s_add_u32 m0, s27, 32768
    s_add_u32 s43, s29, 1024
    buffer_load_dwordx4 v9, s[20:23], s43 offen lds
    v_mfma_f32_16x16x32_bf16 v[108:111], v[32:35], a[64:67], v[108:111]
    v_mfma_f32_16x16x32_bf16 v[112:115], v[32:35], a[68:71], v[112:115]
    s_add_u32 m0, s27, 36864
    s_add_u32 s43, s29, 1152
    buffer_load_dwordx4 v9, s[20:23], s43 offen lds
    v_mfma_f32_16x16x32_bf16 v[116:119], v[32:35], a[72:75], v[116:119]
    v_mfma_f32_16x16x32_bf16 v[120:123], v[32:35], a[76:79], v[120:123]
    s_waitcnt lgkmcnt(2)
    v_mfma_f32_16x16x32_bf16 v[92:95], v[36:39], a[80:83], v[92:95]
    ds_read_b128 v[52:55], v15 offset:12288
    v_mfma_f32_16x16x32_bf16 v[96:99], v[36:39], a[84:87], v[96:99]
    ds_read_b128 v[56:59], v15 offset:14336
    v_mfma_f32_16x16x32_bf16 v[100:103], v[36:39], a[88:91], v[100:103]
    v_mfma_f32_16x16x32_bf16 v[104:107], v[36:39], a[92:95], v[104:107]
    v_mfma_f32_16x16x32_bf16 v[108:111], v[40:43], a[80:83], v[108:111]
    v_mfma_f32_16x16x32_bf16 v[112:115], v[40:43], a[84:87], v[112:115]
    v_mfma_f32_16x16x32_bf16 v[116:119], v[40:43], a[88:91], v[116:119]
    v_mfma_f32_16x16x32_bf16 v[120:123], v[40:43], a[92:95], v[120:123]
    s_waitcnt lgkmcnt(2)
    v_mfma_f32_16x16x32_bf16 v[92:95], v[44:47], a[96:99], v[92:95]
    ds_read_b128 v[28:31], v14 offset:16384
    v_mfma_f32_16x16x32_bf16 v[96:99], v[44:47], a[100:103], v[96:99]
    ds_read_b128 v[32:35], v14 offset:18432
    v_mfma_f32_16x16x32_bf16 v[100:103], v[44:47], a[104:107], v[100:103]
    v_mfma_f32_16x16x32_bf16 v[104:107], v[44:47], a[108:111], v[104:107]
    v_mfma_f32_16x16x32_bf16 v[108:111], v[48:51], a[96:99], v[108:111]
    v_mfma_f32_16x16x32_bf16 v[112:115], v[48:51], a[100:103], v[112:115]
    v_mfma_f32_16x16x32_bf16 v[116:119], v[48:51], a[104:107], v[116:119]
    v_mfma_f32_16x16x32_bf16 v[120:123], v[48:51], a[108:111], v[120:123]
    s_waitcnt lgkmcnt(2)
    v_mfma_f32_16x16x32_bf16 v[92:95], v[52:55], a[112:115], v[92:95]
    ds_read_b128 v[36:39], v15 offset:16384
    v_mfma_f32_16x16x32_bf16 v[96:99], v[52:55], a[116:119], v[96:99]
    ds_read_b128 v[40:43], v15 offset:18432
    v_mfma_f32_16x16x32_bf16 v[100:103], v[52:55], a[120:123], v[100:103]
    v_mfma_f32_16x16x32_bf16 v[104:107], v[52:55], a[124:127], v[104:107]
    v_mfma_f32_16x16x32_bf16 v[108:111], v[56:59], a[112:115], v[108:111]
    v_mfma_f32_16x16x32_bf16 v[112:115], v[56:59], a[116:119], v[112:115]
    v_mfma_f32_16x16x32_bf16 v[116:119], v[56:59], a[120:123], v[116:119]
    v_mfma_f32_16x16x32_bf16 v[120:123], v[56:59], a[124:127], v[120:123]
    s_waitcnt lgkmcnt(2)
    v_mfma_f32_16x16x32_bf16 v[92:95], v[28:31], a[128:131], v[92:95]
    ds_read_b128 v[44:47], v14 offset:20480
    v_mfma_f32_16x16x32_bf16 v[96:99], v[28:31], a[132:135], v[96:99]
    ds_read_b128 v[48:51], v14 offset:22528
    v_mfma_f32_16x16x32_bf16 v[100:103], v[28:31], a[136:139], v[100:103]
    v_mfma_f32_16x16x32_bf16 v[104:107], v[28:31], a[140:143], v[104:107]
    v_mfma_f32_16x16x32_bf16 v[108:111], v[32:35], a[128:131], v[108:111]
    v_mfma_f32_16x16x32_bf16 v[112:115], v[32:35], a[132:135], v[112:115]
    v_mfma_f32_16x16x32_bf16 v[116:119], v[32:35], a[136:139], v[116:119]
    v_mfma_f32_16x16x32_bf16 v[120:123], v[32:35], a[140:143], v[120:123]
    s_waitcnt lgkmcnt(2)
    v_mfma_f32_16x16x32_bf16 v[92:95], v[36:39], a[144:147], v[92:95]
    ds_read_b128 v[52:55], v15 offset:20480
    v_mfma_f32_16x16x32_bf16 v[96:99], v[36:39], a[148:151], v[96:99]
    ds_read_b128 v[56:59], v15 offset:22528
    v_mfma_f32_16x16x32_bf16 v[100:103], v[36:39], a[152:155], v[100:103]
    v_mfma_f32_16x16x32_bf16 v[104:107], v[36:39], a[156:159], v[104:107]
    v_mfma_f32_16x16x32_bf16 v[108:111], v[40:43], a[144:147], v[108:111]
    v_mfma_f32_16x16x32_bf16 v[112:115], v[40:43], a[148:151], v[112:115]
    v_mfma_f32_16x16x32_bf16 v[116:119], v[40:43], a[152:155], v[116:119]
    v_mfma_f32_16x16x32_bf16 v[120:123], v[40:43], a[156:159], v[120:123]
    s_waitcnt lgkmcnt(2)
    v_mfma_f32_16x16x32_bf16 v[92:95], v[44:47], a[160:163], v[92:95]
    ds_read_b128 v[28:31], v14 offset:24576
    v_mfma_f32_16x16x32_bf16 v[96:99], v[44:47], a[164:167], v[96:99]
    ds_read_b128 v[32:35], v14 offset:26624
    v_mfma_f32_16x16x32_bf16 v[100:103], v[44:47], a[168:171], v[100:103]
    v_mfma_f32_16x16x32_bf16 v[104:107], v[44:47], a[172:175], v[104:107]
    v_mfma_f32_16x16x32_bf16 v[108:111], v[48:51], a[160:163], v[108:111]
    v_mfma_f32_16x16x32_bf16 v[112:115], v[48:51], a[164:167], v[112:115]
    v_mfma_f32_16x16x32_bf16 v[116:119], v[48:51], a[168:171], v[116:119]
    v_mfma_f32_16x16x32_bf16 v[120:123], v[48:51], a[172:175], v[120:123]
    s_waitcnt lgkmcnt(2)
    v_mfma_f32_16x16x32_bf16 v[92:95], v[52:55], a[176:179], v[92:95]
    ds_read_b128 v[36:39], v15 offset:24576
    v_mfma_f32_16x16x32_bf16 v[96:99], v[52:55], a[180:183], v[96:99]
    ds_read_b128 v[40:43], v15 offset:26624
    v_mfma_f32_16x16x32_bf16 v[100:103], v[52:55], a[184:187], v[100:103]
    v_mfma_f32_16x16x32_bf16 v[104:107], v[52:55], a[188:191], v[104:107]
    v_mfma_f32_16x16x32_bf16 v[108:111], v[56:59], a[176:179], v[108:111]
    v_mfma_f32_16x16x32_bf16 v[112:115], v[56:59], a[180:183], v[112:115]
    v_mfma_f32_16x16x32_bf16 v[116:119], v[56:59], a[184:187], v[116:119]
    v_mfma_f32_16x16x32_bf16 v[120:123], v[56:59], a[188:191], v[120:123]
    s_waitcnt lgkmcnt(2)
    v_mfma_f32_16x16x32_bf16 v[92:95], v[28:31], a[192:195], v[92:95]
    ds_read_b128 v[44:47], v14 offset:28672
    v_mfma_f32_16x16x32_bf16 v[96:99], v[28:31], a[196:199], v[96:99]
    ds_read_b128 v[48:51], v14 offset:30720
    v_mfma_f32_16x16x32_bf16 v[100:103], v[28:31], a[200:203], v[100:103]
    v_mfma_f32_16x16x32_bf16 v[104:107], v[28:31], a[204:207], v[104:107]
    v_mfma_f32_16x16x32_bf16 v[108:111], v[32:35], a[192:195], v[108:111]
    v_mfma_f32_16x16x32_bf16 v[112:115], v[32:35], a[196:199], v[112:115]
    v_mfma_f32_16x16x32_bf16 v[116:119], v[32:35], a[200:203], v[116:119]
    v_mfma_f32_16x16x32_bf16 v[120:123], v[32:35], a[204:207], v[120:123]
    s_waitcnt lgkmcnt(2)
    v_mfma_f32_16x16x32_bf16 v[92:95], v[36:39], a[208:211], v[92:95]
    ds_read_b128 v[52:55], v15 offset:28672
    v_mfma_f32_16x16x32_bf16 v[96:99], v[36:39], a[212:215], v[96:99]
    ds_read_b128 v[56:59], v15 offset:30720
    v_mfma_f32_16x16x32_bf16 v[100:103], v[36:39], a[216:219], v[100:103]
    v_mfma_f32_16x16x32_bf16 v[104:107], v[36:39], a[220:223], v[104:107]
    v_mfma_f32_16x16x32_bf16 v[108:111], v[40:43], a[208:211], v[108:111]
    v_mfma_f32_16x16x32_bf16 v[112:115], v[40:43], a[212:215], v[112:115]
    v_mfma_f32_16x16x32_bf16 v[116:119], v[40:43], a[216:219], v[116:119]
    v_mfma_f32_16x16x32_bf16 v[120:123], v[40:43], a[220:223], v[120:123]
    s_waitcnt lgkmcnt(2)
    v_mfma_f32_16x16x32_bf16 v[92:95], v[44:47], a[224:227], v[92:95]
    ds_read_b128 v[28:31], v14 offset:32768
    v_mfma_f32_16x16x32_bf16 v[96:99], v[44:47], a[228:231], v[96:99]
    ds_read_b128 v[32:35], v14 offset:34816
    v_mfma_f32_16x16x32_bf16 v[100:103], v[44:47], a[232:235], v[100:103]
    v_mfma_f32_16x16x32_bf16 v[104:107], v[44:47], a[236:239], v[104:107]
    v_mfma_f32_16x16x32_bf16 v[108:111], v[48:51], a[224:227], v[108:111]
    v_mfma_f32_16x16x32_bf16 v[112:115], v[48:51], a[228:231], v[112:115]
    v_mfma_f32_16x16x32_bf16 v[116:119], v[48:51], a[232:235], v[116:119]
    v_mfma_f32_16x16x32_bf16 v[120:123], v[48:51], a[236:239], v[120:123]
    s_waitcnt lgkmcnt(2)
    v_mfma_f32_16x16x32_bf16 v[92:95], v[52:55], a[240:243], v[92:95]
    ds_read_b128 v[36:39], v15 offset:32768
    v_mfma_f32_16x16x32_bf16 v[96:99], v[52:55], a[244:247], v[96:99]
    ds_read_b128 v[40:43], v15 offset:34816
    v_mfma_f32_16x16x32_bf16 v[100:103], v[52:55], a[248:251], v[100:103]
    v_mfma_f32_16x16x32_bf16 v[104:107], v[52:55], a[252:255], v[104:107]
    v_mfma_f32_16x16x32_bf16 v[108:111], v[56:59], a[240:243], v[108:111]
    v_mfma_f32_16x16x32_bf16 v[112:115], v[56:59], a[244:247], v[112:115]
    v_mfma_f32_16x16x32_bf16 v[116:119], v[56:59], a[248:251], v[116:119]
    v_mfma_f32_16x16x32_bf16 v[120:123], v[56:59], a[252:255], v[120:123]
    s_waitcnt lgkmcnt(2)
    v_mfma_f32_16x16x32_bf16 v[92:95], v[28:31], v[124:127], v[92:95]
    ds_read_b128 v[44:47], v14 offset:36864
    v_mfma_f32_16x16x32_bf16 v[96:99], v[28:31], v[128:131], v[96:99]
    ds_read_b128 v[48:51], v14 offset:38912
    v_mfma_f32_16x16x32_bf16 v[100:103], v[28:31], v[132:135], v[100:103]
    v_mfma_f32_16x16x32_bf16 v[104:107], v[28:31], v[136:139], v[104:107]
    v_mfma_f32_16x16x32_bf16 v[108:111], v[32:35], v[124:127], v[108:111]
    v_mfma_f32_16x16x32_bf16 v[112:115], v[32:35], v[128:131], v[112:115]
    v_mfma_f32_16x16x32_bf16 v[116:119], v[32:35], v[132:135], v[116:119]
    v_mfma_f32_16x16x32_bf16 v[120:123], v[32:35], v[136:139], v[120:123]
    s_waitcnt lgkmcnt(2)
    v_mfma_f32_16x16x32_bf16 v[92:95], v[36:39], v[140:143], v[92:95]
    ds_read_b128 v[52:55], v15 offset:36864
    v_mfma_f32_16x16x32_bf16 v[96:99], v[36:39], v[144:147], v[96:99]
    ds_read_b128 v[56:59], v15 offset:38912
    v_mfma_f32_16x16x32_bf16 v[100:103], v[36:39], v[148:151], v[100:103]
    v_mfma_f32_16x16x32_bf16 v[104:107], v[36:39], v[152:155], v[104:107]
    v_mfma_f32_16x16x32_bf16 v[108:111], v[40:43], v[140:143], v[108:111]
    v_mfma_f32_16x16x32_bf16 v[112:115], v[40:43], v[144:147], v[112:115]
    v_mfma_f32_16x16x32_bf16 v[116:119], v[40:43], v[148:151], v[116:119]
    v_mfma_f32_16x16x32_bf16 v[120:123], v[40:43], v[152:155], v[120:123]
    s_waitcnt lgkmcnt(2)
    v_mfma_f32_16x16x32_bf16 v[92:95], v[44:47], v[156:159], v[92:95]
    ds_read_b128 v[28:31], v12 offset:0
    v_mfma_f32_16x16x32_bf16 v[96:99], v[44:47], v[160:163], v[96:99]
    ds_read_b128 v[32:35], v12 offset:2048
    v_mfma_f32_16x16x32_bf16 v[100:103], v[44:47], v[164:167], v[100:103]
    v_mfma_f32_16x16x32_bf16 v[104:107], v[44:47], v[168:171], v[104:107]
    v_mfma_f32_16x16x32_bf16 v[108:111], v[48:51], v[156:159], v[108:111]
    v_mfma_f32_16x16x32_bf16 v[112:115], v[48:51], v[160:163], v[112:115]
    v_mfma_f32_16x16x32_bf16 v[116:119], v[48:51], v[164:167], v[116:119]
    v_mfma_f32_16x16x32_bf16 v[120:123], v[48:51], v[168:171], v[120:123]
    s_waitcnt lgkmcnt(2)
    v_mfma_f32_16x16x32_bf16 v[92:95], v[52:55], v[172:175], v[92:95]
    ds_read_b128 v[36:39], v13 offset:0
    v_mfma_f32_16x16x32_bf16 v[96:99], v[52:55], v[176:179], v[96:99]
    ds_read_b128 v[40:43], v13 offset:2048
    v_mfma_f32_16x16x32_bf16 v[100:103], v[52:55], v[180:183], v[100:103]
    v_mfma_f32_16x16x32_bf16 v[104:107], v[52:55], v[184:187], v[104:107]
    v_mfma_f32_16x16x32_bf16 v[108:111], v[56:59], v[172:175], v[108:111]
    s_add_u32 s50, s62, 0
    s_addc_u32 s51, s63, 0
    s_mul_i32 s40, s65, 2
    s_add_u32 s62, s62, s40
    s_addc_u32 s63, s63, 0
    s_add_u32 s26, s26, 1
    s_mov_b64 s[56:57], -1
    v_mfma_f32_16x16x32_bf16 v[112:115], v[56:59], v[176:179], v[112:115]
    v_mfma_f32_16x16x32_bf16 v[116:119], v[56:59], v[180:183], v[116:119]
    v_mfma_f32_16x16x32_bf16 v[120:123], v[56:59], v[184:187], v[120:123]
    s_cmp_lg_u32 s26, 2
    s_cbranch_scc1 g1_ve
    s_nop 7
    v_cvt_pk_bf16_f32 v92, v92, v93
    v_cvt_pk_bf16_f32 v93, v94, v95
    v_cvt_pk_bf16_f32 v94, v108, v109
    v_cvt_pk_bf16_f32 v95, v110, v111
    global_store_dwordx4 v7, v[92:95], s[50:51] offset:0 sc1
    v_cvt_pk_bf16_f32 v96, v96, v97
    v_cvt_pk_bf16_f32 v97, v98, v99
    v_cvt_pk_bf16_f32 v98, v112, v113
    v_cvt_pk_bf16_f32 v99, v114, v115
    global_store_dwordx4 v7, v[96:99], s[50:51] offset:1024 sc1
    v_cvt_pk_bf16_f32 v100, v100, v101
    v_cvt_pk_bf16_f32 v101, v102, v103
    v_cvt_pk_bf16_f32 v102, v116, v117
    v_cvt_pk_bf16_f32 v103, v118, v119
    global_store_dwordx4 v7, v[100:103], s[50:51] offset:2048 sc1
    v_cvt_pk_bf16_f32 v104, v104, v105
    v_cvt_pk_bf16_f32 v105, v106, v107
    v_cvt_pk_bf16_f32 v106, v120, v121
    v_cvt_pk_bf16_f32 v107, v122, v123
    global_store_dwordx4 v7, v[104:107], s[50:51] offset:3072 sc1
    s_mov_b64 s[56:57], 0
    v_mov_b32 v17, 0
    s_waitcnt vmcnt(0)
    s_barrier
    s_mov_b64 exec, s[48:49]
    global_atomic_add v17, v16, s[98:99] sc1
    s_mov_b64 exec, -1
g1_ve:
    s_cmp_lt_u32 s26, 32
    s_cbranch_scc1 g1_vl
    s_nop 7
    v_cvt_pk_bf16_f32 v92, v92, v93
    v_cvt_pk_bf16_f32 v93, v94, v95
    v_cvt_pk_bf16_f32 v94, v108, v109
    v_cvt_pk_bf16_f32 v95, v110, v111
    global_store_dwordx4 v7, v[92:95], s[50:51] offset:0 sc1
    v_cvt_pk_bf16_f32 v96, v96, v97
    v_cvt_pk_bf16_f32 v97, v98, v99
    v_cvt_pk_bf16_f32 v98, v112, v113
    v_cvt_pk_bf16_f32 v99, v114, v115
    global_store_dwordx4 v7, v[96:99], s[50:51] offset:1024 sc1
    v_cvt_pk_bf16_f32 v100, v100, v101
    v_cvt_pk_bf16_f32 v101, v102, v103
    v_cvt_pk_bf16_f32 v102, v116, v117
    v_cvt_pk_bf16_f32 v103, v118, v119
    global_store_dwordx4 v7, v[100:103], s[50:51] offset:2048 sc1
    v_cvt_pk_bf16_f32 v104, v104, v105
    v_cvt_pk_bf16_f32 v105, v106, v107
    v_cvt_pk_bf16_f32 v106, v120, v121
    v_cvt_pk_bf16_f32 v107, v122, v123
    global_store_dwordx4 v7, v[104:107], s[50:51] offset:3072 sc1
    s_waitcnt vmcnt(0) lgkmcnt(0)
    s_barrier
    s_cmp_ge_i32 s30, 0
    s_cselect_b64 s[46:47], s[48:49], 0
    v_mov_b32 v17, s30
    s_add_u32 s30, s30, 4
    s_mov_b64 exec, s[46:47]
    global_atomic_add v17, v16, s[98:99] sc1
    s_mov_b64 exec, -1
    s_branch g1_end
g1_G:
    v_mul_u32_u24 v7, 3456, v1
    v_lshl_add_u32 v7, v2, 3, v7
    v_add_u32 v8, 55296, v7
    s_mul_i32 s40, s31, 110592
    s_lshl_b32 s41, s4, 6
    s_add_u32 s40, s40, s41
    s_add_u32 s40, s40, 50331648
    s_add_u32 s62, s18, s40
    s_addc_u32 s63, s19, 0
    s_mov_b64 s[50:51], s[62:63]
    s_mov_b32 s65, 110592
    v_mov_b32 v16, 0x10000
    s_mov_b32 s30, -8
g1_gl:
    s_waitcnt lgkmcnt(2)
    v_mfma_f32_16x16x32_bf16 v[60:63], a[0:3], v[28:31], 0
    ds_read_b128 v[44:47], v12 offset:4096
    v_mfma_f32_16x16x32_bf16 v[64:67], a[4:7], v[28:31], 0
    ds_read_b128 v[48:51], v12 offset:6144
    v_mfma_f32_16x16x32_bf16 v[68:71], a[8:11], v[28:31], 0
    v_mfma_f32_16x16x32_bf16 v[72:75], a[12:15], v[28:31], 0
    s_waitcnt vmcnt(14)
    s_barrier
    v_mfma_f32_16x16x32_bf16 v[76:79], a[0:3], v[32:35], 0
    s_cmp_ge_i32 s30, 0
    s_cselect_b64 s[46:47], s[48:49], 0
    v_mov_b32 v17, s30
    s_add_u32 s30, s30, 4
    s_mov_b64 exec, s[46:47]
    global_atomic_add v17, v16, s[98:99] sc1
    s_mov_b64 exec, -1
    v_mfma_f32_16x16x32_bf16 v[80:83], a[4:7], v[32:35], 0
    v_mfma_f32_16x16x32_bf16 v[84:87], a[8:11], v[32:35], 0
    v_add_u32 v14, s28, v10
    v_add_u32 v15, s28, v11
    s_add_u32 s28, s28, 40960
    s_cmp_ge_u32 s28, 163840
    s_cselect_b32 s43, 163840, 0
    s_sub_u32 s28, s28, s43
    v_mfma_f32_16x16x32_bf16 v[88:91], a[12:15], v[32:35], 0
    s_waitcnt lgkmcnt(2)
    s_add_u32 s27, s27, 40960
    s_cmp_ge_u32 s27, 163840
    s_cselect_b32 s43, 163840, 0
    s_sub_u32 s27, s27, s43
    s_add_u32 s40, s26, 3
    s_min_u32 s29, s40, 31
    s_lshl_b32 s29, s29, 1
    s_add_u32 s29, s29, s31
    s_mul_i32 s29, s29, 40960
    v_mfma_f32_16x16x32_bf16 v[60:63], a[16:19], v[36:39], v[60:63]
    ds_read_b128 v[52:55], v13 offset:4096
    s_add_u32 m0, s27, 0
    s_add_u32 s43, s29, 0
    buffer_load_dwordx4 v9, s[20:23], s43 offen lds
    v_mfma_f32_16x16x32_bf16 v[64:67], a[20:23], v[36:39], v[64:67]
    ds_read_b128 v[56:59], v13 offset:6144
    v_mfma_f32_16x16x32_bf16 v[68:71], a[24:27], v[36:39], v[68:71]
    s_add_u32 m0, s27, 4096
    s_add_u32 s43, s29, 128
    buffer_load_dwordx4 v9, s[20:23], s43 offen lds
    v_mfma_f32_16x16x32_bf16 v[72:75], a[28:31], v[36:39], v[72:75]
    v_mfma_f32_16x16x32_bf16 v[76:79], a[16:19], v[40:43], v[76:79]
    s_add_u32 m0, s27, 8192
    s_add_u32 s43, s29, 256
    buffer_load_dwordx4 v9, s[20:23], s43 offen lds
    v_mfma_f32_16x16x32_bf16 v[80:83], a[20:23], v[40:43], v[80:83]
    v_mfma_f32_16x16x32_bf16 v[84:87], a[24:27], v[40:43], v[84:87]
    s_add_u32 m0, s27, 12288
    s_add_u32 s43, s29, 384
    buffer_load_dwordx4 v9, s[20:23], s43 offen lds
    v_mfma_f32_16x16x32_bf16 v[88:91], a[28:31], v[40:43], v[88:91]
    s_waitcnt lgkmcnt(2)
    v_mfma_f32_16x16x32_bf16 v[60:63], a[32:35], v[44:47], v[60:63]
    ds_read_b128 v[28:31], v12 offset:8192
    s_add_u32 m0, s27, 16384
    s_add_u32 s43, s29, 512
    buffer_load_dwordx4 v9, s[20:23], s43 offen lds
    v_mfma_f32_16x16x32_bf16 v[64:67], a[36:39], v[44:47], v[64:67]
    ds_read_b128 v[32:35], v12 offset:10240
    v_mfma_f32_16x16x32_bf16 v[68:71], a[40:43], v[44:47], v[68:71]
    s_add_u32 m0, s27, 20480
    s_add_u32 s43, s29, 640
    buffer_load_dwordx4 v9, s[20:23], s43 offen lds
    v_mfma_f32_16x16x32_bf16 v[72:75], a[44:47], v[44:47], v[72:75]
    v_mfma_f32_16x16x32_bf16 v[76:79], a[32:35], v[48:51], v[76:79]
    s_add_u32 m0, s27, 24576
    s_add_u32 s43, s29, 768
    buffer_load_dwordx4 v9, s[20:23], s43 offen lds
    v_mfma_f32_16x16x32_bf16 v[80:83], a[36:39], v[48:51], v[80:83]
    v_mfma_f32_16x16x32_bf16 v[84:87], a[40:43], v[48:51], v[84:87]
    s_add_u32 m0, s27, 28672
    s_add_u32 s43, s29, 896
    buffer_load_dwordx4 v9, s[20:23], s43 offen lds
    v_mfma_f32_16x16x32_bf16 v[88:91], a[44:47], v[48:51], v[88:91]
    s_waitcnt lgkmcnt(2)
    v_mfma_f32_16x16x32_bf16 v[60:63], a[48:51], v[52:55], v[60:63]
    ds_read_b128 v[36:39], v13 offset:8192
    s_add_u32 m0, s27, 32768
    s_add_u32 s43, s29, 1024
    buffer_load_dwordx4 v9, s[20:23], s43 offen lds
    v_mfma_f32_16x16x32_bf16 v[64:67], a[52:55], v[52:55], v[64:67]
    ds_read_b128 v[40:43], v13 offset:10240
    v_mfma_f32_16x16x32_bf16 v[68:71], a[56:59], v[52:55], v[68:71]
    s_add_u32 m0, s27, 36864
    s_add_u32 s43, s29, 1152
    buffer_load_dwordx4 v9, s[20:23], s43 offen lds
    v_mfma_f32_16x16x32_bf16 v[72:75], a[60:63], v[52:55], v[72:75]
    v_mfma_f32_16x16x32_bf16 v[76:79], a[48:51], v[56:59], v[76:79]
    v_mfma_f32_16x16x32_bf16 v[80:83], a[52:55], v[56:59], v[80:83]
    v_mfma_f32_16x16x32_bf16 v[84:87], a[56:59], v[56:59], v[84:87]
    v_cvt_pk_bf16_f32 v188, v92, v93
    v_cvt_pk_bf16_f32 v189, v94, v95
    v_mfma_f32_16x16x32_bf16 v[88:91], a[60:63], v[56:59], v[88:91]
    s_waitcnt lgkmcnt(2)
    v_cvt_pk_bf16_f32 v190, v96, v97
    v_cvt_pk_bf16_f32 v191, v98, v99
    v_mfma_f32_16x16x32_bf16 v[60:63], a[64:67], v[28:31], v[60:63]
    ds_read_b128 v[44:47], v12 offset:12288
    v_lshlrev_b32 v92, 16, v188
    v_lshlrev_b32 v96, 16, v190
    v_mfma_f32_16x16x32_bf16 v[64:67], a[68:71], v[28:31], v[64:67]
    ds_read_b128 v[48:51], v12 offset:14336
    v_and_b32 v93, 0xffff0000, v188
    v_and_b32 v97, 0xffff0000, v190
    v_mfma_f32_16x16x32_bf16 v[68:71], a[72:75], v[28:31], v[68:71]
    v_lshlrev_b32 v94, 16, v189
    v_lshlrev_b32 v98, 16, v191
    v_mfma_f32_16x16x32_bf16 v[72:75], a[76:79], v[28:31], v[72:75]
    v_and_b32 v95, 0xffff0000, v189
    v_and_b32 v99, 0xffff0000, v191
    v_mfma_f32_16x16x32_bf16 v[76:79], a[64:67], v[32:35], v[76:79]
    v_mul_f32 v192, v92, v92
    v_mul_f32 v193, v93, v93
    v_mfma_f32_16x16x32_bf16 v[80:83], a[68:71], v[32:35], v[80:83]
    v_mul_f32 v194, v94, v94
    v_mul_f32 v195, v95, v95
    v_mfma_f32_16x16x32_bf16 v[84:87], a[72:75], v[32:35], v[84:87]
    v_mul_f32 v192, s55, v192
    v_mul_f32 v193, s55, v193
    v_mfma_f32_16x16x32_bf16 v[88:91], a[76:79], v[32:35], v[88:91]
    s_waitcnt lgkmcnt(2)
    v_mul_f32 v194, s55, v194
    v_mul_f32 v195, s55, v195
    v_mfma_f32_16x16x32_bf16 v[60:63], a[80:83], v[36:39], v[60:63]
    ds_read_b128 v[52:55], v13 offset:12288
    v_fma_f32 v192, v192, v92, v92
    v_fma_f32 v193, v193, v93, v93
    v_mfma_f32_16x16x32_bf16 v[64:67], a[84:87], v[36:39], v[64:67]
    ds_read_b128 v[56:59], v13 offset:14336
    v_fma_f32 v194, v194, v94, v94
    v_fma_f32 v195, v195, v95, v95
    v_mfma_f32_16x16x32_bf16 v[68:71], a[88:91], v[36:39], v[68:71]
    v_mul_f32 v192, s54, v192
    v_mul_f32 v193, s54, v193
    v_mfma_f32_16x16x32_bf16 v[72:75], a[92:95], v[36:39], v[72:75]
    v_mul_f32 v194, s54, v194
    v_mul_f32 v195, s54, v195
    v_mfma_f32_16x16x32_bf16 v[76:79], a[80:83], v[40:43], v[76:79]
    v_exp_f32 v192, v192
    v_exp_f32 v193, v193
    v_mfma_f32_16x16x32_bf16 v[80:83], a[84:87], v[40:43], v[80:83]
    v_exp_f32 v194, v194
    v_exp_f32 v195, v195
    v_mfma_f32_16x16x32_bf16 v[84:87], a[88:91], v[40:43], v[84:87]
    s_nop 0
    v_add_f32 v192, 1.0, v192
    v_mfma_f32_16x16x32_bf16 v[88:91], a[92:95], v[40:43], v[88:91]
    s_waitcnt lgkmcnt(2)
    v_add_f32 v193, 1.0, v193
    v_add_f32 v194, 1.0, v194
    v_mfma_f32_16x16x32_bf16 v[60:63], a[96:99], v[44:47], v[60:63]
    ds_read_b128 v[28:31], v12 offset:16384
    v_add_f32 v195, 1.0, v195
    v_rcp_f32 v192, v192
    v_mfma_f32_16x16x32_bf16 v[64:67], a[100:103], v[44:47], v[64:67]
    ds_read_b128 v[32:35], v12 offset:18432
    v_rcp_f32 v193, v193
    v_rcp_f32 v194, v194
    v_mfma_f32_16x16x32_bf16 v[68:71], a[104:107], v[44:47], v[68:71]
    v_rcp_f32 v195, v195
    s_nop 0
    v_mfma_f32_16x16x32_bf16 v[72:75], a[108:111], v[44:47], v[72:75]
    v_mul_f32 v192, v192, v92
    v_mul_f32 v193, v193, v93
    v_mfma_f32_16x16x32_bf16 v[76:79], a[96:99], v[48:51], v[76:79]
    v_mul_f32 v194, v194, v94
    v_mul_f32 v195, v195, v95
    v_mfma_f32_16x16x32_bf16 v[80:83], a[100:103], v[48:51], v[80:83]
    v_cvt_pk_bf16_f32 v188, v192, v193
    v_cvt_pk_bf16_f32 v189, v194, v195
    v_mfma_f32_16x16x32_bf16 v[84:87], a[104:107], v[48:51], v[84:87]
    v_lshlrev_b32 v192, 16, v188
    v_and_b32 v193, 0xffff0000, v188
    v_mfma_f32_16x16x32_bf16 v[88:91], a[108:111], v[48:51], v[88:91]
    s_waitcnt lgkmcnt(2)
    v_lshlrev_b32 v194, 16, v189
    v_and_b32 v195, 0xffff0000, v189
    v_mfma_f32_16x16x32_bf16 v[60:63], a[112:115], v[52:55], v[60:63]
    ds_read_b128 v[36:39], v13 offset:16384
    v_mul_f32 v192, v192, v96
    v_mul_f32 v193, v193, v97
    v_mfma_f32_16x16x32_bf16 v[64:67], a[116:119], v[52:55], v[64:67]
    ds_read_b128 v[40:43], v13 offset:18432
    v_mul_f32 v194, v194, v98
    v_mul_f32 v195, v195, v99
    v_mfma_f32_16x16x32_bf16 v[68:71], a[120:123], v[52:55], v[68:71]
    v_cvt_pk_bf16_f32 v92, v192, v193
    v_cvt_pk_bf16_f32 v93, v194, v195
    v_mfma_f32_16x16x32_bf16 v[72:75], a[124:127], v[52:55], v[72:75]
    s_mov_b64 exec, s[56:57]
    global_store_dwordx2 v7, v[92:93], s[50:51] offset:0 sc1
    s_mov_b64 exec, -1
    v_cvt_pk_bf16_f32 v188, v100, v101
    v_mfma_f32_16x16x32_bf16 v[76:79], a[112:115], v[56:59], v[76:79]
    v_cvt_pk_bf16_f32 v189, v102, v103
    v_cvt_pk_bf16_f32 v190, v104, v105
    v_mfma_f32_16x16x32_bf16 v[80:83], a[116:119], v[56:59], v[80:83]
    v_cvt_pk_bf16_f32 v191, v106, v107
    v_lshlrev_b32 v100, 16, v188
    v_mfma_f32_16x16x32_bf16 v[84:87], a[120:123], v[56:59], v[84:87]
    v_lshlrev_b32 v104, 16, v190
    v_and_b32 v101, 0xffff0000, v188
    v_mfma_f32_16x16x32_bf16 v[88:91], a[124:127], v[56:59], v[88:91]
    s_waitcnt lgkmcnt(2)
    v_and_b32 v105, 0xffff0000, v190
    v_lshlrev_b32 v102, 16, v189
    v_mfma_f32_16x16x32_bf16 v[60:63], a[128:131], v[28:31], v[60:63]
    ds_read_b128 v[44:47], v12 offset:20480
    v_lshlrev_b32 v106, 16, v191
    v_and_b32 v103, 0xffff0000, v189
    v_mfma_f32_16x16x32_bf16 v[64:67], a[132:135], v[28:31], v[64:67]
    ds_read_b128 v[48:51], v12 offset:22528
    v_and_b32 v107, 0xffff0000, v191
    v_mul_f32 v192, v100, v100
    v_mfma_f32_16x16x32_bf16 v[68:71], a[136:139], v[28:31], v[68:71]
    v_mul_f32 v193, v101, v101
    v_mul_f32 v194, v102, v102
    v_mfma_f32_16x16x32_bf16 v[72:75], a[140:143], v[28:31], v[72:75]
    v_mul_f32 v195, v103, v103
    v_mul_f32 v192, s55, v192
    v_mfma_f32_16x16x32_bf16 v[76:79], a[128:131], v[32:35], v[76:79]
    v_mul_f32 v193, s55, v193
    v_mul_f32 v194, s55, v194
    v_mfma_f32_16x16x32_bf16 v[80:83], a[132:135], v[32:35], v[80:83]
    v_mul_f32 v195, s55, v195
    v_fma_f32 v192, v192, v100, v100
    v_mfma_f32_16x16x32_bf16 v[84:87], a[136:139], v[32:35], v[84:87]
    v_fma_f32 v193, v193, v101, v101
    v_fma_f32 v194, v194, v102, v102
    v_mfma_f32_16x16x32_bf16 v[88:91], a[140:143], v[32:35], v[88:91]
    s_waitcnt lgkmcnt(2)
    v_fma_f32 v195, v195, v103, v103
    v_mul_f32 v192, s54, v192
    v_mfma_f32_16x16x32_bf16 v[60:63], a[144:147], v[36:39], v[60:63]
    ds_read_b128 v[52:55], v13 offset:20480
    v_mul_f32 v193, s54, v193
    v_mul_f32 v194, s54, v194
    v_mfma_f32_16x16x32_bf16 v[64:67], a[148:151], v[36:39], v[64:67]
    ds_read_b128 v[56:59], v13 offset:22528
    v_mul_f32 v195, s54, v195
    v_exp_f32 v192, v192
    v_mfma_f32_16x16x32_bf16 v[68:71], a[152:155], v[36:39], v[68:71]
    v_exp_f32 v193, v193
    v_exp_f32 v194, v194
    v_mfma_f32_16x16x32_bf16 v[72:75], a[156:159], v[36:39], v[72:75]
    v_exp_f32 v195, v195
    s_nop 0
    v_mfma_f32_16x16x32_bf16 v[76:79], a[144:147], v[40:43], v[76:79]
    v_add_f32 v192, 1.0, v192
    v_add_f32 v193, 1.0, v193
    v_mfma_f32_16x16x32_bf16 v[80:83], a[148:151], v[40:43], v[80:83]
    v_add_f32 v194, 1.0, v194
    v_add_f32 v195, 1.0, v195
    v_mfma_f32_16x16x32_bf16 v[84:87], a[152:155], v[40:43], v[84:87]
    v_rcp_f32 v192, v192
    v_rcp_f32 v193, v193
    v_mfma_f32_16x16x32_bf16 v[88:91], a[156:159], v[40:43], v[88:91]
    s_waitcnt lgkmcnt(2)
    v_rcp_f32 v194, v194
    v_rcp_f32 v195, v195
    v_mfma_f32_16x16x32_bf16 v[60:63], a[160:163], v[44:47], v[60:63]
    ds_read_b128 v[28:31], v12 offset:24576
    s_nop 0
    v_mul_f32 v192, v192, v100
    v_mfma_f32_16x16x32_bf16 v[64:67], a[164:167], v[44:47], v[64:67]
    ds_read_b128 v[32:35], v12 offset:26624
    v_mul_f32 v193, v193, v101
    v_mul_f32 v194, v194, v102
    v_mfma_f32_16x16x32_bf16 v[68:71], a[168:171], v[44:47], v[68:71]
    v_mul_f32 v195, v195, v103
    v_cvt_pk_bf16_f32 v188, v192, v193
    v_mfma_f32_16x16x32_bf16 v[72:75], a[172:175], v[44:47], v[72:75]
    v_cvt_pk_bf16_f32 v189, v194, v195
    v_lshlrev_b32 v192, 16, v188
    v_mfma_f32_16x16x32_bf16 v[76:79], a[160:163], v[48:51], v[76:79]
    v_and_b32 v193, 0xffff0000, v188
    v_lshlrev_b32 v194, 16, v189
    v_mfma_f32_16x16x32_bf16 v[80:83], a[164:167], v[48:51], v[80:83]
    v_and_b32 v195, 0xffff0000, v189
    v_mul_f32 v192, v192, v104
    v_mfma_f32_16x16x32_bf16 v[84:87], a[168:171], v[48:51], v[84:87]
    v_mul_f32 v193, v193, v105
    v_mul_f32 v194, v194, v106
    v_mfma_f32_16x16x32_bf16 v[88:91], a[172:175], v[48:51], v[88:91]
    s_waitcnt lgkmcnt(2)
    v_mul_f32 v195, v195, v107
    v_cvt_pk_bf16_f32 v100, v192, v193
    v_mfma_f32_16x16x32_bf16 v[60:63], a[176:179], v[52:55], v[60:63]
    ds_read_b128 v[36:39], v13 offset:24576
    v_cvt_pk_bf16_f32 v101, v194, v195
    s_mov_b64 exec, s[56:57]
    global_store_dwordx2 v7, v[100:101], s[50:51] offset:32 sc1
    s_mov_b64 exec, -1
    v_mfma_f32_16x16x32_bf16 v[64:67], a[180:183], v[52:55], v[64:67]
    ds_read_b128 v[40:43], v13 offset:26624
    v_cvt_pk_bf16_f32 v188, v108, v109
    v_cvt_pk_bf16_f32 v189, v110, v111
    v_mfma_f32_16x16x32_bf16 v[68:71], a[184:187], v[52:55], v[68:71]
    v_cvt_pk_bf16_f32 v190, v112, v113
    v_cvt_pk_bf16_f32 v191, v114, v115
    v_mfma_f32_16x16x32_bf16 v[72:75], a[188:191], v[52:55], v[72:75]
    v_lshlrev_b32 v108, 16, v188
    v_lshlrev_b32 v112, 16, v190
    v_mfma_f32_16x16x32_bf16 v[76:79], a[176:179], v[56:59], v[76:79]
    v_and_b32 v109, 0xffff0000, v188
    v_and_b32 v113, 0xffff0000, v190
    v_mfma_f32_16x16x32_bf16 v[80:83], a[180:183], v[56:59], v[80:83]
    v_lshlrev_b32 v110, 16, v189
    v_lshlrev_b32 v114, 16, v191
    v_mfma_f32_16x16x32_bf16 v[84:87], a[184:187], v[56:59], v[84:87]
    v_and_b32 v111, 0xffff0000, v189
    v_and_b32 v115, 0xffff0000, v191
    v_mfma_f32_16x16x32_bf16 v[88:91], a[188:191], v[56:59], v[88:91]
    s_waitcnt lgkmcnt(2)
    v_mul_f32 v192, v108, v108
    v_mul_f32 v193, v109, v109
    v_mfma_f32_16x16x32_bf16 v[60:63], a[192:195], v[28:31], v[60:63]
    ds_read_b128 v[44:47], v12 offset:28672
    v_mul_f32 v194, v110, v110
    v_mul_f32 v195, v111, v111
    v_mfma_f32_16x16x32_bf16 v[64:67], a[196:199], v[28:31], v[64:67]
    ds_read_b128 v[48:51], v12 offset:30720
    v_mul_f32 v192, s55, v192
    v_mul_f32 v193, s55, v193
    v_mfma_f32_16x16x32_bf16 v[68:71], a[200:203], v[28:31], v[68:71]
    v_mul_f32 v194, s55, v194
    v_mul_f32 v195, s55, v195
    v_mfma_f32_16x16x32_bf16 v[72:75], a[204:207], v[28:31], v[72:75]
    v_fma_f32 v192, v192, v108, v108
    v_fma_f32 v193, v193, v109, v109
    v_mfma_f32_16x16x32_bf16 v[76:79], a[192:195], v[32:35], v[76:79]
    v_fma_f32 v194, v194, v110, v110
    v_fma_f32 v195, v195, v111, v111
    v_mfma_f32_16x16x32_bf16 v[80:83], a[196:199], v[32:35], v[80:83]
    v_mul_f32 v192, s54, v192
    v_mul_f32 v193, s54, v193
    v_mfma_f32_16x16x32_bf16 v[84:87], a[200:203], v[32:35], v[84:87]
    v_mul_f32 v194, s54, v194
    v_mul_f32 v195, s54, v195
    v_mfma_f32_16x16x32_bf16 v[88:91], a[204:207], v[32:35], v[88:91]
    s_waitcnt lgkmcnt(2)
    v_exp_f32 v192, v192
    v_exp_f32 v193, v193
    v_mfma_f32_16x16x32_bf16 v[60:63], a[208:211], v[36:39], v[60:63]
    ds_read_b128 v[52:55], v13 offset:28672
    v_exp_f32 v194, v194
    v_exp_f32 v195, v195
    v_mfma_f32_16x16x32_bf16 v[64:67], a[212:215], v[36:39], v[64:67]
    ds_read_b128 v[56:59], v13 offset:30720
    s_nop 0
    v_add_f32 v192, 1.0, v192
    v_mfma_f32_16x16x32_bf16 v[68:71], a[216:219], v[36:39], v[68:71]
    v_add_f32 v193, 1.0, v193
    v_add_f32 v194, 1.0, v194
    v_mfma_f32_16x16x32_bf16 v[72:75], a[220:223], v[36:39], v[72:75]
    v_add_f32 v195, 1.0, v195
    v_rcp_f32 v192, v192
    v_mfma_f32_16x16x32_bf16 v[76:79], a[208:211], v[40:43], v[76:79]
    v_rcp_f32 v193, v193
    v_rcp_f32 v194, v194
    v_mfma_f32_16x16x32_bf16 v[80:83], a[212:215], v[40:43], v[80:83]
    v_rcp_f32 v195, v195
    s_nop 0
    v_mfma_f32_16x16x32_bf16 v[84:87], a[216:219], v[40:43], v[84:87]
    v_mul_f32 v192, v192, v108
    v_mul_f32 v193, v193, v109
    v_mfma_f32_16x16x32_bf16 v[88:91], a[220:223], v[40:43], v[88:91]
    s_waitcnt lgkmcnt(2)
    v_mul_f32 v194, v194, v110
    v_mul_f32 v195, v195, v111
    v_mfma_f32_16x16x32_bf16 v[60:63], a[224:227], v[44:47], v[60:63]
    ds_read_b128 v[28:31], v12 offset:32768
    v_cvt_pk_bf16_f32 v188, v192, v193
    v_cvt_pk_bf16_f32 v189, v194, v195
    v_mfma_f32_16x16x32_bf16 v[64:67], a[228:231], v[44:47], v[64:67]
    ds_read_b128 v[32:35], v12 offset:34816
    v_lshlrev_b32 v192, 16, v188
    v_and_b32 v193, 0xffff0000, v188
    v_mfma_f32_16x16x32_bf16 v[68:71], a[232:235], v[44:47], v[68:71]
    v_lshlrev_b32 v194, 16, v189
    v_and_b32 v195, 0xffff0000, v189
    v_mfma_f32_16x16x32_bf16 v[72:75], a[236:239], v[44:47], v[72:75]
    v_mul_f32 v192, v192, v112
    v_mul_f32 v193, v193, v113
    v_mfma_f32_16x16x32_bf16 v[76:79], a[224:227], v[48:51], v[76:79]
    v_mul_f32 v194, v194, v114
    v_mul_f32 v195, v195, v115
    v_mfma_f32_16x16x32_bf16 v[80:83], a[228:231], v[48:51], v[80:83]
    v_cvt_pk_bf16_f32 v108, v192, v193
    v_cvt_pk_bf16_f32 v109, v194, v195
    v_mfma_f32_16x16x32_bf16 v[84:87], a[232:235], v[48:51], v[84:87]
    s_mov_b64 exec, s[56:57]
    global_store_dwordx2 v8, v[108:109], s[50:51] offset:0 sc1
    s_mov_b64 exec, -1
    v_cvt_pk_bf16_f32 v188, v116, v117
    v_mfma_f32_16x16x32_bf16 v[88:91], a[236:239], v[48:51], v[88:91]
    s_waitcnt lgkmcnt(2)
    v_cvt_pk_bf16_f32 v189, v118, v119
    v_cvt_pk_bf16_f32 v190, v120, v121
    v_mfma_f32_16x16x32_bf16 v[60:63], a[240:243], v[52:55], v[60:63]
    ds_read_b128 v[36:39], v13 offset:32768
    v_cvt_pk_bf16_f32 v191, v122, v123
    v_lshlrev_b32 v116, 16, v188
    v_mfma_f32_16x16x32_bf16 v[64:67], a[244:247], v[52:55], v[64:67]
    ds_read_b128 v[40:43], v13 offset:34816
    v_lshlrev_b32 v120, 16, v190
    v_and_b32 v117, 0xffff0000, v188
    v_mfma_f32_16x16x32_bf16 v[68:71], a[248:251], v[52:55], v[68:71]
    v_and_b32 v121, 0xffff0000, v190
    v_lshlrev_b32 v118, 16, v189
    v_mfma_f32_16x16x32_bf16 v[72:75], a[252:255], v[52:55], v[72:75]
    v_lshlrev_b32 v122, 16, v191
    v_and_b32 v119, 0xffff0000, v189
    v_mfma_f32_16x16x32_bf16 v[76:79], a[240:243], v[56:59], v[76:79]
    v_and_b32 v123, 0xffff0000, v191
    v_mul_f32 v192, v116, v116
    v_mfma_f32_16x16x32_bf16 v[80:83], a[244:247], v[56:59], v[80:83]
    v_mul_f32 v193, v117, v117
    v_mul_f32 v194, v118, v118
    v_mfma_f32_16x16x32_bf16 v[84:87], a[248:251], v[56:59], v[84:87]
    v_mul_f32 v195, v119, v119
    v_mul_f32 v192, s55, v192
    v_mfma_f32_16x16x32_bf16 v[88:91], a[252:255], v[56:59], v[88:91]
    s_waitcnt lgkmcnt(2)
    v_mul_f32 v193, s55, v193
    v_mul_f32 v194, s55, v194
    v_mfma_f32_16x16x32_bf16 v[60:63], v[124:127], v[28:31], v[60:63]
    ds_read_b128 v[44:47], v12 offset:36864
    v_mul_f32 v195, s55, v195
    v_fma_f32 v192, v192, v116, v116
    v_mfma_f32_16x16x32_bf16 v[64:67], v[128:131], v[28:31], v[64:67]
    ds_read_b128 v[48:51], v12 offset:38912
    v_fma_f32 v193, v193, v117, v117
    v_fma_f32 v194, v194, v118, v118
    v_mfma_f32_16x16x32_bf16 v[68:71], v[132:135], v[28:31], v[68:71]
    v_fma_f32 v195, v195, v119, v119
    v_mul_f32 v192, s54, v192
    v_mfma_f32_16x16x32_bf16 v[72:75], v[136:139], v[28:31], v[72:75]
    v_mul_f32 v193, s54, v193
    v_mul_f32 v194, s54, v194
    v_mfma_f32_16x16x32_bf16 v[76:79], v[124:127], v[32:35], v[76:79]
    v_mul_f32 v195, s54, v195
    v_exp_f32 v192, v192
    v_mfma_f32_16x16x32_bf16 v[80:83], v[128:131], v[32:35], v[80:83]
    v_exp_f32 v193, v193
    v_exp_f32 v194, v194
    v_mfma_f32_16x16x32_bf16 v[84:87], v[132:135], v[32:35], v[84:87]
    v_exp_f32 v195, v195
    s_nop 0
    v_mfma_f32_16x16x32_bf16 v[88:91], v[136:139], v[32:35], v[88:91]
    s_waitcnt lgkmcnt(2)
    v_add_f32 v192, 1.0, v192
    v_add_f32 v193, 1.0, v193
    v_mfma_f32_16x16x32_bf16 v[60:63], v[140:143], v[36:39], v[60:63]
    ds_read_b128 v[52:55], v13 offset:36864
    v_add_f32 v194, 1.0, v194
    v_add_f32 v195, 1.0, v195
    v_mfma_f32_16x16x32_bf16 v[64:67], v[144:147], v[36:39], v[64:67]
    ds_read_b128 v[56:59], v13 offset:38912
    v_rcp_f32 v192, v192
    v_rcp_f32 v193, v193
    v_mfma_f32_16x16x32_bf16 v[68:71], v[148:151], v[36:39], v[68:71]
    v_rcp_f32 v194, v194
    v_rcp_f32 v195, v195
    v_mfma_f32_16x16x32_bf16 v[72:75], v[152:155], v[36:39], v[72:75]
    s_nop 0
    v_mul_f32 v192, v192, v116
    v_mfma_f32_16x16x32_bf16 v[76:79], v[140:143], v[40:43], v[76:79]
    v_mul_f32 v193, v193, v117
    v_mul_f32 v194, v194, v118
    v_mfma_f32_16x16x32_bf16 v[80:83], v[144:147], v[40:43], v[80:83]
    v_mul_f32 v195, v195, v119
    v_cvt_pk_bf16_f32 v188, v192, v193
    v_mfma_f32_16x16x32_bf16 v[84:87], v[148:151], v[40:43], v[84:87]
    v_cvt_pk_bf16_f32 v189, v194, v195
    v_lshlrev_b32 v192, 16, v188
    v_mfma_f32_16x16x32_bf16 v[88:91], v[152:155], v[40:43], v[88:91]
    s_waitcnt lgkmcnt(2)
    v_and_b32 v193, 0xffff0000, v188
    v_lshlrev_b32 v194, 16, v189
    v_mfma_f32_16x16x32_bf16 v[60:63], v[156:159], v[44:47], v[60:63]
    ds_read_b128 v[28:31], v14 offset:0
    v_and_b32 v195, 0xffff0000, v189
    v_mul_f32 v192, v192, v120
    v_mfma_f32_16x16x32_bf16 v[64:67], v[160:163], v[44:47], v[64:67]
    ds_read_b128 v[32:35], v14 offset:2048
    v_mul_f32 v193, v193, v121
    v_mul_f32 v194, v194, v122
    v_mfma_f32_16x16x32_bf16 v[68:71], v[164:167], v[44:47], v[68:71]
    v_mul_f32 v195, v195, v123
    v_cvt_pk_bf16_f32 v116, v192, v193
    v_mfma_f32_16x16x32_bf16 v[72:75], v[168:171], v[44:47], v[72:75]
    v_cvt_pk_bf16_f32 v117, v194, v195
    s_mov_b64 exec, s[56:57]
    global_store_dwordx2 v8, v[116:117], s[50:51] offset:32 sc1
    s_mov_b64 exec, -1
    v_mfma_f32_16x16x32_bf16 v[76:79], v[156:159], v[48:51], v[76:79]
    v_mfma_f32_16x16x32_bf16 v[80:83], v[160:163], v[48:51], v[80:83]
    v_mfma_f32_16x16x32_bf16 v[84:87], v[164:167], v[48:51], v[84:87]
    v_mfma_f32_16x16x32_bf16 v[88:91], v[168:171], v[48:51], v[88:91]
    s_waitcnt lgkmcnt(2)
    v_mfma_f32_16x16x32_bf16 v[60:63], v[172:175], v[52:55], v[60:63]
    ds_read_b128 v[36:39], v15 offset:0
    v_mfma_f32_16x16x32_bf16 v[64:67], v[176:179], v[52:55], v[64:67]
    ds_read_b128 v[40:43], v15 offset:2048
    v_mfma_f32_16x16x32_bf16 v[68:71], v[180:183], v[52:55], v[68:71]
    v_mfma_f32_16x16x32_bf16 v[72:75], v[184:187], v[52:55], v[72:75]
    v_mfma_f32_16x16x32_bf16 v[76:79], v[172:175], v[56:59], v[76:79]
    s_add_u32 s50, s62, 0
    s_addc_u32 s51, s63, 0
    s_mul_i32 s40, s65, 2
    s_add_u32 s62, s62, s40
    s_addc_u32 s63, s63, 0
    s_add_u32 s26, s26, 1
    s_mov_b64 s[56:57], -1
    v_mfma_f32_16x16x32_bf16 v[80:83], v[176:179], v[56:59], v[80:83]
    v_mfma_f32_16x16x32_bf16 v[84:87], v[180:183], v[56:59], v[84:87]
    v_mfma_f32_16x16x32_bf16 v[88:91], v[184:187], v[56:59], v[88:91]
g1_gm:
    s_waitcnt lgkmcnt(2)
    v_mfma_f32_16x16x32_bf16 v[92:95], a[0:3], v[28:31], 0
    ds_read_b128 v[44:47], v14 offset:4096
    v_mfma_f32_16x16x32_bf16 v[96:99], a[4:7], v[28:31], 0
    ds_read_b128 v[48:51], v14 offset:6144
    v_mfma_f32_16x16x32_bf16 v[100:103], a[8:11], v[28:31], 0
    v_mfma_f32_16x16x32_bf16 v[104:107], a[12:15], v[28:31], 0
    s_waitcnt vmcnt(14)
    s_barrier
    v_mfma_f32_16x16x32_bf16 v[108:111], a[0:3], v[32:35], 0
    v_mfma_f32_16x16x32_bf16 v[112:115], a[4:7], v[32:35], 0
    s_mov_b64 exec, s[60:61]
    global_atomic_add v18, v19, s[98:99] sc1
    s_mov_b64 exec, -1
    s_mov_b64 s[60:61], 0
    v_mfma_f32_16x16x32_bf16 v[116:119], a[8:11], v[32:35], 0
    v_add_u32 v12, s28, v10
    v_add_u32 v13, s28, v11
    s_add_u32 s28, s28, 40960
    s_cmp_ge_u32 s28, 163840
    s_cselect_b32 s43, 163840, 0
    s_sub_u32 s28, s28, s43
    v_mfma_f32_16x16x32_bf16 v[120:123], a[12:15], v[32:35], 0
    s_waitcnt lgkmcnt(2)
    s_add_u32 s27, s27, 40960
    s_cmp_ge_u32 s27, 163840
    s_cselect_b32 s43, 163840, 0
    s_sub_u32 s27, s27, s43
    s_add_u32 s40, s26, 3
    s_min_u32 s29, s40, 31
    s_lshl_b32 s29, s29, 1
    s_add_u32 s29, s29, s31
    s_mul_i32 s29, s29, 40960
    v_mfma_f32_16x16x32_bf16 v[92:95], a[16:19], v[36:39], v[92:95]
    ds_read_b128 v[52:55], v15 offset:4096
    s_add_u32 m0, s27, 0
    s_add_u32 s43, s29, 0
    buffer_load_dwordx4 v9, s[20:23], s43 offen lds
    v_mfma_f32_16x16x32_bf16 v[96:99], a[20:23], v[36:39], v[96:99]
    ds_read_b128 v[56:59], v15 offset:6144
    v_mfma_f32_16x16x32_bf16 v[100:103], a[24:27], v[36:39], v[100:103]
    s_add_u32 m0, s27, 4096
    s_add_u32 s43, s29, 128
    buffer_load_dwordx4 v9, s[20:23], s43 offen lds
    v_mfma_f32_16x16x32_bf16 v[104:107], a[28:31], v[36:39], v[104:107]
    v_mfma_f32_16x16x32_bf16 v[108:111], a[16:19], v[40:43], v[108:111]
    s_add_u32 m0, s27, 8192
    s_add_u32 s43, s29, 256
    buffer_load_dwordx4 v9, s[20:23], s43 offen lds
    v_mfma_f32_16x16x32_bf16 v[112:115], a[20:23], v[40:43], v[112:115]
    v_mfma_f32_16x16x32_bf16 v[116:119], a[24:27], v[40:43], v[116:119]
    s_add_u32 m0, s27, 12288
    s_add_u32 s43, s29, 384
    buffer_load_dwordx4 v9, s[20:23], s43 offen lds
    v_mfma_f32_16x16x32_bf16 v[120:123], a[28:31], v[40:43], v[120:123]
    s_waitcnt lgkmcnt(2)
    v_mfma_f32_16x16x32_bf16 v[92:95], a[32:35], v[44:47], v[92:95]
    ds_read_b128 v[28:31], v14 offset:8192
    s_add_u32 m0, s27, 16384
    s_add_u32 s43, s29, 512
    buffer_load_dwordx4 v9, s[20:23], s43 offen lds
    v_mfma_f32_16x16x32_bf16 v[96:99], a[36:39], v[44:47], v[96:99]
    ds_read_b128 v[32:35], v14 offset:10240
    v_mfma_f32_16x16x32_bf16 v[100:103], a[40:43], v[44:47], v[100:103]
    s_add_u32 m0, s27, 20480
    s_add_u32 s43, s29, 640
    buffer_load_dwordx4 v9, s[20:23], s43 offen lds
    v_mfma_f32_16x16x32_bf16 v[104:107], a[44:47], v[44:47], v[104:107]
    v_mfma_f32_16x16x32_bf16 v[108:111], a[32:35], v[48:51], v[108:111]
    s_add_u32 m0, s27, 24576
    s_add_u32 s43, s29, 768
    buffer_load_dwordx4 v9, s[20:23], s43 offen lds
    v_mfma_f32_16x16x32_bf16 v[112:115], a[36:39], v[48:51], v[112:115]
    v_mfma_f32_16x16x32_bf16 v[116:119], a[40:43], v[48:51], v[116:119]
    s_add_u32 m0, s27, 28672
    s_add_u32 s43, s29, 896
    buffer_load_dwordx4 v9, s[20:23], s43 offen lds
    v_mfma_f32_16x16x32_bf16 v[120:123], a[44:47], v[48:51], v[120:123]
    s_waitcnt lgkmcnt(2)
    v_mfma_f32_16x16x32_bf16 v[92:95], a[48:51], v[52:55], v[92:95]
    ds_read_b128 v[36:39], v15 offset:8192
    s_add_u32 m0, s27, 32768
    s_add_u32 s43, s29, 1024
    buffer_load_dwordx4 v9, s[20:23], s43 offen lds
    v_mfma_f32_16x16x32_bf16 v[96:99], a[52:55], v[52:55], v[96:99]
    ds_read_b128 v[40:43], v15 offset:10240
    v_mfma_f32_16x16x32_bf16 v[100:103], a[56:59], v[52:55], v[100:103]
    s_add_u32 m0, s27, 36864
    s_add_u32 s43, s29, 1152
    buffer_load_dwordx4 v9, s[20:23], s43 offen lds
    v_mfma_f32_16x16x32_bf16 v[104:107], a[60:63], v[52:55], v[104:107]
    v_mfma_f32_16x16x32_bf16 v[108:111], a[48:51], v[56:59], v[108:111]
    v_mfma_f32_16x16x32_bf16 v[112:115], a[52:55], v[56:59], v[112:115]
    v_mfma_f32_16x16x32_bf16 v[116:119], a[56:59], v[56:59], v[116:119]
    v_cvt_pk_bf16_f32 v188, v60, v61
    v_cvt_pk_bf16_f32 v189, v62, v63
    v_mfma_f32_16x16x32_bf16 v[120:123], a[60:63], v[56:59], v[120:123]
    s_waitcnt lgkmcnt(2)
    v_cvt_pk_bf16_f32 v190, v64, v65
    v_cvt_pk_bf16_f32 v191, v66, v67
    v_mfma_f32_16x16x32_bf16 v[92:95], a[64:67], v[28:31], v[92:95]
    ds_read_b128 v[44:47], v14 offset:12288
    v_lshlrev_b32 v60, 16, v188
    v_lshlrev_b32 v64, 16, v190
    v_mfma_f32_16x16x32_bf16 v[96:99], a[68:71], v[28:31], v[96:99]
    ds_read_b128 v[48:51], v14 offset:14336
    v_and_b32 v61, 0xffff0000, v188
    v_and_b32 v65, 0xffff0000, v190
    v_mfma_f32_16x16x32_bf16 v[100:103], a[72:75], v[28:31], v[100:103]
    v_lshlrev_b32 v62, 16, v189
    v_lshlrev_b32 v66, 16, v191
    v_mfma_f32_16x16x32_bf16 v[104:107], a[76:79], v[28:31], v[104:107]
    v_and_b32 v63, 0xffff0000, v189
    v_and_b32 v67, 0xffff0000, v191
    v_mfma_f32_16x16x32_bf16 v[108:111], a[64:67], v[32:35], v[108:111]
    v_mul_f32 v192, v60, v60
    v_mul_f32 v193, v61, v61
    v_mfma_f32_16x16x32_bf16 v[112:115], a[68:71], v[32:35], v[112:115]
    v_mul_f32 v194, v62, v62
    v_mul_f32 v195, v63, v63
    v_mfma_f32_16x16x32_bf16 v[116:119], a[72:75], v[32:35], v[116:119]
    v_mul_f32 v192, s55, v192
    v_mul_f32 v193, s55, v193
    v_mfma_f32_16x16x32_bf16 v[120:123], a[76:79], v[32:35], v[120:123]
    s_waitcnt lgkmcnt(2)
    v_mul_f32 v194, s55, v194
    v_mul_f32 v195, s55, v195
    v_mfma_f32_16x16x32_bf16 v[92:95], a[80:83], v[36:39], v[92:95]
    ds_read_b128 v[52:55], v15 offset:12288
    v_fma_f32 v192, v192, v60, v60
    v_fma_f32 v193, v193, v61, v61
    v_mfma_f32_16x16x32_bf16 v[96:99], a[84:87], v[36:39], v[96:99]
    ds_read_b128 v[56:59], v15 offset:14336
    v_fma_f32 v194, v194, v62, v62
    v_fma_f32 v195, v195, v63, v63
    v_mfma_f32_16x16x32_bf16 v[100:103], a[88:91], v[36:39], v[100:103]
    v_mul_f32 v192, s54, v192
    v_mul_f32 v193, s54, v193
    v_mfma_f32_16x16x32_bf16 v[104:107], a[92:95], v[36:39], v[104:107]
    v_mul_f32 v194, s54, v194
    v_mul_f32 v195, s54, v195
    v_mfma_f32_16x16x32_bf16 v[108:111], a[80:83], v[40:43], v[108:111]
    v_exp_f32 v192, v192
    v_exp_f32 v193, v193
    v_mfma_f32_16x16x32_bf16 v[112:115], a[84:87], v[40:43], v[112:115]
    v_exp_f32 v194, v194
    v_exp_f32 v195, v195
    v_mfma_f32_16x16x32_bf16 v[116:119], a[88:91], v[40:43], v[116:119]
    s_nop 0
    v_add_f32 v192, 1.0, v192
    v_mfma_f32_16x16x32_bf16 v[120:123], a[92:95], v[40:43], v[120:123]
    s_waitcnt lgkmcnt(2)
    v_add_f32 v193, 1.0, v193
    v_add_f32 v194, 1.0, v194
    v_mfma_f32_16x16x32_bf16 v[92:95], a[96:99], v[44:47], v[92:95]
    ds_read_b128 v[28:31], v14 offset:16384
    v_add_f32 v195, 1.0, v195
    v_rcp_f32 v192, v192
    v_mfma_f32_16x16x32_bf16 v[96:99], a[100:103], v[44:47], v[96:99]
    ds_read_b128 v[32:35], v14 offset:18432
    v_rcp_f32 v193, v193
    v_rcp_f32 v194, v194
    v_mfma_f32_16x16x32_bf16 v[100:103], a[104:107], v[44:47], v[100:103]
    v_rcp_f32 v195, v195
    s_nop 0
    v_mfma_f32_16x16x32_bf16 v[104:107], a[108:111], v[44:47], v[104:107]
    v_mul_f32 v192, v192, v60
    v_mul_f32 v193, v193, v61
    v_mfma_f32_16x16x32_bf16 v[108:111], a[96:99], v[48:51], v[108:111]
    v_mul_f32 v194, v194, v62
    v_mul_f32 v195, v195, v63
    v_mfma_f32_16x16x32_bf16 v[112:115], a[100:103], v[48:51], v[112:115]
    v_cvt_pk_bf16_f32 v188, v192, v193
    v_cvt_pk_bf16_f32 v189, v194, v195
    v_mfma_f32_16x16x32_bf16 v[116:119], a[104:107], v[48:51], v[116:119]
    v_lshlrev_b32 v192, 16, v188
    v_and_b32 v193, 0xffff0000, v188
    v_mfma_f32_16x16x32_bf16 v[120:123], a[108:111], v[48:51], v[120:123]
    s_waitcnt lgkmcnt(2)
    v_lshlrev_b32 v194, 16, v189
    v_and_b32 v195, 0xffff0000, v189
    v_mfma_f32_16x16x32_bf16 v[92:95], a[112:115], v[52:55], v[92:95]
    ds_read_b128 v[36:39], v15 offset:16384
    v_mul_f32 v192, v192, v64
    v_mul_f32 v193, v193, v65
    v_mfma_f32_16x16x32_bf16 v[96:99], a[116:119], v[52:55], v[96:99]
    ds_read_b128 v[40:43], v15 offset:18432
    v_mul_f32 v194, v194, v66
    v_mul_f32 v195, v195, v67
    v_mfma_f32_16x16x32_bf16 v[100:103], a[120:123], v[52:55], v[100:103]
    v_cvt_pk_bf16_f32 v60, v192, v193
    v_cvt_pk_bf16_f32 v61, v194, v195
    v_mfma_f32_16x16x32_bf16 v[104:107], a[124:127], v[52:55], v[104:107]
    global_store_dwordx2 v7, v[60:61], s[50:51] offset:0 sc1
    v_cvt_pk_bf16_f32 v188, v68, v69
    v_mfma_f32_16x16x32_bf16 v[108:111], a[112:115], v[56:59], v[108:111]
    v_cvt_pk_bf16_f32 v189, v70, v71
    v_cvt_pk_bf16_f32 v190, v72, v73
    v_mfma_f32_16x16x32_bf16 v[112:115], a[116:119], v[56:59], v[112:115]
    v_cvt_pk_bf16_f32 v191, v74, v75
    v_lshlrev_b32 v68, 16, v188
    v_mfma_f32_16x16x32_bf16 v[116:119], a[120:123], v[56:59], v[116:119]
    v_lshlrev_b32 v72, 16, v190
    v_and_b32 v69, 0xffff0000, v188
    v_mfma_f32_16x16x32_bf16 v[120:123], a[124:127], v[56:59], v[120:123]
    s_waitcnt lgkmcnt(2)
    v_and_b32 v73, 0xffff0000, v190
    v_lshlrev_b32 v70, 16, v189
    v_mfma_f32_16x16x32_bf16 v[92:95], a[128:131], v[28:31], v[92:95]
    ds_read_b128 v[44:47], v14 offset:20480
    v_lshlrev_b32 v74, 16, v191
    v_and_b32 v71, 0xffff0000, v189
    v_mfma_f32_16x16x32_bf16 v[96:99], a[132:135], v[28:31], v[96:99]
    ds_read_b128 v[48:51], v14 offset:22528
    v_and_b32 v75, 0xffff0000, v191
    v_mul_f32 v192, v68, v68
    v_mfma_f32_16x16x32_bf16 v[100:103], a[136:139], v[28:31], v[100:103]
    v_mul_f32 v193, v69, v69
    v_mul_f32 v194, v70, v70
    v_mfma_f32_16x16x32_bf16 v[104:107], a[140:143], v[28:31], v[104:107]
    v_mul_f32 v195, v71, v71
    v_mul_f32 v192, s55, v192
    v_mfma_f32_16x16x32_bf16 v[108:111], a[128:131], v[32:35], v[108:111]
    v_mul_f32 v193, s55, v193
    v_mul_f32 v194, s55, v194
    v_mfma_f32_16x16x32_bf16 v[112:115], a[132:135], v[32:35], v[112:115]
    v_mul_f32 v195, s55, v195
    v_fma_f32 v192, v192, v68, v68
    v_mfma_f32_16x16x32_bf16 v[116:119], a[136:139], v[32:35], v[116:119]
    v_fma_f32 v193, v193, v69, v69
    v_fma_f32 v194, v194, v70, v70
    v_mfma_f32_16x16x32_bf16 v[120:123], a[140:143], v[32:35], v[120:123]
    s_waitcnt lgkmcnt(2)
    v_fma_f32 v195, v195, v71, v71
    v_mul_f32 v192, s54, v192
    v_mfma_f32_16x16x32_bf16 v[92:95], a[144:147], v[36:39], v[92:95]
    ds_read_b128 v[52:55], v15 offset:20480
    v_mul_f32 v193, s54, v193
    v_mul_f32 v194, s54, v194
    v_mfma_f32_16x16x32_bf16 v[96:99], a[148:151], v[36:39], v[96:99]
    ds_read_b128 v[56:59], v15 offset:22528
    v_mul_f32 v195, s54, v195
    v_exp_f32 v192, v192
    v_mfma_f32_16x16x32_bf16 v[100:103], a[152:155], v[36:39], v[100:103]
    v_exp_f32 v193, v193
    v_exp_f32 v194, v194
    v_mfma_f32_16x16x32_bf16 v[104:107], a[156:159], v[36:39], v[104:107]
    v_exp_f32 v195, v195
    s_nop 0
    v_mfma_f32_16x16x32_bf16 v[108:111], a[144:147], v[40:43], v[108:111]
    v_add_f32 v192, 1.0, v192
    v_add_f32 v193, 1.0, v193
    v_mfma_f32_16x16x32_bf16 v[112:115], a[148:151], v[40:43], v[112:115]
    v_add_f32 v194, 1.0, v194
    v_add_f32 v195, 1.0, v195
    v_mfma_f32_16x16x32_bf16 v[116:119], a[152:155], v[40:43], v[116:119]
    v_rcp_f32 v192, v192
    v_rcp_f32 v193, v193
    v_mfma_f32_16x16x32_bf16 v[120:123], a[156:159], v[40:43], v[120:123]
    s_waitcnt lgkmcnt(2)
    v_rcp_f32 v194, v194
    v_rcp_f32 v195, v195
    v_mfma_f32_16x16x32_bf16 v[92:95], a[160:163], v[44:47], v[92:95]
    ds_read_b128 v[28:31], v14 offset:24576
    s_nop 0
    v_mul_f32 v192, v192, v68
    v_mfma_f32_16x16x32_bf16 v[96:99], a[164:167], v[44:47], v[96:99]
    ds_read_b128 v[32:35], v14 offset:26624
    v_mul_f32 v193, v193, v69
    v_mul_f32 v194, v194, v70
    v_mfma_f32_16x16x32_bf16 v[100:103], a[168:171], v[44:47], v[100:103]
    v_mul_f32 v195, v195, v71
    v_cvt_pk_bf16_f32 v188, v192, v193
    v_mfma_f32_16x16x32_bf16 v[104:107], a[172:175], v[44:47], v[104:107]
    v_cvt_pk_bf16_f32 v189, v194, v195
    v_lshlrev_b32 v192, 16, v188
    v_mfma_f32_16x16x32_bf16 v[108:111], a[160:163], v[48:51], v[108:111]
    v_and_b32 v193, 0xffff0000, v188
    v_lshlrev_b32 v194, 16, v189
    v_mfma_f32_16x16x32_bf16 v[112:115], a[164:167], v[48:51], v[112:115]
    v_and_b32 v195, 0xffff0000, v189
    v_mul_f32 v192, v192, v72
    v_mfma_f32_16x16x32_bf16 v[116:119], a[168:171], v[48:51], v[116:119]
    v_mul_f32 v193, v193, v73
    v_mul_f32 v194, v194, v74
    v_mfma_f32_16x16x32_bf16 v[120:123], a[172:175], v[48:51], v[120:123]
    s_waitcnt lgkmcnt(2)
    v_mul_f32 v195, v195, v75
    v_cvt_pk_bf16_f32 v68, v192, v193
    v_mfma_f32_16x16x32_bf16 v[92:95], a[176:179], v[52:55], v[92:95]
    ds_read_b128 v[36:39], v15 offset:24576
    v_cvt_pk_bf16_f32 v69, v194, v195
    global_store_dwordx2 v7, v[68:69], s[50:51] offset:32 sc1
    v_mfma_f32_16x16x32_bf16 v[96:99], a[180:183], v[52:55], v[96:99]
    ds_read_b128 v[40:43], v15 offset:26624
    v_cvt_pk_bf16_f32 v188, v76, v77
    v_cvt_pk_bf16_f32 v189, v78, v79
    v_mfma_f32_16x16x32_bf16 v[100:103], a[184:187], v[52:55], v[100:103]
    v_cvt_pk_bf16_f32 v190, v80, v81
    v_cvt_pk_bf16_f32 v191, v82, v83
    v_mfma_f32_16x16x32_bf16 v[104:107], a[188:191], v[52:55], v[104:107]
    v_lshlrev_b32 v76, 16, v188
    v_lshlrev_b32 v80, 16, v190
    v_mfma_f32_16x16x32_bf16 v[108:111], a[176:179], v[56:59], v[108:111]
    v_and_b32 v77, 0xffff0000, v188
    v_and_b32 v81, 0xffff0000, v190
    v_mfma_f32_16x16x32_bf16 v[112:115], a[180:183], v[56:59], v[112:115]
    v_lshlrev_b32 v78, 16, v189
    v_lshlrev_b32 v82, 16, v191
    v_mfma_f32_16x16x32_bf16 v[116:119], a[184:187], v[56:59], v[116:119]
    v_and_b32 v79, 0xffff0000, v189
    v_and_b32 v83, 0xffff0000, v191
    v_mfma_f32_16x16x32_bf16 v[120:123], a[188:191], v[56:59], v[120:123]
    s_waitcnt lgkmcnt(2)
    v_mul_f32 v192, v76, v76
    v_mul_f32 v193, v77, v77
    v_mfma_f32_16x16x32_bf16 v[92:95], a[192:195], v[28:31], v[92:95]
    ds_read_b128 v[44:47], v14 offset:28672
    v_mul_f32 v194, v78, v78
    v_mul_f32 v195, v79, v79
    v_mfma_f32_16x16x32_bf16 v[96:99], a[196:199], v[28:31], v[96:99]
    ds_read_b128 v[48:51], v14 offset:30720
    v_mul_f32 v192, s55, v192
    v_mul_f32 v193, s55, v193
    v_mfma_f32_16x16x32_bf16 v[100:103], a[200:203], v[28:31], v[100:103]
    v_mul_f32 v194, s55, v194
    v_mul_f32 v195, s55, v195
    v_mfma_f32_16x16x32_bf16 v[104:107], a[204:207], v[28:31], v[104:107]
    v_fma_f32 v192, v192, v76, v76
    v_fma_f32 v193, v193, v77, v77
    v_mfma_f32_16x16x32_bf16 v[108:111], a[192:195], v[32:35], v[108:111]
    v_fma_f32 v194, v194, v78, v78
    v_fma_f32 v195, v195, v79, v79
    v_mfma_f32_16x16x32_bf16 v[112:115], a[196:199], v[32:35], v[112:115]
    v_mul_f32 v192, s54, v192
    v_mul_f32 v193, s54, v193
    v_mfma_f32_16x16x32_bf16 v[116:119], a[200:203], v[32:35], v[116:119]
    v_mul_f32 v194, s54, v194
    v_mul_f32 v195, s54, v195
    v_mfma_f32_16x16x32_bf16 v[120:123], a[204:207], v[32:35], v[120:123]
    s_waitcnt lgkmcnt(2)
    v_exp_f32 v192, v192
    v_exp_f32 v193, v193
    v_mfma_f32_16x16x32_bf16 v[92:95], a[208:211], v[36:39], v[92:95]
    ds_read_b128 v[52:55], v15 offset:28672
    v_exp_f32 v194, v194
    v_exp_f32 v195, v195
    v_mfma_f32_16x16x32_bf16 v[96:99], a[212:215], v[36:39], v[96:99]
    ds_read_b128 v[56:59], v15 offset:30720
    s_nop 0
    v_add_f32 v192, 1.0, v192
    v_mfma_f32_16x16x32_bf16 v[100:103], a[216:219], v[36:39], v[100:103]
    v_add_f32 v193, 1.0, v193
    v_add_f32 v194, 1.0, v194
    v_mfma_f32_16x16x32_bf16 v[104:107], a[220:223], v[36:39], v[104:107]
    v_add_f32 v195, 1.0, v195
    v_rcp_f32 v192, v192
    v_mfma_f32_16x16x32_bf16 v[108:111], a[208:211], v[40:43], v[108:111]
    v_rcp_f32 v193, v193
    v_rcp_f32 v194, v194
    v_mfma_f32_16x16x32_bf16 v[112:115], a[212:215], v[40:43], v[112:115]
    v_rcp_f32 v195, v195
    s_nop 0
    v_mfma_f32_16x16x32_bf16 v[116:119], a[216:219], v[40:43], v[116:119]
    v_mul_f32 v192, v192, v76
    v_mul_f32 v193, v193, v77
    v_mfma_f32_16x16x32_bf16 v[120:123], a[220:223], v[40:43], v[120:123]
    s_waitcnt lgkmcnt(2)
    v_mul_f32 v194, v194, v78
    v_mul_f32 v195, v195, v79
    v_mfma_f32_16x16x32_bf16 v[92:95], a[224:227], v[44:47], v[92:95]
    ds_read_b128 v[28:31], v14 offset:32768
    v_cvt_pk_bf16_f32 v188, v192, v193
    v_cvt_pk_bf16_f32 v189, v194, v195
    v_mfma_f32_16x16x32_bf16 v[96:99], a[228:231], v[44:47], v[96:99]
    ds_read_b128 v[32:35], v14 offset:34816
    v_lshlrev_b32 v192, 16, v188
    v_and_b32 v193, 0xffff0000, v188
    v_mfma_f32_16x16x32_bf16 v[100:103], a[232:235], v[44:47], v[100:103]
    v_lshlrev_b32 v194, 16, v189
    v_and_b32 v195, 0xffff0000, v189
    v_mfma_f32_16x16x32_bf16 v[104:107], a[236:239], v[44:47], v[104:107]
    v_mul_f32 v192, v192, v80
    v_mul_f32 v193, v193, v81
    v_mfma_f32_16x16x32_bf16 v[108:111], a[224:227], v[48:51], v[108:111]
    v_mul_f32 v194, v194, v82
    v_mul_f32 v195, v195, v83
    v_mfma_f32_16x16x32_bf16 v[112:115], a[228:231], v[48:51], v[112:115]
    v_cvt_pk_bf16_f32 v76, v192, v193
    v_cvt_pk_bf16_f32 v77, v194, v195
    v_mfma_f32_16x16x32_bf16 v[116:119], a[232:235], v[48:51], v[116:119]
    global_store_dwordx2 v8, v[76:77], s[50:51] offset:0 sc1
    v_cvt_pk_bf16_f32 v188, v84, v85
    v_mfma_f32_16x16x32_bf16 v[120:123], a[236:239], v[48:51], v[120:123]
    s_waitcnt lgkmcnt(2)
    v_cvt_pk_bf16_f32 v189, v86, v87
    v_cvt_pk_bf16_f32 v190, v88, v89
    v_mfma_f32_16x16x32_bf16 v[92:95], a[240:243], v[52:55], v[92:95]
    ds_read_b128 v[36:39], v15 offset:32768
    v_cvt_pk_bf16_f32 v191, v90, v91
    v_lshlrev_b32 v84, 16, v188
    v_mfma_f32_16x16x32_bf16 v[96:99], a[244:247], v[52:55], v[96:99]
    ds_read_b128 v[40:43], v15 offset:34816
    v_lshlrev_b32 v88, 16, v190
    v_and_b32 v85, 0xffff0000, v188
    v_mfma_f32_16x16x32_bf16 v[100:103], a[248:251], v[52:55], v[100:103]
    v_and_b32 v89, 0xffff0000, v190
    v_lshlrev_b32 v86, 16, v189
    v_mfma_f32_16x16x32_bf16 v[104:107], a[252:255], v[52:55], v[104:107]
    v_lshlrev_b32 v90, 16, v191
    v_and_b32 v87, 0xffff0000, v189
    v_mfma_f32_16x16x32_bf16 v[108:111], a[240:243], v[56:59], v[108:111]
    v_and_b32 v91, 0xffff0000, v191
    v_mul_f32 v192, v84, v84
    v_mfma_f32_16x16x32_bf16 v[112:115], a[244:247], v[56:59], v[112:115]
    v_mul_f32 v193, v85, v85
    v_mul_f32 v194, v86, v86
    v_mfma_f32_16x16x32_bf16 v[116:119], a[248:251], v[56:59], v[116:119]
    v_mul_f32 v195, v87, v87
    v_mul_f32 v192, s55, v192
    v_mfma_f32_16x16x32_bf16 v[120:123], a[252:255], v[56:59], v[120:123]
    s_waitcnt lgkmcnt(2)
    v_mul_f32 v193, s55, v193
    v_mul_f32 v194, s55, v194
    v_mfma_f32_16x16x32_bf16 v[92:95], v[124:127], v[28:31], v[92:95]
    ds_read_b128 v[44:47], v14 offset:36864
    v_mul_f32 v195, s55, v195
    v_fma_f32 v192, v192, v84, v84
    v_mfma_f32_16x16x32_bf16 v[96:99], v[128:131], v[28:31], v[96:99]
    ds_read_b128 v[48:51], v14 offset:38912
    v_fma_f32 v193, v193, v85, v85
    v_fma_f32 v194, v194, v86, v86
    v_mfma_f32_16x16x32_bf16 v[100:103], v[132:135], v[28:31], v[100:103]
    v_fma_f32 v195, v195, v87, v87
    v_mul_f32 v192, s54, v192
    v_mfma_f32_16x16x32_bf16 v[104:107], v[136:139], v[28:31], v[104:107]
    v_mul_f32 v193, s54, v193
    v_mul_f32 v194, s54, v194
    v_mfma_f32_16x16x32_bf16 v[108:111], v[124:127], v[32:35], v[108:111]
    v_mul_f32 v195, s54, v195
    v_exp_f32 v192, v192
    v_mfma_f32_16x16x32_bf16 v[112:115], v[128:131], v[32:35], v[112:115]
    v_exp_f32 v193, v193
    v_exp_f32 v194, v194
    v_mfma_f32_16x16x32_bf16 v[116:119], v[132:135], v[32:35], v[116:119]
    v_exp_f32 v195, v195
    s_nop 0
    v_mfma_f32_16x16x32_bf16 v[120:123], v[136:139], v[32:35], v[120:123]
    s_waitcnt lgkmcnt(2)
    v_add_f32 v192, 1.0, v192
    v_add_f32 v193, 1.0, v193
    v_mfma_f32_16x16x32_bf16 v[92:95], v[140:143], v[36:39], v[92:95]
    ds_read_b128 v[52:55], v15 offset:36864
    v_add_f32 v194, 1.0, v194
    v_add_f32 v195, 1.0, v195
    v_mfma_f32_16x16x32_bf16 v[96:99], v[144:147], v[36:39], v[96:99]
    ds_read_b128 v[56:59], v15 offset:38912
    v_rcp_f32 v192, v192
    v_rcp_f32 v193, v193
    v_mfma_f32_16x16x32_bf16 v[100:103], v[148:151], v[36:39], v[100:103]
    v_rcp_f32 v194, v194
    v_rcp_f32 v195, v195
    v_mfma_f32_16x16x32_bf16 v[104:107], v[152:155], v[36:39], v[104:107]
    s_nop 0
    v_mul_f32 v192, v192, v84
    v_mfma_f32_16x16x32_bf16 v[108:111], v[140:143], v[40:43], v[108:111]
    v_mul_f32 v193, v193, v85
    v_mul_f32 v194, v194, v86
    v_mfma_f32_16x16x32_bf16 v[112:115], v[144:147], v[40:43], v[112:115]
    v_mul_f32 v195, v195, v87
    v_cvt_pk_bf16_f32 v188, v192, v193
    v_mfma_f32_16x16x32_bf16 v[116:119], v[148:151], v[40:43], v[116:119]
    v_cvt_pk_bf16_f32 v189, v194, v195
    v_lshlrev_b32 v192, 16, v188
    v_mfma_f32_16x16x32_bf16 v[120:123], v[152:155], v[40:43], v[120:123]
    s_waitcnt lgkmcnt(2)
    v_and_b32 v193, 0xffff0000, v188
    v_lshlrev_b32 v194, 16, v189
    v_mfma_f32_16x16x32_bf16 v[92:95], v[156:159], v[44:47], v[92:95]
    ds_read_b128 v[28:31], v12 offset:0
    v_and_b32 v195, 0xffff0000, v189
    v_mul_f32 v192, v192, v88
    v_mfma_f32_16x16x32_bf16 v[96:99], v[160:163], v[44:47], v[96:99]
    ds_read_b128 v[32:35], v12 offset:2048
    v_mul_f32 v193, v193, v89
    v_mul_f32 v194, v194, v90
    v_mfma_f32_16x16x32_bf16 v[100:103], v[164:167], v[44:47], v[100:103]
    v_mul_f32 v195, v195, v91
    v_cvt_pk_bf16_f32 v84, v192, v193
    v_mfma_f32_16x16x32_bf16 v[104:107], v[168:171], v[44:47], v[104:107]
    v_cvt_pk_bf16_f32 v85, v194, v195
    global_store_dwordx2 v8, v[84:85], s[50:51] offset:32 sc1
    v_mfma_f32_16x16x32_bf16 v[108:111], v[156:159], v[48:51], v[108:111]
    v_mfma_f32_16x16x32_bf16 v[112:115], v[160:163], v[48:51], v[112:115]
    v_mfma_f32_16x16x32_bf16 v[116:119], v[164:167], v[48:51], v[116:119]
    v_mfma_f32_16x16x32_bf16 v[120:123], v[168:171], v[48:51], v[120:123]
    s_waitcnt lgkmcnt(2)
    v_mfma_f32_16x16x32_bf16 v[92:95], v[172:175], v[52:55], v[92:95]
    ds_read_b128 v[36:39], v13 offset:0
    v_mfma_f32_16x16x32_bf16 v[96:99], v[176:179], v[52:55], v[96:99]
    ds_read_b128 v[40:43], v13 offset:2048
    v_mfma_f32_16x16x32_bf16 v[100:103], v[180:183], v[52:55], v[100:103]
    v_mfma_f32_16x16x32_bf16 v[104:107], v[184:187], v[52:55], v[104:107]
    v_mfma_f32_16x16x32_bf16 v[108:111], v[172:175], v[56:59], v[108:111]
    s_add_u32 s50, s62, 0
    s_addc_u32 s51, s63, 0
    s_mul_i32 s40, s65, 2
    s_add_u32 s62, s62, s40
    s_addc_u32 s63, s63, 0
    s_add_u32 s26, s26, 1
    s_mov_b64 s[56:57], -1
    v_mfma_f32_16x16x32_bf16 v[112:115], v[176:179], v[56:59], v[112:115]
    v_mfma_f32_16x16x32_bf16 v[116:119], v[180:183], v[56:59], v[116:119]
    v_mfma_f32_16x16x32_bf16 v[120:123], v[184:187], v[56:59], v[120:123]
    s_cmp_lt_u32 s26, 32
    s_cbranch_scc1 g1_gl
    s_nop 7
    v_cvt_pk_bf16_f32 v188, v92, v93
    v_cvt_pk_bf16_f32 v189, v94, v95
    v_cvt_pk_bf16_f32 v190, v96, v97
    v_cvt_pk_bf16_f32 v191, v98, v99
    v_lshlrev_b32 v92, 16, v188
    v_lshlrev_b32 v96, 16, v190
    v_and_b32 v93, 0xffff0000, v188
    v_and_b32 v97, 0xffff0000, v190
    v_lshlrev_b32 v94, 16, v189
    v_lshlrev_b32 v98, 16, v191
    v_and_b32 v95, 0xffff0000, v189
    v_and_b32 v99, 0xffff0000, v191
    v_mul_f32 v192, v92, v92
    v_mul_f32 v193, v93, v93
    v_mul_f32 v194, v94, v94
    v_mul_f32 v195, v95, v95
    v_mul_f32 v192, s55, v192
    v_mul_f32 v193, s55, v193
    v_mul_f32 v194, s55, v194
    v_mul_f32 v195, s55, v195
    v_fma_f32 v192, v192, v92, v92
    v_fma_f32 v193, v193, v93, v93
    v_fma_f32 v194, v194, v94, v94
    v_fma_f32 v195, v195, v95, v95
    v_mul_f32 v192, s54, v192
    v_mul_f32 v193, s54, v193
    v_mul_f32 v194, s54, v194
    v_mul_f32 v195, s54, v195
    v_exp_f32 v192, v192
    v_exp_f32 v193, v193
    v_exp_f32 v194, v194
    v_exp_f32 v195, v195
    s_nop 0
    v_add_f32 v192, 1.0, v192
    v_add_f32 v193, 1.0, v193
    v_add_f32 v194, 1.0, v194
    v_add_f32 v195, 1.0, v195
    v_rcp_f32 v192, v192
    v_rcp_f32 v193, v193
    v_rcp_f32 v194, v194
    v_rcp_f32 v195, v195
    s_nop 0
    v_mul_f32 v192, v192, v92
    v_mul_f32 v193, v193, v93
    v_mul_f32 v194, v194, v94
    v_mul_f32 v195, v195, v95
    v_cvt_pk_bf16_f32 v188, v192, v193
    v_cvt_pk_bf16_f32 v189, v194, v195
    v_lshlrev_b32 v192, 16, v188
    v_and_b32 v193, 0xffff0000, v188
    v_lshlrev_b32 v194, 16, v189
    v_and_b32 v195, 0xffff0000, v189
    v_mul_f32 v192, v192, v96
    v_mul_f32 v193, v193, v97
    v_mul_f32 v194, v194, v98
    v_mul_f32 v195, v195, v99
    v_cvt_pk_bf16_f32 v92, v192, v193
    v_cvt_pk_bf16_f32 v93, v194, v195
    global_store_dwordx2 v7, v[92:93], s[50:51] offset:0 sc1
    v_cvt_pk_bf16_f32 v188, v100, v101
    v_cvt_pk_bf16_f32 v189, v102, v103
    v_cvt_pk_bf16_f32 v190, v104, v105
    v_cvt_pk_bf16_f32 v191, v106, v107
    v_lshlrev_b32 v100, 16, v188
    v_lshlrev_b32 v104, 16, v190
    v_and_b32 v101, 0xffff0000, v188
    v_and_b32 v105, 0xffff0000, v190
    v_lshlrev_b32 v102, 16, v189
    v_lshlrev_b32 v106, 16, v191
    v_and_b32 v103, 0xffff0000, v189
    v_and_b32 v107, 0xffff0000, v191
    v_mul_f32 v192, v100, v100
    v_mul_f32 v193, v101, v101
    v_mul_f32 v194, v102, v102
    v_mul_f32 v195, v103, v103
    v_mul_f32 v192, s55, v192
    v_mul_f32 v193, s55, v193
    v_mul_f32 v194, s55, v194
    v_mul_f32 v195, s55, v195
    v_fma_f32 v192, v192, v100, v100
    v_fma_f32 v193, v193, v101, v101
    v_fma_f32 v194, v194, v102, v102
    v_fma_f32 v195, v195, v103, v103
    v_mul_f32 v192, s54, v192
    v_mul_f32 v193, s54, v193
    v_mul_f32 v194, s54, v194
    v_mul_f32 v195, s54, v195
    v_exp_f32 v192, v192
    v_exp_f32 v193, v193
    v_exp_f32 v194, v194
    v_exp_f32 v195, v195
    s_nop 0
    v_add_f32 v192, 1.0, v192
    v_add_f32 v193, 1.0, v193
    v_add_f32 v194, 1.0, v194
    v_add_f32 v195, 1.0, v195
    v_rcp_f32 v192, v192
    v_rcp_f32 v193, v193
    v_rcp_f32 v194, v194
    v_rcp_f32 v195, v195
    s_nop 0
    v_mul_f32 v192, v192, v100
    v_mul_f32 v193, v193, v101
    v_mul_f32 v194, v194, v102
    v_mul_f32 v195, v195, v103
    v_cvt_pk_bf16_f32 v188, v192, v193
    v_cvt_pk_bf16_f32 v189, v194, v195
    v_lshlrev_b32 v192, 16, v188
    v_and_b32 v193, 0xffff0000, v188
    v_lshlrev_b32 v194, 16, v189
    v_and_b32 v195, 0xffff0000, v189
    v_mul_f32 v192, v192, v104
    v_mul_f32 v193, v193, v105
    v_mul_f32 v194, v194, v106
    v_mul_f32 v195, v195, v107
    v_cvt_pk_bf16_f32 v100, v192, v193
    v_cvt_pk_bf16_f32 v101, v194, v195
    global_store_dwordx2 v7, v[100:101], s[50:51] offset:32 sc1
    v_cvt_pk_bf16_f32 v188, v108, v109
    v_cvt_pk_bf16_f32 v189, v110, v111
    v_cvt_pk_bf16_f32 v190, v112, v113
    v_cvt_pk_bf16_f32 v191, v114, v115
    v_lshlrev_b32 v108, 16, v188
    v_lshlrev_b32 v112, 16, v190
    v_and_b32 v109, 0xffff0000, v188
    v_and_b32 v113, 0xffff0000, v190
    v_lshlrev_b32 v110, 16, v189
    v_lshlrev_b32 v114, 16, v191
    v_and_b32 v111, 0xffff0000, v189
    v_and_b32 v115, 0xffff0000, v191
    v_mul_f32 v192, v108, v108
    v_mul_f32 v193, v109, v109
    v_mul_f32 v194, v110, v110
    v_mul_f32 v195, v111, v111
    v_mul_f32 v192, s55, v192
    v_mul_f32 v193, s55, v193
    v_mul_f32 v194, s55, v194
    v_mul_f32 v195, s55, v195
    v_fma_f32 v192, v192, v108, v108
    v_fma_f32 v193, v193, v109, v109
    v_fma_f32 v194, v194, v110, v110
    v_fma_f32 v195, v195, v111, v111
    v_mul_f32 v192, s54, v192
    v_mul_f32 v193, s54, v193
    v_mul_f32 v194, s54, v194
    v_mul_f32 v195, s54, v195
    v_exp_f32 v192, v192
    v_exp_f32 v193, v193
    v_exp_f32 v194, v194
    v_exp_f32 v195, v195
    s_nop 0
    v_add_f32 v192, 1.0, v192
    v_add_f32 v193, 1.0, v193
    v_add_f32 v194, 1.0, v194
    v_add_f32 v195, 1.0, v195
    v_rcp_f32 v192, v192
    v_rcp_f32 v193, v193
    v_rcp_f32 v194, v194
    v_rcp_f32 v195, v195
    s_nop 0
    v_mul_f32 v192, v192, v108
    v_mul_f32 v193, v193, v109
    v_mul_f32 v194, v194, v110
    v_mul_f32 v195, v195, v111
    v_cvt_pk_bf16_f32 v188, v192, v193
    v_cvt_pk_bf16_f32 v189, v194, v195
    v_lshlrev_b32 v192, 16, v188
    v_and_b32 v193, 0xffff0000, v188
    v_lshlrev_b32 v194, 16, v189
    v_and_b32 v195, 0xffff0000, v189
    v_mul_f32 v192, v192, v112
    v_mul_f32 v193, v193, v113
    v_mul_f32 v194, v194, v114
    v_mul_f32 v195, v195, v115
    v_cvt_pk_bf16_f32 v108, v192, v193
    v_cvt_pk_bf16_f32 v109, v194, v195
    global_store_dwordx2 v8, v[108:109], s[50:51] offset:0 sc1
    v_cvt_pk_bf16_f32 v188, v116, v117
    v_cvt_pk_bf16_f32 v189, v118, v119
    v_cvt_pk_bf16_f32 v190, v120, v121
    v_cvt_pk_bf16_f32 v191, v122, v123
    v_lshlrev_b32 v116, 16, v188
    v_lshlrev_b32 v120, 16, v190
    v_and_b32 v117, 0xffff0000, v188
    v_and_b32 v121, 0xffff0000, v190
    v_lshlrev_b32 v118, 16, v189
    v_lshlrev_b32 v122, 16, v191
    v_and_b32 v119, 0xffff0000, v189
    v_and_b32 v123, 0xffff0000, v191
    v_mul_f32 v192, v116, v116
    v_mul_f32 v193, v117, v117
    v_mul_f32 v194, v118, v118
    v_mul_f32 v195, v119, v119
    v_mul_f32 v192, s55, v192
    v_mul_f32 v193, s55, v193
    v_mul_f32 v194, s55, v194
    v_mul_f32 v195, s55, v195
    v_fma_f32 v192, v192, v116, v116
    v_fma_f32 v193, v193, v117, v117
    v_fma_f32 v194, v194, v118, v118
    v_fma_f32 v195, v195, v119, v119
    v_mul_f32 v192, s54, v192
    v_mul_f32 v193, s54, v193
    v_mul_f32 v194, s54, v194
    v_mul_f32 v195, s54, v195
    v_exp_f32 v192, v192
    v_exp_f32 v193, v193
    v_exp_f32 v194, v194
    v_exp_f32 v195, v195
    s_nop 0
    v_add_f32 v192, 1.0, v192
    v_add_f32 v193, 1.0, v193
    v_add_f32 v194, 1.0, v194
    v_add_f32 v195, 1.0, v195
    v_rcp_f32 v192, v192
    v_rcp_f32 v193, v193
    v_rcp_f32 v194, v194
    v_rcp_f32 v195, v195
    s_nop 0
    v_mul_f32 v192, v192, v116
    v_mul_f32 v193, v193, v117
    v_mul_f32 v194, v194, v118
    v_mul_f32 v195, v195, v119
    v_cvt_pk_bf16_f32 v188, v192, v193
    v_cvt_pk_bf16_f32 v189, v194, v195
    v_lshlrev_b32 v192, 16, v188
    v_and_b32 v193, 0xffff0000, v188
    v_lshlrev_b32 v194, 16, v189
    v_and_b32 v195, 0xffff0000, v189
    v_mul_f32 v192, v192, v120
    v_mul_f32 v193, v193, v121
    v_mul_f32 v194, v194, v122
    v_mul_f32 v195, v195, v123
    v_cvt_pk_bf16_f32 v116, v192, v193
    v_cvt_pk_bf16_f32 v117, v194, v195
    global_store_dwordx2 v8, v[116:117], s[50:51] offset:32 sc1
    s_waitcnt vmcnt(0) lgkmcnt(0)
    s_barrier
    s_cmp_ge_i32 s30, 0
    s_cselect_b64 s[46:47], s[48:49], 0
    v_mov_b32 v17, s30
    s_add_u32 s30, s30, 4
    s_mov_b64 exec, s[46:47]
    global_atomic_add v17, v16, s[98:99] sc1
    s_mov_b64 exec, -1
    s_cmp_ge_i32 s30, 0
    s_cselect_b64 s[46:47], s[48:49], 0
    v_mov_b32 v17, s30
    s_add_u32 s30, s30, 4
    s_mov_b64 exec, s[46:47]
    global_atomic_add v17, v16, s[98:99] sc1
    s_mov_b64 exec, -1
    s_branch g1_end
g1_end:
    s_cmp_ge_u32 s100, 80
    s_cbranch_scc1 mega_tail
    s_lshr_b32 s3, s100, 4
    s_cmp_lg_u32 s3, 3
    s_cbranch_scc1 mega_down
    s_load_dwordx2 s[6:7], s[0:1], 0
    s_load_dwordx2 s[8:9], s[0:1], 88
    s_load_dwordx2 s[12:13], s[0:1], 112
    v_lshrrev_b32 v2, 6, v0
    v_and_b32 v1, 63, v0
    v_readfirstlane_b32 s3, v2
    s_sub_u32 s4, s100, 48
    s_lshl_b32 s4, s4, 2
    s_add_u32 s4, s4, s3
    s_lshl_b32 s4, s4, 5
    v_lshlrev_b32 v4, 2, v1
    s_waitcnt lgkmcnt(0)
    global_load_dword v16, v4, s[8:9] offset:0
    global_load_dword v17, v4, s[8:9] offset:256
    global_load_dword v18, v4, s[8:9] offset:512
    global_load_dword v19, v4, s[8:9] offset:768
    global_load_dword v20, v4, s[8:9] offset:1024
    s_mul_i32 s14, s4, 1280
    s_add_u32 s6, s6, s14
    s_addc_u32 s7, s7, 0
    s_mov_b32 s5, 0
    v_mov_b32 v30, 0
    s_add_u32 s14, s5, 0
    s_min_u32 s14, s14, 31
    s_mul_i32 s14, s14, 1280
    s_add_u32 s10, s6, s14
    s_addc_u32 s11, s7, 0
    global_load_dword v40, v4, s[10:11] offset:0
    global_load_dword v41, v4, s[10:11] offset:256
    global_load_dword v42, v4, s[10:11] offset:512
    global_load_dword v43, v4, s[10:11] offset:768
    global_load_dword v44, v4, s[10:11] offset:1024
    s_add_u32 s14, s5, 1
    s_min_u32 s14, s14, 31
    s_mul_i32 s14, s14, 1280
    s_add_u32 s10, s6, s14
    s_addc_u32 s11, s7, 0
    global_load_dword v48, v4, s[10:11] offset:0
    global_load_dword v49, v4, s[10:11] offset:256
    global_load_dword v50, v4, s[10:11] offset:512
    global_load_dword v51, v4, s[10:11] offset:768
    global_load_dword v52, v4, s[10:11] offset:1024
    s_add_u32 s14, s5, 2
    s_min_u32 s14, s14, 31
    s_mul_i32 s14, s14, 1280
    s_add_u32 s10, s6, s14
    s_addc_u32 s11, s7, 0
    global_load_dword v56, v4, s[10:11] offset:0
    global_load_dword v57, v4, s[10:11] offset:256
    global_load_dword v58, v4, s[10:11] offset:512
    global_load_dword v59, v4, s[10:11] offset:768
    global_load_dword v60, v4, s[10:11] offset:1024
gt_l:
    s_add_u32 s14, s5, 3
    s_min_u32 s14, s14, 31
    s_mul_i32 s14, s14, 1280
    s_add_u32 s10, s6, s14
    s_addc_u32 s11, s7, 0
    global_load_dword v64, v4, s[10:11] offset:0
    global_load_dword v65, v4, s[10:11] offset:256
    global_load_dword v66, v4, s[10:11] offset:512
    global_load_dword v67, v4, s[10:11] offset:768
    global_load_dword v68, v4, s[10:11] offset:1024
    s_waitcnt vmcnt(15)
    v_mov_b32 v2, 0
    v_lshlrev_b32 v24, 16, v40
    v_lshlrev_b32 v25, 16, v16
    v_and_b32 v26, 0xffff0000, v40
    v_and_b32 v27, 0xffff0000, v16
    v_mul_f32 v24, v24, v25
    v_mul_f32 v26, v26, v27
    v_cvt_pk_bf16_f32 v24, v24, v26
    v_lshlrev_b32 v25, 16, v24
    v_and_b32 v24, 0xffff0000, v24
    v_add_f32 v2, v2, v25
    v_add_f32 v2, v2, v24
    v_lshlrev_b32 v24, 16, v41
    v_lshlrev_b32 v25, 16, v17
    v_and_b32 v26, 0xffff0000, v41
    v_and_b32 v27, 0xffff0000, v17
    v_mul_f32 v24, v24, v25
    v_mul_f32 v26, v26, v27
    v_cvt_pk_bf16_f32 v24, v24, v26
    v_lshlrev_b32 v25, 16, v24
    v_and_b32 v24, 0xffff0000, v24
    v_add_f32 v2, v2, v25
    v_add_f32 v2, v2, v24
    v_lshlrev_b32 v24, 16, v42
    v_lshlrev_b32 v25, 16, v18
    v_and_b32 v26, 0xffff0000, v42
    v_and_b32 v27, 0xffff0000, v18
    v_mul_f32 v24, v24, v25
    v_mul_f32 v26, v26, v27
    v_cvt_pk_bf16_f32 v24, v24, v26
    v_lshlrev_b32 v25, 16, v24
    v_and_b32 v24, 0xffff0000, v24
    v_add_f32 v2, v2, v25
    v_add_f32 v2, v2, v24
    v_lshlrev_b32 v24, 16, v43
    v_lshlrev_b32 v25, 16, v19
    v_and_b32 v26, 0xffff0000, v43
    v_and_b32 v27, 0xffff0000, v19
    v_mul_f32 v24, v24, v25
    v_mul_f32 v26, v26, v27
    v_cvt_pk_bf16_f32 v24, v24, v26
    v_lshlrev_b32 v25, 16, v24
    v_and_b32 v24, 0xffff0000, v24
    v_add_f32 v2, v2, v25
    v_add_f32 v2, v2, v24
    v_lshlrev_b32 v24, 16, v44
    v_lshlrev_b32 v25, 16, v20
    v_and_b32 v26, 0xffff0000, v44
    v_and_b32 v27, 0xffff0000, v20
    v_mul_f32 v24, v24, v25
    v_mul_f32 v26, v26, v27
    v_cvt_pk_bf16_f32 v24, v24, v26
    v_lshlrev_b32 v25, 16, v24
    v_and_b32 v24, 0xffff0000, v24
    v_add_f32 v2, v2, v25
    v_add_f32 v2, v2, v24
    ds_swizzle_b32 v3, v2 offset:1055
    s_waitcnt lgkmcnt(0)
    v_add_f32 v2, v2, v3
    ds_swizzle_b32 v3, v2 offset:2079
    s_waitcnt lgkmcnt(0)
    v_add_f32 v2, v2, v3
    ds_swizzle_b32 v3, v2 offset:4127
    s_waitcnt lgkmcnt(0)
    v_add_f32 v2, v2, v3
    ds_swizzle_b32 v3, v2 offset:8223
    s_waitcnt lgkmcnt(0)
    v_add_f32 v2, v2, v3
    v_mov_b32 v3, v2
    s_nop 1
    v_permlane16_swap_b32 v2, v3
    v_add_f32 v2, v2, v3
    v_mov_b32 v3, v2
    s_nop 1
    v_permlane32_swap_b32 v2, v3
    v_add_f32 v2, v2, v3
    v_cvt_pk_bf16_f32 v2, v2, v2
    v_lshlrev_b32 v2, 16, v2
    v_mul_f32 v2, 0xbfb8aa3b, v2
    v_exp_f32 v2, v2
    s_nop 0
    v_add_f32 v2, 1.0, v2
    v_rcp_f32 v2, v2
    s_nop 0
    v_cvt_pk_bf16_f32 v2, v2, v2
    v_lshlrev_b32 v2, 16, v2
    v_cmp_eq_u32 vcc, s5, v1
    s_nop 1
    v_cndmask_b32 v30, v30, v2, vcc
    s_add_u32 s5, s5, 1
    s_add_u32 s14, s5, 3
    s_min_u32 s14, s14, 31
    s_mul_i32 s14, s14, 1280
    s_add_u32 s10, s6, s14
    s_addc_u32 s11, s7, 0
    global_load_dword v40, v4, s[10:11] offset:0
    global_load_dword v41, v4, s[10:11] offset:256
    global_load_dword v42, v4, s[10:11] offset:512
    global_load_dword v43, v4, s[10:11] offset:768
    global_load_dword v44, v4, s[10:11] offset:1024
    s_waitcnt vmcnt(15)
    v_mov_b32 v2, 0
    v_lshlrev_b32 v24, 16, v48
    v_lshlrev_b32 v25, 16, v16
    v_and_b32 v26, 0xffff0000, v48
    v_and_b32 v27, 0xffff0000, v16
    v_mul_f32 v24, v24, v25
    v_mul_f32 v26, v26, v27
    v_cvt_pk_bf16_f32 v24, v24, v26
    v_lshlrev_b32 v25, 16, v24
    v_and_b32 v24, 0xffff0000, v24
    v_add_f32 v2, v2, v25
    v_add_f32 v2, v2, v24
    v_lshlrev_b32 v24, 16, v49
    v_lshlrev_b32 v25, 16, v17
    v_and_b32 v26, 0xffff0000, v49
    v_and_b32 v27, 0xffff0000, v17
    v_mul_f32 v24, v24, v25
    v_mul_f32 v26, v26, v27
    v_cvt_pk_bf16_f32 v24, v24, v26
    v_lshlrev_b32 v25, 16, v24
    v_and_b32 v24, 0xffff0000, v24
    v_add_f32 v2, v2, v25
    v_add_f32 v2, v2, v24
    v_lshlrev_b32 v24, 16, v50
    v_lshlrev_b32 v25, 16, v18
    v_and_b32 v26, 0xffff0000, v50
    v_and_b32 v27, 0xffff0000, v18
    v_mul_f32 v24, v24, v25
    v_mul_f32 v26, v26, v27
    v_cvt_pk_bf16_f32 v24, v24, v26
    v_lshlrev_b32 v25, 16, v24
    v_and_b32 v24, 0xffff0000, v24
    v_add_f32 v2, v2, v25
    v_add_f32 v2, v2, v24
    v_lshlrev_b32 v24, 16, v51
    v_lshlrev_b32 v25, 16, v19
    v_and_b32 v26, 0xffff0000, v51
    v_and_b32 v27, 0xffff0000, v19
    v_mul_f32 v24, v24, v25
    v_mul_f32 v26, v26, v27
    v_cvt_pk_bf16_f32 v24, v24, v26
    v_lshlrev_b32 v25, 16, v24
    v_and_b32 v24, 0xffff0000, v24
    v_add_f32 v2, v2, v25
    v_add_f32 v2, v2, v24
    v_lshlrev_b32 v24, 16, v52
    v_lshlrev_b32 v25, 16, v20
    v_and_b32 v26, 0xffff0000, v52
    v_and_b32 v27, 0xffff0000, v20
    v_mul_f32 v24, v24, v25
    v_mul_f32 v26, v26, v27
    v_cvt_pk_bf16_f32 v24, v24, v26
    v_lshlrev_b32 v25, 16, v24
    v_and_b32 v24, 0xffff0000, v24
    v_add_f32 v2, v2, v25
    v_add_f32 v2, v2, v24
    ds_swizzle_b32 v3, v2 offset:1055
    s_waitcnt lgkmcnt(0)
    v_add_f32 v2, v2, v3
    ds_swizzle_b32 v3, v2 offset:2079
    s_waitcnt lgkmcnt(0)
    v_add_f32 v2, v2, v3
    ds_swizzle_b32 v3, v2 offset:4127
    s_waitcnt lgkmcnt(0)
    v_add_f32 v2, v2, v3
    ds_swizzle_b32 v3, v2 offset:8223
    s_waitcnt lgkmcnt(0)
    v_add_f32 v2, v2, v3
    v_mov_b32 v3, v2
    s_nop 1
    v_permlane16_swap_b32 v2, v3
    v_add_f32 v2, v2, v3
    v_mov_b32 v3, v2
    s_nop 1
    v_permlane32_swap_b32 v2, v3
    v_add_f32 v2, v2, v3
    v_cvt_pk_bf16_f32 v2, v2, v2
    v_lshlrev_b32 v2, 16, v2
    v_mul_f32 v2, 0xbfb8aa3b, v2
    v_exp_f32 v2, v2
    s_nop 0
    v_add_f32 v2, 1.0, v2
    v_rcp_f32 v2, v2
    s_nop 0
    v_cvt_pk_bf16_f32 v2, v2, v2
    v_lshlrev_b32 v2, 16, v2
    v_cmp_eq_u32 vcc, s5, v1
    s_nop 1
    v_cndmask_b32 v30, v30, v2, vcc
    s_add_u32 s5, s5, 1
    s_add_u32 s14, s5, 3
    s_min_u32 s14, s14, 31
    s_mul_i32 s14, s14, 1280
    s_add_u32 s10, s6, s14
    s_addc_u32 s11, s7, 0
    global_load_dword v48, v4, s[10:11] offset:0
    global_load_dword v49, v4, s[10:11] offset:256
    global_load_dword v50, v4, s[10:11] offset:512
    global_load_dword v51, v4, s[10:11] offset:768
    global_load_dword v52, v4, s[10:11] offset:1024
    s_waitcnt vmcnt(15)
    v_mov_b32 v2, 0
    v_lshlrev_b32 v24, 16, v56
    v_lshlrev_b32 v25, 16, v16
    v_and_b32 v26, 0xffff0000, v56
    v_and_b32 v27, 0xffff0000, v16
    v_mul_f32 v24, v24, v25
    v_mul_f32 v26, v26, v27
    v_cvt_pk_bf16_f32 v24, v24, v26
    v_lshlrev_b32 v25, 16, v24
    v_and_b32 v24, 0xffff0000, v24
    v_add_f32 v2, v2, v25
    v_add_f32 v2, v2, v24
    v_lshlrev_b32 v24, 16, v57
    v_lshlrev_b32 v25, 16, v17
    v_and_b32 v26, 0xffff0000, v57
    v_and_b32 v27, 0xffff0000, v17
    v_mul_f32 v24, v24, v25
    v_mul_f32 v26, v26, v27
    v_cvt_pk_bf16_f32 v24, v24, v26
    v_lshlrev_b32 v25, 16, v24
    v_and_b32 v24, 0xffff0000, v24
    v_add_f32 v2, v2, v25
    v_add_f32 v2, v2, v24
    v_lshlrev_b32 v24, 16, v58
    v_lshlrev_b32 v25, 16, v18
    v_and_b32 v26, 0xffff0000, v58
    v_and_b32 v27, 0xffff0000, v18
    v_mul_f32 v24, v24, v25
    v_mul_f32 v26, v26, v27
    v_cvt_pk_bf16_f32 v24, v24, v26
    v_lshlrev_b32 v25, 16, v24
    v_and_b32 v24, 0xffff0000, v24
    v_add_f32 v2, v2, v25
    v_add_f32 v2, v2, v24
    v_lshlrev_b32 v24, 16, v59
    v_lshlrev_b32 v25, 16, v19
    v_and_b32 v26, 0xffff0000, v59
    v_and_b32 v27, 0xffff0000, v19
    v_mul_f32 v24, v24, v25
    v_mul_f32 v26, v26, v27
    v_cvt_pk_bf16_f32 v24, v24, v26
    v_lshlrev_b32 v25, 16, v24
    v_and_b32 v24, 0xffff0000, v24
    v_add_f32 v2, v2, v25
    v_add_f32 v2, v2, v24
    v_lshlrev_b32 v24, 16, v60
    v_lshlrev_b32 v25, 16, v20
    v_and_b32 v26, 0xffff0000, v60
    v_and_b32 v27, 0xffff0000, v20
    v_mul_f32 v24, v24, v25
    v_mul_f32 v26, v26, v27
    v_cvt_pk_bf16_f32 v24, v24, v26
    v_lshlrev_b32 v25, 16, v24
    v_and_b32 v24, 0xffff0000, v24
    v_add_f32 v2, v2, v25
    v_add_f32 v2, v2, v24
    ds_swizzle_b32 v3, v2 offset:1055
    s_waitcnt lgkmcnt(0)
    v_add_f32 v2, v2, v3
    ds_swizzle_b32 v3, v2 offset:2079
    s_waitcnt lgkmcnt(0)
    v_add_f32 v2, v2, v3
    ds_swizzle_b32 v3, v2 offset:4127
    s_waitcnt lgkmcnt(0)
    v_add_f32 v2, v2, v3
    ds_swizzle_b32 v3, v2 offset:8223
    s_waitcnt lgkmcnt(0)
    v_add_f32 v2, v2, v3
    v_mov_b32 v3, v2
    s_nop 1
    v_permlane16_swap_b32 v2, v3
    v_add_f32 v2, v2, v3
    v_mov_b32 v3, v2
    s_nop 1
    v_permlane32_swap_b32 v2, v3
    v_add_f32 v2, v2, v3
    v_cvt_pk_bf16_f32 v2, v2, v2
    v_lshlrev_b32 v2, 16, v2
    v_mul_f32 v2, 0xbfb8aa3b, v2
    v_exp_f32 v2, v2
    s_nop 0
    v_add_f32 v2, 1.0, v2
    v_rcp_f32 v2, v2
    s_nop 0
    v_cvt_pk_bf16_f32 v2, v2, v2
    v_lshlrev_b32 v2, 16, v2
    v_cmp_eq_u32 vcc, s5, v1
    s_nop 1
    v_cndmask_b32 v30, v30, v2, vcc
    s_add_u32 s5, s5, 1
    s_add_u32 s14, s5, 3
    s_min_u32 s14, s14, 31
    s_mul_i32 s14, s14, 1280
    s_add_u32 s10, s6, s14
    s_addc_u32 s11, s7, 0
    global_load_dword v56, v4, s[10:11] offset:0
    global_load_dword v57, v4, s[10:11] offset:256
    global_load_dword v58, v4, s[10:11] offset:512
    global_load_dword v59, v4, s[10:11] offset:768
    global_load_dword v60, v4, s[10:11] offset:1024
    s_waitcnt vmcnt(15)
    v_mov_b32 v2, 0
    v_lshlrev_b32 v24, 16, v64
    v_lshlrev_b32 v25, 16, v16
    v_and_b32 v26, 0xffff0000, v64
    v_and_b32 v27, 0xffff0000, v16
    v_mul_f32 v24, v24, v25
    v_mul_f32 v26, v26, v27
    v_cvt_pk_bf16_f32 v24, v24, v26
    v_lshlrev_b32 v25, 16, v24
    v_and_b32 v24, 0xffff0000, v24
    v_add_f32 v2, v2, v25
    v_add_f32 v2, v2, v24
    v_lshlrev_b32 v24, 16, v65
    v_lshlrev_b32 v25, 16, v17
    v_and_b32 v26, 0xffff0000, v65
    v_and_b32 v27, 0xffff0000, v17
    v_mul_f32 v24, v24, v25
    v_mul_f32 v26, v26, v27
    v_cvt_pk_bf16_f32 v24, v24, v26
    v_lshlrev_b32 v25, 16, v24
    v_and_b32 v24, 0xffff0000, v24
    v_add_f32 v2, v2, v25
    v_add_f32 v2, v2, v24
    v_lshlrev_b32 v24, 16, v66
    v_lshlrev_b32 v25, 16, v18
    v_and_b32 v26, 0xffff0000, v66
    v_and_b32 v27, 0xffff0000, v18
    v_mul_f32 v24, v24, v25
    v_mul_f32 v26, v26, v27
    v_cvt_pk_bf16_f32 v24, v24, v26
    v_lshlrev_b32 v25, 16, v24
    v_and_b32 v24, 0xffff0000, v24
    v_add_f32 v2, v2, v25
    v_add_f32 v2, v2, v24
    v_lshlrev_b32 v24, 16, v67
    v_lshlrev_b32 v25, 16, v19
    v_and_b32 v26, 0xffff0000, v67
    v_and_b32 v27, 0xffff0000, v19
    v_mul_f32 v24, v24, v25
    v_mul_f32 v26, v26, v27
    v_cvt_pk_bf16_f32 v24, v24, v26
    v_lshlrev_b32 v25, 16, v24
    v_and_b32 v24, 0xffff0000, v24
    v_add_f32 v2, v2, v25
    v_add_f32 v2, v2, v24
    v_lshlrev_b32 v24, 16, v68
    v_lshlrev_b32 v25, 16, v20
    v_and_b32 v26, 0xffff0000, v68
    v_and_b32 v27, 0xffff0000, v20
    v_mul_f32 v24, v24, v25
    v_mul_f32 v26, v26, v27
    v_cvt_pk_bf16_f32 v24, v24, v26
    v_lshlrev_b32 v25, 16, v24
    v_and_b32 v24, 0xffff0000, v24
    v_add_f32 v2, v2, v25
    v_add_f32 v2, v2, v24
    ds_swizzle_b32 v3, v2 offset:1055
    s_waitcnt lgkmcnt(0)
    v_add_f32 v2, v2, v3
    ds_swizzle_b32 v3, v2 offset:2079
    s_waitcnt lgkmcnt(0)
    v_add_f32 v2, v2, v3
    ds_swizzle_b32 v3, v2 offset:4127
    s_waitcnt lgkmcnt(0)
    v_add_f32 v2, v2, v3
    ds_swizzle_b32 v3, v2 offset:8223
    s_waitcnt lgkmcnt(0)
    v_add_f32 v2, v2, v3
    v_mov_b32 v3, v2
    s_nop 1
    v_permlane16_swap_b32 v2, v3
    v_add_f32 v2, v2, v3
    v_mov_b32 v3, v2
    s_nop 1
    v_permlane32_swap_b32 v2, v3
    v_add_f32 v2, v2, v3
    v_cvt_pk_bf16_f32 v2, v2, v2
    v_lshlrev_b32 v2, 16, v2
    v_mul_f32 v2, 0xbfb8aa3b, v2
    v_exp_f32 v2, v2
    s_nop 0
    v_add_f32 v2, 1.0, v2
    v_rcp_f32 v2, v2
    s_nop 0
    v_cvt_pk_bf16_f32 v2, v2, v2
    v_lshlrev_b32 v2, 16, v2
    v_cmp_eq_u32 vcc, s5, v1
    s_nop 1
    v_cndmask_b32 v30, v30, v2, vcc
    s_add_u32 s5, s5, 1
    s_cmp_lt_u32 s5, 32
    s_cbranch_scc1 gt_l
    s_lshl_b32 s14, s4, 2
    s_add_u32 s14, s14, 113246208
    s_add_u32 s12, s12, s14
    s_addc_u32 s13, s13, 0
    s_mov_b32 exec_lo, -1
    s_mov_b32 exec_hi, 0
    global_store_dword v4, v30, s[12:13] sc1
    s_mov_b64 exec, -1
    s_waitcnt vmcnt(0)
    s_barrier
    s_sub_u32 s14, s100, 48
    s_lshl_b32 s14, s14, 2
    s_cmp_lg_u32 s3, 0
    s_cbranch_scc1 gt_sg_n
    v_mov_b32 v2, 16777216
    v_mov_b32 v3, s14
    s_mov_b64 exec, 1
    global_atomic_add v3, v2, s[98:99] sc1
    s_mov_b64 exec, -1
gt_sg_n:
mega_down:
    s_load_dwordx2 s[6:7], s[0:1], 40
    s_load_dwordx2 s[8:9], s[0:1], 80
    s_load_dwordx2 s[10:11], s[0:1], 112
    v_lshrrev_b32 v11, 6, v0
    v_and_b32 v3, 63, v0
    v_readfirstlane_b32 s3, v11
    v_and_b32 v1, 15, v0
    v_lshrrev_b32 v2, 4, v3
    s_lshr_b32 s4, s3, 1
    s_and_b32 s5, s3, 1
    s_waitcnt lgkmcnt(0)
    s_mov_b32 s23, 0x00020000
    s_mov_b32 s27, 0x00020000
    v_and_b32 v11, 7, v1
    v_xor_b32 v11, v11, v2
    v_lshlrev_b32 v11, 4, v11
    v_lshl_add_u32 v7, v1, 7, v11
    s_lshl_b32 s43, s4, 13
    v_add_u32 v7, s43, v7
    v_lshrrev_b32 v11, 2, v1
    v_and_b32 v12, 1, v2
    v_lshl_add_u32 v12, v12, 2, v11
    v_lshl_add_u32 v11, v2, 3, v11
    v_lshlrev_b32 v11, 8, v11
    v_and_b32 v13, 3, v3
    v_lshl_add_u32 v11, v13, 3, v11
    s_lshl_b32 s43, s5, 2
    v_xor_b32 v12, s43, v12
    v_lshl_add_u32 v8, v12, 5, v11
    v_add_u32 v8, 16384, v8
    s_mov_b32 s33, 0
    s_mov_b32 s37, 0
    s_mov_b32 s34, 0
    s_mov_b32 s38, 0
    s_mov_b32 s52, 0
    s_add_u32 s32, s100, 160
    s_mov_b32 s36, s32
    s_and_b32 s43, s100, 15
    s_lshl_b32 s43, s43, 2
    s_cmp_lg_u32 s3, 0
    s_cbranch_scc1 dn_hw_d
    v_mov_b32 v12, s43
    s_mov_b32 s45, 0
dn_hw_l:
    global_load_dword v11, v12, s[98:99] sc1
    s_add_u32 s45, s45, 1
    s_waitcnt vmcnt(0)
    v_readfirstlane_b32 s44, v11
    s_lshr_b32 s44, s44, 16
    s_and_b32 s44, s44, 255
    s_cmp_eq_u32 s44, 28
    s_cbranch_scc1 dn_hw_d
    s_cmp_ge_u32 s45, 8192
    s_cbranch_scc1 dn_hw_d
    s_sleep 32
    s_branch dn_hw_l
dn_hw_d:
    s_barrier
    s_cmp_lg_u32 s52, 0
    s_cbranch_scc1 dn_ls_skip_1
    s_cmp_lg_u32 s33, 0
    s_cbranch_scc1 dn_ls_nodec_2
    s_cmp_ge_u32 s32, 80
    s_cselect_b32 s45, 1, 0
    s_cmp_ge_u32 s32, 160
    s_cselect_b32 s45, 2, s45
    s_mul_i32 s43, s45, 80
    s_sub_u32 s43, s32, s43
    s_lshr_b32 s44, s43, 4
    s_and_b32 s43, s43, 15
    s_lshl_b32 s43, s43, 2
    s_add_u32 s43, s43, s3
    s_lshl_b32 s43, s43, 5
    v_lshlrev_b32 v11, 1, v2
    v_xor_b32 v11, v11, v1
    v_mul_u32_u24 v5, 1280, v2
    s_lshl_b32 s44, s44, 8
    v_add_u32 v5, s44, v5
    v_lshlrev_b32 v11, 4, v11
    v_xor_b32 v12, 128, v11
    v_add_u32 v6, v5, v12
    v_add_u32 v5, v5, v11
    v_lshrrev_b32 v11, 3, v3
    v_and_b32 v12, 7, v3
    v_xor_b32 v12, v12, v11
    v_lshlrev_b32 v12, 4, v12
    s_cmp_eq_u32 s45, 2
    s_cbranch_scc1 dn_ls_pb_3
    s_add_u32 s20, s10, 58720256
    s_addc_u32 s21, s11, 0
    s_and_b32 s21, s21, 0xffff
    s_mov_b32 s22, 16777216
    s_mov_b32 s24, s6
    s_and_b32 s25, s7, 0xffff
    s_mov_b32 s26, 5242880
    s_lshl_b32 s40, s43, 13
    s_lshl_b32 s44, s45, 12
    s_add_u32 s40, s40, s44
    s_mov_b32 s42, 65536
    s_mul_i32 s41, s45, 2621440
    s_mov_b32 s35, 32
    v_lshl_add_u32 v4, v11, 13, v12
    s_branch dn_ls_dd_4
dn_ls_pb_3:
    s_add_u32 s20, s10, 50331648
    s_addc_u32 s21, s11, 0
    s_and_b32 s21, s21, 0xffff
    s_mov_b32 s22, 7077888
    s_mov_b32 s24, s8
    s_and_b32 s25, s9, 0xffff
    s_mov_b32 s26, 2211840
    s_mul_i32 s40, s43, 3456
    s_mov_b32 s42, 27648
    s_mov_b32 s41, 0
    s_mov_b32 s35, 27
    v_mul_u32_u24 v4, 3456, v11
    v_add_u32 v4, v4, v12
dn_ls_dd_4:
    s_mul_i32 s43, s3, 20480
    s_add_u32 s41, s41, s43
dn_ls_nodec_2:
    s_lshl_b32 s43, s3, 12
    s_add_u32 s43, s43, s34
    s_mov_b32 s44, s40
    s_add_u32 m0, s43, 0
    s_nop 0
    buffer_load_dwordx4 v4, s[20:23], s44 offen sc1 lds
    s_add_u32 m0, s43, 1024
    s_add_u32 s44, s44, s42
    buffer_load_dwordx4 v4, s[20:23], s44 offen sc1 lds
    s_add_u32 m0, s43, 2048
    s_add_u32 s44, s44, s42
    buffer_load_dwordx4 v4, s[20:23], s44 offen sc1 lds
    s_add_u32 m0, s43, 3072
    s_add_u32 s44, s44, s42
    buffer_load_dwordx4 v4, s[20:23], s44 offen sc1 lds
    s_add_u32 s40, s40, 128
    s_add_u32 s43, s43, 16384
    s_add_u32 m0, s43, 0
    s_add_u32 s44, s41, 0
    buffer_load_dwordx4 v5, s[24:27], s44 offen lds
    s_add_u32 m0, s43, 1024
    s_add_u32 s44, s41, 5120
    buffer_load_dwordx4 v5, s[24:27], s44 offen lds
    s_add_u32 m0, s43, 2048
    s_add_u32 s44, s41, 10240
    buffer_load_dwordx4 v6, s[24:27], s44 offen lds
    s_add_u32 m0, s43, 3072
    s_add_u32 s44, s41, 15360
    buffer_load_dwordx4 v6, s[24:27], s44 offen lds
    s_add_u32 s41, s41, 81920
    s_add_u32 s34, s34, 32768
    s_and_b32 s34, s34, 131071
    s_add_u32 s33, s33, 1
    s_cmp_lt_u32 s33, s35
    s_cbranch_scc1 dn_ls_skip_1
    s_mov_b32 s33, 0
    s_add_u32 s32, s32, 128
    s_cmp_ge_u32 s32, 240
    s_cselect_b32 s52, 1, 0
dn_ls_skip_1:
    s_cmp_lg_u32 s52, 0
    s_cbranch_scc1 dn_ls_skip_5
    s_cmp_lg_u32 s33, 0
    s_cbranch_scc1 dn_ls_nodec_6
    s_cmp_ge_u32 s32, 80
    s_cselect_b32 s45, 1, 0
    s_cmp_ge_u32 s32, 160
    s_cselect_b32 s45, 2, s45
    s_mul_i32 s43, s45, 80
    s_sub_u32 s43, s32, s43
    s_lshr_b32 s44, s43, 4
    s_and_b32 s43, s43, 15
    s_lshl_b32 s43, s43, 2
    s_add_u32 s43, s43, s3
    s_lshl_b32 s43, s43, 5
    v_lshlrev_b32 v11, 1, v2
    v_xor_b32 v11, v11, v1
    v_mul_u32_u24 v5, 1280, v2
    s_lshl_b32 s44, s44, 8
    v_add_u32 v5, s44, v5
    v_lshlrev_b32 v11, 4, v11
    v_xor_b32 v12, 128, v11
    v_add_u32 v6, v5, v12
    v_add_u32 v5, v5, v11
    v_lshrrev_b32 v11, 3, v3
    v_and_b32 v12, 7, v3
    v_xor_b32 v12, v12, v11
    v_lshlrev_b32 v12, 4, v12
    s_cmp_eq_u32 s45, 2
    s_cbranch_scc1 dn_ls_pb_7
    s_add_u32 s20, s10, 58720256
    s_addc_u32 s21, s11, 0
    s_and_b32 s21, s21, 0xffff
    s_mov_b32 s22, 16777216
    s_mov_b32 s24, s6
    s_and_b32 s25, s7, 0xffff
    s_mov_b32 s26, 5242880
    s_lshl_b32 s40, s43, 13
    s_lshl_b32 s44, s45, 12
    s_add_u32 s40, s40, s44
    s_mov_b32 s42, 65536
    s_mul_i32 s41, s45, 2621440
    s_mov_b32 s35, 32
    v_lshl_add_u32 v4, v11, 13, v12
    s_branch dn_ls_dd_8
dn_ls_pb_7:
    s_add_u32 s20, s10, 50331648
    s_addc_u32 s21, s11, 0
    s_and_b32 s21, s21, 0xffff
    s_mov_b32 s22, 7077888
    s_mov_b32 s24, s8
    s_and_b32 s25, s9, 0xffff
    s_mov_b32 s26, 2211840
    s_mul_i32 s40, s43, 3456
    s_mov_b32 s42, 27648
    s_mov_b32 s41, 0
    s_mov_b32 s35, 27
    v_mul_u32_u24 v4, 3456, v11
    v_add_u32 v4, v4, v12
dn_ls_dd_8:
    s_mul_i32 s43, s3, 20480
    s_add_u32 s41, s41, s43
dn_ls_nodec_6:
    s_lshl_b32 s43, s3, 12
    s_add_u32 s43, s43, s34
    s_mov_b32 s44, s40
    s_add_u32 m0, s43, 0
    s_nop 0
    buffer_load_dwordx4 v4, s[20:23], s44 offen sc1 lds
    s_add_u32 m0, s43, 1024
    s_add_u32 s44, s44, s42
    buffer_load_dwordx4 v4, s[20:23], s44 offen sc1 lds
    s_add_u32 m0, s43, 2048
    s_add_u32 s44, s44, s42
    buffer_load_dwordx4 v4, s[20:23], s44 offen sc1 lds
    s_add_u32 m0, s43, 3072
    s_add_u32 s44, s44, s42
    buffer_load_dwordx4 v4, s[20:23], s44 offen sc1 lds
    s_add_u32 s40, s40, 128
    s_add_u32 s43, s43, 16384
    s_add_u32 m0, s43, 0
    s_add_u32 s44, s41, 0
    buffer_load_dwordx4 v5, s[24:27], s44 offen lds
    s_add_u32 m0, s43, 1024
    s_add_u32 s44, s41, 5120
    buffer_load_dwordx4 v5, s[24:27], s44 offen lds
    s_add_u32 m0, s43, 2048
    s_add_u32 s44, s41, 10240
    buffer_load_dwordx4 v6, s[24:27], s44 offen lds
    s_add_u32 m0, s43, 3072
    s_add_u32 s44, s41, 15360
    buffer_load_dwordx4 v6, s[24:27], s44 offen lds
    s_add_u32 s41, s41, 81920
    s_add_u32 s34, s34, 32768
    s_and_b32 s34, s34, 131071
    s_add_u32 s33, s33, 1
    s_cmp_lt_u32 s33, s35
    s_cbranch_scc1 dn_ls_skip_5
    s_mov_b32 s33, 0
    s_add_u32 s32, s32, 128
    s_cmp_ge_u32 s32, 240
    s_cselect_b32 s52, 1, 0
dn_ls_skip_5:
    s_cmp_lg_u32 s52, 0
    s_cbranch_scc1 dn_ls_skip_9
    s_cmp_lg_u32 s33, 0
    s_cbranch_scc1 dn_ls_nodec_10
    s_cmp_ge_u32 s32, 80
    s_cselect_b32 s45, 1, 0
    s_cmp_ge_u32 s32, 160
    s_cselect_b32 s45, 2, s45
    s_mul_i32 s43, s45, 80
    s_sub_u32 s43, s32, s43
    s_lshr_b32 s44, s43, 4
    s_and_b32 s43, s43, 15
    s_lshl_b32 s43, s43, 2
    s_add_u32 s43, s43, s3
    s_lshl_b32 s43, s43, 5
    v_lshlrev_b32 v11, 1, v2
    v_xor_b32 v11, v11, v1
    v_mul_u32_u24 v5, 1280, v2
    s_lshl_b32 s44, s44, 8
    v_add_u32 v5, s44, v5
    v_lshlrev_b32 v11, 4, v11
    v_xor_b32 v12, 128, v11
    v_add_u32 v6, v5, v12
    v_add_u32 v5, v5, v11
    v_lshrrev_b32 v11, 3, v3
    v_and_b32 v12, 7, v3
    v_xor_b32 v12, v12, v11
    v_lshlrev_b32 v12, 4, v12
    s_cmp_eq_u32 s45, 2
    s_cbranch_scc1 dn_ls_pb_11
    s_add_u32 s20, s10, 58720256
    s_addc_u32 s21, s11, 0
    s_and_b32 s21, s21, 0xffff
    s_mov_b32 s22, 16777216
    s_mov_b32 s24, s6
    s_and_b32 s25, s7, 0xffff
    s_mov_b32 s26, 5242880
    s_lshl_b32 s40, s43, 13
    s_lshl_b32 s44, s45, 12
    s_add_u32 s40, s40, s44
    s_mov_b32 s42, 65536
    s_mul_i32 s41, s45, 2621440
    s_mov_b32 s35, 32
    v_lshl_add_u32 v4, v11, 13, v12
    s_branch dn_ls_dd_12
dn_ls_pb_11:
    s_add_u32 s20, s10, 50331648
    s_addc_u32 s21, s11, 0
    s_and_b32 s21, s21, 0xffff
    s_mov_b32 s22, 7077888
    s_mov_b32 s24, s8
    s_and_b32 s25, s9, 0xffff
    s_mov_b32 s26, 2211840
    s_mul_i32 s40, s43, 3456
    s_mov_b32 s42, 27648
    s_mov_b32 s41, 0
    s_mov_b32 s35, 27
    v_mul_u32_u24 v4, 3456, v11
    v_add_u32 v4, v4, v12
dn_ls_dd_12:
    s_mul_i32 s43, s3, 20480
    s_add_u32 s41, s41, s43
dn_ls_nodec_10:
    s_lshl_b32 s43, s3, 12
    s_add_u32 s43, s43, s34
    s_mov_b32 s44, s40
    s_add_u32 m0, s43, 0
    s_nop 0
    buffer_load_dwordx4 v4, s[20:23], s44 offen sc1 lds
    s_add_u32 m0, s43, 1024
    s_add_u32 s44, s44, s42
    buffer_load_dwordx4 v4, s[20:23], s44 offen sc1 lds
    s_add_u32 m0, s43, 2048
    s_add_u32 s44, s44, s42
    buffer_load_dwordx4 v4, s[20:23], s44 offen sc1 lds
    s_add_u32 m0, s43, 3072
    s_add_u32 s44, s44, s42
    buffer_load_dwordx4 v4, s[20:23], s44 offen sc1 lds
    s_add_u32 s40, s40, 128
    s_add_u32 s43, s43, 16384
    s_add_u32 m0, s43, 0
    s_add_u32 s44, s41, 0
    buffer_load_dwordx4 v5, s[24:27], s44 offen lds
    s_add_u32 m0, s43, 1024
    s_add_u32 s44, s41, 5120
    buffer_load_dwordx4 v5, s[24:27], s44 offen lds
    s_add_u32 m0, s43, 2048
    s_add_u32 s44, s41, 10240
    buffer_load_dwordx4 v6, s[24:27], s44 offen lds
    s_add_u32 m0, s43, 3072
    s_add_u32 s44, s41, 15360
    buffer_load_dwordx4 v6, s[24:27], s44 offen lds
    s_add_u32 s41, s41, 81920
    s_add_u32 s34, s34, 32768
    s_and_b32 s34, s34, 131071
    s_add_u32 s33, s33, 1
    s_cmp_lt_u32 s33, s35
    s_cbranch_scc1 dn_ls_skip_9
    s_mov_b32 s33, 0
    s_add_u32 s32, s32, 128
    s_cmp_ge_u32 s32, 240
    s_cselect_b32 s52, 1, 0
dn_ls_skip_9:
    s_cmp_lg_u32 s52, 0
    s_cbranch_scc1 dn_ls_skip_13
    s_cmp_lg_u32 s33, 0
    s_cbranch_scc1 dn_ls_nodec_14
    s_cmp_ge_u32 s32, 80
    s_cselect_b32 s45, 1, 0
    s_cmp_ge_u32 s32, 160
    s_cselect_b32 s45, 2, s45
    s_mul_i32 s43, s45, 80
    s_sub_u32 s43, s32, s43
    s_lshr_b32 s44, s43, 4
    s_and_b32 s43, s43, 15
    s_lshl_b32 s43, s43, 2
    s_add_u32 s43, s43, s3
    s_lshl_b32 s43, s43, 5
    v_lshlrev_b32 v11, 1, v2
    v_xor_b32 v11, v11, v1
    v_mul_u32_u24 v5, 1280, v2
    s_lshl_b32 s44, s44, 8
    v_add_u32 v5, s44, v5
    v_lshlrev_b32 v11, 4, v11
    v_xor_b32 v12, 128, v11
    v_add_u32 v6, v5, v12
    v_add_u32 v5, v5, v11
    v_lshrrev_b32 v11, 3, v3
    v_and_b32 v12, 7, v3
    v_xor_b32 v12, v12, v11
    v_lshlrev_b32 v12, 4, v12
    s_cmp_eq_u32 s45, 2
    s_cbranch_scc1 dn_ls_pb_15
    s_add_u32 s20, s10, 58720256
    s_addc_u32 s21, s11, 0
    s_and_b32 s21, s21, 0xffff
    s_mov_b32 s22, 16777216
    s_mov_b32 s24, s6
    s_and_b32 s25, s7, 0xffff
    s_mov_b32 s26, 5242880
    s_lshl_b32 s40, s43, 13
    s_lshl_b32 s44, s45, 12
    s_add_u32 s40, s40, s44
    s_mov_b32 s42, 65536
    s_mul_i32 s41, s45, 2621440
    s_mov_b32 s35, 32
    v_lshl_add_u32 v4, v11, 13, v12
    s_branch dn_ls_dd_16
dn_ls_pb_15:
    s_add_u32 s20, s10, 50331648
    s_addc_u32 s21, s11, 0
    s_and_b32 s21, s21, 0xffff
    s_mov_b32 s22, 7077888
    s_mov_b32 s24, s8
    s_and_b32 s25, s9, 0xffff
    s_mov_b32 s26, 2211840
    s_mul_i32 s40, s43, 3456
    s_mov_b32 s42, 27648
    s_mov_b32 s41, 0
    s_mov_b32 s35, 27
    v_mul_u32_u24 v4, 3456, v11
    v_add_u32 v4, v4, v12
dn_ls_dd_16:
    s_mul_i32 s43, s3, 20480
    s_add_u32 s41, s41, s43
dn_ls_nodec_14:
    s_lshl_b32 s43, s3, 12
    s_add_u32 s43, s43, s34
    s_mov_b32 s44, s40
    s_add_u32 m0, s43, 0
    s_nop 0
    buffer_load_dwordx4 v4, s[20:23], s44 offen sc1 lds
    s_add_u32 m0, s43, 1024
    s_add_u32 s44, s44, s42
    buffer_load_dwordx4 v4, s[20:23], s44 offen sc1 lds
    s_add_u32 m0, s43, 2048
    s_add_u32 s44, s44, s42
    buffer_load_dwordx4 v4, s[20:23], s44 offen sc1 lds
    s_add_u32 m0, s43, 3072
    s_add_u32 s44, s44, s42
    buffer_load_dwordx4 v4, s[20:23], s44 offen sc1 lds
    s_add_u32 s40, s40, 128
    s_add_u32 s43, s43, 16384
    s_add_u32 m0, s43, 0
    s_add_u32 s44, s41, 0
    buffer_load_dwordx4 v5, s[24:27], s44 offen lds
    s_add_u32 m0, s43, 1024
    s_add_u32 s44, s41, 5120
    buffer_load_dwordx4 v5, s[24:27], s44 offen lds
    s_add_u32 m0, s43, 2048
    s_add_u32 s44, s41, 10240
    buffer_load_dwordx4 v6, s[24:27], s44 offen lds
    s_add_u32 m0, s43, 3072
    s_add_u32 s44, s41, 15360
    buffer_load_dwordx4 v6, s[24:27], s44 offen lds
    s_add_u32 s41, s41, 81920
    s_add_u32 s34, s34, 32768
    s_and_b32 s34, s34, 131071
    s_add_u32 s33, s33, 1
    s_cmp_lt_u32 s33, s35
    s_cbranch_scc1 dn_ls_skip_13
    s_mov_b32 s33, 0
    s_add_u32 s32, s32, 128
    s_cmp_ge_u32 s32, 240
    s_cselect_b32 s52, 1, 0
dn_ls_skip_13:
    s_cmp_ge_u32 s36, 160
    s_cselect_b32 s39, 27, 32
    s_waitcnt vmcnt(24)
    s_barrier
    v_add_u32 v9, s38, v7
    v_xor_b32 v14, 64, v9
    v_add_u32 v10, s38, v8
    v_xor_b32 v152, 0, v10
    v_xor_b32 v153, 32, v10
    v_xor_b32 v154, 64, v10
    v_xor_b32 v155, 96, v10
    ds_read_b128 v[16:19], v9 offset:0
    ds_read_b128 v[20:23], v9 offset:2048
    ds_read_b128 v[24:27], v9 offset:4096
    ds_read_b128 v[28:31], v9 offset:6144
    ds_read_b64_tr_b16 v[48:49], v152 offset:0
    ds_read_b64_tr_b16 v[50:51], v152 offset:1024
    ds_read_b64_tr_b16 v[52:53], v153 offset:0
    ds_read_b64_tr_b16 v[54:55], v153 offset:1024
    ds_read_b64_tr_b16 v[56:57], v154 offset:0
    ds_read_b64_tr_b16 v[58:59], v154 offset:1024
    ds_read_b64_tr_b16 v[60:61], v155 offset:0
    ds_read_b64_tr_b16 v[62:63], v155 offset:1024
dn_loop:
    ds_read_b128 v[32:35], v14 offset:0
    ds_read_b128 v[36:39], v14 offset:2048
    ds_read_b128 v[40:43], v14 offset:4096
    ds_read_b128 v[44:47], v14 offset:6144
    ds_read_b64_tr_b16 v[64:65], v152 offset:8192
    ds_read_b64_tr_b16 v[66:67], v152 offset:9216
    ds_read_b64_tr_b16 v[68:69], v153 offset:8192
    ds_read_b64_tr_b16 v[70:71], v153 offset:9216
    ds_read_b64_tr_b16 v[72:73], v154 offset:8192
    ds_read_b64_tr_b16 v[74:75], v154 offset:9216
    ds_read_b64_tr_b16 v[76:77], v155 offset:8192
    ds_read_b64_tr_b16 v[78:79], v155 offset:9216
    s_waitcnt lgkmcnt(12)
    s_cmp_eq_u32 s37, 0
    s_cbranch_scc1 dn_f1
    v_mfma_f32_16x16x32_bf16 v[80:83], v[48:51], v[16:19], v[80:83]
    v_mfma_f32_16x16x32_bf16 v[96:99], v[52:55], v[16:19], v[96:99]
    v_mfma_f32_16x16x32_bf16 v[112:115], v[56:59], v[16:19], v[112:115]
    v_mfma_f32_16x16x32_bf16 v[128:131], v[60:63], v[16:19], v[128:131]
    v_mfma_f32_16x16x32_bf16 v[84:87], v[48:51], v[20:23], v[84:87]
    v_mfma_f32_16x16x32_bf16 v[100:103], v[52:55], v[20:23], v[100:103]
    v_mfma_f32_16x16x32_bf16 v[116:119], v[56:59], v[20:23], v[116:119]
    v_mfma_f32_16x16x32_bf16 v[132:135], v[60:63], v[20:23], v[132:135]
    v_mfma_f32_16x16x32_bf16 v[88:91], v[48:51], v[24:27], v[88:91]
    v_mfma_f32_16x16x32_bf16 v[104:107], v[52:55], v[24:27], v[104:107]
    v_mfma_f32_16x16x32_bf16 v[120:123], v[56:59], v[24:27], v[120:123]
    v_mfma_f32_16x16x32_bf16 v[136:139], v[60:63], v[24:27], v[136:139]
    v_mfma_f32_16x16x32_bf16 v[92:95], v[48:51], v[28:31], v[92:95]
    v_mfma_f32_16x16x32_bf16 v[108:111], v[52:55], v[28:31], v[108:111]
    v_mfma_f32_16x16x32_bf16 v[124:127], v[56:59], v[28:31], v[124:127]
    v_mfma_f32_16x16x32_bf16 v[140:143], v[60:63], v[28:31], v[140:143]
    s_branch dn_f2
dn_f1:
    v_mfma_f32_16x16x32_bf16 v[80:83], v[48:51], v[16:19], 0
    v_mfma_f32_16x16x32_bf16 v[96:99], v[52:55], v[16:19], 0
    v_mfma_f32_16x16x32_bf16 v[112:115], v[56:59], v[16:19], 0
    v_mfma_f32_16x16x32_bf16 v[128:131], v[60:63], v[16:19], 0
    v_mfma_f32_16x16x32_bf16 v[84:87], v[48:51], v[20:23], 0
    v_mfma_f32_16x16x32_bf16 v[100:103], v[52:55], v[20:23], 0
    v_mfma_f32_16x16x32_bf16 v[116:119], v[56:59], v[20:23], 0
    v_mfma_f32_16x16x32_bf16 v[132:135], v[60:63], v[20:23], 0
    v_mfma_f32_16x16x32_bf16 v[88:91], v[48:51], v[24:27], 0
    v_mfma_f32_16x16x32_bf16 v[104:107], v[52:55], v[24:27], 0
    v_mfma_f32_16x16x32_bf16 v[120:123], v[56:59], v[24:27], 0
    v_mfma_f32_16x16x32_bf16 v[136:139], v[60:63], v[24:27], 0
    v_mfma_f32_16x16x32_bf16 v[92:95], v[48:51], v[28:31], 0
    v_mfma_f32_16x16x32_bf16 v[108:111], v[52:55], v[28:31], 0
    v_mfma_f32_16x16x32_bf16 v[124:127], v[56:59], v[28:31], 0
    v_mfma_f32_16x16x32_bf16 v[140:143], v[60:63], v[28:31], 0
dn_f2:
    s_cmp_lg_u32 s52, 0
    s_cbranch_scc1 dn_w0
    s_waitcnt vmcnt(16) lgkmcnt(0)
    s_branch dn_w1
dn_w0:
    s_waitcnt vmcnt(0) lgkmcnt(0)
dn_w1:
    s_barrier
    s_cmp_lg_u32 s52, 0
    s_cbranch_scc1 dn_ls_skip_17
    s_cmp_lg_u32 s33, 0
    s_cbranch_scc1 dn_ls_nodec_18
    s_cmp_ge_u32 s32, 80
    s_cselect_b32 s45, 1, 0
    s_cmp_ge_u32 s32, 160
    s_cselect_b32 s45, 2, s45
    s_mul_i32 s43, s45, 80
    s_sub_u32 s43, s32, s43
    s_lshr_b32 s44, s43, 4
    s_and_b32 s43, s43, 15
    s_lshl_b32 s43, s43, 2
    s_add_u32 s43, s43, s3
    s_lshl_b32 s43, s43, 5
    v_lshlrev_b32 v11, 1, v2
    v_xor_b32 v11, v11, v1
    v_mul_u32_u24 v5, 1280, v2
    s_lshl_b32 s44, s44, 8
    v_add_u32 v5, s44, v5
    v_lshlrev_b32 v11, 4, v11
    v_xor_b32 v12, 128, v11
    v_add_u32 v6, v5, v12
    v_add_u32 v5, v5, v11
    v_lshrrev_b32 v11, 3, v3
    v_and_b32 v12, 7, v3
    v_xor_b32 v12, v12, v11
    v_lshlrev_b32 v12, 4, v12
    s_cmp_eq_u32 s45, 2
    s_cbranch_scc1 dn_ls_pb_19
    s_add_u32 s20, s10, 58720256
    s_addc_u32 s21, s11, 0
    s_and_b32 s21, s21, 0xffff
    s_mov_b32 s22, 16777216
    s_mov_b32 s24, s6
    s_and_b32 s25, s7, 0xffff
    s_mov_b32 s26, 5242880
    s_lshl_b32 s40, s43, 13
    s_lshl_b32 s44, s45, 12
    s_add_u32 s40, s40, s44
    s_mov_b32 s42, 65536
    s_mul_i32 s41, s45, 2621440
    s_mov_b32 s35, 32
    v_lshl_add_u32 v4, v11, 13, v12
    s_branch dn_ls_dd_20
dn_ls_pb_19:
    s_add_u32 s20, s10, 50331648
    s_addc_u32 s21, s11, 0
    s_and_b32 s21, s21, 0xffff
    s_mov_b32 s22, 7077888
    s_mov_b32 s24, s8
    s_and_b32 s25, s9, 0xffff
    s_mov_b32 s26, 2211840
    s_mul_i32 s40, s43, 3456
    s_mov_b32 s42, 27648
    s_mov_b32 s41, 0
    s_mov_b32 s35, 27
    v_mul_u32_u24 v4, 3456, v11
    v_add_u32 v4, v4, v12
dn_ls_dd_20:
    s_mul_i32 s43, s3, 20480
    s_add_u32 s41, s41, s43
dn_ls_nodec_18:
    s_lshl_b32 s43, s3, 12
    s_add_u32 s43, s43, s34
    s_mov_b32 s44, s40
    s_add_u32 m0, s43, 0
    s_nop 0
    buffer_load_dwordx4 v4, s[20:23], s44 offen sc1 lds
    s_add_u32 m0, s43, 1024
    s_add_u32 s44, s44, s42
    buffer_load_dwordx4 v4, s[20:23], s44 offen sc1 lds
    s_add_u32 m0, s43, 2048
    s_add_u32 s44, s44, s42
    buffer_load_dwordx4 v4, s[20:23], s44 offen sc1 lds
    s_add_u32 m0, s43, 3072
    s_add_u32 s44, s44, s42
    buffer_load_dwordx4 v4, s[20:23], s44 offen sc1 lds
    s_add_u32 s40, s40, 128
    s_add_u32 s43, s43, 16384
    s_add_u32 m0, s43, 0
    s_add_u32 s44, s41, 0
    buffer_load_dwordx4 v5, s[24:27], s44 offen lds
    s_add_u32 m0, s43, 1024
    s_add_u32 s44, s41, 5120
    buffer_load_dwordx4 v5, s[24:27], s44 offen lds
    s_add_u32 m0, s43, 2048
    s_add_u32 s44, s41, 10240
    buffer_load_dwordx4 v6, s[24:27], s44 offen lds
    s_add_u32 m0, s43, 3072
    s_add_u32 s44, s41, 15360
    buffer_load_dwordx4 v6, s[24:27], s44 offen lds
    s_add_u32 s41, s41, 81920
    s_add_u32 s34, s34, 32768
    s_and_b32 s34, s34, 131071
    s_add_u32 s33, s33, 1
    s_cmp_lt_u32 s33, s35
    s_cbranch_scc1 dn_ls_skip_17
    s_mov_b32 s33, 0
    s_add_u32 s32, s32, 128
    s_cmp_ge_u32 s32, 240
    s_cselect_b32 s52, 1, 0
dn_ls_skip_17:
    s_add_u32 s38, s38, 32768
    s_and_b32 s38, s38, 131071
    v_add_u32 v9, s38, v7
    v_xor_b32 v14, 64, v9
    v_add_u32 v10, s38, v8
    v_xor_b32 v152, 0, v10
    v_xor_b32 v153, 32, v10
    v_xor_b32 v154, 64, v10
    v_xor_b32 v155, 96, v10
    ds_read_b128 v[16:19], v9 offset:0
    ds_read_b128 v[20:23], v9 offset:2048
    ds_read_b128 v[24:27], v9 offset:4096
    ds_read_b128 v[28:31], v9 offset:6144
    ds_read_b64_tr_b16 v[48:49], v152 offset:0
    ds_read_b64_tr_b16 v[50:51], v152 offset:1024
    ds_read_b64_tr_b16 v[52:53], v153 offset:0
    ds_read_b64_tr_b16 v[54:55], v153 offset:1024
    ds_read_b64_tr_b16 v[56:57], v154 offset:0
    ds_read_b64_tr_b16 v[58:59], v154 offset:1024
    ds_read_b64_tr_b16 v[60:61], v155 offset:0
    ds_read_b64_tr_b16 v[62:63], v155 offset:1024
    v_mfma_f32_16x16x32_bf16 v[80:83], v[64:67], v[32:35], v[80:83]
    v_mfma_f32_16x16x32_bf16 v[96:99], v[68:71], v[32:35], v[96:99]
    v_mfma_f32_16x16x32_bf16 v[112:115], v[72:75], v[32:35], v[112:115]
    v_mfma_f32_16x16x32_bf16 v[128:131], v[76:79], v[32:35], v[128:131]
    v_mfma_f32_16x16x32_bf16 v[84:87], v[64:67], v[36:39], v[84:87]
    v_mfma_f32_16x16x32_bf16 v[100:103], v[68:71], v[36:39], v[100:103]
    v_mfma_f32_16x16x32_bf16 v[116:119], v[72:75], v[36:39], v[116:119]
    v_mfma_f32_16x16x32_bf16 v[132:135], v[76:79], v[36:39], v[132:135]
    v_mfma_f32_16x16x32_bf16 v[88:91], v[64:67], v[40:43], v[88:91]
    v_mfma_f32_16x16x32_bf16 v[104:107], v[68:71], v[40:43], v[104:107]
    v_mfma_f32_16x16x32_bf16 v[120:123], v[72:75], v[40:43], v[120:123]
    v_mfma_f32_16x16x32_bf16 v[136:139], v[76:79], v[40:43], v[136:139]
    v_mfma_f32_16x16x32_bf16 v[92:95], v[64:67], v[44:47], v[92:95]
    v_mfma_f32_16x16x32_bf16 v[108:111], v[68:71], v[44:47], v[108:111]
    v_mfma_f32_16x16x32_bf16 v[124:127], v[72:75], v[44:47], v[124:127]
    v_mfma_f32_16x16x32_bf16 v[140:143], v[76:79], v[44:47], v[140:143]
    s_add_u32 s37, s37, 1
    s_cmp_lt_u32 s37, s39
    s_cbranch_scc1 dn_loop
    s_nop 7
    s_sub_u32 s43, s36, 160
    s_lshr_b32 s44, s43, 4
    s_and_b32 s43, s43, 15
    s_lshl_b32 s45, s43, 1
    s_add_u32 s45, s45, s4
    s_mul_i32 s45, s45, 81920
    s_lshl_b32 s44, s44, 1
    s_add_u32 s44, s44, s5
    s_lshl_b32 s44, s44, 7
    s_add_u32 s45, s45, s44
    s_add_u32 s45, s45, 109051904
    s_add_u32 s50, s10, s45
    s_addc_u32 s51, s11, 0
    v_mul_u32_u24 v15, 1280, v1
    v_lshl_add_u32 v15, v2, 3, v15
    v_cvt_pk_bf16_f32 v144, v80, v81
    v_cvt_pk_bf16_f32 v145, v82, v83
    global_store_dwordx2 v15, v[144:145], s[50:51] offset:0 sc1
    v_cvt_pk_bf16_f32 v146, v96, v97
    v_cvt_pk_bf16_f32 v147, v98, v99
    global_store_dwordx2 v15, v[146:147], s[50:51] offset:32 sc1
    v_cvt_pk_bf16_f32 v144, v112, v113
    v_cvt_pk_bf16_f32 v145, v114, v115
    global_store_dwordx2 v15, v[144:145], s[50:51] offset:64 sc1
    v_cvt_pk_bf16_f32 v146, v128, v129
    v_cvt_pk_bf16_f32 v147, v130, v131
    global_store_dwordx2 v15, v[146:147], s[50:51] offset:96 sc1
    v_add_u32 v15, 20480, v15
    v_cvt_pk_bf16_f32 v144, v84, v85
    v_cvt_pk_bf16_f32 v145, v86, v87
    global_store_dwordx2 v15, v[144:145], s[50:51] offset:0 sc1
    v_cvt_pk_bf16_f32 v146, v100, v101
    v_cvt_pk_bf16_f32 v147, v102, v103
    global_store_dwordx2 v15, v[146:147], s[50:51] offset:32 sc1
    v_cvt_pk_bf16_f32 v144, v116, v117
    v_cvt_pk_bf16_f32 v145, v118, v119
    global_store_dwordx2 v15, v[144:145], s[50:51] offset:64 sc1
    v_cvt_pk_bf16_f32 v146, v132, v133
    v_cvt_pk_bf16_f32 v147, v134, v135
    global_store_dwordx2 v15, v[146:147], s[50:51] offset:96 sc1
    v_add_u32 v15, 20480, v15
    v_cvt_pk_bf16_f32 v144, v88, v89
    v_cvt_pk_bf16_f32 v145, v90, v91
    global_store_dwordx2 v15, v[144:145], s[50:51] offset:0 sc1
    v_cvt_pk_bf16_f32 v146, v104, v105
    v_cvt_pk_bf16_f32 v147, v106, v107
    global_store_dwordx2 v15, v[146:147], s[50:51] offset:32 sc1
    v_cvt_pk_bf16_f32 v144, v120, v121
    v_cvt_pk_bf16_f32 v145, v122, v123
    global_store_dwordx2 v15, v[144:145], s[50:51] offset:64 sc1
    v_cvt_pk_bf16_f32 v146, v136, v137
    v_cvt_pk_bf16_f32 v147, v138, v139
    global_store_dwordx2 v15, v[146:147], s[50:51] offset:96 sc1
    v_add_u32 v15, 20480, v15
    v_cvt_pk_bf16_f32 v144, v92, v93
    v_cvt_pk_bf16_f32 v145, v94, v95
    global_store_dwordx2 v15, v[144:145], s[50:51] offset:0 sc1
    v_cvt_pk_bf16_f32 v146, v108, v109
    v_cvt_pk_bf16_f32 v147, v110, v111
    global_store_dwordx2 v15, v[146:147], s[50:51] offset:32 sc1
    v_cvt_pk_bf16_f32 v144, v124, v125
    v_cvt_pk_bf16_f32 v145, v126, v127
    global_store_dwordx2 v15, v[144:145], s[50:51] offset:64 sc1
    v_cvt_pk_bf16_f32 v146, v140, v141
    v_cvt_pk_bf16_f32 v147, v142, v143
    global_store_dwordx2 v15, v[146:147], s[50:51] offset:96 sc1
    s_waitcnt vmcnt(0) lgkmcnt(0)
    s_barrier
    s_lshl_b32 s43, s43, 2
    s_cmp_lg_u32 s3, 0
    s_cbranch_scc1 dn_sg_n
    v_mov_b32 v144, 16777216
    v_mov_b32 v145, s43
    s_mov_b64 exec, 1
    global_atomic_add v145, v144, s[98:99] sc1
    s_mov_b64 exec, -1
dn_sg_n:
mega_tail:
    s_load_dwordx2 s[6:7], s[0:1], 112
    s_load_dwordx2 s[30:31], s[0:1], 96
    s_load_dwordx2 s[32:33], s[0:1], 40
    v_lshrrev_b32 v4, 6, v0
    v_and_b32 v3, 63, v0
    v_readfirstlane_b32 s3, v4
    v_and_b32 v1, 15, v0
    v_lshrrev_b32 v2, 4, v3
    v_cmp_gt_u32 s[16:17], 2, v2
    v_lshlrev_b32 v4, 2, v2
    v_add_u32 v5, 0, v4
    v_cmp_le_u32 s[18:19], v5, v1
    v_add_u32 v5, 1, v4
    v_cmp_le_u32 s[20:21], v5, v1
    v_add_u32 v5, 2, v4
    v_cmp_le_u32 s[22:23], v5, v1
    v_add_u32 v5, 3, v4
    v_cmp_le_u32 s[24:25], v5, v1
    v_lshlrev_b32 v8, 13, v1
    v_lshl_add_u32 v8, v2, 4, v8
    v_and_b32 v4, 7, v1
    v_lshlrev_b32 v9, 13, v4
    v_lshl_add_u32 v9, v2, 4, v9
    v_lshlrev_b32 v10, 12, v1
    v_lshl_add_u32 v10, v2, 3, v10
    v_and_b32 v4, 1, v2
    v_lshlrev_b32 v11, 4, v1
    v_lshl_add_u32 v11, v4, 3, v11
    v_lshlrev_b32 v8, 4, v3
    v_add_u32 v10, 4096, v8
    v_and_b32 v4, 7, v1
    v_lshlrev_b32 v9, 4, v4
    v_lshl_add_u32 v9, v2, 7, v9
    s_mov_b32 s14, 1040356334
    v_mov_b32 v21, 0
    v_lshlrev_b32 v22, 2, v3
    s_mov_b32 s42, 0
    v_lshrrev_b32 v4, 2, v3
    v_mul_u32_u24 v12, 1280, v4
    v_and_b32 v5, 3, v3
    v_lshl_add_u32 v12, v5, 4, v12
    v_lshrrev_b32 v4, 2, v1
    v_lshl_add_u32 v4, v2, 2, v4
    v_lshlrev_b32 v13, 6, v4
    v_lshl_add_u32 v13, v5, 3, v13
    s_lshl_b32 s41, s3, 15
    v_add_u32 v13, s41, v13
    v_lshlrev_b32 v14, 4, v3
    s_lshl_b32 s12, s3, 10
    v_add_u32 v15, s12, v14
    v_add_u32 v14, s41, v14
    v_mul_u32_u24 v16, 1280, v1
    v_lshl_add_u32 v16, v2, 3, v16
    s_lshr_b32 s12, s3, 1
    s_mul_i32 s12, s12, 20480
    s_and_b32 s13, s3, 1
    s_lshl_b32 s13, s13, 5
    s_add_u32 s12, s12, s13
    v_add_u32 v16, s12, v16
    s_waitcnt lgkmcnt(0)
    s_mov_b32 s36, s32
    s_and_b32 s37, s33, 0xffff
    s_mov_b32 s38, 5242880
    s_mov_b32 s39, 0x00020000
    s_mov_b32 s12, 64
    s_cmp_lg_u32 s3, 0
    s_cbranch_scc1 tl_cw_d
    v_mov_b32 v5, s12
    s_mov_b32 s15, 0
tl_cw_l:
    global_load_dword v4, v5, s[98:99] sc1
    s_add_u32 s15, s15, 1
    s_waitcnt vmcnt(0)
    v_readfirstlane_b32 s13, v4
    s_lshr_b32 s13, s13, 0
    s_and_b32 s13, s13, 255
    s_cmp_eq_u32 s13, 64
    s_cbranch_scc1 tl_cw_d
    s_cmp_ge_u32 s15, 8192
    s_cbranch_scc1 tl_cw_d
    s_sleep 100
    s_branch tl_cw_l
tl_cw_d:
    s_barrier
    s_cmp_lt_u32 s100, 80
    s_cbranch_scc1 tl_wo_init
    s_sub_u32 s26, s100, 80
tl_loop:
    s_lshr_b32 s4, s26, 3
    s_and_b32 s27, s26, 7
    s_lshr_b32 s12, s4, 2
    s_lshl_b32 s12, s12, 2
    s_lshr_b32 s12, s4, 2
    s_mov_b32 s28, 0
tl_af_c:
    v_readlane_b32 s13, v21, s12
    s_and_b32 s13, s13, 255
    s_cmp_lg_u32 s13, 64
    s_cbranch_scc1 tl_af_r
    v_readlane_b32 s13, v21, s12
    s_lshr_b32 s13, s13, 8
    s_and_b32 s13, s13, 255
    s_cmp_lg_u32 s13, 32
    s_cbranch_scc1 tl_af_r
    s_branch tl_af_d
tl_af_r:
    s_cmp_ge_u32 s28, 8192
    s_cbranch_scc1 tl_af_d
    s_cmp_eq_u32 s28, 0
    s_cbranch_scc1 tl_af_n
    s_sleep 100
tl_af_n:
    global_load_dword v21, v22, s[98:99] sc1
    s_add_u32 s28, s28, 1
    s_waitcnt vmcnt(0)
    s_branch tl_af_c
tl_af_d:
    s_lshl_b32 s5, s27, 2
    s_add_u32 s5, s5, s3
    s_lshl_b32 s12, s4, 18
    s_lshl_b32 s13, s5, 12
    s_add_u32 s12, s12, s13
    s_add_u32 s8, s6, s12
    s_addc_u32 s9, s7, 0
    s_add_u32 s10, s8, 16777216
    s_addc_u32 s11, s9, 0
    v_add_u32 v4, 0x20000, v8
    global_load_dwordx4 v[28:31], v8, s[8:9] offset:0 sc1
    global_load_dwordx4 v[32:35], v8, s[8:9] offset:1024 sc1
    global_load_dwordx4 v[36:39], v8, s[8:9] offset:2048 sc1
    global_load_dwordx4 v[40:43], v8, s[8:9] offset:3072 sc1
    global_load_dwordx4 v[44:47], v4, s[8:9] offset:0 sc1
    global_load_dwordx4 v[48:51], v4, s[8:9] offset:1024 sc1
    global_load_dwordx4 v[52:55], v4, s[8:9] offset:2048 sc1
    global_load_dwordx4 v[56:59], v4, s[8:9] offset:3072 sc1
    global_load_dwordx4 v[76:79], v8, s[10:11] offset:0 sc1
    global_load_dwordx4 v[80:83], v8, s[10:11] offset:1024 sc1
    global_load_dwordx4 v[84:87], v8, s[10:11] offset:2048 sc1
    global_load_dwordx4 v[88:91], v8, s[10:11] offset:3072 sc1
    global_load_dwordx4 v[92:95], v4, s[10:11] offset:0 sc1
    global_load_dwordx4 v[96:99], v4, s[10:11] offset:1024 sc1
    global_load_dwordx4 v[100:103], v4, s[10:11] offset:2048 sc1
    global_load_dwordx4 v[104:107], v4, s[10:11] offset:3072 sc1
    s_lshl_b32 s12, s5, 13
    s_lshl_b32 s13, s4, 18
    s_add_u32 s12, s12, s13
    s_add_u32 s12, s12, 33554432
    s_add_u32 s8, s6, s12
    s_addc_u32 s9, s7, 0
    global_load_dwordx4 v[110:113], v10, s[8:9] offset:-4096 sc1
    global_load_dwordx4 v[116:119], v10, s[8:9] offset:-3072 sc1
    global_load_dwordx4 v[122:125], v10, s[8:9] offset:-2048 sc1
    global_load_dwordx4 v[128:131], v10, s[8:9] offset:-1024 sc1
    global_load_dwordx4 v[134:137], v10, s[8:9] offset:0 sc1
    global_load_dwordx4 v[140:143], v10, s[8:9] offset:1024 sc1
    global_load_dwordx4 v[146:149], v10, s[8:9] offset:2048 sc1
    global_load_dwordx4 v[152:155], v10, s[8:9] offset:3072 sc1
    s_cmp_ge_u32 s4, 60
    s_cselect_b32 s29, 2, 0
    s_sub_u32 s29, s4, s29
    s_cmp_gt_u32 s42, s29
    s_cbranch_scc1 tl_pd
    s_lshl_b32 s12, s5, 4
    s_add_u32 s12, s12, 117440512
    s_add_u32 s8, s6, s12
    s_addc_u32 s9, s7, 0
    v_and_b32 v5, 12, v22
    s_mov_b32 s28, 0
tl_pl:
    global_load_dword v4, v5, s[8:9] sc1
    s_add_u32 s28, s28, 1
    s_waitcnt vmcnt(0)
    v_readlane_b32 s42, v4, 0
    v_readlane_b32 s12, v4, 1
    s_min_u32 s42, s42, s12
    v_readlane_b32 s12, v4, 2
    s_min_u32 s42, s42, s12
    v_readlane_b32 s12, v4, 3
    s_min_u32 s42, s42, s12
    s_cmp_gt_u32 s42, s29
    s_cbranch_scc1 tl_pd
    s_cmp_ge_u32 s28, 8192
    s_cbranch_scc1 tl_pd
    s_sleep 8
    s_branch tl_pl
tl_pd:
    s_lshl_b32 s13, s5, 11
    s_lshl_b32 s12, s4, 16
    s_add_u32 s12, s12, s13
    s_add_u32 s12, s12, 75497472
    s_add_u32 s8, s6, s12
    s_addc_u32 s9, s7, 0
    s_lshl_b32 s12, s4, 16
    s_lshl_b32 s13, s5, 11
    s_add_u32 s12, s12, s13
    s_add_u32 s12, s12, 79691776
    s_add_u32 s10, s6, s12
    s_addc_u32 s11, s7, 0
    s_mov_b32 s28, 0
tl_kl:
    global_load_dwordx4 v[60:63], v9, s[8:9] offset:0 sc1
    global_load_dwordx4 v[64:67], v9, s[8:9] offset:512 sc1
    global_load_dwordx4 v[68:71], v9, s[8:9] offset:1024 sc1
    global_load_dwordx4 v[72:75], v9, s[8:9] offset:1536 sc1
    global_load_dwordx2 v[108:109], v11, s[10:11] offset:0 sc1
    global_load_dwordx2 v[114:115], v11, s[10:11] offset:256 sc1
    global_load_dwordx2 v[120:121], v11, s[10:11] offset:512 sc1
    global_load_dwordx2 v[126:127], v11, s[10:11] offset:768 sc1
    global_load_dwordx2 v[132:133], v11, s[10:11] offset:1024 sc1
    global_load_dwordx2 v[138:139], v11, s[10:11] offset:1280 sc1
    global_load_dwordx2 v[144:145], v11, s[10:11] offset:1536 sc1
    global_load_dwordx2 v[150:151], v11, s[10:11] offset:1792 sc1
    s_cmp_lt_u32 s4, 60
    s_cbranch_scc1 tl_kd
    s_add_u32 s28, s28, 1
    s_waitcnt vmcnt(0)
    v_max3_u32 v4, v63, v67, v71
    v_max3_u32 v5, v75, v109, v115
    v_max3_u32 v4, v121, v127, v4
    v_max3_u32 v5, v133, v139, v5
    v_max3_u32 v4, v145, v151, v4
    v_max_u32 v4, v4, v5
    v_cmp_eq_u32 vcc, -1, v4
    s_cmp_ge_u32 s28, 8192
    s_cbranch_scc1 tl_kd
    s_cbranch_vccz tl_kd
    s_sleep 5
    s_branch tl_kl
tl_kd:
    s_waitcnt vmcnt(8)
    v_mfma_f32_16x16x32_bf16 v[156:159], v[60:63], v[28:31], 0
    v_mfma_f32_16x16x32_bf16 v[160:163], v[76:79], v[28:31], 0
    v_mfma_f32_16x16x32_bf16 v[164:167], v[60:63], v[44:47], 0
    v_mfma_f32_16x16x32_bf16 v[168:171], v[76:79], v[44:47], 0
    v_mfma_f32_16x16x32_bf16 v[172:175], v[92:95], v[44:47], 0
    v_mfma_f32_16x16x32_bf16 v[156:159], v[64:67], v[32:35], v[156:159]
    v_mfma_f32_16x16x32_bf16 v[160:163], v[80:83], v[32:35], v[160:163]
    v_mfma_f32_16x16x32_bf16 v[164:167], v[64:67], v[48:51], v[164:167]
    v_mfma_f32_16x16x32_bf16 v[168:171], v[80:83], v[48:51], v[168:171]
    v_mfma_f32_16x16x32_bf16 v[172:175], v[96:99], v[48:51], v[172:175]
    v_mfma_f32_16x16x32_bf16 v[156:159], v[68:71], v[36:39], v[156:159]
    v_mfma_f32_16x16x32_bf16 v[160:163], v[84:87], v[36:39], v[160:163]
    v_mfma_f32_16x16x32_bf16 v[164:167], v[68:71], v[52:55], v[164:167]
    v_mfma_f32_16x16x32_bf16 v[168:171], v[84:87], v[52:55], v[168:171]
    v_mfma_f32_16x16x32_bf16 v[172:175], v[100:103], v[52:55], v[172:175]
    v_mfma_f32_16x16x32_bf16 v[156:159], v[72:75], v[40:43], v[156:159]
    v_mfma_f32_16x16x32_bf16 v[160:163], v[88:91], v[40:43], v[160:163]
    v_mfma_f32_16x16x32_bf16 v[164:167], v[72:75], v[56:59], v[164:167]
    v_mfma_f32_16x16x32_bf16 v[168:171], v[88:91], v[56:59], v[168:171]
    v_mfma_f32_16x16x32_bf16 v[172:175], v[104:107], v[56:59], v[172:175]
    s_nop 7
    s_nop 1
    v_mov_b32 v7, 0xff800000
    v_cndmask_b32 v160, v7, v160, s[18:19]
    v_cndmask_b32 v161, v7, v161, s[20:21]
    v_cndmask_b32 v162, v7, v162, s[22:23]
    v_cndmask_b32 v163, v7, v163, s[24:25]
    v_cndmask_b32 v172, v7, v172, s[18:19]
    v_cndmask_b32 v173, v7, v173, s[20:21]
    v_cndmask_b32 v174, v7, v174, s[22:23]
    v_cndmask_b32 v175, v7, v175, s[24:25]
    v_max3_f32 v4, v156, v157, v158
    v_max3_f32 v5, v159, v160, v161
    v_max3_f32 v4, v162, v163, v4
    v_max_f32 v4, v4, v5
    v_mov_b32 v5, v4
    s_nop 1
    v_permlane16_swap_b32 v4, v5
    v_max_f32 v4, v4, v5
    v_mov_b32 v5, v4
    s_nop 1
    v_permlane32_swap_b32 v4, v5
    v_max_f32 v4, v4, v5
    v_mul_f32 v4, s14, v4
    v_fma_f32 v156, v156, s14, -v4
    v_fma_f32 v157, v157, s14, -v4
    v_fma_f32 v158, v158, s14, -v4
    v_fma_f32 v159, v159, s14, -v4
    v_fma_f32 v160, v160, s14, -v4
    v_fma_f32 v161, v161, s14, -v4
    v_fma_f32 v162, v162, s14, -v4
    v_fma_f32 v163, v163, s14, -v4
    v_exp_f32 v156, v156
    v_exp_f32 v157, v157
    v_exp_f32 v158, v158
    v_exp_f32 v159, v159
    v_exp_f32 v160, v160
    v_exp_f32 v161, v161
    v_exp_f32 v162, v162
    v_exp_f32 v163, v163
    s_nop 0
    v_cndmask_b32 v156, 0, v156, s[16:17]
    v_cndmask_b32 v157, 0, v157, s[16:17]
    v_cndmask_b32 v158, 0, v158, s[16:17]
    v_cndmask_b32 v159, 0, v159, s[16:17]
    v_add_f32 v4, v156, v157
    v_add_f32 v5, v158, v159
    v_add_f32 v4, v4, v160
    v_add_f32 v5, v5, v161
    v_add_f32 v4, v4, v162
    v_add_f32 v5, v5, v163
    v_add_f32 v4, v4, v5
    v_mov_b32 v5, v4
    s_nop 1
    v_permlane16_swap_b32 v4, v5
    v_add_f32 v4, v4, v5
    v_mov_b32 v5, v4
    s_nop 1
    v_permlane32_swap_b32 v4, v5
    v_add_f32 v4, v4, v5
    v_rcp_f32 v4, v4
    s_nop 0
    v_mul_f32 v156, v156, v4
    v_mul_f32 v157, v157, v4
    v_mul_f32 v158, v158, v4
    v_mul_f32 v159, v159, v4
    v_mul_f32 v160, v160, v4
    v_mul_f32 v161, v161, v4
    v_mul_f32 v162, v162, v4
    v_mul_f32 v163, v163, v4
    v_max3_f32 v4, v164, v165, v166
    v_max3_f32 v5, v167, v168, v169
    v_max3_f32 v4, v170, v171, v4
    v_max3_f32 v5, v172, v173, v5
    v_max3_f32 v4, v174, v175, v4
    v_max_f32 v4, v4, v5
    v_mov_b32 v5, v4
    s_nop 1
    v_permlane16_swap_b32 v4, v5
    v_max_f32 v4, v4, v5
    v_mov_b32 v5, v4
    s_nop 1
    v_permlane32_swap_b32 v4, v5
    v_max_f32 v4, v4, v5
    v_mul_f32 v4, s14, v4
    v_fma_f32 v164, v164, s14, -v4
    v_fma_f32 v165, v165, s14, -v4
    v_fma_f32 v166, v166, s14, -v4
    v_fma_f32 v167, v167, s14, -v4
    v_fma_f32 v168, v168, s14, -v4
    v_fma_f32 v169, v169, s14, -v4
    v_fma_f32 v170, v170, s14, -v4
    v_fma_f32 v171, v171, s14, -v4
    v_fma_f32 v172, v172, s14, -v4
    v_fma_f32 v173, v173, s14, -v4
    v_fma_f32 v174, v174, s14, -v4
    v_fma_f32 v175, v175, s14, -v4
    v_exp_f32 v164, v164
    v_exp_f32 v165, v165
    v_exp_f32 v166, v166
    v_exp_f32 v167, v167
    v_exp_f32 v168, v168
    v_exp_f32 v169, v169
    v_exp_f32 v170, v170
    v_exp_f32 v171, v171
    v_exp_f32 v172, v172
    v_exp_f32 v173, v173
    v_exp_f32 v174, v174
    v_exp_f32 v175, v175
    s_nop 0
    v_cndmask_b32 v164, 0, v164, s[16:17]
    v_cndmask_b32 v165, 0, v165, s[16:17]
    v_cndmask_b32 v166, 0, v166, s[16:17]
    v_cndmask_b32 v167, 0, v167, s[16:17]
    v_add_f32 v4, v164, v165
    v_add_f32 v5, v166, v167
    v_add_f32 v4, v4, v168
    v_add_f32 v5, v5, v169
    v_add_f32 v4, v4, v170
    v_add_f32 v5, v5, v171
    v_add_f32 v4, v4, v172
    v_add_f32 v5, v5, v173
    v_add_f32 v4, v4, v174
    v_add_f32 v5, v5, v175
    v_add_f32 v4, v4, v5
    v_mov_b32 v5, v4
    s_nop 1
    v_permlane16_swap_b32 v4, v5
    v_add_f32 v4, v4, v5
    v_mov_b32 v5, v4
    s_nop 1
    v_permlane32_swap_b32 v4, v5
    v_add_f32 v4, v4, v5
    v_rcp_f32 v4, v4
    s_nop 0
    v_mul_f32 v164, v164, v4
    v_mul_f32 v165, v165, v4
    v_mul_f32 v166, v166, v4
    v_mul_f32 v167, v167, v4
    v_mul_f32 v168, v168, v4
    v_mul_f32 v169, v169, v4
    v_mul_f32 v170, v170, v4
    v_mul_f32 v171, v171, v4
    v_mul_f32 v172, v172, v4
    v_mul_f32 v173, v173, v4
    v_mul_f32 v174, v174, v4
    v_mul_f32 v175, v175, v4
    v_cvt_pk_bf16_f32 v176, v156, v157
    v_cvt_pk_bf16_f32 v177, v158, v159
    v_cvt_pk_bf16_f32 v178, v160, v161
    v_cvt_pk_bf16_f32 v179, v162, v163
    v_cvt_pk_bf16_f32 v180, v164, v165
    v_cvt_pk_bf16_f32 v181, v166, v167
    v_cvt_pk_bf16_f32 v182, v168, v169
    v_cvt_pk_bf16_f32 v183, v170, v171
    v_cvt_pk_bf16_f32 v184, v172, v173
    v_cvt_pk_bf16_f32 v185, v174, v175
    s_waitcnt vmcnt(0)
    s_nop 0
    v_mfma_f32_16x16x16_bf16 v[28:31], v[108:109], v[176:177], 0
    v_mfma_f32_16x16x16_bf16 v[32:35], v[114:115], v[176:177], 0
    v_mfma_f32_16x16x16_bf16 v[36:39], v[120:121], v[176:177], 0
    v_mfma_f32_16x16x16_bf16 v[40:43], v[126:127], v[176:177], 0
    v_mfma_f32_16x16x16_bf16 v[44:47], v[132:133], v[176:177], 0
    v_mfma_f32_16x16x16_bf16 v[48:51], v[138:139], v[176:177], 0
    v_mfma_f32_16x16x16_bf16 v[52:55], v[144:145], v[176:177], 0
    v_mfma_f32_16x16x16_bf16 v[56:59], v[150:151], v[176:177], 0
    v_mfma_f32_16x16x16_bf16 v[28:31], v[110:111], v[178:179], v[28:31]
    v_mfma_f32_16x16x16_bf16 v[32:35], v[116:117], v[178:179], v[32:35]
    v_mfma_f32_16x16x16_bf16 v[36:39], v[122:123], v[178:179], v[36:39]
    v_mfma_f32_16x16x16_bf16 v[40:43], v[128:129], v[178:179], v[40:43]
    v_mfma_f32_16x16x16_bf16 v[44:47], v[134:135], v[178:179], v[44:47]
    v_mfma_f32_16x16x16_bf16 v[48:51], v[140:141], v[178:179], v[48:51]
    v_mfma_f32_16x16x16_bf16 v[52:55], v[146:147], v[178:179], v[52:55]
    v_mfma_f32_16x16x16_bf16 v[56:59], v[152:153], v[178:179], v[56:59]
    v_mfma_f32_16x16x16_bf16 v[60:63], v[108:109], v[180:181], 0
    v_mfma_f32_16x16x16_bf16 v[64:67], v[114:115], v[180:181], 0
    v_mfma_f32_16x16x16_bf16 v[68:71], v[120:121], v[180:181], 0
    v_mfma_f32_16x16x16_bf16 v[72:75], v[126:127], v[180:181], 0
    v_mfma_f32_16x16x16_bf16 v[76:79], v[132:133], v[180:181], 0
    v_mfma_f32_16x16x16_bf16 v[80:83], v[138:139], v[180:181], 0
    v_mfma_f32_16x16x16_bf16 v[84:87], v[144:145], v[180:181], 0
    v_mfma_f32_16x16x16_bf16 v[88:91], v[150:151], v[180:181], 0
    v_mfma_f32_16x16x16_bf16 v[60:63], v[110:111], v[182:183], v[60:63]
    v_mfma_f32_16x16x16_bf16 v[64:67], v[116:117], v[182:183], v[64:67]
    v_mfma_f32_16x16x16_bf16 v[68:71], v[122:123], v[182:183], v[68:71]
    v_mfma_f32_16x16x16_bf16 v[72:75], v[128:129], v[182:183], v[72:75]
    v_mfma_f32_16x16x16_bf16 v[76:79], v[134:135], v[182:183], v[76:79]
    v_mfma_f32_16x16x16_bf16 v[80:83], v[140:141], v[182:183], v[80:83]
    v_mfma_f32_16x16x16_bf16 v[84:87], v[146:147], v[182:183], v[84:87]
    v_mfma_f32_16x16x16_bf16 v[88:91], v[152:153], v[182:183], v[88:91]
    v_mfma_f32_16x16x16_bf16 v[60:63], v[112:113], v[184:185], v[60:63]
    v_mfma_f32_16x16x16_bf16 v[64:67], v[118:119], v[184:185], v[64:67]
    v_mfma_f32_16x16x16_bf16 v[68:71], v[124:125], v[184:185], v[68:71]
    v_mfma_f32_16x16x16_bf16 v[72:75], v[130:131], v[184:185], v[72:75]
    v_mfma_f32_16x16x16_bf16 v[76:79], v[136:137], v[184:185], v[76:79]
    v_mfma_f32_16x16x16_bf16 v[80:83], v[142:143], v[184:185], v[80:83]
    v_mfma_f32_16x16x16_bf16 v[84:87], v[148:149], v[184:185], v[84:87]
    v_mfma_f32_16x16x16_bf16 v[88:91], v[154:155], v[184:185], v[88:91]
    s_lshl_b32 s12, s4, 18
    s_lshl_b32 s13, s5, 13
    s_add_u32 s12, s12, s13
    s_add_u32 s12, s12, 58720256
    s_add_u32 s8, s6, s12
    s_addc_u32 s9, s7, 0
    v_lshlrev_b32 v4, 4, v3
    v_add_u32 v4, 4096, v4
    s_nop 7
    v_cvt_pk_bf16_f32 v28, v28, v29
    v_cvt_pk_bf16_f32 v29, v30, v31
    v_cvt_pk_bf16_f32 v30, v32, v33
    v_cvt_pk_bf16_f32 v31, v34, v35
    global_store_dwordx4 v4, v[28:31], s[8:9] offset:-4096 sc1
    v_cvt_pk_bf16_f32 v36, v36, v37
    v_cvt_pk_bf16_f32 v37, v38, v39
    v_cvt_pk_bf16_f32 v38, v40, v41
    v_cvt_pk_bf16_f32 v39, v42, v43
    global_store_dwordx4 v4, v[36:39], s[8:9] offset:-2048 sc1
    v_cvt_pk_bf16_f32 v44, v44, v45
    v_cvt_pk_bf16_f32 v45, v46, v47
    v_cvt_pk_bf16_f32 v46, v48, v49
    v_cvt_pk_bf16_f32 v47, v50, v51
    global_store_dwordx4 v4, v[44:47], s[8:9] offset:0 sc1
    v_cvt_pk_bf16_f32 v52, v52, v53
    v_cvt_pk_bf16_f32 v53, v54, v55
    v_cvt_pk_bf16_f32 v54, v56, v57
    v_cvt_pk_bf16_f32 v55, v58, v59
    global_store_dwordx4 v4, v[52:55], s[8:9] offset:2048 sc1
    v_cvt_pk_bf16_f32 v60, v60, v61
    v_cvt_pk_bf16_f32 v61, v62, v63
    v_cvt_pk_bf16_f32 v62, v64, v65
    v_cvt_pk_bf16_f32 v63, v66, v67
    global_store_dwordx4 v4, v[60:63], s[8:9] offset:-3072 sc1
    v_cvt_pk_bf16_f32 v68, v68, v69
    v_cvt_pk_bf16_f32 v69, v70, v71
    v_cvt_pk_bf16_f32 v70, v72, v73
    v_cvt_pk_bf16_f32 v71, v74, v75
    global_store_dwordx4 v4, v[68:71], s[8:9] offset:-1024 sc1
    v_cvt_pk_bf16_f32 v76, v76, v77
    v_cvt_pk_bf16_f32 v77, v78, v79
    v_cvt_pk_bf16_f32 v78, v80, v81
    v_cvt_pk_bf16_f32 v79, v82, v83
    global_store_dwordx4 v4, v[76:79], s[8:9] offset:1024 sc1
    v_cvt_pk_bf16_f32 v84, v84, v85
    v_cvt_pk_bf16_f32 v85, v86, v87
    v_cvt_pk_bf16_f32 v86, v88, v89
    v_cvt_pk_bf16_f32 v87, v90, v91
    global_store_dwordx4 v4, v[84:87], s[8:9] offset:3072 sc1
    s_waitcnt vmcnt(0)
    s_barrier
    s_lshr_b32 s12, s4, 2
    s_lshl_b32 s12, s12, 2
    s_add_u32 s12, s12, 128
    s_and_b32 s13, s4, 3
    s_lshl_b32 s13, s13, 3
    s_lshl_b32 s13, 1, s13
    s_cmp_lg_u32 s3, 0
    s_cbranch_scc1 tl_asg_n
    v_mov_b32 v4, s13
    v_mov_b32 v5, s12
    s_mov_b64 exec, 1
    global_atomic_add v5, v4, s[98:99] sc1
    s_mov_b64 exec, -1
tl_asg_n:
    s_add_u32 s26, s26, 48
    s_cmp_lt_u32 s26, 512
    s_cbranch_scc1 tl_loop
    s_branch tl_done
tl_wo_init:
    s_mul_i32 s12, s100, 3277
    s_lshr_b32 s4, s12, 16
    s_mul_i32 s12, s4, 20
    s_sub_u32 s27, s100, s12
    s_mul_i32 s15, s3, 1310720
    s_lshl_b32 s13, s27, 6
    s_add_u32 s15, s15, s13
    s_add_u32 m0, s41, 0
    s_add_u32 s13, s15, 0
    buffer_load_dwordx4 v12, s[36:39], s13 offen lds
    s_add_u32 m0, s41, 1024
    s_add_u32 s13, s15, 20480
    buffer_load_dwordx4 v12, s[36:39], s13 offen lds
    s_add_u32 m0, s41, 2048
    s_add_u32 s13, s15, 40960
    buffer_load_dwordx4 v12, s[36:39], s13 offen lds
    s_add_u32 m0, s41, 3072
    s_add_u32 s13, s15, 61440
    buffer_load_dwordx4 v12, s[36:39], s13 offen lds
    s_add_u32 m0, s41, 4096
    s_add_u32 s13, s15, 81920
    buffer_load_dwordx4 v12, s[36:39], s13 offen lds
    s_add_u32 m0, s41, 5120
    s_add_u32 s13, s15, 102400
    buffer_load_dwordx4 v12, s[36:39], s13 offen lds
    s_add_u32 m0, s41, 6144
    s_add_u32 s13, s15, 122880
    buffer_load_dwordx4 v12, s[36:39], s13 offen lds
    s_add_u32 m0, s41, 7168
    s_add_u32 s13, s15, 143360
    buffer_load_dwordx4 v12, s[36:39], s13 offen lds
    s_add_u32 m0, s41, 8192
    s_add_u32 s13, s15, 163840
    buffer_load_dwordx4 v12, s[36:39], s13 offen lds
    s_add_u32 m0, s41, 9216
    s_add_u32 s13, s15, 184320
    buffer_load_dwordx4 v12, s[36:39], s13 offen lds
    s_add_u32 m0, s41, 10240
    s_add_u32 s13, s15, 204800
    buffer_load_dwordx4 v12, s[36:39], s13 offen lds
    s_add_u32 m0, s41, 11264
    s_add_u32 s13, s15, 225280
    buffer_load_dwordx4 v12, s[36:39], s13 offen lds
    s_add_u32 m0, s41, 12288
    s_add_u32 s13, s15, 245760
    buffer_load_dwordx4 v12, s[36:39], s13 offen lds
    s_add_u32 m0, s41, 13312
    s_add_u32 s13, s15, 266240
    buffer_load_dwordx4 v12, s[36:39], s13 offen lds
    s_add_u32 m0, s41, 14336
    s_add_u32 s13, s15, 286720
    buffer_load_dwordx4 v12, s[36:39], s13 offen lds
    s_add_u32 m0, s41, 15360
    s_add_u32 s13, s15, 307200
    buffer_load_dwordx4 v12, s[36:39], s13 offen lds
    s_add_u32 m0, s41, 16384
    s_add_u32 s13, s15, 327680
    buffer_load_dwordx4 v12, s[36:39], s13 offen lds
    s_add_u32 m0, s41, 17408
    s_add_u32 s13, s15, 348160
    buffer_load_dwordx4 v12, s[36:39], s13 offen lds
    s_add_u32 m0, s41, 18432
    s_add_u32 s13, s15, 368640
    buffer_load_dwordx4 v12, s[36:39], s13 offen lds
    s_add_u32 m0, s41, 19456
    s_add_u32 s13, s15, 389120
    buffer_load_dwordx4 v12, s[36:39], s13 offen lds
    s_add_u32 m0, s41, 20480
    s_add_u32 s13, s15, 409600
    buffer_load_dwordx4 v12, s[36:39], s13 offen lds
    s_add_u32 m0, s41, 21504
    s_add_u32 s13, s15, 430080
    buffer_load_dwordx4 v12, s[36:39], s13 offen lds
    s_add_u32 m0, s41, 22528
    s_add_u32 s13, s15, 450560
    buffer_load_dwordx4 v12, s[36:39], s13 offen lds
    s_add_u32 m0, s41, 23552
    s_add_u32 s13, s15, 471040
    buffer_load_dwordx4 v12, s[36:39], s13 offen lds
    s_add_u32 m0, s41, 24576
    s_add_u32 s13, s15, 491520
    buffer_load_dwordx4 v12, s[36:39], s13 offen lds
    s_add_u32 m0, s41, 25600
    s_add_u32 s13, s15, 512000
    buffer_load_dwordx4 v12, s[36:39], s13 offen lds
    s_add_u32 m0, s41, 26624
    s_add_u32 s13, s15, 532480
    buffer_load_dwordx4 v12, s[36:39], s13 offen lds
    s_add_u32 m0, s41, 27648
    s_add_u32 s13, s15, 552960
    buffer_load_dwordx4 v12, s[36:39], s13 offen lds
    s_add_u32 m0, s41, 28672
    s_add_u32 s13, s15, 573440
    buffer_load_dwordx4 v12, s[36:39], s13 offen lds
    s_add_u32 m0, s41, 29696
    s_add_u32 s13, s15, 593920
    buffer_load_dwordx4 v12, s[36:39], s13 offen lds
    s_add_u32 m0, s41, 30720
    s_add_u32 s13, s15, 614400
    buffer_load_dwordx4 v12, s[36:39], s13 offen lds
    s_add_u32 m0, s41, 31744
    s_add_u32 s13, s15, 634880
    buffer_load_dwordx4 v12, s[36:39], s13 offen lds
    s_waitcnt vmcnt(0)
    ds_read_b64_tr_b16 a[0:1], v13 offset:0
    ds_read_b64_tr_b16 a[2:3], v13 offset:1024
    ds_read_b64_tr_b16 a[4:5], v13 offset:32
    ds_read_b64_tr_b16 a[6:7], v13 offset:1056
    ds_read_b64_tr_b16 a[8:9], v13 offset:2048
    ds_read_b64_tr_b16 a[10:11], v13 offset:3072
    ds_read_b64_tr_b16 a[12:13], v13 offset:2080
    ds_read_b64_tr_b16 a[14:15], v13 offset:3104
    ds_read_b64_tr_b16 a[16:17], v13 offset:4096
    ds_read_b64_tr_b16 a[18:19], v13 offset:5120
    ds_read_b64_tr_b16 a[20:21], v13 offset:4128
    ds_read_b64_tr_b16 a[22:23], v13 offset:5152
    ds_read_b64_tr_b16 a[24:25], v13 offset:6144
    ds_read_b64_tr_b16 a[26:27], v13 offset:7168
    ds_read_b64_tr_b16 a[28:29], v13 offset:6176
    ds_read_b64_tr_b16 a[30:31], v13 offset:7200
    ds_read_b64_tr_b16 a[32:33], v13 offset:8192
    ds_read_b64_tr_b16 a[34:35], v13 offset:9216
    ds_read_b64_tr_b16 a[36:37], v13 offset:8224
    ds_read_b64_tr_b16 a[38:39], v13 offset:9248
    ds_read_b64_tr_b16 a[40:41], v13 offset:10240
    ds_read_b64_tr_b16 a[42:43], v13 offset:11264
    ds_read_b64_tr_b16 a[44:45], v13 offset:10272
    ds_read_b64_tr_b16 a[46:47], v13 offset:11296
    ds_read_b64_tr_b16 a[48:49], v13 offset:12288
    ds_read_b64_tr_b16 a[50:51], v13 offset:13312
    ds_read_b64_tr_b16 a[52:53], v13 offset:12320
    ds_read_b64_tr_b16 a[54:55], v13 offset:13344
    ds_read_b64_tr_b16 a[56:57], v13 offset:14336
    ds_read_b64_tr_b16 a[58:59], v13 offset:15360
    ds_read_b64_tr_b16 a[60:61], v13 offset:14368
    ds_read_b64_tr_b16 a[62:63], v13 offset:15392
    ds_read_b64_tr_b16 a[64:65], v13 offset:16384
    ds_read_b64_tr_b16 a[66:67], v13 offset:17408
    ds_read_b64_tr_b16 a[68:69], v13 offset:16416
    ds_read_b64_tr_b16 a[70:71], v13 offset:17440
    ds_read_b64_tr_b16 a[72:73], v13 offset:18432
    ds_read_b64_tr_b16 a[74:75], v13 offset:19456
    ds_read_b64_tr_b16 a[76:77], v13 offset:18464
    ds_read_b64_tr_b16 a[78:79], v13 offset:19488
    ds_read_b64_tr_b16 a[80:81], v13 offset:20480
    ds_read_b64_tr_b16 a[82:83], v13 offset:21504
    ds_read_b64_tr_b16 a[84:85], v13 offset:20512
    ds_read_b64_tr_b16 a[86:87], v13 offset:21536
    ds_read_b64_tr_b16 a[88:89], v13 offset:22528
    ds_read_b64_tr_b16 a[90:91], v13 offset:23552
    ds_read_b64_tr_b16 a[92:93], v13 offset:22560
    ds_read_b64_tr_b16 a[94:95], v13 offset:23584
    ds_read_b64_tr_b16 a[96:97], v13 offset:24576
    ds_read_b64_tr_b16 a[98:99], v13 offset:25600
    ds_read_b64_tr_b16 a[100:101], v13 offset:24608
    ds_read_b64_tr_b16 a[102:103], v13 offset:25632
    ds_read_b64_tr_b16 a[104:105], v13 offset:26624
    ds_read_b64_tr_b16 a[106:107], v13 offset:27648
    ds_read_b64_tr_b16 a[108:109], v13 offset:26656
    ds_read_b64_tr_b16 a[110:111], v13 offset:27680
    ds_read_b64_tr_b16 a[112:113], v13 offset:28672
    ds_read_b64_tr_b16 a[114:115], v13 offset:29696
    ds_read_b64_tr_b16 a[116:117], v13 offset:28704
    ds_read_b64_tr_b16 a[118:119], v13 offset:29728
    ds_read_b64_tr_b16 a[120:121], v13 offset:30720
    ds_read_b64_tr_b16 a[122:123], v13 offset:31744
    ds_read_b64_tr_b16 a[124:125], v13 offset:30752
    ds_read_b64_tr_b16 a[126:127], v13 offset:31776
    s_waitcnt lgkmcnt(0)
    s_add_u32 m0, s41, 0
    s_add_u32 s13, s15, 655360
    buffer_load_dwordx4 v12, s[36:39], s13 offen lds
    s_add_u32 m0, s41, 1024
    s_add_u32 s13, s15, 675840
    buffer_load_dwordx4 v12, s[36:39], s13 offen lds
    s_add_u32 m0, s41, 2048
    s_add_u32 s13, s15, 696320
    buffer_load_dwordx4 v12, s[36:39], s13 offen lds
    s_add_u32 m0, s41, 3072
    s_add_u32 s13, s15, 716800
    buffer_load_dwordx4 v12, s[36:39], s13 offen lds
    s_add_u32 m0, s41, 4096
    s_add_u32 s13, s15, 737280
    buffer_load_dwordx4 v12, s[36:39], s13 offen lds
    s_add_u32 m0, s41, 5120
    s_add_u32 s13, s15, 757760
    buffer_load_dwordx4 v12, s[36:39], s13 offen lds
    s_add_u32 m0, s41, 6144
    s_add_u32 s13, s15, 778240
    buffer_load_dwordx4 v12, s[36:39], s13 offen lds
    s_add_u32 m0, s41, 7168
    s_add_u32 s13, s15, 798720
    buffer_load_dwordx4 v12, s[36:39], s13 offen lds
    s_add_u32 m0, s41, 8192
    s_add_u32 s13, s15, 819200
    buffer_load_dwordx4 v12, s[36:39], s13 offen lds
    s_add_u32 m0, s41, 9216
    s_add_u32 s13, s15, 839680
    buffer_load_dwordx4 v12, s[36:39], s13 offen lds
    s_add_u32 m0, s41, 10240
    s_add_u32 s13, s15, 860160
    buffer_load_dwordx4 v12, s[36:39], s13 offen lds
    s_add_u32 m0, s41, 11264
    s_add_u32 s13, s15, 880640
    buffer_load_dwordx4 v12, s[36:39], s13 offen lds
    s_add_u32 m0, s41, 12288
    s_add_u32 s13, s15, 901120
    buffer_load_dwordx4 v12, s[36:39], s13 offen lds
    s_add_u32 m0, s41, 13312
    s_add_u32 s13, s15, 921600
    buffer_load_dwordx4 v12, s[36:39], s13 offen lds
    s_add_u32 m0, s41, 14336
    s_add_u32 s13, s15, 942080
    buffer_load_dwordx4 v12, s[36:39], s13 offen lds
    s_add_u32 m0, s41, 15360
    s_add_u32 s13, s15, 962560
    buffer_load_dwordx4 v12, s[36:39], s13 offen lds
    s_add_u32 m0, s41, 16384
    s_add_u32 s13, s15, 983040
    buffer_load_dwordx4 v12, s[36:39], s13 offen lds
    s_add_u32 m0, s41, 17408
    s_add_u32 s13, s15, 1003520
    buffer_load_dwordx4 v12, s[36:39], s13 offen lds
    s_add_u32 m0, s41, 18432
    s_add_u32 s13, s15, 1024000
    buffer_load_dwordx4 v12, s[36:39], s13 offen lds
    s_add_u32 m0, s41, 19456
    s_add_u32 s13, s15, 1044480
    buffer_load_dwordx4 v12, s[36:39], s13 offen lds
    s_add_u32 m0, s41, 20480
    s_add_u32 s13, s15, 1064960
    buffer_load_dwordx4 v12, s[36:39], s13 offen lds
    s_add_u32 m0, s41, 21504
    s_add_u32 s13, s15, 1085440
    buffer_load_dwordx4 v12, s[36:39], s13 offen lds
    s_add_u32 m0, s41, 22528
    s_add_u32 s13, s15, 1105920
    buffer_load_dwordx4 v12, s[36:39], s13 offen lds
    s_add_u32 m0, s41, 23552
    s_add_u32 s13, s15, 1126400
    buffer_load_dwordx4 v12, s[36:39], s13 offen lds
    s_add_u32 m0, s41, 24576
    s_add_u32 s13, s15, 1146880
    buffer_load_dwordx4 v12, s[36:39], s13 offen lds
    s_add_u32 m0, s41, 25600
    s_add_u32 s13, s15, 1167360
    buffer_load_dwordx4 v12, s[36:39], s13 offen lds
    s_add_u32 m0, s41, 26624
    s_add_u32 s13, s15, 1187840
    buffer_load_dwordx4 v12, s[36:39], s13 offen lds
    s_add_u32 m0, s41, 27648
    s_add_u32 s13, s15, 1208320
    buffer_load_dwordx4 v12, s[36:39], s13 offen lds
    s_add_u32 m0, s41, 28672
    s_add_u32 s13, s15, 1228800
    buffer_load_dwordx4 v12, s[36:39], s13 offen lds
    s_add_u32 m0, s41, 29696
    s_add_u32 s13, s15, 1249280
    buffer_load_dwordx4 v12, s[36:39], s13 offen lds
    s_add_u32 m0, s41, 30720
    s_add_u32 s13, s15, 1269760
    buffer_load_dwordx4 v12, s[36:39], s13 offen lds
    s_add_u32 m0, s41, 31744
    s_add_u32 s13, s15, 1290240
    buffer_load_dwordx4 v12, s[36:39], s13 offen lds
    s_waitcnt vmcnt(0)
    ds_read_b64_tr_b16 a[128:129], v13 offset:0
    ds_read_b64_tr_b16 a[130:131], v13 offset:1024
    ds_read_b64_tr_b16 a[132:133], v13 offset:32
    ds_read_b64_tr_b16 a[134:135], v13 offset:1056
    ds_read_b64_tr_b16 a[136:137], v13 offset:2048
    ds_read_b64_tr_b16 a[138:139], v13 offset:3072
    ds_read_b64_tr_b16 a[140:141], v13 offset:2080
    ds_read_b64_tr_b16 a[142:143], v13 offset:3104
    ds_read_b64_tr_b16 a[144:145], v13 offset:4096
    ds_read_b64_tr_b16 a[146:147], v13 offset:5120
    ds_read_b64_tr_b16 a[148:149], v13 offset:4128
    ds_read_b64_tr_b16 a[150:151], v13 offset:5152
    ds_read_b64_tr_b16 a[152:153], v13 offset:6144
    ds_read_b64_tr_b16 a[154:155], v13 offset:7168
    ds_read_b64_tr_b16 a[156:157], v13 offset:6176
    ds_read_b64_tr_b16 a[158:159], v13 offset:7200
    ds_read_b64_tr_b16 a[160:161], v13 offset:8192
    ds_read_b64_tr_b16 a[162:163], v13 offset:9216
    ds_read_b64_tr_b16 a[164:165], v13 offset:8224
    ds_read_b64_tr_b16 a[166:167], v13 offset:9248
    ds_read_b64_tr_b16 a[168:169], v13 offset:10240
    ds_read_b64_tr_b16 a[170:171], v13 offset:11264
    ds_read_b64_tr_b16 a[172:173], v13 offset:10272
    ds_read_b64_tr_b16 a[174:175], v13 offset:11296
    ds_read_b64_tr_b16 a[176:177], v13 offset:12288
    ds_read_b64_tr_b16 a[178:179], v13 offset:13312
    ds_read_b64_tr_b16 a[180:181], v13 offset:12320
    ds_read_b64_tr_b16 a[182:183], v13 offset:13344
    ds_read_b64_tr_b16 a[184:185], v13 offset:14336
    ds_read_b64_tr_b16 a[186:187], v13 offset:15360
    ds_read_b64_tr_b16 a[188:189], v13 offset:14368
    ds_read_b64_tr_b16 a[190:191], v13 offset:15392
    ds_read_b64_tr_b16 a[192:193], v13 offset:16384
    ds_read_b64_tr_b16 a[194:195], v13 offset:17408
    ds_read_b64_tr_b16 a[196:197], v13 offset:16416
    ds_read_b64_tr_b16 a[198:199], v13 offset:17440
    ds_read_b64_tr_b16 a[200:201], v13 offset:18432
    ds_read_b64_tr_b16 a[202:203], v13 offset:19456
    ds_read_b64_tr_b16 a[204:205], v13 offset:18464
    ds_read_b64_tr_b16 a[206:207], v13 offset:19488
    ds_read_b64_tr_b16 a[208:209], v13 offset:20480
    ds_read_b64_tr_b16 a[210:211], v13 offset:21504
    ds_read_b64_tr_b16 a[212:213], v13 offset:20512
    ds_read_b64_tr_b16 a[214:215], v13 offset:21536
    ds_read_b64_tr_b16 a[216:217], v13 offset:22528
    ds_read_b64_tr_b16 a[218:219], v13 offset:23552
    ds_read_b64_tr_b16 a[220:221], v13 offset:22560
    ds_read_b64_tr_b16 a[222:223], v13 offset:23584
    ds_read_b64_tr_b16 a[224:225], v13 offset:24576
    ds_read_b64_tr_b16 a[226:227], v13 offset:25600
    ds_read_b64_tr_b16 a[228:229], v13 offset:24608
    ds_read_b64_tr_b16 a[230:231], v13 offset:25632
    ds_read_b64_tr_b16 a[232:233], v13 offset:26624
    ds_read_b64_tr_b16 a[234:235], v13 offset:27648
    ds_read_b64_tr_b16 a[236:237], v13 offset:26656
    ds_read_b64_tr_b16 a[238:239], v13 offset:27680
    ds_read_b64_tr_b16 a[240:241], v13 offset:28672
    ds_read_b64_tr_b16 a[242:243], v13 offset:29696
    ds_read_b64_tr_b16 a[244:245], v13 offset:28704
    ds_read_b64_tr_b16 a[246:247], v13 offset:29728
    ds_read_b64_tr_b16 a[248:249], v13 offset:30720
    ds_read_b64_tr_b16 a[250:251], v13 offset:31744
    ds_read_b64_tr_b16 a[252:253], v13 offset:30752
    ds_read_b64_tr_b16 a[254:255], v13 offset:31776
    s_waitcnt lgkmcnt(0)
    s_lshr_b32 s12, s3, 1
    s_mul_i32 s13, s12, 20480
    v_subrev_u32 v23, s13, v16
    s_lshl_b32 s13, s12, 11
    v_subrev_u32 v24, s13, v15
tl_wo:
    s_lshr_b32 s12, s4, 2
    s_add_u32 s15, s12, 32
    s_and_b32 s29, s4, 3
    s_lshl_b32 s29, s29, 3
    s_mov_b32 s28, 0
tl_wf_c:
    v_readlane_b32 s13, v21, s12
    s_lshr_b32 s13, s13, 24
    s_and_b32 s13, s13, 255
    s_cmp_lg_u32 s13, 6
    s_cbranch_scc1 tl_wf_r
    v_readlane_b32 s13, v21, s15
    s_lshr_b32 s13, s13, s29
    s_and_b32 s13, s13, 255
    s_cmp_lg_u32 s13, 8
    s_cbranch_scc1 tl_wf_r
    s_branch tl_wf_d
tl_wf_r:
    s_cmp_ge_u32 s28, 8192
    s_cbranch_scc1 tl_wf_d
    s_cmp_eq_u32 s28, 0
    s_cbranch_scc1 tl_wf_n
    s_sleep 8
tl_wf_n:
    global_load_dword v21, v22, s[98:99] sc1
    s_add_u32 s28, s28, 1
    s_waitcnt vmcnt(0)
    s_branch tl_wf_c
tl_wf_d:
    s_mul_i32 s12, s4, 40960
    s_lshl_b32 s13, s27, 6
    s_add_u32 s40, s12, s13
    s_add_u32 s12, s40, 109051904
    s_add_u32 s10, s6, s12
    s_addc_u32 s11, s7, 0
    global_load_dwordx2 v[18:19], v16, s[10:11] sc1
    s_lshl_b32 s12, s4, 7
    s_lshr_b32 s13, s3, 1
    s_lshl_b32 s13, s13, 6
    s_add_u32 s12, s12, s13
    s_add_u32 s12, s12, 113246208
    s_add_u32 s10, s6, s12
    s_addc_u32 s11, s7, 0
    v_lshlrev_b32 v4, 2, v1
    global_load_dword v20, v4, s[10:11] sc1
    s_lshl_b32 s12, s4, 18
    s_lshl_b32 s13, s3, 16
    s_add_u32 s12, s12, s13
    s_add_u32 s12, s12, 58720256
    s_add_u32 s8, s6, s12
    s_addc_u32 s9, s7, 0
    v_add_u32 v6, 0x20000, v8
    v_lshlrev_b32 v6, 4, v3
    v_add_u32 v6, 4096, v6
    global_load_dwordx4 v[28:31], v6, s[8:9] offset:-4096
    global_load_dwordx4 v[32:35], v6, s[8:9] offset:-3072
    global_load_dwordx4 v[36:39], v6, s[8:9] offset:-2048
    global_load_dwordx4 v[40:43], v6, s[8:9] offset:-1024
    global_load_dwordx4 v[44:47], v6, s[8:9] offset:0
    global_load_dwordx4 v[48:51], v6, s[8:9] offset:1024
    global_load_dwordx4 v[52:55], v6, s[8:9] offset:2048
    global_load_dwordx4 v[56:59], v6, s[8:9] offset:3072
    s_add_u32 s8, s8, 8192
    s_addc_u32 s9, s9, 0
    global_load_dwordx4 v[60:63], v6, s[8:9] offset:-4096
    global_load_dwordx4 v[64:67], v6, s[8:9] offset:-3072
    global_load_dwordx4 v[68:71], v6, s[8:9] offset:-2048
    global_load_dwordx4 v[72:75], v6, s[8:9] offset:-1024
    global_load_dwordx4 v[76:79], v6, s[8:9] offset:0
    global_load_dwordx4 v[80:83], v6, s[8:9] offset:1024
    global_load_dwordx4 v[84:87], v6, s[8:9] offset:2048
    global_load_dwordx4 v[88:91], v6, s[8:9] offset:3072
    s_add_u32 s8, s8, 8192
    s_addc_u32 s9, s9, 0
    global_load_dwordx4 v[92:95], v6, s[8:9] offset:-4096
    global_load_dwordx4 v[96:99], v6, s[8:9] offset:-3072
    global_load_dwordx4 v[100:103], v6, s[8:9] offset:-2048
    global_load_dwordx4 v[104:107], v6, s[8:9] offset:-1024
    global_load_dwordx4 v[108:111], v6, s[8:9] offset:0
    global_load_dwordx4 v[112:115], v6, s[8:9] offset:1024
    global_load_dwordx4 v[116:119], v6, s[8:9] offset:2048
    global_load_dwordx4 v[120:123], v6, s[8:9] offset:3072
    s_add_u32 s8, s8, 8192
    s_addc_u32 s9, s9, 0
    global_load_dwordx4 v[124:127], v6, s[8:9] offset:-4096
    global_load_dwordx4 v[128:131], v6, s[8:9] offset:-3072
    global_load_dwordx4 v[132:135], v6, s[8:9] offset:-2048
    global_load_dwordx4 v[136:139], v6, s[8:9] offset:-1024
    global_load_dwordx4 v[140:143], v6, s[8:9] offset:0
    global_load_dwordx4 v[144:147], v6, s[8:9] offset:1024
    global_load_dwordx4 v[148:151], v6, s[8:9] offset:2048
    global_load_dwordx4 v[152:155], v6, s[8:9] offset:3072
    s_add_u32 s8, s8, 8192
    s_addc_u32 s9, s9, 0
    global_load_dwordx4 v[156:159], v6, s[8:9] offset:-4096
    global_load_dwordx4 v[160:163], v6, s[8:9] offset:-3072
    global_load_dwordx4 v[164:167], v6, s[8:9] offset:-2048
    global_load_dwordx4 v[168:171], v6, s[8:9] offset:-1024
    global_load_dwordx4 v[172:175], v6, s[8:9] offset:0
    global_load_dwordx4 v[176:179], v6, s[8:9] offset:1024
    global_load_dwordx4 v[180:183], v6, s[8:9] offset:2048
    global_load_dwordx4 v[184:187], v6, s[8:9] offset:3072
    s_add_u32 s8, s8, 8192
    s_addc_u32 s9, s9, 0
    global_load_dwordx4 v[188:191], v6, s[8:9] offset:-4096
    global_load_dwordx4 v[192:195], v6, s[8:9] offset:-3072
    global_load_dwordx4 v[196:199], v6, s[8:9] offset:-2048
    global_load_dwordx4 v[200:203], v6, s[8:9] offset:-1024
    global_load_dwordx4 v[204:207], v6, s[8:9] offset:0
    global_load_dwordx4 v[208:211], v6, s[8:9] offset:1024
    global_load_dwordx4 v[212:215], v6, s[8:9] offset:2048
    global_load_dwordx4 v[216:219], v6, s[8:9] offset:3072
    s_add_u32 s8, s8, 8192
    s_addc_u32 s9, s9, 0
    s_waitcnt vmcnt(32)
    v_mfma_f32_16x16x32_bf16 v[220:223], a[0:3], v[28:31], 0
    v_mfma_f32_16x16x32_bf16 v[224:227], a[4:7], v[28:31], 0
    v_mfma_f32_16x16x32_bf16 v[228:231], a[0:3], v[32:35], 0
    v_mfma_f32_16x16x32_bf16 v[232:235], a[4:7], v[32:35], 0
    v_mfma_f32_16x16x32_bf16 v[220:223], a[8:11], v[36:39], v[220:223]
    v_mfma_f32_16x16x32_bf16 v[224:227], a[12:15], v[36:39], v[224:227]
    v_mfma_f32_16x16x32_bf16 v[228:231], a[8:11], v[40:43], v[228:231]
    v_mfma_f32_16x16x32_bf16 v[232:235], a[12:15], v[40:43], v[232:235]
    v_mfma_f32_16x16x32_bf16 v[220:223], a[16:19], v[44:47], v[220:223]
    v_mfma_f32_16x16x32_bf16 v[224:227], a[20:23], v[44:47], v[224:227]
    v_mfma_f32_16x16x32_bf16 v[228:231], a[16:19], v[48:51], v[228:231]
    v_mfma_f32_16x16x32_bf16 v[232:235], a[20:23], v[48:51], v[232:235]
    v_mfma_f32_16x16x32_bf16 v[220:223], a[24:27], v[52:55], v[220:223]
    v_mfma_f32_16x16x32_bf16 v[224:227], a[28:31], v[52:55], v[224:227]
    v_mfma_f32_16x16x32_bf16 v[228:231], a[24:27], v[56:59], v[228:231]
    v_mfma_f32_16x16x32_bf16 v[232:235], a[28:31], v[56:59], v[232:235]
    v_mfma_f32_16x16x32_bf16 v[220:223], a[32:35], v[60:63], v[220:223]
    v_mfma_f32_16x16x32_bf16 v[224:227], a[36:39], v[60:63], v[224:227]
    v_mfma_f32_16x16x32_bf16 v[228:231], a[32:35], v[64:67], v[228:231]
    v_mfma_f32_16x16x32_bf16 v[232:235], a[36:39], v[64:67], v[232:235]
    v_mfma_f32_16x16x32_bf16 v[220:223], a[40:43], v[68:71], v[220:223]
    v_mfma_f32_16x16x32_bf16 v[224:227], a[44:47], v[68:71], v[224:227]
    v_mfma_f32_16x16x32_bf16 v[228:231], a[40:43], v[72:75], v[228:231]
    v_mfma_f32_16x16x32_bf16 v[232:235], a[44:47], v[72:75], v[232:235]
    v_mfma_f32_16x16x32_bf16 v[220:223], a[48:51], v[76:79], v[220:223]
    v_mfma_f32_16x16x32_bf16 v[224:227], a[52:55], v[76:79], v[224:227]
    v_mfma_f32_16x16x32_bf16 v[228:231], a[48:51], v[80:83], v[228:231]
    v_mfma_f32_16x16x32_bf16 v[232:235], a[52:55], v[80:83], v[232:235]
    v_mfma_f32_16x16x32_bf16 v[220:223], a[56:59], v[84:87], v[220:223]
    v_mfma_f32_16x16x32_bf16 v[224:227], a[60:63], v[84:87], v[224:227]
    v_mfma_f32_16x16x32_bf16 v[228:231], a[56:59], v[88:91], v[228:231]
    v_mfma_f32_16x16x32_bf16 v[232:235], a[60:63], v[88:91], v[232:235]
    global_load_dwordx4 v[28:31], v6, s[8:9] offset:-4096
    global_load_dwordx4 v[32:35], v6, s[8:9] offset:-3072
    global_load_dwordx4 v[36:39], v6, s[8:9] offset:-2048
    global_load_dwordx4 v[40:43], v6, s[8:9] offset:-1024
    global_load_dwordx4 v[44:47], v6, s[8:9] offset:0
    global_load_dwordx4 v[48:51], v6, s[8:9] offset:1024
    global_load_dwordx4 v[52:55], v6, s[8:9] offset:2048
    global_load_dwordx4 v[56:59], v6, s[8:9] offset:3072
    s_add_u32 s8, s8, 8192
    s_addc_u32 s9, s9, 0
    global_load_dwordx4 v[60:63], v6, s[8:9] offset:-4096
    global_load_dwordx4 v[64:67], v6, s[8:9] offset:-3072
    global_load_dwordx4 v[68:71], v6, s[8:9] offset:-2048
    global_load_dwordx4 v[72:75], v6, s[8:9] offset:-1024
    global_load_dwordx4 v[76:79], v6, s[8:9] offset:0
    global_load_dwordx4 v[80:83], v6, s[8:9] offset:1024
    global_load_dwordx4 v[84:87], v6, s[8:9] offset:2048
    global_load_dwordx4 v[88:91], v6, s[8:9] offset:3072
    s_add_u32 s8, s8, 8192
    s_addc_u32 s9, s9, 0
    s_waitcnt vmcnt(32)
    v_mfma_f32_16x16x32_bf16 v[220:223], a[64:67], v[92:95], v[220:223]
    v_mfma_f32_16x16x32_bf16 v[224:227], a[68:71], v[92:95], v[224:227]
    v_mfma_f32_16x16x32_bf16 v[228:231], a[64:67], v[96:99], v[228:231]
    v_mfma_f32_16x16x32_bf16 v[232:235], a[68:71], v[96:99], v[232:235]
    v_mfma_f32_16x16x32_bf16 v[220:223], a[72:75], v[100:103], v[220:223]
    v_mfma_f32_16x16x32_bf16 v[224:227], a[76:79], v[100:103], v[224:227]
    v_mfma_f32_16x16x32_bf16 v[228:231], a[72:75], v[104:107], v[228:231]
    v_mfma_f32_16x16x32_bf16 v[232:235], a[76:79], v[104:107], v[232:235]
    v_mfma_f32_16x16x32_bf16 v[220:223], a[80:83], v[108:111], v[220:223]
    v_mfma_f32_16x16x32_bf16 v[224:227], a[84:87], v[108:111], v[224:227]
    v_mfma_f32_16x16x32_bf16 v[228:231], a[80:83], v[112:115], v[228:231]
    v_mfma_f32_16x16x32_bf16 v[232:235], a[84:87], v[112:115], v[232:235]
    v_mfma_f32_16x16x32_bf16 v[220:223], a[88:91], v[116:119], v[220:223]
    v_mfma_f32_16x16x32_bf16 v[224:227], a[92:95], v[116:119], v[224:227]
    v_mfma_f32_16x16x32_bf16 v[228:231], a[88:91], v[120:123], v[228:231]
    v_mfma_f32_16x16x32_bf16 v[232:235], a[92:95], v[120:123], v[232:235]
    v_mfma_f32_16x16x32_bf16 v[220:223], a[96:99], v[124:127], v[220:223]
    v_mfma_f32_16x16x32_bf16 v[224:227], a[100:103], v[124:127], v[224:227]
    v_mfma_f32_16x16x32_bf16 v[228:231], a[96:99], v[128:131], v[228:231]
    v_mfma_f32_16x16x32_bf16 v[232:235], a[100:103], v[128:131], v[232:235]
    v_mfma_f32_16x16x32_bf16 v[220:223], a[104:107], v[132:135], v[220:223]
    v_mfma_f32_16x16x32_bf16 v[224:227], a[108:111], v[132:135], v[224:227]
    v_mfma_f32_16x16x32_bf16 v[228:231], a[104:107], v[136:139], v[228:231]
    v_mfma_f32_16x16x32_bf16 v[232:235], a[108:111], v[136:139], v[232:235]
    v_mfma_f32_16x16x32_bf16 v[220:223], a[112:115], v[140:143], v[220:223]
    v_mfma_f32_16x16x32_bf16 v[224:227], a[116:119], v[140:143], v[224:227]
    v_mfma_f32_16x16x32_bf16 v[228:231], a[112:115], v[144:147], v[228:231]
    v_mfma_f32_16x16x32_bf16 v[232:235], a[116:119], v[144:147], v[232:235]
    v_mfma_f32_16x16x32_bf16 v[220:223], a[120:123], v[148:151], v[220:223]
    v_mfma_f32_16x16x32_bf16 v[224:227], a[124:127], v[148:151], v[224:227]
    v_mfma_f32_16x16x32_bf16 v[228:231], a[120:123], v[152:155], v[228:231]
    v_mfma_f32_16x16x32_bf16 v[232:235], a[124:127], v[152:155], v[232:235]
    s_waitcnt vmcnt(16)
    v_mfma_f32_16x16x32_bf16 v[220:223], a[128:131], v[156:159], v[220:223]
    v_mfma_f32_16x16x32_bf16 v[224:227], a[132:135], v[156:159], v[224:227]
    v_mfma_f32_16x16x32_bf16 v[228:231], a[128:131], v[160:163], v[228:231]
    v_mfma_f32_16x16x32_bf16 v[232:235], a[132:135], v[160:163], v[232:235]
    v_mfma_f32_16x16x32_bf16 v[220:223], a[136:139], v[164:167], v[220:223]
    v_mfma_f32_16x16x32_bf16 v[224:227], a[140:143], v[164:167], v[224:227]
    v_mfma_f32_16x16x32_bf16 v[228:231], a[136:139], v[168:171], v[228:231]
    v_mfma_f32_16x16x32_bf16 v[232:235], a[140:143], v[168:171], v[232:235]
    v_mfma_f32_16x16x32_bf16 v[220:223], a[144:147], v[172:175], v[220:223]
    v_mfma_f32_16x16x32_bf16 v[224:227], a[148:151], v[172:175], v[224:227]
    v_mfma_f32_16x16x32_bf16 v[228:231], a[144:147], v[176:179], v[228:231]
    v_mfma_f32_16x16x32_bf16 v[232:235], a[148:151], v[176:179], v[232:235]
    v_mfma_f32_16x16x32_bf16 v[220:223], a[152:155], v[180:183], v[220:223]
    v_mfma_f32_16x16x32_bf16 v[224:227], a[156:159], v[180:183], v[224:227]
    v_mfma_f32_16x16x32_bf16 v[228:231], a[152:155], v[184:187], v[228:231]
    v_mfma_f32_16x16x32_bf16 v[232:235], a[156:159], v[184:187], v[232:235]
    v_mfma_f32_16x16x32_bf16 v[220:223], a[160:163], v[188:191], v[220:223]
    v_mfma_f32_16x16x32_bf16 v[224:227], a[164:167], v[188:191], v[224:227]
    v_mfma_f32_16x16x32_bf16 v[228:231], a[160:163], v[192:195], v[228:231]
    v_mfma_f32_16x16x32_bf16 v[232:235], a[164:167], v[192:195], v[232:235]
    v_mfma_f32_16x16x32_bf16 v[220:223], a[168:171], v[196:199], v[220:223]
    v_mfma_f32_16x16x32_bf16 v[224:227], a[172:175], v[196:199], v[224:227]
    v_mfma_f32_16x16x32_bf16 v[228:231], a[168:171], v[200:203], v[228:231]
    v_mfma_f32_16x16x32_bf16 v[232:235], a[172:175], v[200:203], v[232:235]
    v_mfma_f32_16x16x32_bf16 v[220:223], a[176:179], v[204:207], v[220:223]
    v_mfma_f32_16x16x32_bf16 v[224:227], a[180:183], v[204:207], v[224:227]
    v_mfma_f32_16x16x32_bf16 v[228:231], a[176:179], v[208:211], v[228:231]
    v_mfma_f32_16x16x32_bf16 v[232:235], a[180:183], v[208:211], v[232:235]
    v_mfma_f32_16x16x32_bf16 v[220:223], a[184:187], v[212:215], v[220:223]
    v_mfma_f32_16x16x32_bf16 v[224:227], a[188:191], v[212:215], v[224:227]
    v_mfma_f32_16x16x32_bf16 v[228:231], a[184:187], v[216:219], v[228:231]
    v_mfma_f32_16x16x32_bf16 v[232:235], a[188:191], v[216:219], v[232:235]
    s_waitcnt vmcnt(0)
    v_mfma_f32_16x16x32_bf16 v[220:223], a[192:195], v[28:31], v[220:223]
    v_mfma_f32_16x16x32_bf16 v[224:227], a[196:199], v[28:31], v[224:227]
    v_mfma_f32_16x16x32_bf16 v[228:231], a[192:195], v[32:35], v[228:231]
    v_mfma_f32_16x16x32_bf16 v[232:235], a[196:199], v[32:35], v[232:235]
    v_mfma_f32_16x16x32_bf16 v[220:223], a[200:203], v[36:39], v[220:223]
    v_mfma_f32_16x16x32_bf16 v[224:227], a[204:207], v[36:39], v[224:227]
    v_mfma_f32_16x16x32_bf16 v[228:231], a[200:203], v[40:43], v[228:231]
    v_mfma_f32_16x16x32_bf16 v[232:235], a[204:207], v[40:43], v[232:235]
    v_mfma_f32_16x16x32_bf16 v[220:223], a[208:211], v[44:47], v[220:223]
    v_mfma_f32_16x16x32_bf16 v[224:227], a[212:215], v[44:47], v[224:227]
    v_mfma_f32_16x16x32_bf16 v[228:231], a[208:211], v[48:51], v[228:231]
    v_mfma_f32_16x16x32_bf16 v[232:235], a[212:215], v[48:51], v[232:235]
    v_mfma_f32_16x16x32_bf16 v[220:223], a[216:219], v[52:55], v[220:223]
    v_mfma_f32_16x16x32_bf16 v[224:227], a[220:223], v[52:55], v[224:227]
    v_mfma_f32_16x16x32_bf16 v[228:231], a[216:219], v[56:59], v[228:231]
    v_mfma_f32_16x16x32_bf16 v[232:235], a[220:223], v[56:59], v[232:235]
    v_mfma_f32_16x16x32_bf16 v[220:223], a[224:227], v[60:63], v[220:223]
    v_mfma_f32_16x16x32_bf16 v[224:227], a[228:231], v[60:63], v[224:227]
    v_mfma_f32_16x16x32_bf16 v[228:231], a[224:227], v[64:67], v[228:231]
    v_mfma_f32_16x16x32_bf16 v[232:235], a[228:231], v[64:67], v[232:235]
    v_mfma_f32_16x16x32_bf16 v[220:223], a[232:235], v[68:71], v[220:223]
    v_mfma_f32_16x16x32_bf16 v[224:227], a[236:239], v[68:71], v[224:227]
    v_mfma_f32_16x16x32_bf16 v[228:231], a[232:235], v[72:75], v[228:231]
    v_mfma_f32_16x16x32_bf16 v[232:235], a[236:239], v[72:75], v[232:235]
    v_mfma_f32_16x16x32_bf16 v[220:223], a[240:243], v[76:79], v[220:223]
    v_mfma_f32_16x16x32_bf16 v[224:227], a[244:247], v[76:79], v[224:227]
    v_mfma_f32_16x16x32_bf16 v[228:231], a[240:243], v[80:83], v[228:231]
    v_mfma_f32_16x16x32_bf16 v[232:235], a[244:247], v[80:83], v[232:235]
    v_mfma_f32_16x16x32_bf16 v[220:223], a[248:251], v[84:87], v[220:223]
    v_mfma_f32_16x16x32_bf16 v[224:227], a[252:255], v[84:87], v[224:227]
    v_mfma_f32_16x16x32_bf16 v[228:231], a[248:251], v[88:91], v[228:231]
    v_mfma_f32_16x16x32_bf16 v[232:235], a[252:255], v[88:91], v[232:235]
    s_nop 7
    s_nop 1
    ds_write_b128 v14, v[220:223] offset:0
    ds_write_b128 v14, v[224:227] offset:1024
    ds_write_b128 v14, v[228:231] offset:2048
    ds_write_b128 v14, v[232:235] offset:3072
    s_waitcnt lgkmcnt(0)
    s_barrier
    v_add_u32 v4, 65536, v15
    ds_read_b128 v[28:31], v15 offset:0
    ds_read_b128 v[32:35], v15 offset:32768
    ds_read_b128 v[36:39], v4 offset:0
    ds_read_b128 v[40:43], v4 offset:32768
    s_waitcnt lgkmcnt(0)
    s_barrier
    v_add_f32 v28, v28, v32
    v_add_f32 v36, v36, v40
    v_add_f32 v29, v29, v33
    v_add_f32 v37, v37, v41
    v_add_f32 v30, v30, v34
    v_add_f32 v38, v38, v42
    v_add_f32 v31, v31, v35
    v_add_f32 v39, v39, v43
    v_add_f32 v28, v28, v36
    v_add_f32 v29, v29, v37
    v_add_f32 v30, v30, v38
    v_add_f32 v31, v31, v39
    v_sub_f32 v5, 1.0, v20
    v_cvt_pk_bf16_f32 v5, v5, v5
    v_lshlrev_b32 v5, 16, v5
    v_cvt_pk_bf16_f32 v32, v28, v29
    v_cvt_pk_bf16_f32 v33, v30, v31
    v_lshlrev_b32 v28, 16, v32
    v_and_b32 v29, 0xffff0000, v32
    v_lshlrev_b32 v36, 16, v18
    v_and_b32 v37, 0xffff0000, v18
    v_lshlrev_b32 v30, 16, v33
    v_and_b32 v31, 0xffff0000, v33
    v_lshlrev_b32 v38, 16, v19
    v_and_b32 v39, 0xffff0000, v19
    v_mul_f32 v28, v28, v20
    v_mul_f32 v36, v36, v5
    v_mul_f32 v29, v29, v20
    v_mul_f32 v37, v37, v5
    v_mul_f32 v30, v30, v20
    v_mul_f32 v38, v38, v5
    v_mul_f32 v31, v31, v20
    v_mul_f32 v39, v39, v5
    v_cvt_pk_bf16_f32 v32, v28, v29
    v_cvt_pk_bf16_f32 v34, v36, v37
    v_cvt_pk_bf16_f32 v33, v30, v31
    v_cvt_pk_bf16_f32 v35, v38, v39
    v_lshlrev_b32 v28, 16, v32
    v_and_b32 v29, 0xffff0000, v32
    v_lshlrev_b32 v36, 16, v34
    v_and_b32 v37, 0xffff0000, v34
    v_lshlrev_b32 v30, 16, v33
    v_and_b32 v31, 0xffff0000, v33
    v_lshlrev_b32 v38, 16, v35
    v_and_b32 v39, 0xffff0000, v35
    v_add_f32 v28, v28, v36
    v_add_f32 v29, v29, v37
    v_add_f32 v30, v30, v38
    v_add_f32 v31, v31, v39
    v_cvt_pk_bf16_f32 v32, v28, v29
    v_cvt_pk_bf16_f32 v33, v30, v31
    s_add_u32 s8, s30, s40
    s_addc_u32 s9, s31, 0
    global_store_dwordx2 v16, v[32:33], s[8:9]
    s_add_u32 s4, s4, 4
    s_cmp_lt_u32 s4, 56
    s_cbranch_scc1 tl_wo
    s_sub_u32 s26, s4, 56
tl_woh:
    s_lshr_b32 s4, s26, 1
    s_add_u32 s4, s4, 56
    s_and_b32 s43, s26, 1
    s_lshr_b32 s12, s4, 2
    s_add_u32 s15, s12, 32
    s_and_b32 s29, s4, 3
    s_lshl_b32 s29, s29, 3
    s_mov_b32 s28, 0
tl_wfh_c:
    v_readlane_b32 s13, v21, s12
    s_lshr_b32 s13, s13, 24
    s_and_b32 s13, s13, 255
    s_cmp_lg_u32 s13, 6
    s_cbranch_scc1 tl_wfh_r
    v_readlane_b32 s13, v21, s15
    s_lshr_b32 s13, s13, s29
    s_and_b32 s13, s13, 255
    s_cmp_lg_u32 s13, 8
    s_cbranch_scc1 tl_wfh_r
    s_branch tl_wfh_d
tl_wfh_r:
    s_cmp_ge_u32 s28, 8192
    s_cbranch_scc1 tl_wfh_d
    s_cmp_eq_u32 s28, 0
    s_cbranch_scc1 tl_wfh_n
    s_sleep 4
tl_wfh_n:
    global_load_dword v21, v22, s[98:99] sc1
    s_add_u32 s28, s28, 1
    s_waitcnt vmcnt(0)
    s_branch tl_wfh_c
tl_wfh_d:
    s_lshl_b32 s12, s4, 18
    s_lshl_b32 s13, s3, 16
    s_add_u32 s12, s12, s13
    s_lshl_b32 s13, s43, 10
    s_add_u32 s12, s12, s13
    s_add_u32 s12, s12, 58720256
    s_add_u32 s8, s6, s12
    s_addc_u32 s9, s7, 0
    v_add_u32 v6, 0x20000, v8
    v_lshlrev_b32 v6, 4, v3
    v_add_u32 v6, 4096, v6
    global_load_dwordx4 v[28:31], v6, s[8:9] offset:-4096
    global_load_dwordx4 v[32:35], v6, s[8:9] offset:-2048
    global_load_dwordx4 v[36:39], v6, s[8:9] offset:0
    global_load_dwordx4 v[40:43], v6, s[8:9] offset:2048
    s_add_u32 s8, s8, 8192
    s_addc_u32 s9, s9, 0
    global_load_dwordx4 v[44:47], v6, s[8:9] offset:-4096
    global_load_dwordx4 v[48:51], v6, s[8:9] offset:-2048
    global_load_dwordx4 v[52:55], v6, s[8:9] offset:0
    global_load_dwordx4 v[56:59], v6, s[8:9] offset:2048
    s_add_u32 s8, s8, 8192
    s_addc_u32 s9, s9, 0
    global_load_dwordx4 v[60:63], v6, s[8:9] offset:-4096
    global_load_dwordx4 v[64:67], v6, s[8:9] offset:-2048
    global_load_dwordx4 v[68:71], v6, s[8:9] offset:0
    global_load_dwordx4 v[72:75], v6, s[8:9] offset:2048
    s_add_u32 s8, s8, 8192
    s_addc_u32 s9, s9, 0
    global_load_dwordx4 v[76:79], v6, s[8:9] offset:-4096
    global_load_dwordx4 v[80:83], v6, s[8:9] offset:-2048
    global_load_dwordx4 v[84:87], v6, s[8:9] offset:0
    global_load_dwordx4 v[88:91], v6, s[8:9] offset:2048
    s_add_u32 s8, s8, 8192
    s_addc_u32 s9, s9, 0
    global_load_dwordx4 v[92:95], v6, s[8:9] offset:-4096
    global_load_dwordx4 v[96:99], v6, s[8:9] offset:-2048
    global_load_dwordx4 v[100:103], v6, s[8:9] offset:0
    global_load_dwordx4 v[104:107], v6, s[8:9] offset:2048
    s_add_u32 s8, s8, 8192
    s_addc_u32 s9, s9, 0
    global_load_dwordx4 v[108:111], v6, s[8:9] offset:-4096
    global_load_dwordx4 v[112:115], v6, s[8:9] offset:-2048
    global_load_dwordx4 v[116:119], v6, s[8:9] offset:0
    global_load_dwordx4 v[120:123], v6, s[8:9] offset:2048
    s_add_u32 s8, s8, 8192
    s_addc_u32 s9, s9, 0
    global_load_dwordx4 v[124:127], v6, s[8:9] offset:-4096
    global_load_dwordx4 v[128:131], v6, s[8:9] offset:-2048
    global_load_dwordx4 v[132:135], v6, s[8:9] offset:0
    global_load_dwordx4 v[136:139], v6, s[8:9] offset:2048
    s_add_u32 s8, s8, 8192
    s_addc_u32 s9, s9, 0
    global_load_dwordx4 v[140:143], v6, s[8:9] offset:-4096
    global_load_dwordx4 v[144:147], v6, s[8:9] offset:-2048
    global_load_dwordx4 v[148:151], v6, s[8:9] offset:0
    global_load_dwordx4 v[152:155], v6, s[8:9] offset:2048
    s_mul_i32 s12, s4, 40960
    s_lshl_b32 s13, s27, 6
    s_add_u32 s40, s12, s13
    s_mul_i32 s13, s43, 20480
    s_add_u32 s40, s40, s13
    s_add_u32 s12, s40, 109051904
    s_add_u32 s10, s6, s12
    s_addc_u32 s11, s7, 0
    global_load_dwordx2 v[18:19], v23, s[10:11] sc1
    s_lshl_b32 s12, s4, 7
    s_lshl_b32 s13, s43, 6
    s_add_u32 s12, s12, s13
    s_add_u32 s12, s12, 113246208
    s_add_u32 s10, s6, s12
    s_addc_u32 s11, s7, 0
    v_lshlrev_b32 v4, 2, v1
    global_load_dword v20, v4, s[10:11] sc1
    s_waitcnt vmcnt(30)
    v_mfma_f32_16x16x32_bf16 v[220:223], a[0:3], v[28:31], 0
    v_mfma_f32_16x16x32_bf16 v[224:227], a[4:7], v[28:31], 0
    v_mfma_f32_16x16x32_bf16 v[228:231], a[8:11], v[32:35], 0
    v_mfma_f32_16x16x32_bf16 v[232:235], a[12:15], v[32:35], 0
    v_mfma_f32_16x16x32_bf16 v[220:223], a[16:19], v[36:39], v[220:223]
    v_mfma_f32_16x16x32_bf16 v[224:227], a[20:23], v[36:39], v[224:227]
    v_mfma_f32_16x16x32_bf16 v[228:231], a[24:27], v[40:43], v[228:231]
    v_mfma_f32_16x16x32_bf16 v[232:235], a[28:31], v[40:43], v[232:235]
    s_waitcnt vmcnt(26)
    v_mfma_f32_16x16x32_bf16 v[220:223], a[32:35], v[44:47], v[220:223]
    v_mfma_f32_16x16x32_bf16 v[224:227], a[36:39], v[44:47], v[224:227]
    v_mfma_f32_16x16x32_bf16 v[228:231], a[40:43], v[48:51], v[228:231]
    v_mfma_f32_16x16x32_bf16 v[232:235], a[44:47], v[48:51], v[232:235]
    v_mfma_f32_16x16x32_bf16 v[220:223], a[48:51], v[52:55], v[220:223]
    v_mfma_f32_16x16x32_bf16 v[224:227], a[52:55], v[52:55], v[224:227]
    v_mfma_f32_16x16x32_bf16 v[228:231], a[56:59], v[56:59], v[228:231]
    v_mfma_f32_16x16x32_bf16 v[232:235], a[60:63], v[56:59], v[232:235]
    s_waitcnt vmcnt(22)
    v_mfma_f32_16x16x32_bf16 v[220:223], a[64:67], v[60:63], v[220:223]
    v_mfma_f32_16x16x32_bf16 v[224:227], a[68:71], v[60:63], v[224:227]
    v_mfma_f32_16x16x32_bf16 v[228:231], a[72:75], v[64:67], v[228:231]
    v_mfma_f32_16x16x32_bf16 v[232:235], a[76:79], v[64:67], v[232:235]
    v_mfma_f32_16x16x32_bf16 v[220:223], a[80:83], v[68:71], v[220:223]
    v_mfma_f32_16x16x32_bf16 v[224:227], a[84:87], v[68:71], v[224:227]
    v_mfma_f32_16x16x32_bf16 v[228:231], a[88:91], v[72:75], v[228:231]
    v_mfma_f32_16x16x32_bf16 v[232:235], a[92:95], v[72:75], v[232:235]
    s_waitcnt vmcnt(18)
    v_mfma_f32_16x16x32_bf16 v[220:223], a[96:99], v[76:79], v[220:223]
    v_mfma_f32_16x16x32_bf16 v[224:227], a[100:103], v[76:79], v[224:227]
    v_mfma_f32_16x16x32_bf16 v[228:231], a[104:107], v[80:83], v[228:231]
    v_mfma_f32_16x16x32_bf16 v[232:235], a[108:111], v[80:83], v[232:235]
    v_mfma_f32_16x16x32_bf16 v[220:223], a[112:115], v[84:87], v[220:223]
    v_mfma_f32_16x16x32_bf16 v[224:227], a[116:119], v[84:87], v[224:227]
    v_mfma_f32_16x16x32_bf16 v[228:231], a[120:123], v[88:91], v[228:231]
    v_mfma_f32_16x16x32_bf16 v[232:235], a[124:127], v[88:91], v[232:235]
    s_waitcnt vmcnt(14)
    v_mfma_f32_16x16x32_bf16 v[220:223], a[128:131], v[92:95], v[220:223]
    v_mfma_f32_16x16x32_bf16 v[224:227], a[132:135], v[92:95], v[224:227]
    v_mfma_f32_16x16x32_bf16 v[228:231], a[136:139], v[96:99], v[228:231]
    v_mfma_f32_16x16x32_bf16 v[232:235], a[140:143], v[96:99], v[232:235]
    v_mfma_f32_16x16x32_bf16 v[220:223], a[144:147], v[100:103], v[220:223]
    v_mfma_f32_16x16x32_bf16 v[224:227], a[148:151], v[100:103], v[224:227]
    v_mfma_f32_16x16x32_bf16 v[228:231], a[152:155], v[104:107], v[228:231]
    v_mfma_f32_16x16x32_bf16 v[232:235], a[156:159], v[104:107], v[232:235]
    s_waitcnt vmcnt(10)
    v_mfma_f32_16x16x32_bf16 v[220:223], a[160:163], v[108:111], v[220:223]
    v_mfma_f32_16x16x32_bf16 v[224:227], a[164:167], v[108:111], v[224:227]
    v_mfma_f32_16x16x32_bf16 v[228:231], a[168:171], v[112:115], v[228:231]
    v_mfma_f32_16x16x32_bf16 v[232:235], a[172:175], v[112:115], v[232:235]
    v_mfma_f32_16x16x32_bf16 v[220:223], a[176:179], v[116:119], v[220:223]
    v_mfma_f32_16x16x32_bf16 v[224:227], a[180:183], v[116:119], v[224:227]
    v_mfma_f32_16x16x32_bf16 v[228:231], a[184:187], v[120:123], v[228:231]
    v_mfma_f32_16x16x32_bf16 v[232:235], a[188:191], v[120:123], v[232:235]
    s_waitcnt vmcnt(6)
    v_mfma_f32_16x16x32_bf16 v[220:223], a[192:195], v[124:127], v[220:223]
    v_mfma_f32_16x16x32_bf16 v[224:227], a[196:199], v[124:127], v[224:227]
    v_mfma_f32_16x16x32_bf16 v[228:231], a[200:203], v[128:131], v[228:231]
    v_mfma_f32_16x16x32_bf16 v[232:235], a[204:207], v[128:131], v[232:235]
    v_mfma_f32_16x16x32_bf16 v[220:223], a[208:211], v[132:135], v[220:223]
    v_mfma_f32_16x16x32_bf16 v[224:227], a[212:215], v[132:135], v[224:227]
    v_mfma_f32_16x16x32_bf16 v[228:231], a[216:219], v[136:139], v[228:231]
    v_mfma_f32_16x16x32_bf16 v[232:235], a[220:223], v[136:139], v[232:235]
    s_waitcnt vmcnt(2)
    v_mfma_f32_16x16x32_bf16 v[220:223], a[224:227], v[140:143], v[220:223]
    v_mfma_f32_16x16x32_bf16 v[224:227], a[228:231], v[140:143], v[224:227]
    v_mfma_f32_16x16x32_bf16 v[228:231], a[232:235], v[144:147], v[228:231]
    v_mfma_f32_16x16x32_bf16 v[232:235], a[236:239], v[144:147], v[232:235]
    v_mfma_f32_16x16x32_bf16 v[220:223], a[240:243], v[148:151], v[220:223]
    v_mfma_f32_16x16x32_bf16 v[224:227], a[244:247], v[148:151], v[224:227]
    v_mfma_f32_16x16x32_bf16 v[228:231], a[248:251], v[152:155], v[228:231]
    v_mfma_f32_16x16x32_bf16 v[232:235], a[252:255], v[152:155], v[232:235]
    s_nop 7
    s_nop 1
    v_add_f32 v220, v220, v228
    v_add_f32 v221, v221, v229
    v_add_f32 v222, v222, v230
    v_add_f32 v223, v223, v231
    v_add_f32 v224, v224, v232
    v_add_f32 v225, v225, v233
    v_add_f32 v226, v226, v234
    v_add_f32 v227, v227, v235
    ds_write_b128 v14, v[220:223] offset:0
    ds_write_b128 v14, v[224:227] offset:1024
    s_waitcnt lgkmcnt(0)
    s_barrier
    v_add_u32 v4, 65536, v24
    ds_read_b128 v[28:31], v24 offset:0
    ds_read_b128 v[32:35], v24 offset:32768
    ds_read_b128 v[36:39], v4 offset:0
    ds_read_b128 v[40:43], v4 offset:32768
    s_waitcnt vmcnt(0) lgkmcnt(0)
    s_barrier
    v_add_f32 v28, v28, v32
    v_add_f32 v36, v36, v40
    v_add_f32 v29, v29, v33
    v_add_f32 v37, v37, v41
    v_add_f32 v30, v30, v34
    v_add_f32 v38, v38, v42
    v_add_f32 v31, v31, v35
    v_add_f32 v39, v39, v43
    v_add_f32 v28, v28, v36
    v_add_f32 v29, v29, v37
    v_add_f32 v30, v30, v38
    v_add_f32 v31, v31, v39
    v_sub_f32 v5, 1.0, v20
    v_cvt_pk_bf16_f32 v5, v5, v5
    v_lshlrev_b32 v5, 16, v5
    v_cvt_pk_bf16_f32 v32, v28, v29
    v_cvt_pk_bf16_f32 v33, v30, v31
    v_lshlrev_b32 v28, 16, v32
    v_and_b32 v29, 0xffff0000, v32
    v_lshlrev_b32 v36, 16, v18
    v_and_b32 v37, 0xffff0000, v18
    v_lshlrev_b32 v30, 16, v33
    v_and_b32 v31, 0xffff0000, v33
    v_lshlrev_b32 v38, 16, v19
    v_and_b32 v39, 0xffff0000, v19
    v_mul_f32 v28, v28, v20
    v_mul_f32 v36, v36, v5
    v_mul_f32 v29, v29, v20
    v_mul_f32 v37, v37, v5
    v_mul_f32 v30, v30, v20
    v_mul_f32 v38, v38, v5
    v_mul_f32 v31, v31, v20
    v_mul_f32 v39, v39, v5
    v_cvt_pk_bf16_f32 v32, v28, v29
    v_cvt_pk_bf16_f32 v34, v36, v37
    v_cvt_pk_bf16_f32 v33, v30, v31
    v_cvt_pk_bf16_f32 v35, v38, v39
    v_lshlrev_b32 v28, 16, v32
    v_and_b32 v29, 0xffff0000, v32
    v_lshlrev_b32 v36, 16, v34
    v_and_b32 v37, 0xffff0000, v34
    v_lshlrev_b32 v30, 16, v33
    v_and_b32 v31, 0xffff0000, v33
    v_lshlrev_b32 v38, 16, v35
    v_and_b32 v39, 0xffff0000, v35
    v_add_f32 v28, v28, v36
    v_add_f32 v29, v29, v37
    v_add_f32 v30, v30, v38
    v_add_f32 v31, v31, v39
    v_cvt_pk_bf16_f32 v32, v28, v29
    v_cvt_pk_bf16_f32 v33, v30, v31
    s_add_u32 s8, s30, s40
    s_addc_u32 s9, s31, 0
    global_store_dwordx2 v23, v[32:33], s[8:9]
    s_add_u32 s26, s26, 4
    s_cmp_lt_u32 s26, 16
    s_cbranch_scc1 tl_woh
tl_done:
    s_waitcnt vmcnt(0)
mega_end:
    s_endpgm
.section .rodata,"a"
.p2align 6
.amdhsa_kernel mega_kernel
  .amdhsa_next_free_vgpr 512
  .amdhsa_next_free_sgpr 102
  .amdhsa_accum_offset 256
  .amdhsa_group_segment_fixed_size 0
  .amdhsa_kernarg_size 120
  .amdhsa_user_sgpr_count 2
  .amdhsa_user_sgpr_kernarg_segment_ptr 1
  .amdhsa_system_sgpr_workgroup_id_x 1
.end_amdhsa_kernel
```
